```python
import torch

def _softmax(x, axis=-1):
    return torch.softmax(x, dim=axis)

def _gelu(x):
    return torch.nn.functional.gelu(x, approximate='tanh')

def _silu(x):
    return torch.nn.functional.silu(x)

def _sigmoid(x):
    return torch.sigmoid(x)

def _layernorm(x, axis=-1, eps=1e-05):
    m = x.mean(dim=axis, keepdim=True)
    v = x.var(dim=axis, keepdim=True, unbiased=False)
    return (x - m) / torch.sqrt(v + eps)

def _scatter_add(tgt, idx, src, axis=0):
    return tgt.clone().index_add_(axis, idx, src)

def _segment_sum(src, seg, n):
    out = torch.zeros((n,) + src.shape[1:], dtype=src.dtype)
    return out.index_add_(0, seg, src)

def _pad(x, pw):
    flat = tuple((v for pair in reversed(pw) for v in pair))
    return torch.nn.functional.pad(x, flat)
kernel_name = 'adaLN_cond__mha_block_cached__mixer_s_mlp__prompt'

def setup_inputs():

    _w = lambda a: (lambda t: t.to(torch.bfloat16) if t.is_floating_point() else t)(torch.as_tensor(a))

    def _A_setup():
        B, Sq, D = (1, 2048, 640)
        H, Sk, Dh = (32, 2048, 192)
        return {'x': _w((lambda *s: torch.randn(*s, dtype=torch.bfloat16) * 0.1)(B, Sq, D)), 'k_cache': _w((lambda *s: torch.randn(*s, dtype=torch.bfloat16) * 0.8)(B, H, Sk, Dh)), 'v_cache': _w((lambda *s: torch.randn(*s, dtype=torch.bfloat16) * 0.8)(B, H, Sk, Dh)), 'wq': _w((lambda *s: torch.randn(*s, dtype=torch.bfloat16) * 0.8)(D, H * Dh) * D ** (-0.5)), 'wo': _w((lambda *s: torch.randn(*s, dtype=torch.bfloat16) * 0.8)(H * Dh, D) * (H * Dh) ** (-0.5))}
    _A_in = _A_setup()

    def _B_setup():
        B, S, D, F = (1, 2048, 640, 1536)
        return {'x': _w((lambda *s: torch.randn(*s, dtype=torch.bfloat16) * 0.1)(B, S, D)), 'w1': _w((lambda *s: torch.randn(*s, dtype=torch.bfloat16) * 3.2)(D, D) * D ** (-0.5)), 'w2': _w((lambda *s: torch.randn(*s, dtype=torch.bfloat16) * 3.2)(D, D) * D ** (-0.5)), 'w3': _w((lambda *s: torch.randn(*s, dtype=torch.bfloat16) * 3.2)(D, F) * D ** (-0.5)), 'w4': _w((lambda *s: torch.randn(*s, dtype=torch.bfloat16) * 3.2)(F, D) * F ** (-0.5))}
    _B_in = _B_setup()
    return {'A_x': _A_in['x'], 'A_k_cache': _A_in['k_cache'], 'A_v_cache': _A_in['v_cache'], 'A_wq': _A_in['wq'], 'A_wo': _A_in['wo'], 'B_x': _B_in['x'], 'B_w1': _B_in['w1'], 'B_w2': _B_in['w2'], 'B_w3': _B_in['w3'], 'B_w4': _B_in['w4'], 'c': _w((lambda *s: torch.randn(*s, dtype=torch.bfloat16) * 0.2)(1, 640) * 8.0), 'w_mod': _w((lambda *s: torch.randn(*s, dtype=torch.bfloat16) * 0.2)(640, 6 * 640) * 640 ** (-0.5) * 8.0)}

def reference(A_x, A_k_cache, A_v_cache, A_wq, A_wo, B_x, B_w1, B_w2, B_w3, B_w4, c, w_mod):

    def _A_ref(x, k_cache, v_cache, wq, wo):
        B, Sq, D = x.shape
        H, Dh = (32, 192)
        q = (lambda x, *d: x.permute(*d))((x @ wq).reshape(B, Sq, H, Dh), 0, 2, 1, 3)
        scores = torch.einsum('bhqd,bhkd->bhqk', q, k_cache) * Dh ** (-0.5)
        p = _softmax(scores, axis=-1)
        o = torch.einsum('bhqk,bhkd->bhqd', p, v_cache)
        return (lambda x, *d: x.permute(*d))(o, 0, 2, 1, 3).reshape(B, Sq, H * Dh) @ wo

    def _B_ref(x, w1, w2, w3, w4):
        B, S, D = x.shape
        h = _gelu(_layernorm(x, axis=-1) @ w1)
        c = D // 4
        g0 = _pad(h[:, :, 0 * c:1 * c], ((0, 0), (1, 0), (0, 0)))[:, :S, :]
        g1 = _pad(h[:, :, 1 * c:2 * c], ((0, 0), (0, 1), (0, 0)))[:, 1:, :]
        g2 = _pad(h[:, :, 2 * c:3 * c], ((0, 0), (2, 0), (0, 0)))[:, :S, :]
        g3 = _pad(h[:, :, 3 * c:], ((0, 0), (0, 2), (0, 0)))[:, 2:, :]
        hs = torch.concatenate([g0, g1, g2, g3], axis=-1) @ w2
        x1 = x + hs
        h2 = _gelu(_layernorm(x1, axis=-1) @ w3) @ w4
        return x1 + h2
    x = A_x
    mod = (_silu(c) @ w_mod).reshape(c.shape[0], 6, 1, -1)
    sa, ca, ga, sb, cb, gb = (mod[:, 0].clone(), mod[:, 1].clone(), mod[:, 2].clone(), mod[:, 3].clone(), mod[:, 4].clone(), mod[:, 5].clone())
    h = _layernorm(x, axis=-1) * (1 + ca) + sa
    x = x + ga * _A_ref(h, A_k_cache, A_v_cache, A_wq, A_wo)
    h = _layernorm(x, axis=-1) * (1 + cb) + sb
    x = x + gb * _B_ref(h, B_w1, B_w2, B_w3, B_w4)
    return x
```

```asm
; @launch grid=(256,1,1) block=(256,1,1) lds=163840
.amdgcn_target "amdgcn-amd-amdhsa--gfx950"
.text
.globl adaLN_cond__mha_block_cached__mixer_s_mlp__prompt_kernel
.p2align 8
.type adaLN_cond__mha_block_cached__mixer_s_mlp__prompt_kernel,@function
adaLN_cond__mha_block_cached__mixer_s_mlp__prompt_kernel:
s_getpc_b64 s[84:85]
L_entry_pc:
s_mov_b32 s86, L_tail_pc-L_entry_pc
s_mov_b32 s87, 0x20000
v_lshlrev_b32 v18, 7, v0
buffer_load_dword v18, v18, s[84:87], 0 offen
s_cmp_ge_u32 s2, 256
s_cbranch_scc1 L_attn_end
s_load_dwordx4 s[16:19], s[0:1], 8
s_load_dwordx2 s[12:13], s[0:1], 24
s_load_dwordx2 s[4:5], s[0:1], 112
v_lshrrev_b32 v1, 6, v0
v_and_b32 v0, 63, v0
v_readfirstlane_b32 s28, v1
s_cmp_ge_u32 s2, 104
s_cbranch_scc1 L_gemv_issued
s_load_dwordx4 s[60:63], s[0:1], 80
s_load_dwordx2 s[64:65], s[0:1], 64
s_cmp_lt_u32 s2, 40
s_cselect_b32 s52, 10, 20
s_cselect_b32 s6, 1, 0
s_and_b32 s55, s2, s6
s_lshr_b32 s54, s2, 1
s_sub_u32 s7, s2, 20
s_cmp_lt_u32 s2, 40
s_cselect_b32 s54, s54, s7
s_sub_u32 s7, s2, 80
s_cmp_ge_u32 s2, 80
s_cselect_b32 s54, s7, s54
s_cselect_b64 s[56:57], -1, 0
s_movk_i32 s53, 3072
s_cselect_b32 s53, s53, 7680
s_lshl_b32 s6, s28, 3
v_lshrrev_b32 v150, 3, v0
v_add_u32 v150, s6, v150
v_mul_lo_u32 v150, v150, s52
s_mul_i32 s6, s55, 320
v_add_u32 v150, s6, v150
v_lshlrev_b32 v151, 1, v150
v_mul_lo_u32 v150, v150, s53
v_and_b32 v152, 7, v0
v_lshl_add_u32 v150, v152, 4, v150
s_waitcnt lgkmcnt(0)
s_cmp_ge_u32 s2, 80
s_cselect_b32 s48, s64, s62
s_cselect_b32 s49, s65, s63
s_mul_i32 s50, s53, 640
s_mov_b32 s51, 0x20000
s_mov_b32 s62, 1280
s_mov_b32 s63, 0x20000
s_lshl_b32 s58, s54, 7
buffer_load_dwordx4 v[112:115], v151, s[60:63], 0 offen
buffer_load_dwordx4 v[116:119], v151, s[60:63], 0 offen offset:16
buffer_load_dwordx2 v[120:121], v151, s[60:63], 0 offen offset:32
buffer_load_dwordx4 v[164:167], v150, s[48:51], s58 offen
s_add_u32 s58, s58, s53
buffer_load_dwordx4 v[168:171], v150, s[48:51], s58 offen
s_add_u32 s58, s58, s53
buffer_load_dwordx4 v[172:175], v150, s[48:51], s58 offen
s_add_u32 s58, s58, s53
buffer_load_dwordx4 v[176:179], v150, s[48:51], s58 offen
s_add_u32 s58, s58, s53
buffer_load_dwordx4 v[180:183], v150, s[48:51], s58 offen
s_add_u32 s58, s58, s53
buffer_load_dwordx4 v[184:187], v150, s[48:51], s58 offen
s_add_u32 s58, s58, s53
buffer_load_dwordx4 v[188:191], v150, s[48:51], s58 offen
s_add_u32 s58, s58, s53
buffer_load_dwordx4 v[192:195], v150, s[48:51], s58 offen
s_add_u32 s58, s58, s53
buffer_load_dwordx4 v[196:199], v150, s[48:51], s58 offen
s_add_u32 s58, s58, s53
buffer_load_dwordx4 v[200:203], v150, s[48:51], s58 offen
s_add_u32 s58, s58, s53
s_cmp_eq_u32 s52, 10
s_cbranch_scc1 L_gemv_issued
buffer_load_dwordx4 v[204:207], v150, s[48:51], s58 offen
s_add_u32 s58, s58, s53
buffer_load_dwordx4 v[208:211], v150, s[48:51], s58 offen
s_add_u32 s58, s58, s53
buffer_load_dwordx4 v[212:215], v150, s[48:51], s58 offen
s_add_u32 s58, s58, s53
buffer_load_dwordx4 v[216:219], v150, s[48:51], s58 offen
s_add_u32 s58, s58, s53
buffer_load_dwordx4 v[220:223], v150, s[48:51], s58 offen
s_add_u32 s58, s58, s53
buffer_load_dwordx4 v[224:227], v150, s[48:51], s58 offen
s_add_u32 s58, s58, s53
buffer_load_dwordx4 v[228:231], v150, s[48:51], s58 offen
s_add_u32 s58, s58, s53
buffer_load_dwordx4 v[232:235], v150, s[48:51], s58 offen
s_add_u32 s58, s58, s53
buffer_load_dwordx4 v[236:239], v150, s[48:51], s58 offen
s_add_u32 s58, s58, s53
buffer_load_dwordx4 v[240:243], v150, s[48:51], s58 offen
s_add_u32 s58, s58, s53
L_gemv_issued:
s_and_b32 s46, s2, 7
s_lshl_b32 s46, s46, 2
s_lshr_b32 s3, s2, 3
s_and_b32 s3, s3, 3
s_add_u32 s46, s46, s3
s_lshr_b32 s47, s2, 5
s_mul_i32 s29, s28, 3072
s_mov_b32 s36, 0x46800000
s_mov_b32 s40, 0x3dd53b95
s_mov_b32 s41, s40
s_mov_b32 s32, 0
s_mov_b32 s33, 12288
s_mov_b32 s34, 0
s_mov_b32 s35, 12288
v_lshlrev_b32 v11, 4, v0
v_lshrrev_b32 v20, 4, v0
v_and_b32 v21, 15, v0
v_lshrrev_b32 v22, 1, v21
v_xor_b32 v22, v22, v20
v_lshlrev_b32 v22, 4, v22
v_and_b32 v23, 7, v0
v_lshl_add_u32 v22, v23, 7, v22
v_bfe_u32 v23, v0, 3, 1
v_mul_u32_u24 v23, 3072, v23
v_add_u32 v2, v22, v23
v_xor_b32 v3, 64, v2
v_bfe_u32 v21, v0, 2, 2
v_and_b32 v22, 1, v20
v_lshl_add_u32 v23, v22, 2, v21
v_lshrrev_b32 v24, 1, v23
v_lshlrev_b32 v24, 1, v24
v_bfe_u32 v25, v0, 1, 1
v_xor_b32 v24, v24, v25
v_lshlrev_b32 v24, 4, v24
v_lshl_add_u32 v24, v23, 7, v24
v_and_b32 v25, 1, v0
v_lshl_add_u32 v24, v25, 3, v24
v_lshrrev_b32 v25, 1, v20
v_mul_u32_u24 v25, 3072, v25
v_add_u32 v24, v24, v25
v_add_u32 v4, 49152, v24
v_xor_b32 v5, 32, v4
v_xor_b32 v6, 64, v4
v_xor_b32 v7, 96, v4
v_lshrrev_b32 v21, 3, v0
v_and_b32 v22, 7, v0
v_lshlrev_b32 v23, 1, v20
v_xor_b32 v23, v23, v22
v_lshlrev_b32 v23, 4, v23
s_and_b32 s3, s28, 1
s_lshl_b32 s3, s3, 2
v_add_u32 v24, s3, v20
v_xor_b32 v24, v24, v22
v_lshlrev_b32 v24, 4, v24
s_lshl_b32 s3, s28, 3
v_add_u32 v21, s3, v21
v_mul_u32_u24 v25, 384, v21
v_add_u32 v8, v25, v24
v_add_u32 v9, v25, v23
v_mul_u32_u24 v25, 12288, v21
v_add_u32 v10, v25, v23
s_waitcnt lgkmcnt(0)
s_mul_i32 s3, s46, 786432
s_add_u32 s20, s18, s3
s_addc_u32 s21, s19, 0
s_add_u32 s16, s16, s3
s_addc_u32 s17, s17, 0
s_mov_b32 s18, 786432
s_mov_b32 s19, 0x20000
s_mov_b32 s22, 786432
s_mov_b32 s23, 0x20000
s_mul_i32 s3, s46, 384
s_add_u32 s12, s12, s3
s_addc_u32 s13, s13, 0
s_sub_u32 s14, 7864320, s3
s_mov_b32 s15, 0x20000
s_lshl_b32 s3, s47, 2
s_add_u32 s3, s3, s28
s_lshl_b32 s3, s3, 2
s_mul_i32 s6, s3, 20480
s_add_u32 s6, s6, 1048576
s_add_u32 s8, s4, s6
s_addc_u32 s9, s5, 0
s_mov_b32 s10, 81920
s_mov_b32 s11, 0x20000
s_add_u32 s24, s4, 67108864
s_addc_u32 s25, s5, 0
s_mov_b32 s26, 25165824
s_mov_b32 s27, 0x20000
s_mul_i32 s6, s3, 196608
s_mul_i32 s7, s46, 6144
s_add_u32 s42, s6, s7
s_add_u32 s43, s42, 196608
s_add_u32 s44, s43, 196608
s_add_u32 s45, s44, 196608
v_mov_b32 v31, 1
s_load_dwordx2 s[72:73], s[0:1], 0
s_add_u32 s68, s4, 524288
s_addc_u32 s69, s5, 0
s_mov_b32 s70, 360448
s_mov_b32 s71, 0x20000
s_add_u32 s76, s4, 0
s_addc_u32 s77, s5, 0
s_mov_b32 s78, 7680
s_mov_b32 s79, 0x20000
s_add_u32 s84, s4, 1048576
s_addc_u32 s85, s5, 0
s_mov_b32 s86, 2621440
s_mov_b32 s87, 0x20000
s_waitcnt lgkmcnt(0)
s_mov_b32 s74, 2621440
s_mov_b32 s75, 0x20000
v_lshrrev_b32 v24, 4, v0
v_bfe_u32 v25, v0, 2, 2
v_and_b32 v26, 1, v24
v_lshl_add_u32 v25, v26, 2, v25
v_and_b32 v26, 6, v25
v_and_b32 v27, 3, v0
v_xor_b32 v26, v26, v27
v_lshlrev_b32 v26, 4, v26
v_lshl_add_u32 v26, v25, 7, v26
v_lshrrev_b32 v24, 1, v24
v_mul_u32_u24 v24, 3072, v24
v_add_u32 v26, v26, v24
v_add_u32 v20, 49152, v26
v_xor_b32 v21, 64, v20
v_add_u32 v22, 49152, v20
v_add_u32 v23, 49152, v21
v_add_u32 v24, 0, v11
v_add_u32 v25, 20480, v11
v_add_u32 v26, 40960, v11
v_add_u32 v27, 61440, v11
v_and_b32 v40, 7, v0
v_bfe_u32 v41, v0, 3, 2
v_lshrrev_b32 v42, 5, v0
s_lshl_b32 s89, s28, 1
v_add_u32 v42, s89, v42
s_and_b32 s89, s2, 1
s_lshl_b32 s89, s89, 3
v_add_u32 v43, s89, v40
v_lshl_add_u32 v44, v41, 4, v43
v_lshlrev_b32 v44, 4, v44
v_lshl_add_u32 v32, v42, 10, v44
v_mul_u32_u24 v44, 1280, v43
v_lshl_add_u32 v44, v42, 6, v44
v_lshl_add_u32 v34, v41, 3, v44
v_lshlrev_b32 v44, 6, v42
v_lshl_add_u32 v36, v41, 4, v44
v_lshlrev_b32 v39, 5, v40
s_lshl_b32 s89, s28, 3
v_add_u32 v38, s89, v39
v_add_u32 v38, 162816, v38
v_add_u32 v39, 162816, v39
s_cmp_lt_u32 s28, 2
s_cselect_b32 s89, 0, 0x40000000
v_add_u32 v33, s89, v32
v_add_u32 v33, 16384, v33
v_add_u32 v35, s89, v34
v_add_u32 v37, s89, v36
s_lshr_b32 s89, s2, 1
s_mul_i32 s80, s89, 20480
s_add_u32 s82, s80, 8192
buffer_load_dwordx2 v[40:41], v34, s[72:75], s80 offen offset:0
buffer_load_dwordx2 v[42:43], v34, s[72:75], s80 offen offset:32
buffer_load_dwordx2 v[44:45], v34, s[72:75], s80 offen offset:512
buffer_load_dwordx2 v[46:47], v34, s[72:75], s80 offen offset:544
buffer_load_dwordx2 v[48:49], v35, s[72:75], s80 offen offset:1024
buffer_load_dwordx2 v[50:51], v35, s[72:75], s80 offen offset:1056
v_mov_b32 v28, v32
v_mov_b32 v29, v33
v_mov_b32 v30, v38
v_mov_b32 v16, v39
v_mov_b32 v17, v36
s_cmp_ge_u32 s2, 104
s_cbranch_scc1 L_gemv_idle
s_cmp_eq_u32 s52, 10
s_cbranch_scc1 L_gemv_short
v_mov_b32 v104, 0
v_mov_b32 v105, 0
v_mov_b32 v106, 0
v_mov_b32 v107, 0
v_mov_b32 v108, 0
v_mov_b32 v109, 0
v_mov_b32 v110, 0
v_mov_b32 v111, 0
s_waitcnt vmcnt(26)
v_lshlrev_b32 v124, 16, v112
v_and_b32 v125, 0xffff0000, v112
v_lshlrev_b32 v126, 16, v113
v_and_b32 v127, 0xffff0000, v113
v_lshlrev_b32 v128, 16, v114
v_and_b32 v129, 0xffff0000, v114
v_lshlrev_b32 v130, 16, v115
v_and_b32 v131, 0xffff0000, v115
v_lshlrev_b32 v132, 16, v116
v_and_b32 v133, 0xffff0000, v116
s_mov_b32 s6, 0xbfb8aa3b
v_mul_f32 v154, s6, v124
v_mul_f32 v155, s6, v125
v_mul_f32 v156, s6, v126
v_mul_f32 v157, s6, v127
v_mul_f32 v158, s6, v128
v_mul_f32 v159, s6, v129
v_mul_f32 v160, s6, v130
v_mul_f32 v161, s6, v131
v_mul_f32 v162, s6, v132
v_mul_f32 v163, s6, v133
v_exp_f32 v154, v154
v_exp_f32 v155, v155
v_exp_f32 v156, v156
v_exp_f32 v157, v157
v_exp_f32 v158, v158
v_exp_f32 v159, v159
v_exp_f32 v160, v160
v_exp_f32 v161, v161
v_exp_f32 v162, v162
v_exp_f32 v163, v163
v_add_f32 v154, 1.0, v154
v_add_f32 v155, 1.0, v155
v_add_f32 v156, 1.0, v156
v_add_f32 v157, 1.0, v157
v_add_f32 v158, 1.0, v158
v_add_f32 v159, 1.0, v159
v_add_f32 v160, 1.0, v160
v_add_f32 v161, 1.0, v161
v_add_f32 v162, 1.0, v162
v_add_f32 v163, 1.0, v163
v_rcp_f32 v154, v154
v_rcp_f32 v155, v155
v_rcp_f32 v156, v156
v_rcp_f32 v157, v157
v_rcp_f32 v158, v158
v_rcp_f32 v159, v159
v_rcp_f32 v160, v160
v_rcp_f32 v161, v161
v_rcp_f32 v162, v162
v_rcp_f32 v163, v163
v_mul_f32 v124, v124, v154
v_mul_f32 v125, v125, v155
v_mul_f32 v126, v126, v156
v_mul_f32 v127, v127, v157
v_mul_f32 v128, v128, v158
v_mul_f32 v129, v129, v159
v_mul_f32 v130, v130, v160
v_mul_f32 v131, v131, v161
v_mul_f32 v132, v132, v162
v_mul_f32 v133, v133, v163
v_cvt_pk_bf16_f32 v124, v124, v124
v_cvt_pk_bf16_f32 v125, v125, v125
v_cvt_pk_bf16_f32 v126, v126, v126
v_cvt_pk_bf16_f32 v127, v127, v127
v_cvt_pk_bf16_f32 v128, v128, v128
v_cvt_pk_bf16_f32 v129, v129, v129
v_cvt_pk_bf16_f32 v130, v130, v130
v_cvt_pk_bf16_f32 v131, v131, v131
v_cvt_pk_bf16_f32 v132, v132, v132
v_cvt_pk_bf16_f32 v133, v133, v133
v_lshlrev_b32 v124, 16, v124
v_lshlrev_b32 v125, 16, v125
v_lshlrev_b32 v126, 16, v126
v_lshlrev_b32 v127, 16, v127
v_lshlrev_b32 v128, 16, v128
v_lshlrev_b32 v129, 16, v129
v_lshlrev_b32 v130, 16, v130
v_lshlrev_b32 v131, 16, v131
v_lshlrev_b32 v132, 16, v132
v_lshlrev_b32 v133, 16, v133
v_cndmask_b32 v124, v124, 1.0, s[56:57]
v_cndmask_b32 v125, v125, 1.0, s[56:57]
v_cndmask_b32 v126, v126, 1.0, s[56:57]
v_cndmask_b32 v127, v127, 1.0, s[56:57]
v_cndmask_b32 v128, v128, 1.0, s[56:57]
v_cndmask_b32 v129, v129, 1.0, s[56:57]
v_cndmask_b32 v130, v130, 1.0, s[56:57]
v_cndmask_b32 v131, v131, 1.0, s[56:57]
v_cndmask_b32 v132, v132, 1.0, s[56:57]
v_cndmask_b32 v133, v133, 1.0, s[56:57]
v_lshlrev_b32 v134, 16, v117
v_and_b32 v135, 0xffff0000, v117
v_lshlrev_b32 v136, 16, v118
v_and_b32 v137, 0xffff0000, v118
v_lshlrev_b32 v138, 16, v119
v_and_b32 v139, 0xffff0000, v119
v_lshlrev_b32 v140, 16, v120
v_and_b32 v141, 0xffff0000, v120
v_lshlrev_b32 v142, 16, v121
v_and_b32 v143, 0xffff0000, v121
s_mov_b32 s6, 0xbfb8aa3b
v_mul_f32 v154, s6, v134
v_mul_f32 v155, s6, v135
v_mul_f32 v156, s6, v136
v_mul_f32 v157, s6, v137
v_mul_f32 v158, s6, v138
v_mul_f32 v159, s6, v139
v_mul_f32 v160, s6, v140
v_mul_f32 v161, s6, v141
v_mul_f32 v162, s6, v142
v_mul_f32 v163, s6, v143
v_exp_f32 v154, v154
v_exp_f32 v155, v155
v_exp_f32 v156, v156
v_exp_f32 v157, v157
v_exp_f32 v158, v158
v_exp_f32 v159, v159
v_exp_f32 v160, v160
v_exp_f32 v161, v161
v_exp_f32 v162, v162
v_exp_f32 v163, v163
v_add_f32 v154, 1.0, v154
v_add_f32 v155, 1.0, v155
v_add_f32 v156, 1.0, v156
v_add_f32 v157, 1.0, v157
v_add_f32 v158, 1.0, v158
v_add_f32 v159, 1.0, v159
v_add_f32 v160, 1.0, v160
v_add_f32 v161, 1.0, v161
v_add_f32 v162, 1.0, v162
v_add_f32 v163, 1.0, v163
v_rcp_f32 v154, v154
v_rcp_f32 v155, v155
v_rcp_f32 v156, v156
v_rcp_f32 v157, v157
v_rcp_f32 v158, v158
v_rcp_f32 v159, v159
v_rcp_f32 v160, v160
v_rcp_f32 v161, v161
v_rcp_f32 v162, v162
v_rcp_f32 v163, v163
v_mul_f32 v134, v134, v154
v_mul_f32 v135, v135, v155
v_mul_f32 v136, v136, v156
v_mul_f32 v137, v137, v157
v_mul_f32 v138, v138, v158
v_mul_f32 v139, v139, v159
v_mul_f32 v140, v140, v160
v_mul_f32 v141, v141, v161
v_mul_f32 v142, v142, v162
v_mul_f32 v143, v143, v163
v_cvt_pk_bf16_f32 v134, v134, v134
v_cvt_pk_bf16_f32 v135, v135, v135
v_cvt_pk_bf16_f32 v136, v136, v136
v_cvt_pk_bf16_f32 v137, v137, v137
v_cvt_pk_bf16_f32 v138, v138, v138
v_cvt_pk_bf16_f32 v139, v139, v139
v_cvt_pk_bf16_f32 v140, v140, v140
v_cvt_pk_bf16_f32 v141, v141, v141
v_cvt_pk_bf16_f32 v142, v142, v142
v_cvt_pk_bf16_f32 v143, v143, v143
v_lshlrev_b32 v134, 16, v134
v_lshlrev_b32 v135, 16, v135
v_lshlrev_b32 v136, 16, v136
v_lshlrev_b32 v137, 16, v137
v_lshlrev_b32 v138, 16, v138
v_lshlrev_b32 v139, 16, v139
v_lshlrev_b32 v140, 16, v140
v_lshlrev_b32 v141, 16, v141
v_lshlrev_b32 v142, 16, v142
v_lshlrev_b32 v143, 16, v143
v_cndmask_b32 v134, v134, 1.0, s[56:57]
v_cndmask_b32 v135, v135, 1.0, s[56:57]
v_cndmask_b32 v136, v136, 1.0, s[56:57]
v_cndmask_b32 v137, v137, 1.0, s[56:57]
v_cndmask_b32 v138, v138, 1.0, s[56:57]
v_cndmask_b32 v139, v139, 1.0, s[56:57]
v_cndmask_b32 v140, v140, 1.0, s[56:57]
v_cndmask_b32 v141, v141, 1.0, s[56:57]
v_cndmask_b32 v142, v142, 1.0, s[56:57]
v_cndmask_b32 v143, v143, 1.0, s[56:57]
s_waitcnt vmcnt(25)
v_lshlrev_b32 v154, 16, v164
v_and_b32 v155, 0xffff0000, v164
v_pk_fma_f32 v[104:105], v[154:155], v[124:125], v[104:105] op_sel_hi:[1,0,1]
v_lshlrev_b32 v156, 16, v165
v_and_b32 v157, 0xffff0000, v165
v_pk_fma_f32 v[106:107], v[156:157], v[124:125], v[106:107] op_sel_hi:[1,0,1]
v_lshlrev_b32 v158, 16, v166
v_and_b32 v159, 0xffff0000, v166
v_pk_fma_f32 v[108:109], v[158:159], v[124:125], v[108:109] op_sel_hi:[1,0,1]
v_lshlrev_b32 v160, 16, v167
v_and_b32 v161, 0xffff0000, v167
v_pk_fma_f32 v[110:111], v[160:161], v[124:125], v[110:111] op_sel_hi:[1,0,1]
s_waitcnt vmcnt(24)
v_lshlrev_b32 v154, 16, v168
v_and_b32 v155, 0xffff0000, v168
v_pk_fma_f32 v[104:105], v[154:155], v[124:125], v[104:105] op_sel:[0,1,0] op_sel_hi:[1,1,1]
v_lshlrev_b32 v156, 16, v169
v_and_b32 v157, 0xffff0000, v169
v_pk_fma_f32 v[106:107], v[156:157], v[124:125], v[106:107] op_sel:[0,1,0] op_sel_hi:[1,1,1]
v_lshlrev_b32 v158, 16, v170
v_and_b32 v159, 0xffff0000, v170
v_pk_fma_f32 v[108:109], v[158:159], v[124:125], v[108:109] op_sel:[0,1,0] op_sel_hi:[1,1,1]
v_lshlrev_b32 v160, 16, v171
v_and_b32 v161, 0xffff0000, v171
v_pk_fma_f32 v[110:111], v[160:161], v[124:125], v[110:111] op_sel:[0,1,0] op_sel_hi:[1,1,1]
s_waitcnt vmcnt(23)
v_lshlrev_b32 v154, 16, v172
v_and_b32 v155, 0xffff0000, v172
v_pk_fma_f32 v[104:105], v[154:155], v[126:127], v[104:105] op_sel_hi:[1,0,1]
v_lshlrev_b32 v156, 16, v173
v_and_b32 v157, 0xffff0000, v173
v_pk_fma_f32 v[106:107], v[156:157], v[126:127], v[106:107] op_sel_hi:[1,0,1]
v_lshlrev_b32 v158, 16, v174
v_and_b32 v159, 0xffff0000, v174
v_pk_fma_f32 v[108:109], v[158:159], v[126:127], v[108:109] op_sel_hi:[1,0,1]
v_lshlrev_b32 v160, 16, v175
v_and_b32 v161, 0xffff0000, v175
v_pk_fma_f32 v[110:111], v[160:161], v[126:127], v[110:111] op_sel_hi:[1,0,1]
s_waitcnt vmcnt(22)
v_lshlrev_b32 v154, 16, v176
v_and_b32 v155, 0xffff0000, v176
v_pk_fma_f32 v[104:105], v[154:155], v[126:127], v[104:105] op_sel:[0,1,0] op_sel_hi:[1,1,1]
v_lshlrev_b32 v156, 16, v177
v_and_b32 v157, 0xffff0000, v177
v_pk_fma_f32 v[106:107], v[156:157], v[126:127], v[106:107] op_sel:[0,1,0] op_sel_hi:[1,1,1]
v_lshlrev_b32 v158, 16, v178
v_and_b32 v159, 0xffff0000, v178
v_pk_fma_f32 v[108:109], v[158:159], v[126:127], v[108:109] op_sel:[0,1,0] op_sel_hi:[1,1,1]
v_lshlrev_b32 v160, 16, v179
v_and_b32 v161, 0xffff0000, v179
v_pk_fma_f32 v[110:111], v[160:161], v[126:127], v[110:111] op_sel:[0,1,0] op_sel_hi:[1,1,1]
s_waitcnt vmcnt(21)
v_lshlrev_b32 v154, 16, v180
v_and_b32 v155, 0xffff0000, v180
v_pk_fma_f32 v[104:105], v[154:155], v[128:129], v[104:105] op_sel_hi:[1,0,1]
v_lshlrev_b32 v156, 16, v181
v_and_b32 v157, 0xffff0000, v181
v_pk_fma_f32 v[106:107], v[156:157], v[128:129], v[106:107] op_sel_hi:[1,0,1]
v_lshlrev_b32 v158, 16, v182
v_and_b32 v159, 0xffff0000, v182
v_pk_fma_f32 v[108:109], v[158:159], v[128:129], v[108:109] op_sel_hi:[1,0,1]
v_lshlrev_b32 v160, 16, v183
v_and_b32 v161, 0xffff0000, v183
v_pk_fma_f32 v[110:111], v[160:161], v[128:129], v[110:111] op_sel_hi:[1,0,1]
s_waitcnt vmcnt(20)
v_lshlrev_b32 v154, 16, v184
v_and_b32 v155, 0xffff0000, v184
v_pk_fma_f32 v[104:105], v[154:155], v[128:129], v[104:105] op_sel:[0,1,0] op_sel_hi:[1,1,1]
v_lshlrev_b32 v156, 16, v185
v_and_b32 v157, 0xffff0000, v185
v_pk_fma_f32 v[106:107], v[156:157], v[128:129], v[106:107] op_sel:[0,1,0] op_sel_hi:[1,1,1]
v_lshlrev_b32 v158, 16, v186
v_and_b32 v159, 0xffff0000, v186
v_pk_fma_f32 v[108:109], v[158:159], v[128:129], v[108:109] op_sel:[0,1,0] op_sel_hi:[1,1,1]
v_lshlrev_b32 v160, 16, v187
v_and_b32 v161, 0xffff0000, v187
v_pk_fma_f32 v[110:111], v[160:161], v[128:129], v[110:111] op_sel:[0,1,0] op_sel_hi:[1,1,1]
s_waitcnt vmcnt(19)
v_lshlrev_b32 v154, 16, v188
v_and_b32 v155, 0xffff0000, v188
v_pk_fma_f32 v[104:105], v[154:155], v[130:131], v[104:105] op_sel_hi:[1,0,1]
v_lshlrev_b32 v156, 16, v189
v_and_b32 v157, 0xffff0000, v189
v_pk_fma_f32 v[106:107], v[156:157], v[130:131], v[106:107] op_sel_hi:[1,0,1]
v_lshlrev_b32 v158, 16, v190
v_and_b32 v159, 0xffff0000, v190
v_pk_fma_f32 v[108:109], v[158:159], v[130:131], v[108:109] op_sel_hi:[1,0,1]
v_lshlrev_b32 v160, 16, v191
v_and_b32 v161, 0xffff0000, v191
v_pk_fma_f32 v[110:111], v[160:161], v[130:131], v[110:111] op_sel_hi:[1,0,1]
s_waitcnt vmcnt(18)
v_lshlrev_b32 v154, 16, v192
v_and_b32 v155, 0xffff0000, v192
v_pk_fma_f32 v[104:105], v[154:155], v[130:131], v[104:105] op_sel:[0,1,0] op_sel_hi:[1,1,1]
v_lshlrev_b32 v156, 16, v193
v_and_b32 v157, 0xffff0000, v193
v_pk_fma_f32 v[106:107], v[156:157], v[130:131], v[106:107] op_sel:[0,1,0] op_sel_hi:[1,1,1]
v_lshlrev_b32 v158, 16, v194
v_and_b32 v159, 0xffff0000, v194
v_pk_fma_f32 v[108:109], v[158:159], v[130:131], v[108:109] op_sel:[0,1,0] op_sel_hi:[1,1,1]
v_lshlrev_b32 v160, 16, v195
v_and_b32 v161, 0xffff0000, v195
v_pk_fma_f32 v[110:111], v[160:161], v[130:131], v[110:111] op_sel:[0,1,0] op_sel_hi:[1,1,1]
s_waitcnt vmcnt(17)
v_lshlrev_b32 v154, 16, v196
v_and_b32 v155, 0xffff0000, v196
v_pk_fma_f32 v[104:105], v[154:155], v[132:133], v[104:105] op_sel_hi:[1,0,1]
v_lshlrev_b32 v156, 16, v197
v_and_b32 v157, 0xffff0000, v197
v_pk_fma_f32 v[106:107], v[156:157], v[132:133], v[106:107] op_sel_hi:[1,0,1]
v_lshlrev_b32 v158, 16, v198
v_and_b32 v159, 0xffff0000, v198
v_pk_fma_f32 v[108:109], v[158:159], v[132:133], v[108:109] op_sel_hi:[1,0,1]
v_lshlrev_b32 v160, 16, v199
v_and_b32 v161, 0xffff0000, v199
v_pk_fma_f32 v[110:111], v[160:161], v[132:133], v[110:111] op_sel_hi:[1,0,1]
s_waitcnt vmcnt(16)
v_lshlrev_b32 v154, 16, v200
v_and_b32 v155, 0xffff0000, v200
v_pk_fma_f32 v[104:105], v[154:155], v[132:133], v[104:105] op_sel:[0,1,0] op_sel_hi:[1,1,1]
v_lshlrev_b32 v156, 16, v201
v_and_b32 v157, 0xffff0000, v201
v_pk_fma_f32 v[106:107], v[156:157], v[132:133], v[106:107] op_sel:[0,1,0] op_sel_hi:[1,1,1]
v_lshlrev_b32 v158, 16, v202
v_and_b32 v159, 0xffff0000, v202
v_pk_fma_f32 v[108:109], v[158:159], v[132:133], v[108:109] op_sel:[0,1,0] op_sel_hi:[1,1,1]
v_lshlrev_b32 v160, 16, v203
v_and_b32 v161, 0xffff0000, v203
v_pk_fma_f32 v[110:111], v[160:161], v[132:133], v[110:111] op_sel:[0,1,0] op_sel_hi:[1,1,1]
s_waitcnt vmcnt(15)
v_lshlrev_b32 v154, 16, v204
v_and_b32 v155, 0xffff0000, v204
v_pk_fma_f32 v[104:105], v[154:155], v[134:135], v[104:105] op_sel_hi:[1,0,1]
v_lshlrev_b32 v156, 16, v205
v_and_b32 v157, 0xffff0000, v205
v_pk_fma_f32 v[106:107], v[156:157], v[134:135], v[106:107] op_sel_hi:[1,0,1]
v_lshlrev_b32 v158, 16, v206
v_and_b32 v159, 0xffff0000, v206
v_pk_fma_f32 v[108:109], v[158:159], v[134:135], v[108:109] op_sel_hi:[1,0,1]
v_lshlrev_b32 v160, 16, v207
v_and_b32 v161, 0xffff0000, v207
v_pk_fma_f32 v[110:111], v[160:161], v[134:135], v[110:111] op_sel_hi:[1,0,1]
s_waitcnt vmcnt(14)
v_lshlrev_b32 v154, 16, v208
v_and_b32 v155, 0xffff0000, v208
v_pk_fma_f32 v[104:105], v[154:155], v[134:135], v[104:105] op_sel:[0,1,0] op_sel_hi:[1,1,1]
v_lshlrev_b32 v156, 16, v209
v_and_b32 v157, 0xffff0000, v209
v_pk_fma_f32 v[106:107], v[156:157], v[134:135], v[106:107] op_sel:[0,1,0] op_sel_hi:[1,1,1]
v_lshlrev_b32 v158, 16, v210
v_and_b32 v159, 0xffff0000, v210
v_pk_fma_f32 v[108:109], v[158:159], v[134:135], v[108:109] op_sel:[0,1,0] op_sel_hi:[1,1,1]
v_lshlrev_b32 v160, 16, v211
v_and_b32 v161, 0xffff0000, v211
v_pk_fma_f32 v[110:111], v[160:161], v[134:135], v[110:111] op_sel:[0,1,0] op_sel_hi:[1,1,1]
s_waitcnt vmcnt(13)
v_lshlrev_b32 v154, 16, v212
v_and_b32 v155, 0xffff0000, v212
v_pk_fma_f32 v[104:105], v[154:155], v[136:137], v[104:105] op_sel_hi:[1,0,1]
v_lshlrev_b32 v156, 16, v213
v_and_b32 v157, 0xffff0000, v213
v_pk_fma_f32 v[106:107], v[156:157], v[136:137], v[106:107] op_sel_hi:[1,0,1]
v_lshlrev_b32 v158, 16, v214
v_and_b32 v159, 0xffff0000, v214
v_pk_fma_f32 v[108:109], v[158:159], v[136:137], v[108:109] op_sel_hi:[1,0,1]
v_lshlrev_b32 v160, 16, v215
v_and_b32 v161, 0xffff0000, v215
v_pk_fma_f32 v[110:111], v[160:161], v[136:137], v[110:111] op_sel_hi:[1,0,1]
s_waitcnt vmcnt(12)
v_lshlrev_b32 v154, 16, v216
v_and_b32 v155, 0xffff0000, v216
v_pk_fma_f32 v[104:105], v[154:155], v[136:137], v[104:105] op_sel:[0,1,0] op_sel_hi:[1,1,1]
v_lshlrev_b32 v156, 16, v217
v_and_b32 v157, 0xffff0000, v217
v_pk_fma_f32 v[106:107], v[156:157], v[136:137], v[106:107] op_sel:[0,1,0] op_sel_hi:[1,1,1]
v_lshlrev_b32 v158, 16, v218
v_and_b32 v159, 0xffff0000, v218
v_pk_fma_f32 v[108:109], v[158:159], v[136:137], v[108:109] op_sel:[0,1,0] op_sel_hi:[1,1,1]
v_lshlrev_b32 v160, 16, v219
v_and_b32 v161, 0xffff0000, v219
v_pk_fma_f32 v[110:111], v[160:161], v[136:137], v[110:111] op_sel:[0,1,0] op_sel_hi:[1,1,1]
s_waitcnt vmcnt(11)
v_lshlrev_b32 v154, 16, v220
v_and_b32 v155, 0xffff0000, v220
v_pk_fma_f32 v[104:105], v[154:155], v[138:139], v[104:105] op_sel_hi:[1,0,1]
v_lshlrev_b32 v156, 16, v221
v_and_b32 v157, 0xffff0000, v221
v_pk_fma_f32 v[106:107], v[156:157], v[138:139], v[106:107] op_sel_hi:[1,0,1]
v_lshlrev_b32 v158, 16, v222
v_and_b32 v159, 0xffff0000, v222
v_pk_fma_f32 v[108:109], v[158:159], v[138:139], v[108:109] op_sel_hi:[1,0,1]
v_lshlrev_b32 v160, 16, v223
v_and_b32 v161, 0xffff0000, v223
v_pk_fma_f32 v[110:111], v[160:161], v[138:139], v[110:111] op_sel_hi:[1,0,1]
s_waitcnt vmcnt(10)
v_lshlrev_b32 v154, 16, v224
v_and_b32 v155, 0xffff0000, v224
v_pk_fma_f32 v[104:105], v[154:155], v[138:139], v[104:105] op_sel:[0,1,0] op_sel_hi:[1,1,1]
v_lshlrev_b32 v156, 16, v225
v_and_b32 v157, 0xffff0000, v225
v_pk_fma_f32 v[106:107], v[156:157], v[138:139], v[106:107] op_sel:[0,1,0] op_sel_hi:[1,1,1]
v_lshlrev_b32 v158, 16, v226
v_and_b32 v159, 0xffff0000, v226
v_pk_fma_f32 v[108:109], v[158:159], v[138:139], v[108:109] op_sel:[0,1,0] op_sel_hi:[1,1,1]
v_lshlrev_b32 v160, 16, v227
v_and_b32 v161, 0xffff0000, v227
v_pk_fma_f32 v[110:111], v[160:161], v[138:139], v[110:111] op_sel:[0,1,0] op_sel_hi:[1,1,1]
s_waitcnt vmcnt(9)
v_lshlrev_b32 v154, 16, v228
v_and_b32 v155, 0xffff0000, v228
v_pk_fma_f32 v[104:105], v[154:155], v[140:141], v[104:105] op_sel_hi:[1,0,1]
v_lshlrev_b32 v156, 16, v229
v_and_b32 v157, 0xffff0000, v229
v_pk_fma_f32 v[106:107], v[156:157], v[140:141], v[106:107] op_sel_hi:[1,0,1]
v_lshlrev_b32 v158, 16, v230
v_and_b32 v159, 0xffff0000, v230
v_pk_fma_f32 v[108:109], v[158:159], v[140:141], v[108:109] op_sel_hi:[1,0,1]
v_lshlrev_b32 v160, 16, v231
v_and_b32 v161, 0xffff0000, v231
v_pk_fma_f32 v[110:111], v[160:161], v[140:141], v[110:111] op_sel_hi:[1,0,1]
s_waitcnt vmcnt(8)
v_lshlrev_b32 v154, 16, v232
v_and_b32 v155, 0xffff0000, v232
v_pk_fma_f32 v[104:105], v[154:155], v[140:141], v[104:105] op_sel:[0,1,0] op_sel_hi:[1,1,1]
v_lshlrev_b32 v156, 16, v233
v_and_b32 v157, 0xffff0000, v233
v_pk_fma_f32 v[106:107], v[156:157], v[140:141], v[106:107] op_sel:[0,1,0] op_sel_hi:[1,1,1]
v_lshlrev_b32 v158, 16, v234
v_and_b32 v159, 0xffff0000, v234
v_pk_fma_f32 v[108:109], v[158:159], v[140:141], v[108:109] op_sel:[0,1,0] op_sel_hi:[1,1,1]
v_lshlrev_b32 v160, 16, v235
v_and_b32 v161, 0xffff0000, v235
v_pk_fma_f32 v[110:111], v[160:161], v[140:141], v[110:111] op_sel:[0,1,0] op_sel_hi:[1,1,1]
s_waitcnt vmcnt(7)
v_lshlrev_b32 v154, 16, v236
v_and_b32 v155, 0xffff0000, v236
v_pk_fma_f32 v[104:105], v[154:155], v[142:143], v[104:105] op_sel_hi:[1,0,1]
v_lshlrev_b32 v156, 16, v237
v_and_b32 v157, 0xffff0000, v237
v_pk_fma_f32 v[106:107], v[156:157], v[142:143], v[106:107] op_sel_hi:[1,0,1]
v_lshlrev_b32 v158, 16, v238
v_and_b32 v159, 0xffff0000, v238
v_pk_fma_f32 v[108:109], v[158:159], v[142:143], v[108:109] op_sel_hi:[1,0,1]
v_lshlrev_b32 v160, 16, v239
v_and_b32 v161, 0xffff0000, v239
v_pk_fma_f32 v[110:111], v[160:161], v[142:143], v[110:111] op_sel_hi:[1,0,1]
s_waitcnt vmcnt(6)
v_lshlrev_b32 v154, 16, v240
v_and_b32 v155, 0xffff0000, v240
v_pk_fma_f32 v[104:105], v[154:155], v[142:143], v[104:105] op_sel:[0,1,0] op_sel_hi:[1,1,1]
v_lshlrev_b32 v156, 16, v241
v_and_b32 v157, 0xffff0000, v241
v_pk_fma_f32 v[106:107], v[156:157], v[142:143], v[106:107] op_sel:[0,1,0] op_sel_hi:[1,1,1]
v_lshlrev_b32 v158, 16, v242
v_and_b32 v159, 0xffff0000, v242
v_pk_fma_f32 v[108:109], v[158:159], v[142:143], v[108:109] op_sel:[0,1,0] op_sel_hi:[1,1,1]
v_lshlrev_b32 v160, 16, v243
v_and_b32 v161, 0xffff0000, v243
v_pk_fma_f32 v[110:111], v[160:161], v[142:143], v[110:111] op_sel:[0,1,0] op_sel_hi:[1,1,1]
s_branch L_gemv_red
L_gemv_short:
s_lshl_b32 s6, s2, 2
s_add_u32 s6, s6, s28
s_lshl_b32 s6, s6, 13
v_lshl_add_u32 v35, v0, 7, s6
v_mov_b32 v36, 0
buffer_store_dword v36, v35, s[68:71], 0 offen sc1
v_mov_b32 v104, 0
v_mov_b32 v105, 0
v_mov_b32 v106, 0
v_mov_b32 v107, 0
v_mov_b32 v108, 0
v_mov_b32 v109, 0
v_mov_b32 v110, 0
v_mov_b32 v111, 0
s_waitcnt vmcnt(17)
v_lshlrev_b32 v124, 16, v112
v_and_b32 v125, 0xffff0000, v112
v_lshlrev_b32 v126, 16, v113
v_and_b32 v127, 0xffff0000, v113
v_lshlrev_b32 v128, 16, v114
v_and_b32 v129, 0xffff0000, v114
v_lshlrev_b32 v130, 16, v115
v_and_b32 v131, 0xffff0000, v115
v_lshlrev_b32 v132, 16, v116
v_and_b32 v133, 0xffff0000, v116
s_mov_b32 s6, 0xbfb8aa3b
v_mul_f32 v154, s6, v124
v_mul_f32 v155, s6, v125
v_mul_f32 v156, s6, v126
v_mul_f32 v157, s6, v127
v_mul_f32 v158, s6, v128
v_mul_f32 v159, s6, v129
v_mul_f32 v160, s6, v130
v_mul_f32 v161, s6, v131
v_mul_f32 v162, s6, v132
v_mul_f32 v163, s6, v133
v_exp_f32 v154, v154
v_exp_f32 v155, v155
v_exp_f32 v156, v156
v_exp_f32 v157, v157
v_exp_f32 v158, v158
v_exp_f32 v159, v159
v_exp_f32 v160, v160
v_exp_f32 v161, v161
v_exp_f32 v162, v162
v_exp_f32 v163, v163
v_add_f32 v154, 1.0, v154
v_add_f32 v155, 1.0, v155
v_add_f32 v156, 1.0, v156
v_add_f32 v157, 1.0, v157
v_add_f32 v158, 1.0, v158
v_add_f32 v159, 1.0, v159
v_add_f32 v160, 1.0, v160
v_add_f32 v161, 1.0, v161
v_add_f32 v162, 1.0, v162
v_add_f32 v163, 1.0, v163
v_rcp_f32 v154, v154
v_rcp_f32 v155, v155
v_rcp_f32 v156, v156
v_rcp_f32 v157, v157
v_rcp_f32 v158, v158
v_rcp_f32 v159, v159
v_rcp_f32 v160, v160
v_rcp_f32 v161, v161
v_rcp_f32 v162, v162
v_rcp_f32 v163, v163
v_mul_f32 v124, v124, v154
v_mul_f32 v125, v125, v155
v_mul_f32 v126, v126, v156
v_mul_f32 v127, v127, v157
v_mul_f32 v128, v128, v158
v_mul_f32 v129, v129, v159
v_mul_f32 v130, v130, v160
v_mul_f32 v131, v131, v161
v_mul_f32 v132, v132, v162
v_mul_f32 v133, v133, v163
v_cvt_pk_bf16_f32 v124, v124, v124
v_cvt_pk_bf16_f32 v125, v125, v125
v_cvt_pk_bf16_f32 v126, v126, v126
v_cvt_pk_bf16_f32 v127, v127, v127
v_cvt_pk_bf16_f32 v128, v128, v128
v_cvt_pk_bf16_f32 v129, v129, v129
v_cvt_pk_bf16_f32 v130, v130, v130
v_cvt_pk_bf16_f32 v131, v131, v131
v_cvt_pk_bf16_f32 v132, v132, v132
v_cvt_pk_bf16_f32 v133, v133, v133
v_lshlrev_b32 v124, 16, v124
v_lshlrev_b32 v125, 16, v125
v_lshlrev_b32 v126, 16, v126
v_lshlrev_b32 v127, 16, v127
v_lshlrev_b32 v128, 16, v128
v_lshlrev_b32 v129, 16, v129
v_lshlrev_b32 v130, 16, v130
v_lshlrev_b32 v131, 16, v131
v_lshlrev_b32 v132, 16, v132
v_lshlrev_b32 v133, 16, v133
v_cndmask_b32 v124, v124, 1.0, s[56:57]
v_cndmask_b32 v125, v125, 1.0, s[56:57]
v_cndmask_b32 v126, v126, 1.0, s[56:57]
v_cndmask_b32 v127, v127, 1.0, s[56:57]
v_cndmask_b32 v128, v128, 1.0, s[56:57]
v_cndmask_b32 v129, v129, 1.0, s[56:57]
v_cndmask_b32 v130, v130, 1.0, s[56:57]
v_cndmask_b32 v131, v131, 1.0, s[56:57]
v_cndmask_b32 v132, v132, 1.0, s[56:57]
v_cndmask_b32 v133, v133, 1.0, s[56:57]
s_waitcnt vmcnt(16)
v_lshlrev_b32 v154, 16, v164
v_and_b32 v155, 0xffff0000, v164
v_pk_fma_f32 v[104:105], v[154:155], v[124:125], v[104:105] op_sel_hi:[1,0,1]
v_lshlrev_b32 v156, 16, v165
v_and_b32 v157, 0xffff0000, v165
v_pk_fma_f32 v[106:107], v[156:157], v[124:125], v[106:107] op_sel_hi:[1,0,1]
v_lshlrev_b32 v158, 16, v166
v_and_b32 v159, 0xffff0000, v166
v_pk_fma_f32 v[108:109], v[158:159], v[124:125], v[108:109] op_sel_hi:[1,0,1]
v_lshlrev_b32 v160, 16, v167
v_and_b32 v161, 0xffff0000, v167
v_pk_fma_f32 v[110:111], v[160:161], v[124:125], v[110:111] op_sel_hi:[1,0,1]
s_waitcnt vmcnt(15)
v_lshlrev_b32 v154, 16, v168
v_and_b32 v155, 0xffff0000, v168
v_pk_fma_f32 v[104:105], v[154:155], v[124:125], v[104:105] op_sel:[0,1,0] op_sel_hi:[1,1,1]
v_lshlrev_b32 v156, 16, v169
v_and_b32 v157, 0xffff0000, v169
v_pk_fma_f32 v[106:107], v[156:157], v[124:125], v[106:107] op_sel:[0,1,0] op_sel_hi:[1,1,1]
v_lshlrev_b32 v158, 16, v170
v_and_b32 v159, 0xffff0000, v170
v_pk_fma_f32 v[108:109], v[158:159], v[124:125], v[108:109] op_sel:[0,1,0] op_sel_hi:[1,1,1]
v_lshlrev_b32 v160, 16, v171
v_and_b32 v161, 0xffff0000, v171
v_pk_fma_f32 v[110:111], v[160:161], v[124:125], v[110:111] op_sel:[0,1,0] op_sel_hi:[1,1,1]
s_waitcnt vmcnt(14)
v_lshlrev_b32 v154, 16, v172
v_and_b32 v155, 0xffff0000, v172
v_pk_fma_f32 v[104:105], v[154:155], v[126:127], v[104:105] op_sel_hi:[1,0,1]
v_lshlrev_b32 v156, 16, v173
v_and_b32 v157, 0xffff0000, v173
v_pk_fma_f32 v[106:107], v[156:157], v[126:127], v[106:107] op_sel_hi:[1,0,1]
v_lshlrev_b32 v158, 16, v174
v_and_b32 v159, 0xffff0000, v174
v_pk_fma_f32 v[108:109], v[158:159], v[126:127], v[108:109] op_sel_hi:[1,0,1]
v_lshlrev_b32 v160, 16, v175
v_and_b32 v161, 0xffff0000, v175
v_pk_fma_f32 v[110:111], v[160:161], v[126:127], v[110:111] op_sel_hi:[1,0,1]
s_waitcnt vmcnt(13)
v_lshlrev_b32 v154, 16, v176
v_and_b32 v155, 0xffff0000, v176
v_pk_fma_f32 v[104:105], v[154:155], v[126:127], v[104:105] op_sel:[0,1,0] op_sel_hi:[1,1,1]
v_lshlrev_b32 v156, 16, v177
v_and_b32 v157, 0xffff0000, v177
v_pk_fma_f32 v[106:107], v[156:157], v[126:127], v[106:107] op_sel:[0,1,0] op_sel_hi:[1,1,1]
v_lshlrev_b32 v158, 16, v178
v_and_b32 v159, 0xffff0000, v178
v_pk_fma_f32 v[108:109], v[158:159], v[126:127], v[108:109] op_sel:[0,1,0] op_sel_hi:[1,1,1]
v_lshlrev_b32 v160, 16, v179
v_and_b32 v161, 0xffff0000, v179
v_pk_fma_f32 v[110:111], v[160:161], v[126:127], v[110:111] op_sel:[0,1,0] op_sel_hi:[1,1,1]
s_waitcnt vmcnt(12)
v_lshlrev_b32 v154, 16, v180
v_and_b32 v155, 0xffff0000, v180
v_pk_fma_f32 v[104:105], v[154:155], v[128:129], v[104:105] op_sel_hi:[1,0,1]
v_lshlrev_b32 v156, 16, v181
v_and_b32 v157, 0xffff0000, v181
v_pk_fma_f32 v[106:107], v[156:157], v[128:129], v[106:107] op_sel_hi:[1,0,1]
v_lshlrev_b32 v158, 16, v182
v_and_b32 v159, 0xffff0000, v182
v_pk_fma_f32 v[108:109], v[158:159], v[128:129], v[108:109] op_sel_hi:[1,0,1]
v_lshlrev_b32 v160, 16, v183
v_and_b32 v161, 0xffff0000, v183
v_pk_fma_f32 v[110:111], v[160:161], v[128:129], v[110:111] op_sel_hi:[1,0,1]
s_waitcnt vmcnt(11)
v_lshlrev_b32 v154, 16, v184
v_and_b32 v155, 0xffff0000, v184
v_pk_fma_f32 v[104:105], v[154:155], v[128:129], v[104:105] op_sel:[0,1,0] op_sel_hi:[1,1,1]
v_lshlrev_b32 v156, 16, v185
v_and_b32 v157, 0xffff0000, v185
v_pk_fma_f32 v[106:107], v[156:157], v[128:129], v[106:107] op_sel:[0,1,0] op_sel_hi:[1,1,1]
v_lshlrev_b32 v158, 16, v186
v_and_b32 v159, 0xffff0000, v186
v_pk_fma_f32 v[108:109], v[158:159], v[128:129], v[108:109] op_sel:[0,1,0] op_sel_hi:[1,1,1]
v_lshlrev_b32 v160, 16, v187
v_and_b32 v161, 0xffff0000, v187
v_pk_fma_f32 v[110:111], v[160:161], v[128:129], v[110:111] op_sel:[0,1,0] op_sel_hi:[1,1,1]
s_waitcnt vmcnt(10)
v_lshlrev_b32 v154, 16, v188
v_and_b32 v155, 0xffff0000, v188
v_pk_fma_f32 v[104:105], v[154:155], v[130:131], v[104:105] op_sel_hi:[1,0,1]
v_lshlrev_b32 v156, 16, v189
v_and_b32 v157, 0xffff0000, v189
v_pk_fma_f32 v[106:107], v[156:157], v[130:131], v[106:107] op_sel_hi:[1,0,1]
v_lshlrev_b32 v158, 16, v190
v_and_b32 v159, 0xffff0000, v190
v_pk_fma_f32 v[108:109], v[158:159], v[130:131], v[108:109] op_sel_hi:[1,0,1]
v_lshlrev_b32 v160, 16, v191
v_and_b32 v161, 0xffff0000, v191
v_pk_fma_f32 v[110:111], v[160:161], v[130:131], v[110:111] op_sel_hi:[1,0,1]
s_waitcnt vmcnt(9)
v_lshlrev_b32 v154, 16, v192
v_and_b32 v155, 0xffff0000, v192
v_pk_fma_f32 v[104:105], v[154:155], v[130:131], v[104:105] op_sel:[0,1,0] op_sel_hi:[1,1,1]
v_lshlrev_b32 v156, 16, v193
v_and_b32 v157, 0xffff0000, v193
v_pk_fma_f32 v[106:107], v[156:157], v[130:131], v[106:107] op_sel:[0,1,0] op_sel_hi:[1,1,1]
v_lshlrev_b32 v158, 16, v194
v_and_b32 v159, 0xffff0000, v194
v_pk_fma_f32 v[108:109], v[158:159], v[130:131], v[108:109] op_sel:[0,1,0] op_sel_hi:[1,1,1]
v_lshlrev_b32 v160, 16, v195
v_and_b32 v161, 0xffff0000, v195
v_pk_fma_f32 v[110:111], v[160:161], v[130:131], v[110:111] op_sel:[0,1,0] op_sel_hi:[1,1,1]
s_waitcnt vmcnt(8)
v_lshlrev_b32 v154, 16, v196
v_and_b32 v155, 0xffff0000, v196
v_pk_fma_f32 v[104:105], v[154:155], v[132:133], v[104:105] op_sel_hi:[1,0,1]
v_lshlrev_b32 v156, 16, v197
v_and_b32 v157, 0xffff0000, v197
v_pk_fma_f32 v[106:107], v[156:157], v[132:133], v[106:107] op_sel_hi:[1,0,1]
v_lshlrev_b32 v158, 16, v198
v_and_b32 v159, 0xffff0000, v198
v_pk_fma_f32 v[108:109], v[158:159], v[132:133], v[108:109] op_sel_hi:[1,0,1]
v_lshlrev_b32 v160, 16, v199
v_and_b32 v161, 0xffff0000, v199
v_pk_fma_f32 v[110:111], v[160:161], v[132:133], v[110:111] op_sel_hi:[1,0,1]
s_waitcnt vmcnt(7)
v_lshlrev_b32 v154, 16, v200
v_and_b32 v155, 0xffff0000, v200
v_pk_fma_f32 v[104:105], v[154:155], v[132:133], v[104:105] op_sel:[0,1,0] op_sel_hi:[1,1,1]
v_lshlrev_b32 v156, 16, v201
v_and_b32 v157, 0xffff0000, v201
v_pk_fma_f32 v[106:107], v[156:157], v[132:133], v[106:107] op_sel:[0,1,0] op_sel_hi:[1,1,1]
v_lshlrev_b32 v158, 16, v202
v_and_b32 v159, 0xffff0000, v202
v_pk_fma_f32 v[108:109], v[158:159], v[132:133], v[108:109] op_sel:[0,1,0] op_sel_hi:[1,1,1]
v_lshlrev_b32 v160, 16, v203
v_and_b32 v161, 0xffff0000, v203
v_pk_fma_f32 v[110:111], v[160:161], v[132:133], v[110:111] op_sel:[0,1,0] op_sel_hi:[1,1,1]
L_gemv_red:
s_nop 1
v_add_f32_dpp v104, v104, v104 row_ror:8 row_mask:0xf bank_mask:0xf
v_add_f32_dpp v105, v105, v105 row_ror:8 row_mask:0xf bank_mask:0xf
v_add_f32_dpp v106, v106, v106 row_ror:8 row_mask:0xf bank_mask:0xf
v_add_f32_dpp v107, v107, v107 row_ror:8 row_mask:0xf bank_mask:0xf
v_add_f32_dpp v108, v108, v108 row_ror:8 row_mask:0xf bank_mask:0xf
v_add_f32_dpp v109, v109, v109 row_ror:8 row_mask:0xf bank_mask:0xf
v_add_f32_dpp v110, v110, v110 row_ror:8 row_mask:0xf bank_mask:0xf
v_add_f32_dpp v111, v111, v111 row_ror:8 row_mask:0xf bank_mask:0xf
v_mov_b32 v154, v104
v_mov_b32 v155, v105
v_mov_b32 v156, v106
v_mov_b32 v157, v107
v_mov_b32 v158, v108
v_mov_b32 v159, v109
v_mov_b32 v160, v110
v_mov_b32 v161, v111
v_permlane32_swap_b32 v104, v154
v_permlane32_swap_b32 v105, v155
v_permlane32_swap_b32 v106, v156
v_permlane32_swap_b32 v107, v157
v_permlane32_swap_b32 v108, v158
v_permlane32_swap_b32 v109, v159
v_permlane32_swap_b32 v110, v160
v_permlane32_swap_b32 v111, v161
v_pk_add_f32 v[104:105], v[104:105], v[154:155]
v_pk_add_f32 v[106:107], v[106:107], v[156:157]
v_pk_add_f32 v[108:109], v[108:109], v[158:159]
v_pk_add_f32 v[110:111], v[110:111], v[160:161]
v_mov_b32 v154, v104
v_mov_b32 v155, v105
v_mov_b32 v156, v106
v_mov_b32 v157, v107
v_mov_b32 v158, v108
v_mov_b32 v159, v109
v_mov_b32 v160, v110
v_mov_b32 v161, v111
v_permlane16_swap_b32 v104, v154
v_permlane16_swap_b32 v105, v155
v_permlane16_swap_b32 v106, v156
v_permlane16_swap_b32 v107, v157
v_permlane16_swap_b32 v108, v158
v_permlane16_swap_b32 v109, v159
v_permlane16_swap_b32 v110, v160
v_permlane16_swap_b32 v111, v161
v_pk_add_f32 v[104:105], v[104:105], v[154:155]
v_pk_add_f32 v[106:107], v[106:107], v[156:157]
v_pk_add_f32 v[108:109], v[108:109], v[158:159]
v_pk_add_f32 v[110:111], v[110:111], v[160:161]
s_lshl_b32 s6, s28, 8
v_lshl_add_u32 v35, v152, 5, s6
ds_write_b128 v35, v[104:107] offset:4096
ds_write_b128 v35, v[108:111] offset:4112
s_waitcnt vmcnt(0) lgkmcnt(0)
s_barrier
s_cmp_lg_u32 s28, 0
s_cbranch_scc1 L_gemv_done
v_lshlrev_b32 v35, 2, v0
ds_read_b32 v104, v35 offset:4096
ds_read_b32 v105, v35 offset:4352
ds_read_b32 v106, v35 offset:4608
ds_read_b32 v107, v35 offset:4864
v_bfe_u32 v36, v0, 2, 2
v_lshlrev_b32 v36, 3, v36
v_bfe_u32 v37, v0, 4, 1
v_lshl_add_u32 v36, v37, 2, v36
v_and_b32 v37, 35, v0
v_add_u32 v36, v36, v37
s_waitcnt lgkmcnt(0)
v_pk_add_f32 v[104:105], v[104:105], v[106:107]
v_add_f32 v104, v104, v105
s_cmp_ge_u32 s2, 40
s_cbranch_scc1 L_gemv_late
s_add_u32 s48, s4, 32768
s_addc_u32 s49, s5, 0
s_mov_b32 s50, 10240
s_mov_b32 s51, 0x20000
s_load_dwordx2 s[60:61], s[0:1], 104
s_mul_i32 s6, s55, 5120
s_lshl_b32 s7, s54, 8
s_add_u32 s6, s6, s7
v_lshlrev_b32 v36, 2, v36
buffer_store_dword v104, v36, s[48:51], s6 offen sc1
s_mov_b32 s62, 256
s_mov_b32 s63, 0x20000
s_waitcnt vmcnt(0) lgkmcnt(0)
s_mov_b64 exec, 1
v_mov_b32 v36, 1
buffer_atomic_add v36, off, s[60:63], 0 sc0 sc1
s_waitcnt vmcnt(0)
v_cmp_eq_u32 vcc, 39, v36
s_and_b64 exec, exec, vcc
s_cbranch_execz L_gemv_nolast
v_mov_b32 v36, 40
buffer_store_dword v36, off, s[60:63], 0 offset:128 sc1
L_gemv_nolast:
s_mov_b64 exec, -1
s_branch L_gemv_done
L_gemv_late:
s_cmp_ge_u32 s2, 80
s_cbranch_scc1 L_gemv_cs
v_cvt_pk_bf16_f32 v104, v104, v104
v_lshlrev_b32 v105, 16, v104
v_add_f32 v105, 1.0, v105
v_cvt_pk_bf16_f32 v105, v105, v105
s_sub_u32 s6, s54, 40
s_cmp_lt_u32 s6, 10
s_cselect_b64 s[60:61], -1, 0
s_lshl_b32 s6, s54, 7
v_lshlrev_b32 v36, 1, v36
v_cndmask_b32 v104, v104, v105, s[60:61]
buffer_store_short v104, v36, s[76:79], s6 offen sc1
s_branch L_gemv_done
L_gemv_cs:
s_add_u32 s48, s4, 16384
s_addc_u32 s49, s5, 0
s_mov_b32 s50, 6144
s_mov_b32 s51, 0x20000
s_lshl_b32 s6, s54, 8
buffer_store_dword v104, v35, s[48:51], s6 offen sc1
s_branch L_gemv_done
L_gemv_idle:
s_getpc_b64 s[48:49]
L_front_pc:
s_mov_b32 s50, L_tail_pc-L_front_pc
s_mov_b32 s51, 0x20000
s_sub_u32 s6, s2, 104
s_lshr_b32 s6, s6, 3
s_lshl_b32 s6, s6, 2
s_add_u32 s6, s6, s28
s_lshl_b32 s6, s6, 10
v_lshrrev_b32 v35, 3, v0
v_lshl_add_u32 v35, v35, 7, s6
buffer_load_dword v18, v35, s[48:51], 0 offen
L_gemv_done:
v_mov_b32 v32, v28
v_mov_b32 v33, v29
v_mov_b32 v38, v30
v_mov_b32 v39, v16
v_mov_b32 v36, v17
s_load_dwordx2 s[48:49], s[0:1], 104
s_mov_b32 s50, 256
s_mov_b32 s51, 0x20000
s_mov_b32 s38, 0
s_mov_b32 s39, 393216
s_mov_b32 s37, 0
s_add_u32 m0, s29, 98304
s_nop 0
buffer_load_dwordx4 v10, s[12:15], s38 offen offset:0 lds
s_add_u32 m0, s29, 99200
s_nop 0
buffer_load_dwordx4 v10, s[12:15], s38 offen offset:128 lds
s_add_u32 m0, s29, 100096
s_nop 0
buffer_load_dwordx4 v10, s[12:15], s38 offen offset:256 lds
s_add_u32 m0, s29, 110592
s_nop 0
buffer_load_dwordx4 v10, s[12:15], s39 offen offset:0 lds
s_add_u32 m0, s29, 111488
s_nop 0
buffer_load_dwordx4 v10, s[12:15], s39 offen offset:128 lds
s_add_u32 m0, s29, 112384
s_nop 0
buffer_load_dwordx4 v10, s[12:15], s39 offen offset:256 lds
s_mov_b32 s38, 786432
s_mov_b32 s39, 1179648
s_mov_b32 s37, 2048
s_add_u32 m0, s29, 122880
s_nop 0
buffer_load_dwordx4 v10, s[12:15], s38 offen offset:0 lds
s_add_u32 m0, s29, 123776
s_nop 0
buffer_load_dwordx4 v10, s[12:15], s38 offen offset:128 lds
s_add_u32 m0, s29, 124672
s_nop 0
buffer_load_dwordx4 v10, s[12:15], s38 offen offset:256 lds
s_add_u32 m0, s29, 135168
s_nop 0
buffer_load_dwordx4 v10, s[12:15], s39 offen offset:0 lds
s_add_u32 m0, s29, 136064
s_nop 0
buffer_load_dwordx4 v10, s[12:15], s39 offen offset:128 lds
s_add_u32 m0, s29, 136960
s_nop 0
buffer_load_dwordx4 v10, s[12:15], s39 offen offset:256 lds
s_waitcnt vmcnt(12)
v_lshlrev_b32 v80, 16, v40
v_and_b32 v81, 0xffff0000, v40
v_lshlrev_b32 v82, 16, v41
v_and_b32 v83, 0xffff0000, v41
v_lshlrev_b32 v84, 16, v42
v_and_b32 v85, 0xffff0000, v42
v_lshlrev_b32 v86, 16, v43
v_and_b32 v87, 0xffff0000, v43
v_lshlrev_b32 v88, 16, v44
v_and_b32 v89, 0xffff0000, v44
v_lshlrev_b32 v90, 16, v45
v_and_b32 v91, 0xffff0000, v45
v_lshlrev_b32 v92, 16, v46
v_and_b32 v93, 0xffff0000, v46
v_lshlrev_b32 v94, 16, v47
v_and_b32 v95, 0xffff0000, v47
v_lshlrev_b32 v96, 16, v48
v_and_b32 v97, 0xffff0000, v48
v_lshlrev_b32 v98, 16, v49
v_and_b32 v99, 0xffff0000, v49
v_lshlrev_b32 v100, 16, v50
v_and_b32 v101, 0xffff0000, v50
v_lshlrev_b32 v102, 16, v51
v_and_b32 v103, 0xffff0000, v51
v_pk_add_f32 v[72:73], v[80:81], v[82:83]
v_pk_mul_f32 v[74:75], v[80:81], v[80:81]
v_pk_fma_f32 v[74:75], v[82:83], v[82:83], v[74:75]
v_pk_add_f32 v[72:73], v[72:73], v[84:85]
v_pk_fma_f32 v[74:75], v[84:85], v[84:85], v[74:75]
v_pk_add_f32 v[72:73], v[72:73], v[86:87]
v_pk_fma_f32 v[74:75], v[86:87], v[86:87], v[74:75]
v_pk_add_f32 v[72:73], v[72:73], v[88:89]
v_pk_fma_f32 v[74:75], v[88:89], v[88:89], v[74:75]
v_pk_add_f32 v[72:73], v[72:73], v[90:91]
v_pk_fma_f32 v[74:75], v[90:91], v[90:91], v[74:75]
v_pk_add_f32 v[72:73], v[72:73], v[92:93]
v_pk_fma_f32 v[74:75], v[92:93], v[92:93], v[74:75]
v_pk_add_f32 v[72:73], v[72:73], v[94:95]
v_pk_fma_f32 v[74:75], v[94:95], v[94:95], v[74:75]
v_pk_add_f32 v[72:73], v[72:73], v[96:97]
v_pk_fma_f32 v[74:75], v[96:97], v[96:97], v[74:75]
v_pk_add_f32 v[72:73], v[72:73], v[98:99]
v_pk_fma_f32 v[74:75], v[98:99], v[98:99], v[74:75]
v_pk_add_f32 v[72:73], v[72:73], v[100:101]
v_pk_fma_f32 v[74:75], v[100:101], v[100:101], v[74:75]
v_pk_add_f32 v[72:73], v[72:73], v[102:103]
v_pk_fma_f32 v[74:75], v[102:103], v[102:103], v[74:75]
v_add_f32 v72, v72, v73
v_add_f32 v73, v74, v75
s_nop 1
v_add_f32_dpp v72, v72, v72 row_ror:8 row_mask:0xf bank_mask:0xf
v_add_f32_dpp v73, v73, v73 row_ror:8 row_mask:0xf bank_mask:0xf
v_mov_b32 v64, v72
v_mov_b32 v65, v73
s_nop 0
v_permlane32_swap_b32 v72, v64
v_permlane32_swap_b32 v73, v65
v_pk_add_f32 v[72:73], v[72:73], v[64:65]
v_mov_b32 v64, v72
v_mov_b32 v65, v73
s_nop 0
v_permlane16_swap_b32 v72, v64
v_permlane16_swap_b32 v73, v65
v_pk_add_f32 v[72:73], v[72:73], v[64:65]
ds_write_b64 v38, v[72:73] offset:0
s_waitcnt lgkmcnt(0)
s_barrier
ds_read_b128 v[64:67], v39 offset:0
ds_read_b128 v[68:71], v39 offset:16
s_waitcnt lgkmcnt(0)
v_pk_add_f32 v[64:65], v[64:65], v[66:67]
v_pk_add_f32 v[68:69], v[68:69], v[70:71]
v_pk_add_f32 v[72:73], v[64:65], v[68:69]
v_mul_f32 v72, 0x3acccccd, v72
v_mov_b32 v74, 0x3727c5ac
v_fmac_f32 v74, 0x3acccccd, v73
v_fma_f32 v75, -v72, v72, v74
v_max_f32 v74, 0x3727c5ac, v75
v_rsq_f32 v74, v74
s_nop 0
v_mul_f32 v72, v72, v74
v_pk_fma_f32 v[80:81], v[80:81], v[74:75], v[72:73] op_sel_hi:[1,0,0] neg_lo:[0,0,1] neg_hi:[0,0,1]
v_pk_fma_f32 v[82:83], v[82:83], v[74:75], v[72:73] op_sel_hi:[1,0,0] neg_lo:[0,0,1] neg_hi:[0,0,1]
v_pk_fma_f32 v[84:85], v[84:85], v[74:75], v[72:73] op_sel_hi:[1,0,0] neg_lo:[0,0,1] neg_hi:[0,0,1]
v_pk_fma_f32 v[86:87], v[86:87], v[74:75], v[72:73] op_sel_hi:[1,0,0] neg_lo:[0,0,1] neg_hi:[0,0,1]
v_pk_fma_f32 v[88:89], v[88:89], v[74:75], v[72:73] op_sel_hi:[1,0,0] neg_lo:[0,0,1] neg_hi:[0,0,1]
v_pk_fma_f32 v[90:91], v[90:91], v[74:75], v[72:73] op_sel_hi:[1,0,0] neg_lo:[0,0,1] neg_hi:[0,0,1]
v_pk_fma_f32 v[92:93], v[92:93], v[74:75], v[72:73] op_sel_hi:[1,0,0] neg_lo:[0,0,1] neg_hi:[0,0,1]
v_pk_fma_f32 v[94:95], v[94:95], v[74:75], v[72:73] op_sel_hi:[1,0,0] neg_lo:[0,0,1] neg_hi:[0,0,1]
v_pk_fma_f32 v[96:97], v[96:97], v[74:75], v[72:73] op_sel_hi:[1,0,0] neg_lo:[0,0,1] neg_hi:[0,0,1]
v_pk_fma_f32 v[98:99], v[98:99], v[74:75], v[72:73] op_sel_hi:[1,0,0] neg_lo:[0,0,1] neg_hi:[0,0,1]
v_pk_fma_f32 v[100:101], v[100:101], v[74:75], v[72:73] op_sel_hi:[1,0,0] neg_lo:[0,0,1] neg_hi:[0,0,1]
v_pk_fma_f32 v[102:103], v[102:103], v[74:75], v[72:73] op_sel_hi:[1,0,0] neg_lo:[0,0,1] neg_hi:[0,0,1]
s_add_u32 s52, s4, 32768
s_addc_u32 s53, s5, 0
s_mov_b32 s54, 10240
s_mov_b32 s55, 0x20000
s_lshl_b32 s6, s28, 6
v_add_u32 v12, s6, v0
v_lshlrev_b32 v13, 1, v12
v_lshlrev_b32 v12, 2, v12
s_movk_i32 s58, 4096
s_movk_i32 s59, 5120
s_movk_i32 s60, 9216
s_waitcnt lgkmcnt(0)
s_cmp_lg_u32 s28, 0
s_cbranch_scc1 L_mp_skip
s_waitcnt lgkmcnt(0)
buffer_load_dword v19, off, s[48:51], 0 offset:128 sc1
s_mov_b32 s101, 0x200000
s_waitcnt vmcnt(0)
L_poll1:
v_cmp_gt_u32 vcc, 40, v19
s_cbranch_vccz L_go1
s_sub_u32 s101, s101, 1
s_cmp_eq_u32 s101, 0
s_cbranch_scc1 L_go1
buffer_load_dword v19, off, s[48:51], 0 offset:128 sc1
s_waitcnt vmcnt(0)
s_branch L_poll1
L_go1:
L_mp_skip:
s_barrier
buffer_load_dword v40, v12, s[52:55], 0 offen offset:0 sc1
buffer_load_dword v41, v12, s[52:55], s59 offen offset:0 sc1
buffer_load_dword v42, v12, s[52:55], 0 offen offset:1024 sc1
buffer_load_dword v43, v12, s[52:55], s59 offen offset:1024 sc1
buffer_load_dword v44, v12, s[52:55], 0 offen offset:2048 sc1
buffer_load_dword v45, v12, s[52:55], s59 offen offset:2048 sc1
buffer_load_dword v46, v12, s[52:55], 0 offen offset:3072 sc1
buffer_load_dword v47, v12, s[52:55], s59 offen offset:3072 sc1
buffer_load_dword v48, v12, s[52:55], s58 offen offset:0 sc1
buffer_load_dword v49, v12, s[52:55], s60 offen offset:0 sc1
s_sub_u32 s6, s2, 40
s_cmp_ge_u32 s6, 64
s_cselect_b32 s6, 1, s28
s_cmp_lg_u32 s6, 0
s_cbranch_scc1 L_nolate
s_mov_b32 s6, 16384
s_mov_b64 exec, 1
buffer_atomic_add v31, off, s[68:71], s6 sc1
s_mov_b64 exec, -1
L_nolate:
s_getreg_b32 s83, hwreg(HW_REG_XCC_ID, 0, 4)
s_and_b32 s6, s2, 7
s_lshl_b32 s6, s6, 4
s_add_u32 s83, s83, s6
s_lshl_b32 s83, s83, 7
s_add_u32 s83, s83, 229376
s_cmp_lg_u32 s28, 0
s_cbranch_scc1 L_nocensus
s_mov_b64 exec, 1
buffer_atomic_add v31, off, s[68:71], s83 sc1
s_mov_b64 exec, -1
L_nocensus:
s_waitcnt vmcnt(0)
v_add_f32 v40, v40, v41
v_add_f32 v42, v42, v43
v_add_f32 v44, v44, v45
v_add_f32 v46, v46, v47
v_add_f32 v48, v48, v49
v_cvt_pk_bf16_f32 v40, v40, v40
v_cvt_pk_bf16_f32 v42, v42, v42
v_cvt_pk_bf16_f32 v44, v44, v44
v_cvt_pk_bf16_f32 v46, v46, v46
v_cvt_pk_bf16_f32 v48, v48, v48
v_lshlrev_b32 v45, 16, v44
v_add_f32 v45, 1.0, v45
v_cvt_pk_bf16_f32 v45, v45, v45
v_lshlrev_b32 v47, 16, v46
v_add_f32 v47, 1.0, v47
v_cvt_pk_bf16_f32 v47, v47, v47
v_lshlrev_b32 v49, 16, v48
v_add_f32 v49, 1.0, v49
v_cvt_pk_bf16_f32 v49, v49, v49
s_cmp_ge_u32 s28, 2
s_cselect_b64 s[60:61], -1, 0
v_cndmask_b32 v45, v44, v45, s[60:61]
ds_write_b16 v13, v40 offset:0
ds_write_b16 v13, v42 offset:512
ds_write_b16 v13, v45 offset:1024
ds_write_b16 v13, v47 offset:1536
ds_write_b16 v13, v49 offset:2048
s_waitcnt lgkmcnt(0)
s_barrier
ds_read_b128 v[128:131], v36 offset:0
ds_read_b128 v[116:119], v36 offset:1280
ds_read_b128 v[132:135], v36 offset:512
ds_read_b128 v[120:123], v36 offset:1792
ds_read_b128 v[136:139], v36 offset:1024
ds_read_b128 v[124:127], v36 offset:2304
s_waitcnt lgkmcnt(0)
v_lshlrev_b32 v64, 16, v116
v_and_b32 v65, 0xffff0000, v116
v_lshlrev_b32 v66, 16, v128
v_and_b32 v67, 0xffff0000, v128
v_pk_fma_f32 v[80:81], v[80:81], v[64:65], v[66:67]
v_lshlrev_b32 v68, 16, v117
v_and_b32 v69, 0xffff0000, v117
v_lshlrev_b32 v70, 16, v129
v_and_b32 v71, 0xffff0000, v129
v_pk_fma_f32 v[82:83], v[82:83], v[68:69], v[70:71]
v_lshlrev_b32 v64, 16, v118
v_and_b32 v65, 0xffff0000, v118
v_lshlrev_b32 v66, 16, v130
v_and_b32 v67, 0xffff0000, v130
v_pk_fma_f32 v[84:85], v[84:85], v[64:65], v[66:67]
v_lshlrev_b32 v68, 16, v119
v_and_b32 v69, 0xffff0000, v119
v_lshlrev_b32 v70, 16, v131
v_and_b32 v71, 0xffff0000, v131
v_pk_fma_f32 v[86:87], v[86:87], v[68:69], v[70:71]
v_lshlrev_b32 v64, 16, v120
v_and_b32 v65, 0xffff0000, v120
v_lshlrev_b32 v66, 16, v132
v_and_b32 v67, 0xffff0000, v132
v_pk_fma_f32 v[88:89], v[88:89], v[64:65], v[66:67]
v_lshlrev_b32 v68, 16, v121
v_and_b32 v69, 0xffff0000, v121
v_lshlrev_b32 v70, 16, v133
v_and_b32 v71, 0xffff0000, v133
v_pk_fma_f32 v[90:91], v[90:91], v[68:69], v[70:71]
v_lshlrev_b32 v64, 16, v122
v_and_b32 v65, 0xffff0000, v122
v_lshlrev_b32 v66, 16, v134
v_and_b32 v67, 0xffff0000, v134
v_pk_fma_f32 v[92:93], v[92:93], v[64:65], v[66:67]
v_lshlrev_b32 v68, 16, v123
v_and_b32 v69, 0xffff0000, v123
v_lshlrev_b32 v70, 16, v135
v_and_b32 v71, 0xffff0000, v135
v_pk_fma_f32 v[94:95], v[94:95], v[68:69], v[70:71]
v_lshlrev_b32 v64, 16, v124
v_and_b32 v65, 0xffff0000, v124
v_lshlrev_b32 v66, 16, v136
v_and_b32 v67, 0xffff0000, v136
v_pk_fma_f32 v[96:97], v[96:97], v[64:65], v[66:67]
v_lshlrev_b32 v68, 16, v125
v_and_b32 v69, 0xffff0000, v125
v_lshlrev_b32 v70, 16, v137
v_and_b32 v71, 0xffff0000, v137
v_pk_fma_f32 v[98:99], v[98:99], v[68:69], v[70:71]
v_lshlrev_b32 v64, 16, v126
v_and_b32 v65, 0xffff0000, v126
v_lshlrev_b32 v66, 16, v138
v_and_b32 v67, 0xffff0000, v138
v_pk_fma_f32 v[100:101], v[100:101], v[64:65], v[66:67]
v_lshlrev_b32 v68, 16, v127
v_and_b32 v69, 0xffff0000, v127
v_lshlrev_b32 v70, 16, v139
v_and_b32 v71, 0xffff0000, v139
v_pk_fma_f32 v[102:103], v[102:103], v[68:69], v[70:71]
v_pk_mul_f32 v[80:81], v[80:81], s[40:41]
v_pk_mul_f32 v[82:83], v[82:83], s[40:41]
v_pk_mul_f32 v[84:85], v[84:85], s[40:41]
v_pk_mul_f32 v[86:87], v[86:87], s[40:41]
v_pk_mul_f32 v[88:89], v[88:89], s[40:41]
v_pk_mul_f32 v[90:91], v[90:91], s[40:41]
v_pk_mul_f32 v[92:93], v[92:93], s[40:41]
v_pk_mul_f32 v[94:95], v[94:95], s[40:41]
v_pk_mul_f32 v[96:97], v[96:97], s[40:41]
v_pk_mul_f32 v[98:99], v[98:99], s[40:41]
v_pk_mul_f32 v[100:101], v[100:101], s[40:41]
v_pk_mul_f32 v[102:103], v[102:103], s[40:41]
v_cvt_pk_bf16_f32 v104, v80, v81
v_cvt_pk_bf16_f32 v105, v82, v83
v_cvt_pk_bf16_f32 v106, v84, v85
v_cvt_pk_bf16_f32 v107, v86, v87
v_cvt_pk_bf16_f32 v108, v88, v89
v_cvt_pk_bf16_f32 v109, v90, v91
v_cvt_pk_bf16_f32 v110, v92, v93
v_cvt_pk_bf16_f32 v111, v94, v95
v_cvt_pk_bf16_f32 v112, v96, v97
v_cvt_pk_bf16_f32 v113, v98, v99
v_cvt_pk_bf16_f32 v114, v100, v101
v_cvt_pk_bf16_f32 v115, v102, v103
buffer_store_dwordx4 v[104:107], v32, s[84:87], s80 offen sc1
buffer_store_dwordx4 v[108:111], v32, s[84:87], s82 offen sc1
buffer_store_dwordx4 v[112:115], v33, s[84:87], s80 offen sc1
s_lshr_b32 s95, s2, 3
s_lshl_b32 s95, s95, 7
s_waitcnt vmcnt(0)
s_barrier
s_cmp_lg_u32 s28, 0
s_cbranch_scc1 L_nosig3
s_mov_b64 exec, 1
buffer_atomic_add v31, off, s[68:71], s95 sc1
s_mov_b64 exec, -1
L_nosig3:
s_mov_b32 s38, 1572864
s_mov_b32 s39, 1966080
s_mov_b32 s37, 4096
s_add_u32 m0, s29, 49152
s_nop 0
buffer_load_dwordx4 v10, s[12:15], s38 offen offset:0 lds
s_add_u32 m0, s29, 50048
s_nop 0
buffer_load_dwordx4 v10, s[12:15], s38 offen offset:128 lds
s_add_u32 m0, s29, 50944
s_nop 0
buffer_load_dwordx4 v10, s[12:15], s38 offen offset:256 lds
s_add_u32 m0, s29, 61440
s_nop 0
buffer_load_dwordx4 v10, s[12:15], s39 offen offset:0 lds
s_add_u32 m0, s29, 62336
s_nop 0
buffer_load_dwordx4 v10, s[12:15], s39 offen offset:128 lds
s_add_u32 m0, s29, 63232
s_nop 0
buffer_load_dwordx4 v10, s[12:15], s39 offen offset:256 lds
s_load_dwordx8 s[92:99], s[0:1], 48
s_lshl_b32 s48, s2, 2
s_add_u32 s48, s48, s28
v_lshrrev_b32 v34, 3, v0
v_and_b32 v35, 7, v0
v_lshlrev_b32 v35, 4, v35
v_lshrrev_b32 v36, 2, v0
v_lshlrev_b32 v36, 7, v36
v_and_b32 v37, 3, v0
v_lshl_add_u32 v36, v37, 3, v36
s_lshl_b32 s82, s28, 12
s_add_u32 s82, s82, 147456
v_add_u32 v30, s82, v36
s_add_u32 s60, s4, 27262976
s_addc_u32 s61, s5, 0
s_mov_b32 s62, 5570560
s_mov_b32 s63, 0x20000
s_waitcnt lgkmcnt(0)
s_mov_b32 s52, s92
s_mov_b32 s53, s93
s_mov_b32 s49, s48
s_mov_b32 s91, 0
s_sub_u32 s6, s48, 200
s_cmp_ge_u32 s48, 200
s_cselect_b32 s52, s94, s52
s_cselect_b32 s53, s95, s53
s_cselect_b32 s49, s6, s49
s_cselect_b32 s91, 819200, s91
s_sub_u32 s6, s48, 400
s_cmp_ge_u32 s48, 400
s_cselect_b32 s52, s96, s52
s_cselect_b32 s53, s97, s53
s_cselect_b32 s49, s6, s49
s_cselect_b32 s91, 1638400, s91
s_cselect_b32 s90, 6, 5
s_movk_i32 s89, 20
s_sub_u32 s6, s48, 880
s_cmp_ge_u32 s48, 880
s_cselect_b32 s52, s98, s52
s_cselect_b32 s53, s99, s53
s_cselect_b32 s49, s6, s49
s_cselect_b32 s91, 3604480, s91
s_cselect_b32 s90, 5, s90
s_cselect_b32 s89, 48, s89
s_cmp_eq_u32 s90, 6
s_movk_i32 s88, 1280
s_cselect_b32 s88, 3072, s88
s_movk_i32 s6, 6554
s_cselect_b32 s6, 2731, s6
s_cselect_b32 s7, 24, 10
s_mul_i32 s50, s49, s6
s_lshr_b32 s50, s50, 16
s_mul_i32 s7, s7, s50
s_sub_u32 s51, s49, s7
s_mul_i32 s54, s88, s89
s_lshl_b32 s54, s54, 5
s_cmp_lt_u32 s48, 1360
s_cselect_b32 s54, s54, 0
s_cselect_b32 s91, s91, 0x40000000
s_mov_b32 s55, 0x20000
v_mul_lo_u32 v28, v34, s88
v_add_u32 v28, v28, v35
s_mul_i32 s6, s50, s88
s_lshl_b32 s6, s6, 5
s_lshl_b32 s7, s51, 7
s_add_u32 s64, s6, s7
s_lshl_b32 s66, s88, 3
s_lshl_b32 s51, s51, 2
s_cmp_eq_u32 s90, 6
s_movk_i32 s6, 13108
s_cselect_b32 s6, 10923, s6
s_cselect_b32 s3, 0, 1
s_mul_i32 s6, s6, s51
s_lshr_b32 s6, s6, 16
s_mul_i32 s7, s6, s90
s_sub_u32 s7, s51, s7
s_and_b32 s3, s3, s6
s_sub_u32 s7, s7, s3
s_add_u32 s3, s7, 5
s_min_u32 s7, s7, s3
s_mul_i32 s6, s6, s89
s_add_u32 s6, s6, s50
s_mul_i32 s6, s6, s90
s_add_u32 s6, s6, s7
s_lshl_b32 s6, s6, 10
s_add_u32 s72, s6, s91
s_add_u32 s51, s51, 1
s_cmp_eq_u32 s90, 6
s_movk_i32 s6, 13108
s_cselect_b32 s6, 10923, s6
s_cselect_b32 s3, 0, 1
s_mul_i32 s6, s6, s51
s_lshr_b32 s6, s6, 16
s_mul_i32 s7, s6, s90
s_sub_u32 s7, s51, s7
s_and_b32 s3, s3, s6
s_sub_u32 s7, s7, s3
s_add_u32 s3, s7, 5
s_min_u32 s7, s7, s3
s_mul_i32 s6, s6, s89
s_add_u32 s6, s6, s50
s_mul_i32 s6, s6, s90
s_add_u32 s6, s6, s7
s_lshl_b32 s6, s6, 10
s_add_u32 s73, s6, s91
s_add_u32 s51, s51, 1
s_cmp_eq_u32 s90, 6
s_movk_i32 s6, 13108
s_cselect_b32 s6, 10923, s6
s_cselect_b32 s3, 0, 1
s_mul_i32 s6, s6, s51
s_lshr_b32 s6, s6, 16
s_mul_i32 s7, s6, s90
s_sub_u32 s7, s51, s7
s_and_b32 s3, s3, s6
s_sub_u32 s7, s7, s3
s_add_u32 s3, s7, 5
s_min_u32 s7, s7, s3
s_mul_i32 s6, s6, s89
s_add_u32 s6, s6, s50
s_mul_i32 s6, s6, s90
s_add_u32 s6, s6, s7
s_lshl_b32 s6, s6, 10
s_add_u32 s74, s6, s91
s_add_u32 s51, s51, 1
s_cmp_eq_u32 s90, 6
s_movk_i32 s6, 13108
s_cselect_b32 s6, 10923, s6
s_cselect_b32 s3, 0, 1
s_mul_i32 s6, s6, s51
s_lshr_b32 s6, s6, 16
s_mul_i32 s7, s6, s90
s_sub_u32 s7, s51, s7
s_and_b32 s3, s3, s6
s_sub_u32 s7, s7, s3
s_add_u32 s3, s7, 5
s_min_u32 s7, s7, s3
s_mul_i32 s6, s6, s89
s_add_u32 s6, s6, s50
s_mul_i32 s6, s6, s90
s_add_u32 s6, s6, s7
s_lshl_b32 s6, s6, 10
s_add_u32 s75, s6, s91
s_add_u32 s51, s51, 1
s_add_u32 s48, s48, 1024
s_mov_b32 s56, s92
s_mov_b32 s57, s93
s_mov_b32 s49, s48
s_mov_b32 s91, 0
s_sub_u32 s6, s48, 200
s_cmp_ge_u32 s48, 200
s_cselect_b32 s56, s94, s56
s_cselect_b32 s57, s95, s57
s_cselect_b32 s49, s6, s49
s_cselect_b32 s91, 819200, s91
s_sub_u32 s6, s48, 400
s_cmp_ge_u32 s48, 400
s_cselect_b32 s56, s96, s56
s_cselect_b32 s57, s97, s57
s_cselect_b32 s49, s6, s49
s_cselect_b32 s91, 1638400, s91
s_cselect_b32 s90, 6, 5
s_movk_i32 s89, 20
s_sub_u32 s6, s48, 880
s_cmp_ge_u32 s48, 880
s_cselect_b32 s56, s98, s56
s_cselect_b32 s57, s99, s57
s_cselect_b32 s49, s6, s49
s_cselect_b32 s91, 3604480, s91
s_cselect_b32 s90, 5, s90
s_cselect_b32 s89, 48, s89
s_cmp_eq_u32 s90, 6
s_movk_i32 s88, 1280
s_cselect_b32 s88, 3072, s88
s_movk_i32 s6, 6554
s_cselect_b32 s6, 2731, s6
s_cselect_b32 s7, 24, 10
s_mul_i32 s50, s49, s6
s_lshr_b32 s50, s50, 16
s_mul_i32 s7, s7, s50
s_sub_u32 s51, s49, s7
s_mul_i32 s58, s88, s89
s_lshl_b32 s58, s58, 5
s_cmp_lt_u32 s48, 1360
s_cselect_b32 s58, s58, 0
s_cselect_b32 s91, s91, 0x40000000
s_mov_b32 s59, 0x20000
v_mul_lo_u32 v29, v34, s88
v_add_u32 v29, v29, v35
s_mul_i32 s6, s50, s88
s_lshl_b32 s6, s6, 5
s_lshl_b32 s7, s51, 7
s_add_u32 s65, s6, s7
s_lshl_b32 s67, s88, 3
s_lshl_b32 s51, s51, 2
s_cmp_eq_u32 s90, 6
s_movk_i32 s6, 13108
s_cselect_b32 s6, 10923, s6
s_cselect_b32 s3, 0, 1
s_mul_i32 s6, s6, s51
s_lshr_b32 s6, s6, 16
s_mul_i32 s7, s6, s90
s_sub_u32 s7, s51, s7
s_and_b32 s3, s3, s6
s_sub_u32 s7, s7, s3
s_add_u32 s3, s7, 5
s_min_u32 s7, s7, s3
s_mul_i32 s6, s6, s89
s_add_u32 s6, s6, s50
s_mul_i32 s6, s6, s90
s_add_u32 s6, s6, s7
s_lshl_b32 s6, s6, 10
s_add_u32 s76, s6, s91
s_add_u32 s51, s51, 1
s_cmp_eq_u32 s90, 6
s_movk_i32 s6, 13108
s_cselect_b32 s6, 10923, s6
s_cselect_b32 s3, 0, 1
s_mul_i32 s6, s6, s51
s_lshr_b32 s6, s6, 16
s_mul_i32 s7, s6, s90
s_sub_u32 s7, s51, s7
s_and_b32 s3, s3, s6
s_sub_u32 s7, s7, s3
s_add_u32 s3, s7, 5
s_min_u32 s7, s7, s3
s_mul_i32 s6, s6, s89
s_add_u32 s6, s6, s50
s_mul_i32 s6, s6, s90
s_add_u32 s6, s6, s7
s_lshl_b32 s6, s6, 10
s_add_u32 s77, s6, s91
s_add_u32 s51, s51, 1
s_cmp_eq_u32 s90, 6
s_movk_i32 s6, 13108
s_cselect_b32 s6, 10923, s6
s_cselect_b32 s3, 0, 1
s_mul_i32 s6, s6, s51
s_lshr_b32 s6, s6, 16
s_mul_i32 s7, s6, s90
s_sub_u32 s7, s51, s7
s_and_b32 s3, s3, s6
s_sub_u32 s7, s7, s3
s_add_u32 s3, s7, 5
s_min_u32 s7, s7, s3
s_mul_i32 s6, s6, s89
s_add_u32 s6, s6, s50
s_mul_i32 s6, s6, s90
s_add_u32 s6, s6, s7
s_lshl_b32 s6, s6, 10
s_add_u32 s78, s6, s91
s_add_u32 s51, s51, 1
s_cmp_eq_u32 s90, 6
s_movk_i32 s6, 13108
s_cselect_b32 s6, 10923, s6
s_cselect_b32 s3, 0, 1
s_mul_i32 s6, s6, s51
s_lshr_b32 s6, s6, 16
s_mul_i32 s7, s6, s90
s_sub_u32 s7, s51, s7
s_and_b32 s3, s3, s6
s_sub_u32 s7, s7, s3
s_add_u32 s3, s7, 5
s_min_u32 s7, s7, s3
s_mul_i32 s6, s6, s89
s_add_u32 s6, s6, s50
s_mul_i32 s6, s6, s90
s_add_u32 s6, s6, s7
s_lshl_b32 s6, s6, 10
s_add_u32 s79, s6, s91
s_add_u32 s51, s51, 1
s_add_u32 s48, s48, 1024
s_lshl_b32 s95, s47, 2
s_add_u32 s95, s95, s28
s_lshl_b32 s95, s95, 7
buffer_load_dword v19, off, s[68:71], s95 sc1
s_mov_b32 s101, 0x200000
s_waitcnt vmcnt(0)
L_poll4:
v_cmp_gt_u32 vcc, 8, v19
s_cbranch_vccz L_go4
s_sub_u32 s101, s101, 1
s_cmp_eq_u32 s101, 0
s_cbranch_scc1 L_go4
buffer_load_dword v19, off, s[68:71], s95 sc1
s_waitcnt vmcnt(0)
s_branch L_poll4
L_go4:
s_mov_b32 s38, 0
s_mov_b32 s39, 393216
s_mov_b32 s37, 0
buffer_load_dwordx4 a[0:3], v24, s[8:11], s37 offen offset:0 sc1
buffer_load_dwordx4 a[4:7], v24, s[8:11], s37 offen offset:1024 sc1
buffer_load_dwordx4 a[8:11], v25, s[8:11], s37 offen offset:0 sc1
buffer_load_dwordx4 a[12:15], v25, s[8:11], s37 offen offset:1024 sc1
buffer_load_dwordx4 a[16:19], v26, s[8:11], s37 offen offset:0 sc1
buffer_load_dwordx4 a[20:23], v26, s[8:11], s37 offen offset:1024 sc1
buffer_load_dwordx4 a[24:27], v27, s[8:11], s37 offen offset:0 sc1
buffer_load_dwordx4 a[28:31], v27, s[8:11], s37 offen offset:1024 sc1
s_barrier
ds_read_b64_tr_b16 v[32:33], v22 offset:0
ds_read_b64_tr_b16 v[34:35], v22 offset:6144
ds_read_b64_tr_b16 v[36:37], v22 offset:12288
ds_read_b64_tr_b16 v[38:39], v22 offset:18432
s_waitcnt vmcnt(0) lgkmcnt(0)
v_mfma_f32_16x16x32_bf16 v[64:67], v[32:35], a[0:3], 0
s_mov_b32 s37, 2048
ds_read_b64_tr_b16 v[40:41], v22 offset:8
v_mfma_f32_16x16x32_bf16 v[64:67], v[36:39], a[4:7], v[64:67]
buffer_load_dwordx4 a[32:35], v24, s[8:11], s37 offen offset:0 sc1
v_mfma_f32_16x16x32_bf16 v[68:71], v[32:35], a[8:11], 0
ds_read_b64_tr_b16 v[42:43], v22 offset:6152
v_mfma_f32_16x16x32_bf16 v[68:71], v[36:39], a[12:15], v[68:71]
ds_read_b64_tr_b16 v[44:45], v22 offset:12296
v_mfma_f32_16x16x32_bf16 v[72:75], v[32:35], a[16:19], 0
ds_read_b64_tr_b16 v[46:47], v22 offset:18440
v_mfma_f32_16x16x32_bf16 v[72:75], v[36:39], a[20:23], v[72:75]
v_mfma_f32_16x16x32_bf16 v[76:79], v[32:35], a[24:27], 0
buffer_load_dwordx4 a[36:39], v24, s[8:11], s37 offen offset:1024 sc1
v_mfma_f32_16x16x32_bf16 v[76:79], v[36:39], a[28:31], v[76:79]
s_waitcnt lgkmcnt(0)
ds_read_b64_tr_b16 v[32:33], v23 offset:0
v_mfma_f32_16x16x32_bf16 v[80:83], v[40:43], a[0:3], 0
ds_read_b64_tr_b16 v[34:35], v23 offset:6144
v_mfma_f32_16x16x32_bf16 v[80:83], v[44:47], a[4:7], v[80:83]
ds_read_b64_tr_b16 v[36:37], v23 offset:12288
v_mfma_f32_16x16x32_bf16 v[84:87], v[40:43], a[8:11], 0
ds_read_b64_tr_b16 v[38:39], v23 offset:18432
v_mfma_f32_16x16x32_bf16 v[84:87], v[44:47], a[12:15], v[84:87]
v_mfma_f32_16x16x32_bf16 v[88:91], v[40:43], a[16:19], 0
buffer_load_dwordx4 a[40:43], v25, s[8:11], s37 offen offset:0 sc1
v_mfma_f32_16x16x32_bf16 v[88:91], v[44:47], a[20:23], v[88:91]
v_mfma_f32_16x16x32_bf16 v[92:95], v[40:43], a[24:27], 0
v_mfma_f32_16x16x32_bf16 v[92:95], v[44:47], a[28:31], v[92:95]
s_waitcnt lgkmcnt(0)
ds_read_b64_tr_b16 v[40:41], v23 offset:8
v_mfma_f32_16x16x32_bf16 v[96:99], v[32:35], a[0:3], 0
ds_read_b64_tr_b16 v[42:43], v23 offset:6152
v_mfma_f32_16x16x32_bf16 v[96:99], v[36:39], a[4:7], v[96:99]
buffer_load_dwordx4 a[44:47], v25, s[8:11], s37 offen offset:1024 sc1
v_mfma_f32_16x16x32_bf16 v[100:103], v[32:35], a[8:11], 0
ds_read_b64_tr_b16 v[44:45], v23 offset:12296
v_mfma_f32_16x16x32_bf16 v[100:103], v[36:39], a[12:15], v[100:103]
ds_read_b64_tr_b16 v[46:47], v23 offset:18440
v_mfma_f32_16x16x32_bf16 v[104:107], v[32:35], a[16:19], 0
v_mfma_f32_16x16x32_bf16 v[104:107], v[36:39], a[20:23], v[104:107]
v_mfma_f32_16x16x32_bf16 v[108:111], v[32:35], a[24:27], 0
v_mfma_f32_16x16x32_bf16 v[108:111], v[36:39], a[28:31], v[108:111]
s_waitcnt lgkmcnt(0)
ds_read_b64_tr_b16 v[32:33], v22 offset:1024
v_mfma_f32_16x16x32_bf16 v[112:115], v[40:43], a[0:3], 0
buffer_load_dwordx4 a[48:51], v26, s[8:11], s37 offen offset:0 sc1
v_mfma_f32_16x16x32_bf16 v[112:115], v[44:47], a[4:7], v[112:115]
ds_read_b64_tr_b16 v[34:35], v22 offset:7168
v_mfma_f32_16x16x32_bf16 v[116:119], v[40:43], a[8:11], 0
ds_read_b64_tr_b16 v[36:37], v22 offset:13312
v_mfma_f32_16x16x32_bf16 v[116:119], v[44:47], a[12:15], v[116:119]
ds_read_b64_tr_b16 v[38:39], v22 offset:19456
v_mfma_f32_16x16x32_bf16 v[120:123], v[40:43], a[16:19], 0
buffer_load_dwordx4 a[52:55], v26, s[8:11], s37 offen offset:1024 sc1
v_mfma_f32_16x16x32_bf16 v[120:123], v[44:47], a[20:23], v[120:123]
v_mfma_f32_16x16x32_bf16 v[124:127], v[40:43], a[24:27], 0
v_mfma_f32_16x16x32_bf16 v[124:127], v[44:47], a[28:31], v[124:127]
s_waitcnt lgkmcnt(0)
ds_read_b64_tr_b16 v[40:41], v22 offset:1032
v_mfma_f32_16x16x32_bf16 v[128:131], v[32:35], a[0:3], 0
ds_read_b64_tr_b16 v[42:43], v22 offset:7176
v_mfma_f32_16x16x32_bf16 v[128:131], v[36:39], a[4:7], v[128:131]
ds_read_b64_tr_b16 v[44:45], v22 offset:13320
v_mfma_f32_16x16x32_bf16 v[132:135], v[32:35], a[8:11], 0
buffer_load_dwordx4 a[56:59], v27, s[8:11], s37 offen offset:0 sc1
v_mfma_f32_16x16x32_bf16 v[132:135], v[36:39], a[12:15], v[132:135]
ds_read_b64_tr_b16 v[46:47], v22 offset:19464
v_mfma_f32_16x16x32_bf16 v[136:139], v[32:35], a[16:19], 0
v_mfma_f32_16x16x32_bf16 v[136:139], v[36:39], a[20:23], v[136:139]
v_mfma_f32_16x16x32_bf16 v[140:143], v[32:35], a[24:27], 0
v_mfma_f32_16x16x32_bf16 v[140:143], v[36:39], a[28:31], v[140:143]
s_waitcnt lgkmcnt(0)
ds_read_b64_tr_b16 v[32:33], v23 offset:1024
v_mfma_f32_16x16x32_bf16 v[144:147], v[40:43], a[0:3], 0
buffer_load_dwordx4 a[60:63], v27, s[8:11], s37 offen offset:1024 sc1
v_mfma_f32_16x16x32_bf16 v[144:147], v[44:47], a[4:7], v[144:147]
ds_read_b64_tr_b16 v[34:35], v23 offset:7168
v_mfma_f32_16x16x32_bf16 v[148:151], v[40:43], a[8:11], 0
ds_read_b64_tr_b16 v[36:37], v23 offset:13312
v_mfma_f32_16x16x32_bf16 v[148:151], v[44:47], a[12:15], v[148:151]
ds_read_b64_tr_b16 v[38:39], v23 offset:19456
v_mfma_f32_16x16x32_bf16 v[152:155], v[40:43], a[16:19], 0
s_mov_b32 s37, 4096
v_mfma_f32_16x16x32_bf16 v[152:155], v[44:47], a[20:23], v[152:155]
buffer_load_dwordx4 a[64:67], v24, s[8:11], s37 offen offset:0 sc1
v_mfma_f32_16x16x32_bf16 v[156:159], v[40:43], a[24:27], 0
v_mfma_f32_16x16x32_bf16 v[156:159], v[44:47], a[28:31], v[156:159]
s_waitcnt lgkmcnt(0)
ds_read_b64_tr_b16 v[40:41], v23 offset:1032
v_mfma_f32_16x16x32_bf16 v[160:163], v[32:35], a[0:3], 0
ds_read_b64_tr_b16 v[42:43], v23 offset:7176
v_mfma_f32_16x16x32_bf16 v[160:163], v[36:39], a[4:7], v[160:163]
ds_read_b64_tr_b16 v[44:45], v23 offset:13320
v_mfma_f32_16x16x32_bf16 v[164:167], v[32:35], a[8:11], 0
buffer_load_dwordx4 a[68:71], v24, s[8:11], s37 offen offset:1024 sc1
v_mfma_f32_16x16x32_bf16 v[164:167], v[36:39], a[12:15], v[164:167]
ds_read_b64_tr_b16 v[46:47], v23 offset:19464
v_mfma_f32_16x16x32_bf16 v[168:171], v[32:35], a[16:19], 0
v_mfma_f32_16x16x32_bf16 v[168:171], v[36:39], a[20:23], v[168:171]
v_mfma_f32_16x16x32_bf16 v[172:175], v[32:35], a[24:27], 0
v_mfma_f32_16x16x32_bf16 v[172:175], v[36:39], a[28:31], v[172:175]
s_waitcnt lgkmcnt(0)
ds_read_b64_tr_b16 v[32:33], v22 offset:2048
v_mfma_f32_16x16x32_bf16 v[176:179], v[40:43], a[0:3], 0
buffer_load_dwordx4 a[72:75], v25, s[8:11], s37 offen offset:0 sc1
v_mfma_f32_16x16x32_bf16 v[176:179], v[44:47], a[4:7], v[176:179]
ds_read_b64_tr_b16 v[34:35], v22 offset:8192
v_mfma_f32_16x16x32_bf16 v[180:183], v[40:43], a[8:11], 0
ds_read_b64_tr_b16 v[36:37], v22 offset:14336
v_mfma_f32_16x16x32_bf16 v[180:183], v[44:47], a[12:15], v[180:183]
ds_read_b64_tr_b16 v[38:39], v22 offset:20480
v_mfma_f32_16x16x32_bf16 v[184:187], v[40:43], a[16:19], 0
v_mfma_f32_16x16x32_bf16 v[184:187], v[44:47], a[20:23], v[184:187]
buffer_load_dwordx4 a[76:79], v25, s[8:11], s37 offen offset:1024 sc1
v_mfma_f32_16x16x32_bf16 v[188:191], v[40:43], a[24:27], 0
v_mfma_f32_16x16x32_bf16 v[188:191], v[44:47], a[28:31], v[188:191]
s_waitcnt lgkmcnt(0)
ds_read_b64_tr_b16 v[40:41], v22 offset:2056
v_mfma_f32_16x16x32_bf16 v[192:195], v[32:35], a[0:3], 0
ds_read_b64_tr_b16 v[42:43], v22 offset:8200
v_mfma_f32_16x16x32_bf16 v[192:195], v[36:39], a[4:7], v[192:195]
ds_read_b64_tr_b16 v[44:45], v22 offset:14344
v_mfma_f32_16x16x32_bf16 v[196:199], v[32:35], a[8:11], 0
ds_read_b64_tr_b16 v[46:47], v22 offset:20488
v_mfma_f32_16x16x32_bf16 v[196:199], v[36:39], a[12:15], v[196:199]
buffer_load_dwordx4 a[80:83], v26, s[8:11], s37 offen offset:0 sc1
v_mfma_f32_16x16x32_bf16 v[200:203], v[32:35], a[16:19], 0
v_mfma_f32_16x16x32_bf16 v[200:203], v[36:39], a[20:23], v[200:203]
v_mfma_f32_16x16x32_bf16 v[204:207], v[32:35], a[24:27], 0
v_mfma_f32_16x16x32_bf16 v[204:207], v[36:39], a[28:31], v[204:207]
s_waitcnt lgkmcnt(0)
ds_read_b64_tr_b16 v[32:33], v23 offset:2048
v_mfma_f32_16x16x32_bf16 v[208:211], v[40:43], a[0:3], 0
buffer_load_dwordx4 a[84:87], v26, s[8:11], s37 offen offset:1024 sc1
v_mfma_f32_16x16x32_bf16 v[208:211], v[44:47], a[4:7], v[208:211]
ds_read_b64_tr_b16 v[34:35], v23 offset:8192
v_mfma_f32_16x16x32_bf16 v[212:215], v[40:43], a[8:11], 0
ds_read_b64_tr_b16 v[36:37], v23 offset:14336
v_mfma_f32_16x16x32_bf16 v[212:215], v[44:47], a[12:15], v[212:215]
ds_read_b64_tr_b16 v[38:39], v23 offset:20480
v_mfma_f32_16x16x32_bf16 v[216:219], v[40:43], a[16:19], 0
v_mfma_f32_16x16x32_bf16 v[216:219], v[44:47], a[20:23], v[216:219]
v_mfma_f32_16x16x32_bf16 v[220:223], v[40:43], a[24:27], 0
buffer_load_dwordx4 a[88:91], v27, s[8:11], s37 offen offset:0 sc1
v_mfma_f32_16x16x32_bf16 v[220:223], v[44:47], a[28:31], v[220:223]
s_waitcnt lgkmcnt(0)
ds_read_b64_tr_b16 v[40:41], v23 offset:2056
v_mfma_f32_16x16x32_bf16 v[224:227], v[32:35], a[0:3], 0
ds_read_b64_tr_b16 v[42:43], v23 offset:8200
v_mfma_f32_16x16x32_bf16 v[224:227], v[36:39], a[4:7], v[224:227]
ds_read_b64_tr_b16 v[44:45], v23 offset:14344
v_mfma_f32_16x16x32_bf16 v[228:231], v[32:35], a[8:11], 0
ds_read_b64_tr_b16 v[46:47], v23 offset:20488
v_mfma_f32_16x16x32_bf16 v[228:231], v[36:39], a[12:15], v[228:231]
buffer_load_dwordx4 a[92:95], v27, s[8:11], s37 offen offset:1024 sc1
v_mfma_f32_16x16x32_bf16 v[232:235], v[32:35], a[16:19], 0
v_mfma_f32_16x16x32_bf16 v[232:235], v[36:39], a[20:23], v[232:235]
v_mfma_f32_16x16x32_bf16 v[236:239], v[32:35], a[24:27], 0
v_mfma_f32_16x16x32_bf16 v[236:239], v[36:39], a[28:31], v[236:239]
s_waitcnt lgkmcnt(0)
ds_read_b64_tr_b16 v[32:33], v22 offset:24576
v_mfma_f32_16x16x32_bf16 v[240:243], v[40:43], a[0:3], 0
ds_read_b64_tr_b16 v[34:35], v22 offset:30720
v_mfma_f32_16x16x32_bf16 v[240:243], v[44:47], a[4:7], v[240:243]
ds_read_b64_tr_b16 v[36:37], v22 offset:36864
v_mfma_f32_16x16x32_bf16 v[244:247], v[40:43], a[8:11], 0
ds_read_b64_tr_b16 v[38:39], v22 offset:43008
v_mfma_f32_16x16x32_bf16 v[244:247], v[44:47], a[12:15], v[244:247]
v_mfma_f32_16x16x32_bf16 v[248:251], v[40:43], a[16:19], 0
v_mfma_f32_16x16x32_bf16 v[248:251], v[44:47], a[20:23], v[248:251]
v_mfma_f32_16x16x32_bf16 v[252:255], v[40:43], a[24:27], 0
v_mfma_f32_16x16x32_bf16 v[252:255], v[44:47], a[28:31], v[252:255]
s_waitcnt vmcnt(8) lgkmcnt(0)
v_mfma_f32_16x16x32_bf16 v[64:67], v[32:35], a[32:35], v[64:67]
s_mov_b32 s37, 6144
ds_read_b64_tr_b16 v[40:41], v22 offset:24584
v_mfma_f32_16x16x32_bf16 v[64:67], v[36:39], a[36:39], v[64:67]
buffer_load_dwordx4 a[96:99], v24, s[8:11], s37 offen offset:0 sc1
v_mfma_f32_16x16x32_bf16 v[68:71], v[32:35], a[40:43], v[68:71]
ds_read_b64_tr_b16 v[42:43], v22 offset:30728
v_mfma_f32_16x16x32_bf16 v[68:71], v[36:39], a[44:47], v[68:71]
ds_read_b64_tr_b16 v[44:45], v22 offset:36872
v_mfma_f32_16x16x32_bf16 v[72:75], v[32:35], a[48:51], v[72:75]
ds_read_b64_tr_b16 v[46:47], v22 offset:43016
v_mfma_f32_16x16x32_bf16 v[72:75], v[36:39], a[52:55], v[72:75]
buffer_load_dwordx4 a[100:103], v24, s[8:11], s37 offen offset:1024 sc1
v_mfma_f32_16x16x32_bf16 v[76:79], v[32:35], a[56:59], v[76:79]
v_mfma_f32_16x16x32_bf16 v[76:79], v[36:39], a[60:63], v[76:79]
s_waitcnt lgkmcnt(0)
ds_read_b64_tr_b16 v[32:33], v23 offset:24576
v_mfma_f32_16x16x32_bf16 v[80:83], v[40:43], a[32:35], v[80:83]
ds_read_b64_tr_b16 v[34:35], v23 offset:30720
v_mfma_f32_16x16x32_bf16 v[80:83], v[44:47], a[36:39], v[80:83]
buffer_load_dwordx4 a[104:107], v25, s[8:11], s37 offen offset:0 sc1
v_mfma_f32_16x16x32_bf16 v[84:87], v[40:43], a[40:43], v[84:87]
ds_read_b64_tr_b16 v[36:37], v23 offset:36864
v_mfma_f32_16x16x32_bf16 v[84:87], v[44:47], a[44:47], v[84:87]
ds_read_b64_tr_b16 v[38:39], v23 offset:43008
v_mfma_f32_16x16x32_bf16 v[88:91], v[40:43], a[48:51], v[88:91]
v_mfma_f32_16x16x32_bf16 v[88:91], v[44:47], a[52:55], v[88:91]
buffer_load_dwordx4 a[108:111], v25, s[8:11], s37 offen offset:1024 sc1
v_mfma_f32_16x16x32_bf16 v[92:95], v[40:43], a[56:59], v[92:95]
v_mfma_f32_16x16x32_bf16 v[92:95], v[44:47], a[60:63], v[92:95]
s_waitcnt lgkmcnt(0)
ds_read_b64_tr_b16 v[40:41], v23 offset:24584
v_mfma_f32_16x16x32_bf16 v[96:99], v[32:35], a[32:35], v[96:99]
ds_read_b64_tr_b16 v[42:43], v23 offset:30728
v_mfma_f32_16x16x32_bf16 v[96:99], v[36:39], a[36:39], v[96:99]
buffer_load_dwordx4 a[112:115], v26, s[8:11], s37 offen offset:0 sc1
v_mfma_f32_16x16x32_bf16 v[100:103], v[32:35], a[40:43], v[100:103]
ds_read_b64_tr_b16 v[44:45], v23 offset:36872
v_mfma_f32_16x16x32_bf16 v[100:103], v[36:39], a[44:47], v[100:103]
ds_read_b64_tr_b16 v[46:47], v23 offset:43016
v_mfma_f32_16x16x32_bf16 v[104:107], v[32:35], a[48:51], v[104:107]
v_mfma_f32_16x16x32_bf16 v[104:107], v[36:39], a[52:55], v[104:107]
buffer_load_dwordx4 a[116:119], v26, s[8:11], s37 offen offset:1024 sc1
v_mfma_f32_16x16x32_bf16 v[108:111], v[32:35], a[56:59], v[108:111]
v_mfma_f32_16x16x32_bf16 v[108:111], v[36:39], a[60:63], v[108:111]
s_waitcnt lgkmcnt(0)
ds_read_b64_tr_b16 v[32:33], v22 offset:25600
v_mfma_f32_16x16x32_bf16 v[112:115], v[40:43], a[32:35], v[112:115]
ds_read_b64_tr_b16 v[34:35], v22 offset:31744
v_mfma_f32_16x16x32_bf16 v[112:115], v[44:47], a[36:39], v[112:115]
buffer_load_dwordx4 a[120:123], v27, s[8:11], s37 offen offset:0 sc1
v_mfma_f32_16x16x32_bf16 v[116:119], v[40:43], a[40:43], v[116:119]
ds_read_b64_tr_b16 v[36:37], v22 offset:37888
v_mfma_f32_16x16x32_bf16 v[116:119], v[44:47], a[44:47], v[116:119]
ds_read_b64_tr_b16 v[38:39], v22 offset:44032
v_mfma_f32_16x16x32_bf16 v[120:123], v[40:43], a[48:51], v[120:123]
v_mfma_f32_16x16x32_bf16 v[120:123], v[44:47], a[52:55], v[120:123]
buffer_load_dwordx4 a[124:127], v27, s[8:11], s37 offen offset:1024 sc1
v_mfma_f32_16x16x32_bf16 v[124:127], v[40:43], a[56:59], v[124:127]
v_mfma_f32_16x16x32_bf16 v[124:127], v[44:47], a[60:63], v[124:127]
s_waitcnt lgkmcnt(0)
ds_read_b64_tr_b16 v[40:41], v22 offset:25608
v_mfma_f32_16x16x32_bf16 v[128:131], v[32:35], a[32:35], v[128:131]
s_mov_b32 s38, 2359296
s_mov_b32 s39, 2752512
s_add_u32 m0, s29, 73728
v_mfma_f32_16x16x32_bf16 v[128:131], v[36:39], a[36:39], v[128:131]
ds_read_b64_tr_b16 v[42:43], v22 offset:31752
v_mfma_f32_16x16x32_bf16 v[132:135], v[32:35], a[40:43], v[132:135]
buffer_load_dwordx4 v10, s[12:15], s38 offen offset:0 nt lds
v_mfma_f32_16x16x32_bf16 v[132:135], v[36:39], a[44:47], v[132:135]
ds_read_b64_tr_b16 v[44:45], v22 offset:37896
v_mfma_f32_16x16x32_bf16 v[136:139], v[32:35], a[48:51], v[136:139]
s_add_u32 m0, s29, 74624
ds_read_b64_tr_b16 v[46:47], v22 offset:44040
v_mfma_f32_16x16x32_bf16 v[136:139], v[36:39], a[52:55], v[136:139]
v_mfma_f32_16x16x32_bf16 v[140:143], v[32:35], a[56:59], v[140:143]
buffer_load_dwordx4 v10, s[12:15], s38 offen offset:128 nt lds
v_mfma_f32_16x16x32_bf16 v[140:143], v[36:39], a[60:63], v[140:143]
s_waitcnt lgkmcnt(0)
ds_read_b64_tr_b16 v[32:33], v23 offset:25600
v_mfma_f32_16x16x32_bf16 v[144:147], v[40:43], a[32:35], v[144:147]
s_add_u32 m0, s29, 75520
ds_read_b64_tr_b16 v[34:35], v23 offset:31744
v_mfma_f32_16x16x32_bf16 v[144:147], v[44:47], a[36:39], v[144:147]
ds_read_b64_tr_b16 v[36:37], v23 offset:37888
v_mfma_f32_16x16x32_bf16 v[148:151], v[40:43], a[40:43], v[148:151]
buffer_load_dwordx4 v10, s[12:15], s38 offen offset:256 nt lds
v_mfma_f32_16x16x32_bf16 v[148:151], v[44:47], a[44:47], v[148:151]
ds_read_b64_tr_b16 v[38:39], v23 offset:44032
v_mfma_f32_16x16x32_bf16 v[152:155], v[40:43], a[48:51], v[152:155]
s_add_u32 m0, s29, 86016
v_mfma_f32_16x16x32_bf16 v[152:155], v[44:47], a[52:55], v[152:155]
v_mfma_f32_16x16x32_bf16 v[156:159], v[40:43], a[56:59], v[156:159]
buffer_load_dwordx4 v10, s[12:15], s39 offen offset:0 nt lds
v_mfma_f32_16x16x32_bf16 v[156:159], v[44:47], a[60:63], v[156:159]
s_waitcnt lgkmcnt(0)
ds_read_b64_tr_b16 v[40:41], v23 offset:25608
v_mfma_f32_16x16x32_bf16 v[160:163], v[32:35], a[32:35], v[160:163]
s_add_u32 m0, s29, 86912
ds_read_b64_tr_b16 v[42:43], v23 offset:31752
v_mfma_f32_16x16x32_bf16 v[160:163], v[36:39], a[36:39], v[160:163]
ds_read_b64_tr_b16 v[44:45], v23 offset:37896
v_mfma_f32_16x16x32_bf16 v[164:167], v[32:35], a[40:43], v[164:167]
buffer_load_dwordx4 v10, s[12:15], s39 offen offset:128 nt lds
v_mfma_f32_16x16x32_bf16 v[164:167], v[36:39], a[44:47], v[164:167]
ds_read_b64_tr_b16 v[46:47], v23 offset:44040
v_mfma_f32_16x16x32_bf16 v[168:171], v[32:35], a[48:51], v[168:171]
s_add_u32 m0, s29, 87808
v_mfma_f32_16x16x32_bf16 v[168:171], v[36:39], a[52:55], v[168:171]
v_mfma_f32_16x16x32_bf16 v[172:175], v[32:35], a[56:59], v[172:175]
buffer_load_dwordx4 v10, s[12:15], s39 offen offset:256 nt lds
v_mfma_f32_16x16x32_bf16 v[172:175], v[36:39], a[60:63], v[172:175]
s_waitcnt lgkmcnt(0)
ds_read_b64_tr_b16 v[32:33], v22 offset:26624
v_mfma_f32_16x16x32_bf16 v[176:179], v[40:43], a[32:35], v[176:179]
s_mov_b32 s37, 8192
ds_read_b64_tr_b16 v[34:35], v22 offset:32768
v_mfma_f32_16x16x32_bf16 v[176:179], v[44:47], a[36:39], v[176:179]
buffer_load_dwordx4 a[128:131], v24, s[8:11], s37 offen offset:0 sc1
v_mfma_f32_16x16x32_bf16 v[180:183], v[40:43], a[40:43], v[180:183]
ds_read_b64_tr_b16 v[36:37], v22 offset:38912
v_mfma_f32_16x16x32_bf16 v[180:183], v[44:47], a[44:47], v[180:183]
ds_read_b64_tr_b16 v[38:39], v22 offset:45056
v_mfma_f32_16x16x32_bf16 v[184:187], v[40:43], a[48:51], v[184:187]
v_mfma_f32_16x16x32_bf16 v[184:187], v[44:47], a[52:55], v[184:187]
buffer_load_dwordx4 a[132:135], v24, s[8:11], s37 offen offset:1024 sc1
v_mfma_f32_16x16x32_bf16 v[188:191], v[40:43], a[56:59], v[188:191]
v_mfma_f32_16x16x32_bf16 v[188:191], v[44:47], a[60:63], v[188:191]
s_waitcnt lgkmcnt(0)
ds_read_b64_tr_b16 v[40:41], v22 offset:26632
v_mfma_f32_16x16x32_bf16 v[192:195], v[32:35], a[32:35], v[192:195]
ds_read_b64_tr_b16 v[42:43], v22 offset:32776
v_mfma_f32_16x16x32_bf16 v[192:195], v[36:39], a[36:39], v[192:195]
buffer_load_dwordx4 a[136:139], v25, s[8:11], s37 offen offset:0 sc1
v_mfma_f32_16x16x32_bf16 v[196:199], v[32:35], a[40:43], v[196:199]
ds_read_b64_tr_b16 v[44:45], v22 offset:38920
v_mfma_f32_16x16x32_bf16 v[196:199], v[36:39], a[44:47], v[196:199]
ds_read_b64_tr_b16 v[46:47], v22 offset:45064
v_mfma_f32_16x16x32_bf16 v[200:203], v[32:35], a[48:51], v[200:203]
v_mfma_f32_16x16x32_bf16 v[200:203], v[36:39], a[52:55], v[200:203]
buffer_load_dwordx4 a[140:143], v25, s[8:11], s37 offen offset:1024 sc1
v_mfma_f32_16x16x32_bf16 v[204:207], v[32:35], a[56:59], v[204:207]
v_mfma_f32_16x16x32_bf16 v[204:207], v[36:39], a[60:63], v[204:207]
s_waitcnt lgkmcnt(0)
ds_read_b64_tr_b16 v[32:33], v23 offset:26624
v_mfma_f32_16x16x32_bf16 v[208:211], v[40:43], a[32:35], v[208:211]
ds_read_b64_tr_b16 v[34:35], v23 offset:32768
v_mfma_f32_16x16x32_bf16 v[208:211], v[44:47], a[36:39], v[208:211]
buffer_load_dwordx4 a[144:147], v26, s[8:11], s37 offen offset:0 sc1
v_mfma_f32_16x16x32_bf16 v[212:215], v[40:43], a[40:43], v[212:215]
ds_read_b64_tr_b16 v[36:37], v23 offset:38912
v_mfma_f32_16x16x32_bf16 v[212:215], v[44:47], a[44:47], v[212:215]
ds_read_b64_tr_b16 v[38:39], v23 offset:45056
v_mfma_f32_16x16x32_bf16 v[216:219], v[40:43], a[48:51], v[216:219]
v_mfma_f32_16x16x32_bf16 v[216:219], v[44:47], a[52:55], v[216:219]
buffer_load_dwordx4 a[148:151], v26, s[8:11], s37 offen offset:1024 sc1
v_mfma_f32_16x16x32_bf16 v[220:223], v[40:43], a[56:59], v[220:223]
v_mfma_f32_16x16x32_bf16 v[220:223], v[44:47], a[60:63], v[220:223]
s_waitcnt lgkmcnt(0)
ds_read_b64_tr_b16 v[40:41], v23 offset:26632
v_mfma_f32_16x16x32_bf16 v[224:227], v[32:35], a[32:35], v[224:227]
ds_read_b64_tr_b16 v[42:43], v23 offset:32776
v_mfma_f32_16x16x32_bf16 v[224:227], v[36:39], a[36:39], v[224:227]
buffer_load_dwordx4 a[152:155], v27, s[8:11], s37 offen offset:0 sc1
v_mfma_f32_16x16x32_bf16 v[228:231], v[32:35], a[40:43], v[228:231]
ds_read_b64_tr_b16 v[44:45], v23 offset:38920
v_mfma_f32_16x16x32_bf16 v[228:231], v[36:39], a[44:47], v[228:231]
ds_read_b64_tr_b16 v[46:47], v23 offset:45064
v_mfma_f32_16x16x32_bf16 v[232:235], v[32:35], a[48:51], v[232:235]
v_mfma_f32_16x16x32_bf16 v[232:235], v[36:39], a[52:55], v[232:235]
buffer_load_dwordx4 a[156:159], v27, s[8:11], s37 offen offset:1024 sc1
v_mfma_f32_16x16x32_bf16 v[236:239], v[32:35], a[56:59], v[236:239]
v_mfma_f32_16x16x32_bf16 v[236:239], v[36:39], a[60:63], v[236:239]
s_waitcnt lgkmcnt(0)
s_waitcnt vmcnt(8)
s_barrier
v_mfma_f32_16x16x32_bf16 v[240:243], v[40:43], a[32:35], v[240:243]
ds_read_b64_tr_b16 v[32:33], v20 offset:0
v_mfma_f32_16x16x32_bf16 v[240:243], v[44:47], a[36:39], v[240:243]
ds_read_b64_tr_b16 v[34:35], v20 offset:6144
v_mfma_f32_16x16x32_bf16 v[244:247], v[40:43], a[40:43], v[244:247]
ds_read_b64_tr_b16 v[36:37], v20 offset:12288
v_mfma_f32_16x16x32_bf16 v[244:247], v[44:47], a[44:47], v[244:247]
ds_read_b64_tr_b16 v[38:39], v20 offset:18432
v_mfma_f32_16x16x32_bf16 v[248:251], v[40:43], a[48:51], v[248:251]
v_mfma_f32_16x16x32_bf16 v[248:251], v[44:47], a[52:55], v[248:251]
v_mfma_f32_16x16x32_bf16 v[252:255], v[40:43], a[56:59], v[252:255]
v_mfma_f32_16x16x32_bf16 v[252:255], v[44:47], a[60:63], v[252:255]
s_waitcnt lgkmcnt(0)
v_mfma_f32_16x16x32_bf16 v[64:67], v[32:35], a[64:67], v[64:67]
s_mov_b32 s38, 3932160
s_mov_b32 s39, 4325376
s_mov_b32 s37, 10240
s_mov_b32 s38, 3145728
s_mov_b32 s39, 3538944
v_mfma_f32_16x16x32_bf16 v[64:67], v[36:39], a[68:71], v[64:67]
s_add_u32 m0, s29, 98304
ds_read_b64_tr_b16 v[40:41], v20 offset:8
v_mfma_f32_16x16x32_bf16 v[68:71], v[32:35], a[72:75], v[68:71]
ds_read_b64_tr_b16 v[42:43], v20 offset:6152
v_mfma_f32_16x16x32_bf16 v[68:71], v[36:39], a[76:79], v[68:71]
buffer_load_dwordx4 v10, s[12:15], s38 offen offset:0 nt lds
v_mfma_f32_16x16x32_bf16 v[72:75], v[32:35], a[80:83], v[72:75]
ds_read_b64_tr_b16 v[44:45], v20 offset:12296
v_mfma_f32_16x16x32_bf16 v[72:75], v[36:39], a[84:87], v[72:75]
s_add_u32 m0, s29, 99200
ds_read_b64_tr_b16 v[46:47], v20 offset:18440
v_mfma_f32_16x16x32_bf16 v[76:79], v[32:35], a[88:91], v[76:79]
v_mfma_f32_16x16x32_bf16 v[76:79], v[36:39], a[92:95], v[76:79]
s_waitcnt lgkmcnt(0)
ds_read_b64_tr_b16 v[32:33], v21 offset:0
v_mfma_f32_16x16x32_bf16 v[80:83], v[40:43], a[64:67], v[80:83]
ds_read_b64_tr_b16 v[34:35], v21 offset:6144
v_mfma_f32_16x16x32_bf16 v[80:83], v[44:47], a[68:71], v[80:83]
buffer_load_dwordx4 v10, s[12:15], s38 offen offset:128 nt lds
v_mfma_f32_16x16x32_bf16 v[84:87], v[40:43], a[72:75], v[84:87]
ds_read_b64_tr_b16 v[36:37], v21 offset:12288
v_mfma_f32_16x16x32_bf16 v[84:87], v[44:47], a[76:79], v[84:87]
s_add_u32 m0, s29, 100096
ds_read_b64_tr_b16 v[38:39], v21 offset:18432
v_mfma_f32_16x16x32_bf16 v[88:91], v[40:43], a[80:83], v[88:91]
v_mfma_f32_16x16x32_bf16 v[88:91], v[44:47], a[84:87], v[88:91]
v_mfma_f32_16x16x32_bf16 v[92:95], v[40:43], a[88:91], v[92:95]
v_mfma_f32_16x16x32_bf16 v[92:95], v[44:47], a[92:95], v[92:95]
s_waitcnt lgkmcnt(0)
ds_read_b64_tr_b16 v[40:41], v21 offset:8
v_mfma_f32_16x16x32_bf16 v[96:99], v[32:35], a[64:67], v[96:99]
buffer_load_dwordx4 v10, s[12:15], s38 offen offset:256 nt lds
v_mfma_f32_16x16x32_bf16 v[96:99], v[36:39], a[68:71], v[96:99]
s_add_u32 m0, s29, 110592
ds_read_b64_tr_b16 v[42:43], v21 offset:6152
v_mfma_f32_16x16x32_bf16 v[100:103], v[32:35], a[72:75], v[100:103]
ds_read_b64_tr_b16 v[44:45], v21 offset:12296
v_mfma_f32_16x16x32_bf16 v[100:103], v[36:39], a[76:79], v[100:103]
ds_read_b64_tr_b16 v[46:47], v21 offset:18440
v_mfma_f32_16x16x32_bf16 v[104:107], v[32:35], a[80:83], v[104:107]
v_mfma_f32_16x16x32_bf16 v[104:107], v[36:39], a[84:87], v[104:107]
buffer_load_dwordx4 v10, s[12:15], s39 offen offset:0 nt lds
v_mfma_f32_16x16x32_bf16 v[108:111], v[32:35], a[88:91], v[108:111]
v_mfma_f32_16x16x32_bf16 v[108:111], v[36:39], a[92:95], v[108:111]
s_waitcnt lgkmcnt(0)
ds_read_b64_tr_b16 v[32:33], v20 offset:1024
v_mfma_f32_16x16x32_bf16 v[112:115], v[40:43], a[64:67], v[112:115]
s_add_u32 m0, s29, 111488
ds_read_b64_tr_b16 v[34:35], v20 offset:7168
v_mfma_f32_16x16x32_bf16 v[112:115], v[44:47], a[68:71], v[112:115]
ds_read_b64_tr_b16 v[36:37], v20 offset:13312
v_mfma_f32_16x16x32_bf16 v[116:119], v[40:43], a[72:75], v[116:119]
ds_read_b64_tr_b16 v[38:39], v20 offset:19456
v_mfma_f32_16x16x32_bf16 v[116:119], v[44:47], a[76:79], v[116:119]
buffer_load_dwordx4 v10, s[12:15], s39 offen offset:128 nt lds
v_mfma_f32_16x16x32_bf16 v[120:123], v[40:43], a[80:83], v[120:123]
v_mfma_f32_16x16x32_bf16 v[120:123], v[44:47], a[84:87], v[120:123]
s_add_u32 m0, s29, 112384
v_mfma_f32_16x16x32_bf16 v[124:127], v[40:43], a[88:91], v[124:127]
v_mfma_f32_16x16x32_bf16 v[124:127], v[44:47], a[92:95], v[124:127]
s_waitcnt lgkmcnt(0)
ds_read_b64_tr_b16 v[40:41], v20 offset:1032
v_mfma_f32_16x16x32_bf16 v[128:131], v[32:35], a[64:67], v[128:131]
ds_read_b64_tr_b16 v[42:43], v20 offset:7176
v_mfma_f32_16x16x32_bf16 v[128:131], v[36:39], a[68:71], v[128:131]
buffer_load_dwordx4 v10, s[12:15], s39 offen offset:256 nt lds
v_mfma_f32_16x16x32_bf16 v[132:135], v[32:35], a[72:75], v[132:135]
ds_read_b64_tr_b16 v[44:45], v20 offset:13320
v_mfma_f32_16x16x32_bf16 v[132:135], v[36:39], a[76:79], v[132:135]
ds_read_b64_tr_b16 v[46:47], v20 offset:19464
v_mfma_f32_16x16x32_bf16 v[136:139], v[32:35], a[80:83], v[136:139]
v_mfma_f32_16x16x32_bf16 v[136:139], v[36:39], a[84:87], v[136:139]
v_mfma_f32_16x16x32_bf16 v[140:143], v[32:35], a[88:91], v[140:143]
v_mfma_f32_16x16x32_bf16 v[140:143], v[36:39], a[92:95], v[140:143]
s_waitcnt lgkmcnt(0)
ds_read_b64_tr_b16 v[32:33], v21 offset:1024
v_mfma_f32_16x16x32_bf16 v[144:147], v[40:43], a[64:67], v[144:147]
buffer_load_dwordx4 a[160:163], v24, s[8:11], s37 offen offset:0 sc1
v_mfma_f32_16x16x32_bf16 v[144:147], v[44:47], a[68:71], v[144:147]
ds_read_b64_tr_b16 v[34:35], v21 offset:7168
v_mfma_f32_16x16x32_bf16 v[148:151], v[40:43], a[72:75], v[148:151]
ds_read_b64_tr_b16 v[36:37], v21 offset:13312
v_mfma_f32_16x16x32_bf16 v[148:151], v[44:47], a[76:79], v[148:151]
ds_read_b64_tr_b16 v[38:39], v21 offset:19456
v_mfma_f32_16x16x32_bf16 v[152:155], v[40:43], a[80:83], v[152:155]
v_mfma_f32_16x16x32_bf16 v[152:155], v[44:47], a[84:87], v[152:155]
buffer_load_dwordx4 a[164:167], v24, s[8:11], s37 offen offset:1024 sc1
v_mfma_f32_16x16x32_bf16 v[156:159], v[40:43], a[88:91], v[156:159]
v_mfma_f32_16x16x32_bf16 v[156:159], v[44:47], a[92:95], v[156:159]
s_waitcnt lgkmcnt(0)
ds_read_b64_tr_b16 v[40:41], v21 offset:1032
v_mfma_f32_16x16x32_bf16 v[160:163], v[32:35], a[64:67], v[160:163]
ds_read_b64_tr_b16 v[42:43], v21 offset:7176
v_mfma_f32_16x16x32_bf16 v[160:163], v[36:39], a[68:71], v[160:163]
ds_read_b64_tr_b16 v[44:45], v21 offset:13320
v_mfma_f32_16x16x32_bf16 v[164:167], v[32:35], a[72:75], v[164:167]
ds_read_b64_tr_b16 v[46:47], v21 offset:19464
v_mfma_f32_16x16x32_bf16 v[164:167], v[36:39], a[76:79], v[164:167]
v_mfma_f32_16x16x32_bf16 v[168:171], v[32:35], a[80:83], v[168:171]
buffer_load_dwordx4 a[168:171], v25, s[8:11], s37 offen offset:0 sc1
v_mfma_f32_16x16x32_bf16 v[168:171], v[36:39], a[84:87], v[168:171]
v_mfma_f32_16x16x32_bf16 v[172:175], v[32:35], a[88:91], v[172:175]
v_mfma_f32_16x16x32_bf16 v[172:175], v[36:39], a[92:95], v[172:175]
s_waitcnt lgkmcnt(0)
ds_read_b64_tr_b16 v[32:33], v20 offset:2048
v_mfma_f32_16x16x32_bf16 v[176:179], v[40:43], a[64:67], v[176:179]
ds_read_b64_tr_b16 v[34:35], v20 offset:8192
v_mfma_f32_16x16x32_bf16 v[176:179], v[44:47], a[68:71], v[176:179]
ds_read_b64_tr_b16 v[36:37], v20 offset:14336
v_mfma_f32_16x16x32_bf16 v[180:183], v[40:43], a[72:75], v[180:183]
buffer_load_dwordx4 a[172:175], v25, s[8:11], s37 offen offset:1024 sc1
v_mfma_f32_16x16x32_bf16 v[180:183], v[44:47], a[76:79], v[180:183]
ds_read_b64_tr_b16 v[38:39], v20 offset:20480
v_mfma_f32_16x16x32_bf16 v[184:187], v[40:43], a[80:83], v[184:187]
v_mfma_f32_16x16x32_bf16 v[184:187], v[44:47], a[84:87], v[184:187]
v_mfma_f32_16x16x32_bf16 v[188:191], v[40:43], a[88:91], v[188:191]
v_mfma_f32_16x16x32_bf16 v[188:191], v[44:47], a[92:95], v[188:191]
s_waitcnt lgkmcnt(0)
ds_read_b64_tr_b16 v[40:41], v20 offset:2056
v_mfma_f32_16x16x32_bf16 v[192:195], v[32:35], a[64:67], v[192:195]
ds_read_b64_tr_b16 v[42:43], v20 offset:8200
v_mfma_f32_16x16x32_bf16 v[192:195], v[36:39], a[68:71], v[192:195]
buffer_load_dwordx4 a[176:179], v26, s[8:11], s37 offen offset:0 sc1
v_mfma_f32_16x16x32_bf16 v[196:199], v[32:35], a[72:75], v[196:199]
ds_read_b64_tr_b16 v[44:45], v20 offset:14344
v_mfma_f32_16x16x32_bf16 v[196:199], v[36:39], a[76:79], v[196:199]
ds_read_b64_tr_b16 v[46:47], v20 offset:20488
v_mfma_f32_16x16x32_bf16 v[200:203], v[32:35], a[80:83], v[200:203]
v_mfma_f32_16x16x32_bf16 v[200:203], v[36:39], a[84:87], v[200:203]
v_mfma_f32_16x16x32_bf16 v[204:207], v[32:35], a[88:91], v[204:207]
v_mfma_f32_16x16x32_bf16 v[204:207], v[36:39], a[92:95], v[204:207]
s_waitcnt lgkmcnt(0)
ds_read_b64_tr_b16 v[32:33], v21 offset:2048
v_mfma_f32_16x16x32_bf16 v[208:211], v[40:43], a[64:67], v[208:211]
buffer_load_dwordx4 a[180:183], v26, s[8:11], s37 offen offset:1024 sc1
v_mfma_f32_16x16x32_bf16 v[208:211], v[44:47], a[68:71], v[208:211]
ds_read_b64_tr_b16 v[34:35], v21 offset:8192
v_mfma_f32_16x16x32_bf16 v[212:215], v[40:43], a[72:75], v[212:215]
ds_read_b64_tr_b16 v[36:37], v21 offset:14336
v_mfma_f32_16x16x32_bf16 v[212:215], v[44:47], a[76:79], v[212:215]
ds_read_b64_tr_b16 v[38:39], v21 offset:20480
v_mfma_f32_16x16x32_bf16 v[216:219], v[40:43], a[80:83], v[216:219]
v_mfma_f32_16x16x32_bf16 v[216:219], v[44:47], a[84:87], v[216:219]
v_mfma_f32_16x16x32_bf16 v[220:223], v[40:43], a[88:91], v[220:223]
buffer_load_dwordx4 a[184:187], v27, s[8:11], s37 offen offset:0 sc1
v_mfma_f32_16x16x32_bf16 v[220:223], v[44:47], a[92:95], v[220:223]
s_waitcnt lgkmcnt(0)
ds_read_b64_tr_b16 v[40:41], v21 offset:2056
v_mfma_f32_16x16x32_bf16 v[224:227], v[32:35], a[64:67], v[224:227]
ds_read_b64_tr_b16 v[42:43], v21 offset:8200
v_mfma_f32_16x16x32_bf16 v[224:227], v[36:39], a[68:71], v[224:227]
ds_read_b64_tr_b16 v[44:45], v21 offset:14344
v_mfma_f32_16x16x32_bf16 v[228:231], v[32:35], a[72:75], v[228:231]
ds_read_b64_tr_b16 v[46:47], v21 offset:20488
v_mfma_f32_16x16x32_bf16 v[228:231], v[36:39], a[76:79], v[228:231]
v_mfma_f32_16x16x32_bf16 v[232:235], v[32:35], a[80:83], v[232:235]
buffer_load_dwordx4 a[188:191], v27, s[8:11], s37 offen offset:1024 sc1
v_mfma_f32_16x16x32_bf16 v[232:235], v[36:39], a[84:87], v[232:235]
v_mfma_f32_16x16x32_bf16 v[236:239], v[32:35], a[88:91], v[236:239]
v_mfma_f32_16x16x32_bf16 v[236:239], v[36:39], a[92:95], v[236:239]
s_waitcnt lgkmcnt(0)
ds_read_b64_tr_b16 v[32:33], v20 offset:24576
v_mfma_f32_16x16x32_bf16 v[240:243], v[40:43], a[64:67], v[240:243]
ds_read_b64_tr_b16 v[34:35], v20 offset:30720
v_mfma_f32_16x16x32_bf16 v[240:243], v[44:47], a[68:71], v[240:243]
ds_read_b64_tr_b16 v[36:37], v20 offset:36864
v_mfma_f32_16x16x32_bf16 v[244:247], v[40:43], a[72:75], v[244:247]
ds_read_b64_tr_b16 v[38:39], v20 offset:43008
v_mfma_f32_16x16x32_bf16 v[244:247], v[44:47], a[76:79], v[244:247]
v_mfma_f32_16x16x32_bf16 v[248:251], v[40:43], a[80:83], v[248:251]
v_mfma_f32_16x16x32_bf16 v[248:251], v[44:47], a[84:87], v[248:251]
v_mfma_f32_16x16x32_bf16 v[252:255], v[40:43], a[88:91], v[252:255]
v_mfma_f32_16x16x32_bf16 v[252:255], v[44:47], a[92:95], v[252:255]
s_waitcnt lgkmcnt(0)
v_mfma_f32_16x16x32_bf16 v[64:67], v[32:35], a[96:99], v[64:67]
s_mov_b32 s38, 4718592
s_mov_b32 s39, 5111808
s_mov_b32 s37, 12288
s_mov_b32 s38, 3932160
s_mov_b32 s39, 4325376
v_mfma_f32_16x16x32_bf16 v[64:67], v[36:39], a[100:103], v[64:67]
s_add_u32 m0, s29, 122880
ds_read_b64_tr_b16 v[40:41], v20 offset:24584
v_mfma_f32_16x16x32_bf16 v[68:71], v[32:35], a[104:107], v[68:71]
ds_read_b64_tr_b16 v[42:43], v20 offset:30728
v_mfma_f32_16x16x32_bf16 v[68:71], v[36:39], a[108:111], v[68:71]
buffer_load_dwordx4 v10, s[12:15], s38 offen offset:0 nt lds
v_mfma_f32_16x16x32_bf16 v[72:75], v[32:35], a[112:115], v[72:75]
ds_read_b64_tr_b16 v[44:45], v20 offset:36872
v_mfma_f32_16x16x32_bf16 v[72:75], v[36:39], a[116:119], v[72:75]
s_add_u32 m0, s29, 123776
ds_read_b64_tr_b16 v[46:47], v20 offset:43016
v_mfma_f32_16x16x32_bf16 v[76:79], v[32:35], a[120:123], v[76:79]
v_mfma_f32_16x16x32_bf16 v[76:79], v[36:39], a[124:127], v[76:79]
s_waitcnt lgkmcnt(0)
ds_read_b64_tr_b16 v[32:33], v21 offset:24576
v_mfma_f32_16x16x32_bf16 v[80:83], v[40:43], a[96:99], v[80:83]
ds_read_b64_tr_b16 v[34:35], v21 offset:30720
v_mfma_f32_16x16x32_bf16 v[80:83], v[44:47], a[100:103], v[80:83]
buffer_load_dwordx4 v10, s[12:15], s38 offen offset:128 nt lds
v_mfma_f32_16x16x32_bf16 v[84:87], v[40:43], a[104:107], v[84:87]
ds_read_b64_tr_b16 v[36:37], v21 offset:36864
v_mfma_f32_16x16x32_bf16 v[84:87], v[44:47], a[108:111], v[84:87]
s_add_u32 m0, s29, 124672
ds_read_b64_tr_b16 v[38:39], v21 offset:43008
v_mfma_f32_16x16x32_bf16 v[88:91], v[40:43], a[112:115], v[88:91]
v_mfma_f32_16x16x32_bf16 v[88:91], v[44:47], a[116:119], v[88:91]
v_mfma_f32_16x16x32_bf16 v[92:95], v[40:43], a[120:123], v[92:95]
v_mfma_f32_16x16x32_bf16 v[92:95], v[44:47], a[124:127], v[92:95]
s_waitcnt lgkmcnt(0)
ds_read_b64_tr_b16 v[40:41], v21 offset:24584
v_mfma_f32_16x16x32_bf16 v[96:99], v[32:35], a[96:99], v[96:99]
buffer_load_dwordx4 v10, s[12:15], s38 offen offset:256 nt lds
v_mfma_f32_16x16x32_bf16 v[96:99], v[36:39], a[100:103], v[96:99]
s_add_u32 m0, s29, 135168
ds_read_b64_tr_b16 v[42:43], v21 offset:30728
v_mfma_f32_16x16x32_bf16 v[100:103], v[32:35], a[104:107], v[100:103]
ds_read_b64_tr_b16 v[44:45], v21 offset:36872
v_mfma_f32_16x16x32_bf16 v[100:103], v[36:39], a[108:111], v[100:103]
ds_read_b64_tr_b16 v[46:47], v21 offset:43016
v_mfma_f32_16x16x32_bf16 v[104:107], v[32:35], a[112:115], v[104:107]
v_mfma_f32_16x16x32_bf16 v[104:107], v[36:39], a[116:119], v[104:107]
buffer_load_dwordx4 v10, s[12:15], s39 offen offset:0 nt lds
v_mfma_f32_16x16x32_bf16 v[108:111], v[32:35], a[120:123], v[108:111]
v_mfma_f32_16x16x32_bf16 v[108:111], v[36:39], a[124:127], v[108:111]
s_waitcnt lgkmcnt(0)
ds_read_b64_tr_b16 v[32:33], v20 offset:25600
v_mfma_f32_16x16x32_bf16 v[112:115], v[40:43], a[96:99], v[112:115]
s_add_u32 m0, s29, 136064
ds_read_b64_tr_b16 v[34:35], v20 offset:31744
v_mfma_f32_16x16x32_bf16 v[112:115], v[44:47], a[100:103], v[112:115]
ds_read_b64_tr_b16 v[36:37], v20 offset:37888
v_mfma_f32_16x16x32_bf16 v[116:119], v[40:43], a[104:107], v[116:119]
ds_read_b64_tr_b16 v[38:39], v20 offset:44032
v_mfma_f32_16x16x32_bf16 v[116:119], v[44:47], a[108:111], v[116:119]
buffer_load_dwordx4 v10, s[12:15], s39 offen offset:128 nt lds
v_mfma_f32_16x16x32_bf16 v[120:123], v[40:43], a[112:115], v[120:123]
v_mfma_f32_16x16x32_bf16 v[120:123], v[44:47], a[116:119], v[120:123]
s_add_u32 m0, s29, 136960
v_mfma_f32_16x16x32_bf16 v[124:127], v[40:43], a[120:123], v[124:127]
v_mfma_f32_16x16x32_bf16 v[124:127], v[44:47], a[124:127], v[124:127]
s_waitcnt lgkmcnt(0)
ds_read_b64_tr_b16 v[40:41], v20 offset:25608
v_mfma_f32_16x16x32_bf16 v[128:131], v[32:35], a[96:99], v[128:131]
ds_read_b64_tr_b16 v[42:43], v20 offset:31752
v_mfma_f32_16x16x32_bf16 v[128:131], v[36:39], a[100:103], v[128:131]
buffer_load_dwordx4 v10, s[12:15], s39 offen offset:256 nt lds
v_mfma_f32_16x16x32_bf16 v[132:135], v[32:35], a[104:107], v[132:135]
ds_read_b64_tr_b16 v[44:45], v20 offset:37896
v_mfma_f32_16x16x32_bf16 v[132:135], v[36:39], a[108:111], v[132:135]
ds_read_b64_tr_b16 v[46:47], v20 offset:44040
v_mfma_f32_16x16x32_bf16 v[136:139], v[32:35], a[112:115], v[136:139]
v_mfma_f32_16x16x32_bf16 v[136:139], v[36:39], a[116:119], v[136:139]
v_mfma_f32_16x16x32_bf16 v[140:143], v[32:35], a[120:123], v[140:143]
v_mfma_f32_16x16x32_bf16 v[140:143], v[36:39], a[124:127], v[140:143]
s_waitcnt lgkmcnt(0)
ds_read_b64_tr_b16 v[32:33], v21 offset:25600
v_mfma_f32_16x16x32_bf16 v[144:147], v[40:43], a[96:99], v[144:147]
buffer_load_dwordx4 a[192:195], v24, s[8:11], s37 offen offset:0 sc1
v_mfma_f32_16x16x32_bf16 v[144:147], v[44:47], a[100:103], v[144:147]
ds_read_b64_tr_b16 v[34:35], v21 offset:31744
v_mfma_f32_16x16x32_bf16 v[148:151], v[40:43], a[104:107], v[148:151]
ds_read_b64_tr_b16 v[36:37], v21 offset:37888
v_mfma_f32_16x16x32_bf16 v[148:151], v[44:47], a[108:111], v[148:151]
ds_read_b64_tr_b16 v[38:39], v21 offset:44032
v_mfma_f32_16x16x32_bf16 v[152:155], v[40:43], a[112:115], v[152:155]
v_mfma_f32_16x16x32_bf16 v[152:155], v[44:47], a[116:119], v[152:155]
buffer_load_dwordx4 a[196:199], v24, s[8:11], s37 offen offset:1024 sc1
v_mfma_f32_16x16x32_bf16 v[156:159], v[40:43], a[120:123], v[156:159]
v_mfma_f32_16x16x32_bf16 v[156:159], v[44:47], a[124:127], v[156:159]
s_waitcnt lgkmcnt(0)
ds_read_b64_tr_b16 v[40:41], v21 offset:25608
v_mfma_f32_16x16x32_bf16 v[160:163], v[32:35], a[96:99], v[160:163]
ds_read_b64_tr_b16 v[42:43], v21 offset:31752
v_mfma_f32_16x16x32_bf16 v[160:163], v[36:39], a[100:103], v[160:163]
ds_read_b64_tr_b16 v[44:45], v21 offset:37896
v_mfma_f32_16x16x32_bf16 v[164:167], v[32:35], a[104:107], v[164:167]
ds_read_b64_tr_b16 v[46:47], v21 offset:44040
v_mfma_f32_16x16x32_bf16 v[164:167], v[36:39], a[108:111], v[164:167]
v_mfma_f32_16x16x32_bf16 v[168:171], v[32:35], a[112:115], v[168:171]
buffer_load_dwordx4 a[200:203], v25, s[8:11], s37 offen offset:0 sc1
v_mfma_f32_16x16x32_bf16 v[168:171], v[36:39], a[116:119], v[168:171]
v_mfma_f32_16x16x32_bf16 v[172:175], v[32:35], a[120:123], v[172:175]
v_mfma_f32_16x16x32_bf16 v[172:175], v[36:39], a[124:127], v[172:175]
s_waitcnt lgkmcnt(0)
ds_read_b64_tr_b16 v[32:33], v20 offset:26624
v_mfma_f32_16x16x32_bf16 v[176:179], v[40:43], a[96:99], v[176:179]
ds_read_b64_tr_b16 v[34:35], v20 offset:32768
v_mfma_f32_16x16x32_bf16 v[176:179], v[44:47], a[100:103], v[176:179]
ds_read_b64_tr_b16 v[36:37], v20 offset:38912
v_mfma_f32_16x16x32_bf16 v[180:183], v[40:43], a[104:107], v[180:183]
buffer_load_dwordx4 a[204:207], v25, s[8:11], s37 offen offset:1024 sc1
v_mfma_f32_16x16x32_bf16 v[180:183], v[44:47], a[108:111], v[180:183]
ds_read_b64_tr_b16 v[38:39], v20 offset:45056
v_mfma_f32_16x16x32_bf16 v[184:187], v[40:43], a[112:115], v[184:187]
v_mfma_f32_16x16x32_bf16 v[184:187], v[44:47], a[116:119], v[184:187]
v_mfma_f32_16x16x32_bf16 v[188:191], v[40:43], a[120:123], v[188:191]
v_mfma_f32_16x16x32_bf16 v[188:191], v[44:47], a[124:127], v[188:191]
s_waitcnt lgkmcnt(0)
ds_read_b64_tr_b16 v[40:41], v20 offset:26632
v_mfma_f32_16x16x32_bf16 v[192:195], v[32:35], a[96:99], v[192:195]
ds_read_b64_tr_b16 v[42:43], v20 offset:32776
v_mfma_f32_16x16x32_bf16 v[192:195], v[36:39], a[100:103], v[192:195]
buffer_load_dwordx4 a[208:211], v26, s[8:11], s37 offen offset:0 sc1
v_mfma_f32_16x16x32_bf16 v[196:199], v[32:35], a[104:107], v[196:199]
ds_read_b64_tr_b16 v[44:45], v20 offset:38920
v_mfma_f32_16x16x32_bf16 v[196:199], v[36:39], a[108:111], v[196:199]
ds_read_b64_tr_b16 v[46:47], v20 offset:45064
v_mfma_f32_16x16x32_bf16 v[200:203], v[32:35], a[112:115], v[200:203]
v_mfma_f32_16x16x32_bf16 v[200:203], v[36:39], a[116:119], v[200:203]
v_mfma_f32_16x16x32_bf16 v[204:207], v[32:35], a[120:123], v[204:207]
v_mfma_f32_16x16x32_bf16 v[204:207], v[36:39], a[124:127], v[204:207]
s_waitcnt lgkmcnt(0)
ds_read_b64_tr_b16 v[32:33], v21 offset:26624
v_mfma_f32_16x16x32_bf16 v[208:211], v[40:43], a[96:99], v[208:211]
buffer_load_dwordx4 a[212:215], v26, s[8:11], s37 offen offset:1024 sc1
v_mfma_f32_16x16x32_bf16 v[208:211], v[44:47], a[100:103], v[208:211]
ds_read_b64_tr_b16 v[34:35], v21 offset:32768
v_mfma_f32_16x16x32_bf16 v[212:215], v[40:43], a[104:107], v[212:215]
ds_read_b64_tr_b16 v[36:37], v21 offset:38912
v_mfma_f32_16x16x32_bf16 v[212:215], v[44:47], a[108:111], v[212:215]
ds_read_b64_tr_b16 v[38:39], v21 offset:45056
v_mfma_f32_16x16x32_bf16 v[216:219], v[40:43], a[112:115], v[216:219]
v_mfma_f32_16x16x32_bf16 v[216:219], v[44:47], a[116:119], v[216:219]
v_mfma_f32_16x16x32_bf16 v[220:223], v[40:43], a[120:123], v[220:223]
buffer_load_dwordx4 a[216:219], v27, s[8:11], s37 offen offset:0 sc1
v_mfma_f32_16x16x32_bf16 v[220:223], v[44:47], a[124:127], v[220:223]
s_waitcnt lgkmcnt(0)
ds_read_b64_tr_b16 v[40:41], v21 offset:26632
v_mfma_f32_16x16x32_bf16 v[224:227], v[32:35], a[96:99], v[224:227]
ds_read_b64_tr_b16 v[42:43], v21 offset:32776
v_mfma_f32_16x16x32_bf16 v[224:227], v[36:39], a[100:103], v[224:227]
ds_read_b64_tr_b16 v[44:45], v21 offset:38920
v_mfma_f32_16x16x32_bf16 v[228:231], v[32:35], a[104:107], v[228:231]
ds_read_b64_tr_b16 v[46:47], v21 offset:45064
v_mfma_f32_16x16x32_bf16 v[228:231], v[36:39], a[108:111], v[228:231]
v_mfma_f32_16x16x32_bf16 v[232:235], v[32:35], a[112:115], v[232:235]
buffer_load_dwordx4 a[220:223], v27, s[8:11], s37 offen offset:1024 sc1
v_mfma_f32_16x16x32_bf16 v[232:235], v[36:39], a[116:119], v[232:235]
v_mfma_f32_16x16x32_bf16 v[236:239], v[32:35], a[120:123], v[236:239]
v_mfma_f32_16x16x32_bf16 v[236:239], v[36:39], a[124:127], v[236:239]
s_waitcnt lgkmcnt(0)
s_waitcnt vmcnt(8)
s_barrier
v_mfma_f32_16x16x32_bf16 v[240:243], v[40:43], a[96:99], v[240:243]
ds_read_b64_tr_b16 v[32:33], v22 offset:0
v_mfma_f32_16x16x32_bf16 v[240:243], v[44:47], a[100:103], v[240:243]
ds_read_b64_tr_b16 v[34:35], v22 offset:6144
v_mfma_f32_16x16x32_bf16 v[244:247], v[40:43], a[104:107], v[244:247]
ds_read_b64_tr_b16 v[36:37], v22 offset:12288
v_mfma_f32_16x16x32_bf16 v[244:247], v[44:47], a[108:111], v[244:247]
ds_read_b64_tr_b16 v[38:39], v22 offset:18432
v_mfma_f32_16x16x32_bf16 v[248:251], v[40:43], a[112:115], v[248:251]
v_mfma_f32_16x16x32_bf16 v[248:251], v[44:47], a[116:119], v[248:251]
v_mfma_f32_16x16x32_bf16 v[252:255], v[40:43], a[120:123], v[252:255]
v_mfma_f32_16x16x32_bf16 v[252:255], v[44:47], a[124:127], v[252:255]
s_waitcnt lgkmcnt(0)
v_mfma_f32_16x16x32_bf16 v[64:67], v[32:35], a[128:131], v[64:67]
s_mov_b32 s38, 5505024
s_mov_b32 s39, 5898240
s_mov_b32 s37, 14336
s_mov_b32 s38, 4718592
s_mov_b32 s39, 5111808
v_mfma_f32_16x16x32_bf16 v[64:67], v[36:39], a[132:135], v[64:67]
s_add_u32 m0, s29, 49152
ds_read_b64_tr_b16 v[40:41], v22 offset:8
v_mfma_f32_16x16x32_bf16 v[68:71], v[32:35], a[136:139], v[68:71]
ds_read_b64_tr_b16 v[42:43], v22 offset:6152
v_mfma_f32_16x16x32_bf16 v[68:71], v[36:39], a[140:143], v[68:71]
buffer_load_dwordx4 v10, s[12:15], s38 offen offset:0 nt lds
v_mfma_f32_16x16x32_bf16 v[72:75], v[32:35], a[144:147], v[72:75]
ds_read_b64_tr_b16 v[44:45], v22 offset:12296
v_mfma_f32_16x16x32_bf16 v[72:75], v[36:39], a[148:151], v[72:75]
s_add_u32 m0, s29, 50048
ds_read_b64_tr_b16 v[46:47], v22 offset:18440
v_mfma_f32_16x16x32_bf16 v[76:79], v[32:35], a[152:155], v[76:79]
v_mfma_f32_16x16x32_bf16 v[76:79], v[36:39], a[156:159], v[76:79]
s_waitcnt lgkmcnt(0)
ds_read_b64_tr_b16 v[32:33], v23 offset:0
v_mfma_f32_16x16x32_bf16 v[80:83], v[40:43], a[128:131], v[80:83]
ds_read_b64_tr_b16 v[34:35], v23 offset:6144
v_mfma_f32_16x16x32_bf16 v[80:83], v[44:47], a[132:135], v[80:83]
buffer_load_dwordx4 v10, s[12:15], s38 offen offset:128 nt lds
v_mfma_f32_16x16x32_bf16 v[84:87], v[40:43], a[136:139], v[84:87]
ds_read_b64_tr_b16 v[36:37], v23 offset:12288
v_mfma_f32_16x16x32_bf16 v[84:87], v[44:47], a[140:143], v[84:87]
s_add_u32 m0, s29, 50944
ds_read_b64_tr_b16 v[38:39], v23 offset:18432
v_mfma_f32_16x16x32_bf16 v[88:91], v[40:43], a[144:147], v[88:91]
v_mfma_f32_16x16x32_bf16 v[88:91], v[44:47], a[148:151], v[88:91]
v_mfma_f32_16x16x32_bf16 v[92:95], v[40:43], a[152:155], v[92:95]
v_mfma_f32_16x16x32_bf16 v[92:95], v[44:47], a[156:159], v[92:95]
s_waitcnt lgkmcnt(0)
ds_read_b64_tr_b16 v[40:41], v23 offset:8
v_mfma_f32_16x16x32_bf16 v[96:99], v[32:35], a[128:131], v[96:99]
buffer_load_dwordx4 v10, s[12:15], s38 offen offset:256 nt lds
v_mfma_f32_16x16x32_bf16 v[96:99], v[36:39], a[132:135], v[96:99]
s_add_u32 m0, s29, 61440
ds_read_b64_tr_b16 v[42:43], v23 offset:6152
v_mfma_f32_16x16x32_bf16 v[100:103], v[32:35], a[136:139], v[100:103]
ds_read_b64_tr_b16 v[44:45], v23 offset:12296
v_mfma_f32_16x16x32_bf16 v[100:103], v[36:39], a[140:143], v[100:103]
ds_read_b64_tr_b16 v[46:47], v23 offset:18440
v_mfma_f32_16x16x32_bf16 v[104:107], v[32:35], a[144:147], v[104:107]
v_mfma_f32_16x16x32_bf16 v[104:107], v[36:39], a[148:151], v[104:107]
buffer_load_dwordx4 v10, s[12:15], s39 offen offset:0 nt lds
v_mfma_f32_16x16x32_bf16 v[108:111], v[32:35], a[152:155], v[108:111]
v_mfma_f32_16x16x32_bf16 v[108:111], v[36:39], a[156:159], v[108:111]
s_waitcnt lgkmcnt(0)
ds_read_b64_tr_b16 v[32:33], v22 offset:1024
v_mfma_f32_16x16x32_bf16 v[112:115], v[40:43], a[128:131], v[112:115]
s_add_u32 m0, s29, 62336
ds_read_b64_tr_b16 v[34:35], v22 offset:7168
v_mfma_f32_16x16x32_bf16 v[112:115], v[44:47], a[132:135], v[112:115]
ds_read_b64_tr_b16 v[36:37], v22 offset:13312
v_mfma_f32_16x16x32_bf16 v[116:119], v[40:43], a[136:139], v[116:119]
ds_read_b64_tr_b16 v[38:39], v22 offset:19456
v_mfma_f32_16x16x32_bf16 v[116:119], v[44:47], a[140:143], v[116:119]
buffer_load_dwordx4 v10, s[12:15], s39 offen offset:128 nt lds
v_mfma_f32_16x16x32_bf16 v[120:123], v[40:43], a[144:147], v[120:123]
v_mfma_f32_16x16x32_bf16 v[120:123], v[44:47], a[148:151], v[120:123]
s_add_u32 m0, s29, 63232
v_mfma_f32_16x16x32_bf16 v[124:127], v[40:43], a[152:155], v[124:127]
v_mfma_f32_16x16x32_bf16 v[124:127], v[44:47], a[156:159], v[124:127]
s_waitcnt lgkmcnt(0)
ds_read_b64_tr_b16 v[40:41], v22 offset:1032
v_mfma_f32_16x16x32_bf16 v[128:131], v[32:35], a[128:131], v[128:131]
ds_read_b64_tr_b16 v[42:43], v22 offset:7176
v_mfma_f32_16x16x32_bf16 v[128:131], v[36:39], a[132:135], v[128:131]
buffer_load_dwordx4 v10, s[12:15], s39 offen offset:256 nt lds
v_mfma_f32_16x16x32_bf16 v[132:135], v[32:35], a[136:139], v[132:135]
ds_read_b64_tr_b16 v[44:45], v22 offset:13320
v_mfma_f32_16x16x32_bf16 v[132:135], v[36:39], a[140:143], v[132:135]
ds_read_b64_tr_b16 v[46:47], v22 offset:19464
v_mfma_f32_16x16x32_bf16 v[136:139], v[32:35], a[144:147], v[136:139]
v_mfma_f32_16x16x32_bf16 v[136:139], v[36:39], a[148:151], v[136:139]
v_mfma_f32_16x16x32_bf16 v[140:143], v[32:35], a[152:155], v[140:143]
v_mfma_f32_16x16x32_bf16 v[140:143], v[36:39], a[156:159], v[140:143]
s_waitcnt lgkmcnt(0)
ds_read_b64_tr_b16 v[32:33], v23 offset:1024
v_mfma_f32_16x16x32_bf16 v[144:147], v[40:43], a[128:131], v[144:147]
buffer_load_dwordx4 a[224:227], v24, s[8:11], s37 offen offset:0 sc1
v_mfma_f32_16x16x32_bf16 v[144:147], v[44:47], a[132:135], v[144:147]
ds_read_b64_tr_b16 v[34:35], v23 offset:7168
v_mfma_f32_16x16x32_bf16 v[148:151], v[40:43], a[136:139], v[148:151]
ds_read_b64_tr_b16 v[36:37], v23 offset:13312
v_mfma_f32_16x16x32_bf16 v[148:151], v[44:47], a[140:143], v[148:151]
ds_read_b64_tr_b16 v[38:39], v23 offset:19456
v_mfma_f32_16x16x32_bf16 v[152:155], v[40:43], a[144:147], v[152:155]
v_mfma_f32_16x16x32_bf16 v[152:155], v[44:47], a[148:151], v[152:155]
buffer_load_dwordx4 a[228:231], v24, s[8:11], s37 offen offset:1024 sc1
v_mfma_f32_16x16x32_bf16 v[156:159], v[40:43], a[152:155], v[156:159]
v_mfma_f32_16x16x32_bf16 v[156:159], v[44:47], a[156:159], v[156:159]
s_waitcnt lgkmcnt(0)
ds_read_b64_tr_b16 v[40:41], v23 offset:1032
v_mfma_f32_16x16x32_bf16 v[160:163], v[32:35], a[128:131], v[160:163]
ds_read_b64_tr_b16 v[42:43], v23 offset:7176
v_mfma_f32_16x16x32_bf16 v[160:163], v[36:39], a[132:135], v[160:163]
ds_read_b64_tr_b16 v[44:45], v23 offset:13320
v_mfma_f32_16x16x32_bf16 v[164:167], v[32:35], a[136:139], v[164:167]
ds_read_b64_tr_b16 v[46:47], v23 offset:19464
v_mfma_f32_16x16x32_bf16 v[164:167], v[36:39], a[140:143], v[164:167]
v_mfma_f32_16x16x32_bf16 v[168:171], v[32:35], a[144:147], v[168:171]
buffer_load_dwordx4 a[232:235], v25, s[8:11], s37 offen offset:0 sc1
v_mfma_f32_16x16x32_bf16 v[168:171], v[36:39], a[148:151], v[168:171]
v_mfma_f32_16x16x32_bf16 v[172:175], v[32:35], a[152:155], v[172:175]
v_mfma_f32_16x16x32_bf16 v[172:175], v[36:39], a[156:159], v[172:175]
s_waitcnt lgkmcnt(0)
ds_read_b64_tr_b16 v[32:33], v22 offset:2048
v_mfma_f32_16x16x32_bf16 v[176:179], v[40:43], a[128:131], v[176:179]
ds_read_b64_tr_b16 v[34:35], v22 offset:8192
v_mfma_f32_16x16x32_bf16 v[176:179], v[44:47], a[132:135], v[176:179]
ds_read_b64_tr_b16 v[36:37], v22 offset:14336
v_mfma_f32_16x16x32_bf16 v[180:183], v[40:43], a[136:139], v[180:183]
buffer_load_dwordx4 a[236:239], v25, s[8:11], s37 offen offset:1024 sc1
v_mfma_f32_16x16x32_bf16 v[180:183], v[44:47], a[140:143], v[180:183]
ds_read_b64_tr_b16 v[38:39], v22 offset:20480
v_mfma_f32_16x16x32_bf16 v[184:187], v[40:43], a[144:147], v[184:187]
v_mfma_f32_16x16x32_bf16 v[184:187], v[44:47], a[148:151], v[184:187]
v_mfma_f32_16x16x32_bf16 v[188:191], v[40:43], a[152:155], v[188:191]
v_mfma_f32_16x16x32_bf16 v[188:191], v[44:47], a[156:159], v[188:191]
s_waitcnt lgkmcnt(0)
ds_read_b64_tr_b16 v[40:41], v22 offset:2056
v_mfma_f32_16x16x32_bf16 v[192:195], v[32:35], a[128:131], v[192:195]
ds_read_b64_tr_b16 v[42:43], v22 offset:8200
v_mfma_f32_16x16x32_bf16 v[192:195], v[36:39], a[132:135], v[192:195]
buffer_load_dwordx4 a[240:243], v26, s[8:11], s37 offen offset:0 sc1
v_mfma_f32_16x16x32_bf16 v[196:199], v[32:35], a[136:139], v[196:199]
ds_read_b64_tr_b16 v[44:45], v22 offset:14344
v_mfma_f32_16x16x32_bf16 v[196:199], v[36:39], a[140:143], v[196:199]
ds_read_b64_tr_b16 v[46:47], v22 offset:20488
v_mfma_f32_16x16x32_bf16 v[200:203], v[32:35], a[144:147], v[200:203]
v_mfma_f32_16x16x32_bf16 v[200:203], v[36:39], a[148:151], v[200:203]
v_mfma_f32_16x16x32_bf16 v[204:207], v[32:35], a[152:155], v[204:207]
v_mfma_f32_16x16x32_bf16 v[204:207], v[36:39], a[156:159], v[204:207]
s_waitcnt lgkmcnt(0)
ds_read_b64_tr_b16 v[32:33], v23 offset:2048
v_mfma_f32_16x16x32_bf16 v[208:211], v[40:43], a[128:131], v[208:211]
buffer_load_dwordx4 a[244:247], v26, s[8:11], s37 offen offset:1024 sc1
v_mfma_f32_16x16x32_bf16 v[208:211], v[44:47], a[132:135], v[208:211]
ds_read_b64_tr_b16 v[34:35], v23 offset:8192
v_mfma_f32_16x16x32_bf16 v[212:215], v[40:43], a[136:139], v[212:215]
ds_read_b64_tr_b16 v[36:37], v23 offset:14336
v_mfma_f32_16x16x32_bf16 v[212:215], v[44:47], a[140:143], v[212:215]
ds_read_b64_tr_b16 v[38:39], v23 offset:20480
v_mfma_f32_16x16x32_bf16 v[216:219], v[40:43], a[144:147], v[216:219]
v_mfma_f32_16x16x32_bf16 v[216:219], v[44:47], a[148:151], v[216:219]
v_mfma_f32_16x16x32_bf16 v[220:223], v[40:43], a[152:155], v[220:223]
buffer_load_dwordx4 a[248:251], v27, s[8:11], s37 offen offset:0 sc1
v_mfma_f32_16x16x32_bf16 v[220:223], v[44:47], a[156:159], v[220:223]
s_waitcnt lgkmcnt(0)
ds_read_b64_tr_b16 v[40:41], v23 offset:2056
v_mfma_f32_16x16x32_bf16 v[224:227], v[32:35], a[128:131], v[224:227]
ds_read_b64_tr_b16 v[42:43], v23 offset:8200
v_mfma_f32_16x16x32_bf16 v[224:227], v[36:39], a[132:135], v[224:227]
ds_read_b64_tr_b16 v[44:45], v23 offset:14344
v_mfma_f32_16x16x32_bf16 v[228:231], v[32:35], a[136:139], v[228:231]
ds_read_b64_tr_b16 v[46:47], v23 offset:20488
v_mfma_f32_16x16x32_bf16 v[228:231], v[36:39], a[140:143], v[228:231]
v_mfma_f32_16x16x32_bf16 v[232:235], v[32:35], a[144:147], v[232:235]
buffer_load_dwordx4 a[252:255], v27, s[8:11], s37 offen offset:1024 sc1
v_mfma_f32_16x16x32_bf16 v[232:235], v[36:39], a[148:151], v[232:235]
v_mfma_f32_16x16x32_bf16 v[236:239], v[32:35], a[152:155], v[236:239]
v_mfma_f32_16x16x32_bf16 v[236:239], v[36:39], a[156:159], v[236:239]
s_waitcnt lgkmcnt(0)
ds_read_b64_tr_b16 v[32:33], v22 offset:24576
v_mfma_f32_16x16x32_bf16 v[240:243], v[40:43], a[128:131], v[240:243]
ds_read_b64_tr_b16 v[34:35], v22 offset:30720
v_mfma_f32_16x16x32_bf16 v[240:243], v[44:47], a[132:135], v[240:243]
ds_read_b64_tr_b16 v[36:37], v22 offset:36864
v_mfma_f32_16x16x32_bf16 v[244:247], v[40:43], a[136:139], v[244:247]
ds_read_b64_tr_b16 v[38:39], v22 offset:43008
v_mfma_f32_16x16x32_bf16 v[244:247], v[44:47], a[140:143], v[244:247]
v_mfma_f32_16x16x32_bf16 v[248:251], v[40:43], a[144:147], v[248:251]
v_mfma_f32_16x16x32_bf16 v[248:251], v[44:47], a[148:151], v[248:251]
v_mfma_f32_16x16x32_bf16 v[252:255], v[40:43], a[152:155], v[252:255]
v_mfma_f32_16x16x32_bf16 v[252:255], v[44:47], a[156:159], v[252:255]
s_waitcnt lgkmcnt(0)
v_mfma_f32_16x16x32_bf16 v[64:67], v[32:35], a[160:163], v[64:67]
s_mov_b32 s38, 6291456
s_mov_b32 s39, 6684672
s_mov_b32 s37, 16384
s_mov_b32 s38, 5505024
s_mov_b32 s39, 5898240
v_mfma_f32_16x16x32_bf16 v[64:67], v[36:39], a[164:167], v[64:67]
s_add_u32 m0, s29, 73728
ds_read_b64_tr_b16 v[40:41], v22 offset:24584
v_mfma_f32_16x16x32_bf16 v[68:71], v[32:35], a[168:171], v[68:71]
ds_read_b64_tr_b16 v[42:43], v22 offset:30728
v_mfma_f32_16x16x32_bf16 v[68:71], v[36:39], a[172:175], v[68:71]
buffer_load_dwordx4 v10, s[12:15], s38 offen offset:0 nt lds
v_mfma_f32_16x16x32_bf16 v[72:75], v[32:35], a[176:179], v[72:75]
ds_read_b64_tr_b16 v[44:45], v22 offset:36872
v_mfma_f32_16x16x32_bf16 v[72:75], v[36:39], a[180:183], v[72:75]
s_add_u32 m0, s29, 74624
ds_read_b64_tr_b16 v[46:47], v22 offset:43016
v_mfma_f32_16x16x32_bf16 v[76:79], v[32:35], a[184:187], v[76:79]
v_mfma_f32_16x16x32_bf16 v[76:79], v[36:39], a[188:191], v[76:79]
s_waitcnt lgkmcnt(0)
ds_read_b64_tr_b16 v[32:33], v23 offset:24576
v_mfma_f32_16x16x32_bf16 v[80:83], v[40:43], a[160:163], v[80:83]
ds_read_b64_tr_b16 v[34:35], v23 offset:30720
v_mfma_f32_16x16x32_bf16 v[80:83], v[44:47], a[164:167], v[80:83]
buffer_load_dwordx4 v10, s[12:15], s38 offen offset:128 nt lds
v_mfma_f32_16x16x32_bf16 v[84:87], v[40:43], a[168:171], v[84:87]
ds_read_b64_tr_b16 v[36:37], v23 offset:36864
v_mfma_f32_16x16x32_bf16 v[84:87], v[44:47], a[172:175], v[84:87]
s_add_u32 m0, s29, 75520
ds_read_b64_tr_b16 v[38:39], v23 offset:43008
v_mfma_f32_16x16x32_bf16 v[88:91], v[40:43], a[176:179], v[88:91]
v_mfma_f32_16x16x32_bf16 v[88:91], v[44:47], a[180:183], v[88:91]
v_mfma_f32_16x16x32_bf16 v[92:95], v[40:43], a[184:187], v[92:95]
v_mfma_f32_16x16x32_bf16 v[92:95], v[44:47], a[188:191], v[92:95]
s_waitcnt lgkmcnt(0)
ds_read_b64_tr_b16 v[40:41], v23 offset:24584
v_mfma_f32_16x16x32_bf16 v[96:99], v[32:35], a[160:163], v[96:99]
buffer_load_dwordx4 v10, s[12:15], s38 offen offset:256 nt lds
v_mfma_f32_16x16x32_bf16 v[96:99], v[36:39], a[164:167], v[96:99]
s_add_u32 m0, s29, 86016
ds_read_b64_tr_b16 v[42:43], v23 offset:30728
v_mfma_f32_16x16x32_bf16 v[100:103], v[32:35], a[168:171], v[100:103]
ds_read_b64_tr_b16 v[44:45], v23 offset:36872
v_mfma_f32_16x16x32_bf16 v[100:103], v[36:39], a[172:175], v[100:103]
ds_read_b64_tr_b16 v[46:47], v23 offset:43016
v_mfma_f32_16x16x32_bf16 v[104:107], v[32:35], a[176:179], v[104:107]
v_mfma_f32_16x16x32_bf16 v[104:107], v[36:39], a[180:183], v[104:107]
buffer_load_dwordx4 v10, s[12:15], s39 offen offset:0 nt lds
v_mfma_f32_16x16x32_bf16 v[108:111], v[32:35], a[184:187], v[108:111]
v_mfma_f32_16x16x32_bf16 v[108:111], v[36:39], a[188:191], v[108:111]
s_waitcnt lgkmcnt(0)
ds_read_b64_tr_b16 v[32:33], v22 offset:25600
v_mfma_f32_16x16x32_bf16 v[112:115], v[40:43], a[160:163], v[112:115]
s_add_u32 m0, s29, 86912
ds_read_b64_tr_b16 v[34:35], v22 offset:31744
v_mfma_f32_16x16x32_bf16 v[112:115], v[44:47], a[164:167], v[112:115]
ds_read_b64_tr_b16 v[36:37], v22 offset:37888
v_mfma_f32_16x16x32_bf16 v[116:119], v[40:43], a[168:171], v[116:119]
ds_read_b64_tr_b16 v[38:39], v22 offset:44032
v_mfma_f32_16x16x32_bf16 v[116:119], v[44:47], a[172:175], v[116:119]
buffer_load_dwordx4 v10, s[12:15], s39 offen offset:128 nt lds
v_mfma_f32_16x16x32_bf16 v[120:123], v[40:43], a[176:179], v[120:123]
v_mfma_f32_16x16x32_bf16 v[120:123], v[44:47], a[180:183], v[120:123]
s_add_u32 m0, s29, 87808
v_mfma_f32_16x16x32_bf16 v[124:127], v[40:43], a[184:187], v[124:127]
v_mfma_f32_16x16x32_bf16 v[124:127], v[44:47], a[188:191], v[124:127]
s_waitcnt lgkmcnt(0)
ds_read_b64_tr_b16 v[40:41], v22 offset:25608
v_mfma_f32_16x16x32_bf16 v[128:131], v[32:35], a[160:163], v[128:131]
ds_read_b64_tr_b16 v[42:43], v22 offset:31752
v_mfma_f32_16x16x32_bf16 v[128:131], v[36:39], a[164:167], v[128:131]
buffer_load_dwordx4 v10, s[12:15], s39 offen offset:256 nt lds
v_mfma_f32_16x16x32_bf16 v[132:135], v[32:35], a[168:171], v[132:135]
ds_read_b64_tr_b16 v[44:45], v22 offset:37896
v_mfma_f32_16x16x32_bf16 v[132:135], v[36:39], a[172:175], v[132:135]
ds_read_b64_tr_b16 v[46:47], v22 offset:44040
v_mfma_f32_16x16x32_bf16 v[136:139], v[32:35], a[176:179], v[136:139]
v_mfma_f32_16x16x32_bf16 v[136:139], v[36:39], a[180:183], v[136:139]
v_mfma_f32_16x16x32_bf16 v[140:143], v[32:35], a[184:187], v[140:143]
v_mfma_f32_16x16x32_bf16 v[140:143], v[36:39], a[188:191], v[140:143]
s_waitcnt lgkmcnt(0)
ds_read_b64_tr_b16 v[32:33], v23 offset:25600
v_mfma_f32_16x16x32_bf16 v[144:147], v[40:43], a[160:163], v[144:147]
buffer_load_dwordx4 a[0:3], v24, s[8:11], s37 offen offset:0 sc1
v_mfma_f32_16x16x32_bf16 v[144:147], v[44:47], a[164:167], v[144:147]
ds_read_b64_tr_b16 v[34:35], v23 offset:31744
v_mfma_f32_16x16x32_bf16 v[148:151], v[40:43], a[168:171], v[148:151]
ds_read_b64_tr_b16 v[36:37], v23 offset:37888
v_mfma_f32_16x16x32_bf16 v[148:151], v[44:47], a[172:175], v[148:151]
ds_read_b64_tr_b16 v[38:39], v23 offset:44032
v_mfma_f32_16x16x32_bf16 v[152:155], v[40:43], a[176:179], v[152:155]
v_mfma_f32_16x16x32_bf16 v[152:155], v[44:47], a[180:183], v[152:155]
buffer_load_dwordx4 a[4:7], v24, s[8:11], s37 offen offset:1024 sc1
v_mfma_f32_16x16x32_bf16 v[156:159], v[40:43], a[184:187], v[156:159]
v_mfma_f32_16x16x32_bf16 v[156:159], v[44:47], a[188:191], v[156:159]
s_waitcnt lgkmcnt(0)
ds_read_b64_tr_b16 v[40:41], v23 offset:25608
v_mfma_f32_16x16x32_bf16 v[160:163], v[32:35], a[160:163], v[160:163]
ds_read_b64_tr_b16 v[42:43], v23 offset:31752
v_mfma_f32_16x16x32_bf16 v[160:163], v[36:39], a[164:167], v[160:163]
ds_read_b64_tr_b16 v[44:45], v23 offset:37896
v_mfma_f32_16x16x32_bf16 v[164:167], v[32:35], a[168:171], v[164:167]
ds_read_b64_tr_b16 v[46:47], v23 offset:44040
v_mfma_f32_16x16x32_bf16 v[164:167], v[36:39], a[172:175], v[164:167]
v_mfma_f32_16x16x32_bf16 v[168:171], v[32:35], a[176:179], v[168:171]
buffer_load_dwordx4 a[8:11], v25, s[8:11], s37 offen offset:0 sc1
v_mfma_f32_16x16x32_bf16 v[168:171], v[36:39], a[180:183], v[168:171]
v_mfma_f32_16x16x32_bf16 v[172:175], v[32:35], a[184:187], v[172:175]
v_mfma_f32_16x16x32_bf16 v[172:175], v[36:39], a[188:191], v[172:175]
s_waitcnt lgkmcnt(0)
ds_read_b64_tr_b16 v[32:33], v22 offset:26624
v_mfma_f32_16x16x32_bf16 v[176:179], v[40:43], a[160:163], v[176:179]
ds_read_b64_tr_b16 v[34:35], v22 offset:32768
v_mfma_f32_16x16x32_bf16 v[176:179], v[44:47], a[164:167], v[176:179]
ds_read_b64_tr_b16 v[36:37], v22 offset:38912
v_mfma_f32_16x16x32_bf16 v[180:183], v[40:43], a[168:171], v[180:183]
buffer_load_dwordx4 a[12:15], v25, s[8:11], s37 offen offset:1024 sc1
v_mfma_f32_16x16x32_bf16 v[180:183], v[44:47], a[172:175], v[180:183]
ds_read_b64_tr_b16 v[38:39], v22 offset:45056
v_mfma_f32_16x16x32_bf16 v[184:187], v[40:43], a[176:179], v[184:187]
v_mfma_f32_16x16x32_bf16 v[184:187], v[44:47], a[180:183], v[184:187]
v_mfma_f32_16x16x32_bf16 v[188:191], v[40:43], a[184:187], v[188:191]
v_mfma_f32_16x16x32_bf16 v[188:191], v[44:47], a[188:191], v[188:191]
s_waitcnt lgkmcnt(0)
ds_read_b64_tr_b16 v[40:41], v22 offset:26632
v_mfma_f32_16x16x32_bf16 v[192:195], v[32:35], a[160:163], v[192:195]
ds_read_b64_tr_b16 v[42:43], v22 offset:32776
v_mfma_f32_16x16x32_bf16 v[192:195], v[36:39], a[164:167], v[192:195]
buffer_load_dwordx4 a[16:19], v26, s[8:11], s37 offen offset:0 sc1
v_mfma_f32_16x16x32_bf16 v[196:199], v[32:35], a[168:171], v[196:199]
ds_read_b64_tr_b16 v[44:45], v22 offset:38920
v_mfma_f32_16x16x32_bf16 v[196:199], v[36:39], a[172:175], v[196:199]
ds_read_b64_tr_b16 v[46:47], v22 offset:45064
v_mfma_f32_16x16x32_bf16 v[200:203], v[32:35], a[176:179], v[200:203]
v_mfma_f32_16x16x32_bf16 v[200:203], v[36:39], a[180:183], v[200:203]
v_mfma_f32_16x16x32_bf16 v[204:207], v[32:35], a[184:187], v[204:207]
v_mfma_f32_16x16x32_bf16 v[204:207], v[36:39], a[188:191], v[204:207]
s_waitcnt lgkmcnt(0)
ds_read_b64_tr_b16 v[32:33], v23 offset:26624
v_mfma_f32_16x16x32_bf16 v[208:211], v[40:43], a[160:163], v[208:211]
buffer_load_dwordx4 a[20:23], v26, s[8:11], s37 offen offset:1024 sc1
v_mfma_f32_16x16x32_bf16 v[208:211], v[44:47], a[164:167], v[208:211]
ds_read_b64_tr_b16 v[34:35], v23 offset:32768
v_mfma_f32_16x16x32_bf16 v[212:215], v[40:43], a[168:171], v[212:215]
ds_read_b64_tr_b16 v[36:37], v23 offset:38912
v_mfma_f32_16x16x32_bf16 v[212:215], v[44:47], a[172:175], v[212:215]
ds_read_b64_tr_b16 v[38:39], v23 offset:45056
v_mfma_f32_16x16x32_bf16 v[216:219], v[40:43], a[176:179], v[216:219]
v_mfma_f32_16x16x32_bf16 v[216:219], v[44:47], a[180:183], v[216:219]
v_mfma_f32_16x16x32_bf16 v[220:223], v[40:43], a[184:187], v[220:223]
buffer_load_dwordx4 a[24:27], v27, s[8:11], s37 offen offset:0 sc1
v_mfma_f32_16x16x32_bf16 v[220:223], v[44:47], a[188:191], v[220:223]
s_waitcnt lgkmcnt(0)
ds_read_b64_tr_b16 v[40:41], v23 offset:26632
v_mfma_f32_16x16x32_bf16 v[224:227], v[32:35], a[160:163], v[224:227]
ds_read_b64_tr_b16 v[42:43], v23 offset:32776
v_mfma_f32_16x16x32_bf16 v[224:227], v[36:39], a[164:167], v[224:227]
ds_read_b64_tr_b16 v[44:45], v23 offset:38920
v_mfma_f32_16x16x32_bf16 v[228:231], v[32:35], a[168:171], v[228:231]
ds_read_b64_tr_b16 v[46:47], v23 offset:45064
v_mfma_f32_16x16x32_bf16 v[228:231], v[36:39], a[172:175], v[228:231]
v_mfma_f32_16x16x32_bf16 v[232:235], v[32:35], a[176:179], v[232:235]
buffer_load_dwordx4 a[28:31], v27, s[8:11], s37 offen offset:1024 sc1
v_mfma_f32_16x16x32_bf16 v[232:235], v[36:39], a[180:183], v[232:235]
v_mfma_f32_16x16x32_bf16 v[236:239], v[32:35], a[184:187], v[236:239]
v_mfma_f32_16x16x32_bf16 v[236:239], v[36:39], a[188:191], v[236:239]
s_waitcnt lgkmcnt(0)
s_waitcnt vmcnt(8)
s_barrier
v_mfma_f32_16x16x32_bf16 v[240:243], v[40:43], a[160:163], v[240:243]
ds_read_b64_tr_b16 v[32:33], v20 offset:0
v_mfma_f32_16x16x32_bf16 v[240:243], v[44:47], a[164:167], v[240:243]
ds_read_b64_tr_b16 v[34:35], v20 offset:6144
v_mfma_f32_16x16x32_bf16 v[244:247], v[40:43], a[168:171], v[244:247]
ds_read_b64_tr_b16 v[36:37], v20 offset:12288
v_mfma_f32_16x16x32_bf16 v[244:247], v[44:47], a[172:175], v[244:247]
ds_read_b64_tr_b16 v[38:39], v20 offset:18432
v_mfma_f32_16x16x32_bf16 v[248:251], v[40:43], a[176:179], v[248:251]
v_mfma_f32_16x16x32_bf16 v[248:251], v[44:47], a[180:183], v[248:251]
v_mfma_f32_16x16x32_bf16 v[252:255], v[40:43], a[184:187], v[252:255]
v_mfma_f32_16x16x32_bf16 v[252:255], v[44:47], a[188:191], v[252:255]
s_waitcnt lgkmcnt(0)
v_mfma_f32_16x16x32_bf16 v[64:67], v[32:35], a[192:195], v[64:67]
s_mov_b32 s38, 7077888
s_mov_b32 s39, 7471104
s_mov_b32 s37, 18432
s_mov_b32 s38, 6291456
s_mov_b32 s39, 6684672
v_mfma_f32_16x16x32_bf16 v[64:67], v[36:39], a[196:199], v[64:67]
s_add_u32 m0, s29, 98304
ds_read_b64_tr_b16 v[40:41], v20 offset:8
v_mfma_f32_16x16x32_bf16 v[68:71], v[32:35], a[200:203], v[68:71]
ds_read_b64_tr_b16 v[42:43], v20 offset:6152
v_mfma_f32_16x16x32_bf16 v[68:71], v[36:39], a[204:207], v[68:71]
buffer_load_dwordx4 v10, s[12:15], s38 offen offset:0 nt lds
v_mfma_f32_16x16x32_bf16 v[72:75], v[32:35], a[208:211], v[72:75]
ds_read_b64_tr_b16 v[44:45], v20 offset:12296
v_mfma_f32_16x16x32_bf16 v[72:75], v[36:39], a[212:215], v[72:75]
s_add_u32 m0, s29, 99200
ds_read_b64_tr_b16 v[46:47], v20 offset:18440
v_mfma_f32_16x16x32_bf16 v[76:79], v[32:35], a[216:219], v[76:79]
v_mfma_f32_16x16x32_bf16 v[76:79], v[36:39], a[220:223], v[76:79]
s_waitcnt lgkmcnt(0)
ds_read_b64_tr_b16 v[32:33], v21 offset:0
v_mfma_f32_16x16x32_bf16 v[80:83], v[40:43], a[192:195], v[80:83]
ds_read_b64_tr_b16 v[34:35], v21 offset:6144
v_mfma_f32_16x16x32_bf16 v[80:83], v[44:47], a[196:199], v[80:83]
buffer_load_dwordx4 v10, s[12:15], s38 offen offset:128 nt lds
v_mfma_f32_16x16x32_bf16 v[84:87], v[40:43], a[200:203], v[84:87]
ds_read_b64_tr_b16 v[36:37], v21 offset:12288
v_mfma_f32_16x16x32_bf16 v[84:87], v[44:47], a[204:207], v[84:87]
s_add_u32 m0, s29, 100096
ds_read_b64_tr_b16 v[38:39], v21 offset:18432
v_mfma_f32_16x16x32_bf16 v[88:91], v[40:43], a[208:211], v[88:91]
v_mfma_f32_16x16x32_bf16 v[88:91], v[44:47], a[212:215], v[88:91]
v_mfma_f32_16x16x32_bf16 v[92:95], v[40:43], a[216:219], v[92:95]
v_mfma_f32_16x16x32_bf16 v[92:95], v[44:47], a[220:223], v[92:95]
s_waitcnt lgkmcnt(0)
ds_read_b64_tr_b16 v[40:41], v21 offset:8
v_mfma_f32_16x16x32_bf16 v[96:99], v[32:35], a[192:195], v[96:99]
buffer_load_dwordx4 v10, s[12:15], s38 offen offset:256 nt lds
v_mfma_f32_16x16x32_bf16 v[96:99], v[36:39], a[196:199], v[96:99]
s_add_u32 m0, s29, 110592
ds_read_b64_tr_b16 v[42:43], v21 offset:6152
v_mfma_f32_16x16x32_bf16 v[100:103], v[32:35], a[200:203], v[100:103]
ds_read_b64_tr_b16 v[44:45], v21 offset:12296
v_mfma_f32_16x16x32_bf16 v[100:103], v[36:39], a[204:207], v[100:103]
ds_read_b64_tr_b16 v[46:47], v21 offset:18440
v_mfma_f32_16x16x32_bf16 v[104:107], v[32:35], a[208:211], v[104:107]
v_mfma_f32_16x16x32_bf16 v[104:107], v[36:39], a[212:215], v[104:107]
buffer_load_dwordx4 v10, s[12:15], s39 offen offset:0 nt lds
v_mfma_f32_16x16x32_bf16 v[108:111], v[32:35], a[216:219], v[108:111]
v_mfma_f32_16x16x32_bf16 v[108:111], v[36:39], a[220:223], v[108:111]
s_waitcnt lgkmcnt(0)
ds_read_b64_tr_b16 v[32:33], v20 offset:1024
v_mfma_f32_16x16x32_bf16 v[112:115], v[40:43], a[192:195], v[112:115]
s_add_u32 m0, s29, 111488
ds_read_b64_tr_b16 v[34:35], v20 offset:7168
v_mfma_f32_16x16x32_bf16 v[112:115], v[44:47], a[196:199], v[112:115]
ds_read_b64_tr_b16 v[36:37], v20 offset:13312
v_mfma_f32_16x16x32_bf16 v[116:119], v[40:43], a[200:203], v[116:119]
ds_read_b64_tr_b16 v[38:39], v20 offset:19456
v_mfma_f32_16x16x32_bf16 v[116:119], v[44:47], a[204:207], v[116:119]
buffer_load_dwordx4 v10, s[12:15], s39 offen offset:128 nt lds
v_mfma_f32_16x16x32_bf16 v[120:123], v[40:43], a[208:211], v[120:123]
v_mfma_f32_16x16x32_bf16 v[120:123], v[44:47], a[212:215], v[120:123]
s_add_u32 m0, s29, 112384
v_mfma_f32_16x16x32_bf16 v[124:127], v[40:43], a[216:219], v[124:127]
v_mfma_f32_16x16x32_bf16 v[124:127], v[44:47], a[220:223], v[124:127]
s_waitcnt lgkmcnt(0)
ds_read_b64_tr_b16 v[40:41], v20 offset:1032
v_mfma_f32_16x16x32_bf16 v[128:131], v[32:35], a[192:195], v[128:131]
ds_read_b64_tr_b16 v[42:43], v20 offset:7176
v_mfma_f32_16x16x32_bf16 v[128:131], v[36:39], a[196:199], v[128:131]
buffer_load_dwordx4 v10, s[12:15], s39 offen offset:256 nt lds
v_mfma_f32_16x16x32_bf16 v[132:135], v[32:35], a[200:203], v[132:135]
ds_read_b64_tr_b16 v[44:45], v20 offset:13320
v_mfma_f32_16x16x32_bf16 v[132:135], v[36:39], a[204:207], v[132:135]
ds_read_b64_tr_b16 v[46:47], v20 offset:19464
v_mfma_f32_16x16x32_bf16 v[136:139], v[32:35], a[208:211], v[136:139]
v_mfma_f32_16x16x32_bf16 v[136:139], v[36:39], a[212:215], v[136:139]
v_mfma_f32_16x16x32_bf16 v[140:143], v[32:35], a[216:219], v[140:143]
v_mfma_f32_16x16x32_bf16 v[140:143], v[36:39], a[220:223], v[140:143]
s_waitcnt lgkmcnt(0)
ds_read_b64_tr_b16 v[32:33], v21 offset:1024
v_mfma_f32_16x16x32_bf16 v[144:147], v[40:43], a[192:195], v[144:147]
buffer_load_dwordx4 a[32:35], v24, s[8:11], s37 offen offset:0 sc1
v_mfma_f32_16x16x32_bf16 v[144:147], v[44:47], a[196:199], v[144:147]
ds_read_b64_tr_b16 v[34:35], v21 offset:7168
v_mfma_f32_16x16x32_bf16 v[148:151], v[40:43], a[200:203], v[148:151]
ds_read_b64_tr_b16 v[36:37], v21 offset:13312
v_mfma_f32_16x16x32_bf16 v[148:151], v[44:47], a[204:207], v[148:151]
ds_read_b64_tr_b16 v[38:39], v21 offset:19456
v_mfma_f32_16x16x32_bf16 v[152:155], v[40:43], a[208:211], v[152:155]
v_mfma_f32_16x16x32_bf16 v[152:155], v[44:47], a[212:215], v[152:155]
buffer_load_dwordx4 a[36:39], v24, s[8:11], s37 offen offset:1024 sc1
v_mfma_f32_16x16x32_bf16 v[156:159], v[40:43], a[216:219], v[156:159]
v_mfma_f32_16x16x32_bf16 v[156:159], v[44:47], a[220:223], v[156:159]
s_waitcnt lgkmcnt(0)
ds_read_b64_tr_b16 v[40:41], v21 offset:1032
v_mfma_f32_16x16x32_bf16 v[160:163], v[32:35], a[192:195], v[160:163]
ds_read_b64_tr_b16 v[42:43], v21 offset:7176
v_mfma_f32_16x16x32_bf16 v[160:163], v[36:39], a[196:199], v[160:163]
ds_read_b64_tr_b16 v[44:45], v21 offset:13320
v_mfma_f32_16x16x32_bf16 v[164:167], v[32:35], a[200:203], v[164:167]
ds_read_b64_tr_b16 v[46:47], v21 offset:19464
v_mfma_f32_16x16x32_bf16 v[164:167], v[36:39], a[204:207], v[164:167]
v_mfma_f32_16x16x32_bf16 v[168:171], v[32:35], a[208:211], v[168:171]
buffer_load_dwordx4 a[40:43], v25, s[8:11], s37 offen offset:0 sc1
v_mfma_f32_16x16x32_bf16 v[168:171], v[36:39], a[212:215], v[168:171]
v_mfma_f32_16x16x32_bf16 v[172:175], v[32:35], a[216:219], v[172:175]
v_mfma_f32_16x16x32_bf16 v[172:175], v[36:39], a[220:223], v[172:175]
s_waitcnt lgkmcnt(0)
ds_read_b64_tr_b16 v[32:33], v20 offset:2048
v_mfma_f32_16x16x32_bf16 v[176:179], v[40:43], a[192:195], v[176:179]
ds_read_b64_tr_b16 v[34:35], v20 offset:8192
v_mfma_f32_16x16x32_bf16 v[176:179], v[44:47], a[196:199], v[176:179]
ds_read_b64_tr_b16 v[36:37], v20 offset:14336
v_mfma_f32_16x16x32_bf16 v[180:183], v[40:43], a[200:203], v[180:183]
buffer_load_dwordx4 a[44:47], v25, s[8:11], s37 offen offset:1024 sc1
v_mfma_f32_16x16x32_bf16 v[180:183], v[44:47], a[204:207], v[180:183]
ds_read_b64_tr_b16 v[38:39], v20 offset:20480
v_mfma_f32_16x16x32_bf16 v[184:187], v[40:43], a[208:211], v[184:187]
v_mfma_f32_16x16x32_bf16 v[184:187], v[44:47], a[212:215], v[184:187]
v_mfma_f32_16x16x32_bf16 v[188:191], v[40:43], a[216:219], v[188:191]
v_mfma_f32_16x16x32_bf16 v[188:191], v[44:47], a[220:223], v[188:191]
s_waitcnt lgkmcnt(0)
ds_read_b64_tr_b16 v[40:41], v20 offset:2056
v_mfma_f32_16x16x32_bf16 v[192:195], v[32:35], a[192:195], v[192:195]
ds_read_b64_tr_b16 v[42:43], v20 offset:8200
v_mfma_f32_16x16x32_bf16 v[192:195], v[36:39], a[196:199], v[192:195]
buffer_load_dwordx4 a[48:51], v26, s[8:11], s37 offen offset:0 sc1
v_mfma_f32_16x16x32_bf16 v[196:199], v[32:35], a[200:203], v[196:199]
ds_read_b64_tr_b16 v[44:45], v20 offset:14344
v_mfma_f32_16x16x32_bf16 v[196:199], v[36:39], a[204:207], v[196:199]
ds_read_b64_tr_b16 v[46:47], v20 offset:20488
v_mfma_f32_16x16x32_bf16 v[200:203], v[32:35], a[208:211], v[200:203]
v_mfma_f32_16x16x32_bf16 v[200:203], v[36:39], a[212:215], v[200:203]
v_mfma_f32_16x16x32_bf16 v[204:207], v[32:35], a[216:219], v[204:207]
v_mfma_f32_16x16x32_bf16 v[204:207], v[36:39], a[220:223], v[204:207]
s_waitcnt lgkmcnt(0)
ds_read_b64_tr_b16 v[32:33], v21 offset:2048
v_mfma_f32_16x16x32_bf16 v[208:211], v[40:43], a[192:195], v[208:211]
buffer_load_dwordx4 a[52:55], v26, s[8:11], s37 offen offset:1024 sc1
v_mfma_f32_16x16x32_bf16 v[208:211], v[44:47], a[196:199], v[208:211]
ds_read_b64_tr_b16 v[34:35], v21 offset:8192
v_mfma_f32_16x16x32_bf16 v[212:215], v[40:43], a[200:203], v[212:215]
ds_read_b64_tr_b16 v[36:37], v21 offset:14336
v_mfma_f32_16x16x32_bf16 v[212:215], v[44:47], a[204:207], v[212:215]
ds_read_b64_tr_b16 v[38:39], v21 offset:20480
v_mfma_f32_16x16x32_bf16 v[216:219], v[40:43], a[208:211], v[216:219]
v_mfma_f32_16x16x32_bf16 v[216:219], v[44:47], a[212:215], v[216:219]
v_mfma_f32_16x16x32_bf16 v[220:223], v[40:43], a[216:219], v[220:223]
buffer_load_dwordx4 a[56:59], v27, s[8:11], s37 offen offset:0 sc1
v_mfma_f32_16x16x32_bf16 v[220:223], v[44:47], a[220:223], v[220:223]
s_waitcnt lgkmcnt(0)
ds_read_b64_tr_b16 v[40:41], v21 offset:2056
v_mfma_f32_16x16x32_bf16 v[224:227], v[32:35], a[192:195], v[224:227]
ds_read_b64_tr_b16 v[42:43], v21 offset:8200
v_mfma_f32_16x16x32_bf16 v[224:227], v[36:39], a[196:199], v[224:227]
ds_read_b64_tr_b16 v[44:45], v21 offset:14344
v_mfma_f32_16x16x32_bf16 v[228:231], v[32:35], a[200:203], v[228:231]
ds_read_b64_tr_b16 v[46:47], v21 offset:20488
v_mfma_f32_16x16x32_bf16 v[228:231], v[36:39], a[204:207], v[228:231]
v_mfma_f32_16x16x32_bf16 v[232:235], v[32:35], a[208:211], v[232:235]
buffer_load_dwordx4 a[60:63], v27, s[8:11], s37 offen offset:1024 sc1
v_mfma_f32_16x16x32_bf16 v[232:235], v[36:39], a[212:215], v[232:235]
v_mfma_f32_16x16x32_bf16 v[236:239], v[32:35], a[216:219], v[236:239]
v_mfma_f32_16x16x32_bf16 v[236:239], v[36:39], a[220:223], v[236:239]
s_waitcnt lgkmcnt(0)
ds_read_b64_tr_b16 v[32:33], v20 offset:24576
v_mfma_f32_16x16x32_bf16 v[240:243], v[40:43], a[192:195], v[240:243]
ds_read_b64_tr_b16 v[34:35], v20 offset:30720
v_mfma_f32_16x16x32_bf16 v[240:243], v[44:47], a[196:199], v[240:243]
ds_read_b64_tr_b16 v[36:37], v20 offset:36864
v_mfma_f32_16x16x32_bf16 v[244:247], v[40:43], a[200:203], v[244:247]
ds_read_b64_tr_b16 v[38:39], v20 offset:43008
v_mfma_f32_16x16x32_bf16 v[244:247], v[44:47], a[204:207], v[244:247]
v_mfma_f32_16x16x32_bf16 v[248:251], v[40:43], a[208:211], v[248:251]
v_mfma_f32_16x16x32_bf16 v[248:251], v[44:47], a[212:215], v[248:251]
v_mfma_f32_16x16x32_bf16 v[252:255], v[40:43], a[216:219], v[252:255]
v_mfma_f32_16x16x32_bf16 v[252:255], v[44:47], a[220:223], v[252:255]
s_waitcnt lgkmcnt(0)
v_mfma_f32_16x16x32_bf16 v[64:67], v[32:35], a[224:227], v[64:67]
s_mov_b32 s38, 7077888
s_mov_b32 s39, 7471104
s_add_u32 m0, s29, 122880
v_mfma_f32_16x16x32_bf16 v[64:67], v[36:39], a[228:231], v[64:67]
ds_read_b64_tr_b16 v[40:41], v20 offset:24584
v_mfma_f32_16x16x32_bf16 v[68:71], v[32:35], a[232:235], v[68:71]
ds_read_b64_tr_b16 v[42:43], v20 offset:30728
v_mfma_f32_16x16x32_bf16 v[68:71], v[36:39], a[236:239], v[68:71]
buffer_load_dwordx4 v10, s[12:15], s38 offen offset:0 nt lds
v_mfma_f32_16x16x32_bf16 v[72:75], v[32:35], a[240:243], v[72:75]
s_add_u32 m0, s29, 123776
ds_read_b64_tr_b16 v[44:45], v20 offset:36872
v_mfma_f32_16x16x32_bf16 v[72:75], v[36:39], a[244:247], v[72:75]
ds_read_b64_tr_b16 v[46:47], v20 offset:43016
v_mfma_f32_16x16x32_bf16 v[76:79], v[32:35], a[248:251], v[76:79]
v_mfma_f32_16x16x32_bf16 v[76:79], v[36:39], a[252:255], v[76:79]
s_waitcnt lgkmcnt(0)
ds_read_b64_tr_b16 v[32:33], v21 offset:24576
v_mfma_f32_16x16x32_bf16 v[80:83], v[40:43], a[224:227], v[80:83]
buffer_load_dwordx4 v10, s[12:15], s38 offen offset:128 nt lds
v_mfma_f32_16x16x32_bf16 v[80:83], v[44:47], a[228:231], v[80:83]
s_add_u32 m0, s29, 124672
ds_read_b64_tr_b16 v[34:35], v21 offset:30720
v_mfma_f32_16x16x32_bf16 v[84:87], v[40:43], a[232:235], v[84:87]
ds_read_b64_tr_b16 v[36:37], v21 offset:36864
v_mfma_f32_16x16x32_bf16 v[84:87], v[44:47], a[236:239], v[84:87]
buffer_load_dwordx4 v10, s[12:15], s38 offen offset:256 nt lds
v_mfma_f32_16x16x32_bf16 v[88:91], v[40:43], a[240:243], v[88:91]
s_add_u32 m0, s29, 135168
ds_read_b64_tr_b16 v[38:39], v21 offset:43008
v_mfma_f32_16x16x32_bf16 v[88:91], v[44:47], a[244:247], v[88:91]
v_mfma_f32_16x16x32_bf16 v[92:95], v[40:43], a[248:251], v[92:95]
v_mfma_f32_16x16x32_bf16 v[92:95], v[44:47], a[252:255], v[92:95]
s_waitcnt lgkmcnt(0)
ds_read_b64_tr_b16 v[40:41], v21 offset:24584
v_mfma_f32_16x16x32_bf16 v[96:99], v[32:35], a[224:227], v[96:99]
buffer_load_dwordx4 v10, s[12:15], s39 offen offset:0 nt lds
v_mfma_f32_16x16x32_bf16 v[96:99], v[36:39], a[228:231], v[96:99]
s_add_u32 m0, s29, 136064
ds_read_b64_tr_b16 v[42:43], v21 offset:30728
v_mfma_f32_16x16x32_bf16 v[100:103], v[32:35], a[232:235], v[100:103]
ds_read_b64_tr_b16 v[44:45], v21 offset:36872
v_mfma_f32_16x16x32_bf16 v[100:103], v[36:39], a[236:239], v[100:103]
buffer_load_dwordx4 v10, s[12:15], s39 offen offset:128 nt lds
v_mfma_f32_16x16x32_bf16 v[104:107], v[32:35], a[240:243], v[104:107]
s_add_u32 m0, s29, 136960
ds_read_b64_tr_b16 v[46:47], v21 offset:43016
v_mfma_f32_16x16x32_bf16 v[104:107], v[36:39], a[244:247], v[104:107]
v_mfma_f32_16x16x32_bf16 v[108:111], v[32:35], a[248:251], v[108:111]
v_mfma_f32_16x16x32_bf16 v[108:111], v[36:39], a[252:255], v[108:111]
s_waitcnt lgkmcnt(0)
ds_read_b64_tr_b16 v[32:33], v20 offset:25600
v_mfma_f32_16x16x32_bf16 v[112:115], v[40:43], a[224:227], v[112:115]
buffer_load_dwordx4 v10, s[12:15], s39 offen offset:256 nt lds
v_mfma_f32_16x16x32_bf16 v[112:115], v[44:47], a[228:231], v[112:115]
s_add_u32 m0, s29, 0
ds_read_b64_tr_b16 v[34:35], v20 offset:31744
v_mfma_f32_16x16x32_bf16 v[116:119], v[40:43], a[232:235], v[116:119]
ds_read_b64_tr_b16 v[36:37], v20 offset:37888
v_mfma_f32_16x16x32_bf16 v[116:119], v[44:47], a[236:239], v[116:119]
ds_read_b64_tr_b16 v[38:39], v20 offset:44032
v_mfma_f32_16x16x32_bf16 v[120:123], v[40:43], a[240:243], v[120:123]
buffer_load_dwordx4 v8, s[16:19], s32 offen offset:0 nt lds
v_mfma_f32_16x16x32_bf16 v[120:123], v[44:47], a[244:247], v[120:123]
s_add_u32 m0, s29, 896
v_mfma_f32_16x16x32_bf16 v[124:127], v[40:43], a[248:251], v[124:127]
v_mfma_f32_16x16x32_bf16 v[124:127], v[44:47], a[252:255], v[124:127]
s_waitcnt lgkmcnt(0)
ds_read_b64_tr_b16 v[40:41], v20 offset:25608
v_mfma_f32_16x16x32_bf16 v[128:131], v[32:35], a[224:227], v[128:131]
buffer_load_dwordx4 v8, s[16:19], s32 offen offset:128 nt lds
v_mfma_f32_16x16x32_bf16 v[128:131], v[36:39], a[228:231], v[128:131]
s_add_u32 m0, s29, 1792
ds_read_b64_tr_b16 v[42:43], v20 offset:31752
v_mfma_f32_16x16x32_bf16 v[132:135], v[32:35], a[232:235], v[132:135]
ds_read_b64_tr_b16 v[44:45], v20 offset:37896
v_mfma_f32_16x16x32_bf16 v[132:135], v[36:39], a[236:239], v[132:135]
ds_read_b64_tr_b16 v[46:47], v20 offset:44040
v_mfma_f32_16x16x32_bf16 v[136:139], v[32:35], a[240:243], v[136:139]
buffer_load_dwordx4 v8, s[16:19], s32 offen offset:256 nt lds
v_mfma_f32_16x16x32_bf16 v[136:139], v[36:39], a[244:247], v[136:139]
s_add_u32 m0, s29, 12288
v_mfma_f32_16x16x32_bf16 v[140:143], v[32:35], a[248:251], v[140:143]
v_mfma_f32_16x16x32_bf16 v[140:143], v[36:39], a[252:255], v[140:143]
s_waitcnt lgkmcnt(0)
ds_read_b64_tr_b16 v[32:33], v21 offset:25600
v_mfma_f32_16x16x32_bf16 v[144:147], v[40:43], a[224:227], v[144:147]
buffer_load_dwordx4 v8, s[16:19], s33 offen offset:0 nt lds
v_mfma_f32_16x16x32_bf16 v[144:147], v[44:47], a[228:231], v[144:147]
s_add_u32 m0, s29, 13184
ds_read_b64_tr_b16 v[34:35], v21 offset:31744
v_mfma_f32_16x16x32_bf16 v[148:151], v[40:43], a[232:235], v[148:151]
ds_read_b64_tr_b16 v[36:37], v21 offset:37888
v_mfma_f32_16x16x32_bf16 v[148:151], v[44:47], a[236:239], v[148:151]
ds_read_b64_tr_b16 v[38:39], v21 offset:44032
v_mfma_f32_16x16x32_bf16 v[152:155], v[40:43], a[240:243], v[152:155]
buffer_load_dwordx4 v8, s[16:19], s33 offen offset:128 nt lds
v_mfma_f32_16x16x32_bf16 v[152:155], v[44:47], a[244:247], v[152:155]
s_add_u32 m0, s29, 14080
v_mfma_f32_16x16x32_bf16 v[156:159], v[40:43], a[248:251], v[156:159]
v_mfma_f32_16x16x32_bf16 v[156:159], v[44:47], a[252:255], v[156:159]
s_waitcnt lgkmcnt(0)
ds_read_b64_tr_b16 v[40:41], v21 offset:25608
v_mfma_f32_16x16x32_bf16 v[160:163], v[32:35], a[224:227], v[160:163]
buffer_load_dwordx4 v8, s[16:19], s33 offen offset:256 nt lds
v_mfma_f32_16x16x32_bf16 v[160:163], v[36:39], a[228:231], v[160:163]
ds_read_b64_tr_b16 v[42:43], v21 offset:31752
v_mfma_f32_16x16x32_bf16 v[164:167], v[32:35], a[232:235], v[164:167]
ds_read_b64_tr_b16 v[44:45], v21 offset:37896
v_mfma_f32_16x16x32_bf16 v[164:167], v[36:39], a[236:239], v[164:167]
ds_read_b64_tr_b16 v[46:47], v21 offset:44040
v_mfma_f32_16x16x32_bf16 v[168:171], v[32:35], a[240:243], v[168:171]
s_add_u32 m0, s82, 0
s_nop 0
v_mfma_f32_16x16x32_bf16 v[168:171], v[36:39], a[244:247], v[168:171]
v_mfma_f32_16x16x32_bf16 v[172:175], v[32:35], a[248:251], v[172:175]
buffer_load_dwordx4 v28, s[52:55], s64 offen lds
v_mfma_f32_16x16x32_bf16 v[172:175], v[36:39], a[252:255], v[172:175]
s_waitcnt lgkmcnt(0)
ds_read_b64_tr_b16 v[32:33], v20 offset:26624
v_mfma_f32_16x16x32_bf16 v[176:179], v[40:43], a[224:227], v[176:179]
ds_read_b64_tr_b16 v[34:35], v20 offset:32768
v_mfma_f32_16x16x32_bf16 v[176:179], v[44:47], a[228:231], v[176:179]
ds_read_b64_tr_b16 v[36:37], v20 offset:38912
v_mfma_f32_16x16x32_bf16 v[180:183], v[40:43], a[232:235], v[180:183]
ds_read_b64_tr_b16 v[38:39], v20 offset:45056
v_mfma_f32_16x16x32_bf16 v[180:183], v[44:47], a[236:239], v[180:183]
s_add_u32 m0, s82, 1024
s_add_u32 s64, s64, s66
v_mfma_f32_16x16x32_bf16 v[184:187], v[40:43], a[240:243], v[184:187]
v_mfma_f32_16x16x32_bf16 v[184:187], v[44:47], a[244:247], v[184:187]
v_mfma_f32_16x16x32_bf16 v[188:191], v[40:43], a[248:251], v[188:191]
buffer_load_dwordx4 v28, s[52:55], s64 offen lds
v_mfma_f32_16x16x32_bf16 v[188:191], v[44:47], a[252:255], v[188:191]
s_waitcnt lgkmcnt(0)
ds_read_b64_tr_b16 v[40:41], v20 offset:26632
v_mfma_f32_16x16x32_bf16 v[192:195], v[32:35], a[224:227], v[192:195]
ds_read_b64_tr_b16 v[42:43], v20 offset:32776
v_mfma_f32_16x16x32_bf16 v[192:195], v[36:39], a[228:231], v[192:195]
ds_read_b64_tr_b16 v[44:45], v20 offset:38920
v_mfma_f32_16x16x32_bf16 v[196:199], v[32:35], a[232:235], v[196:199]
ds_read_b64_tr_b16 v[46:47], v20 offset:45064
v_mfma_f32_16x16x32_bf16 v[196:199], v[36:39], a[236:239], v[196:199]
s_add_u32 m0, s82, 2048
s_add_u32 s64, s64, s66
v_mfma_f32_16x16x32_bf16 v[200:203], v[32:35], a[240:243], v[200:203]
v_mfma_f32_16x16x32_bf16 v[200:203], v[36:39], a[244:247], v[200:203]
v_mfma_f32_16x16x32_bf16 v[204:207], v[32:35], a[248:251], v[204:207]
buffer_load_dwordx4 v28, s[52:55], s64 offen lds
v_mfma_f32_16x16x32_bf16 v[204:207], v[36:39], a[252:255], v[204:207]
s_waitcnt lgkmcnt(0)
ds_read_b64_tr_b16 v[32:33], v21 offset:26624
v_mfma_f32_16x16x32_bf16 v[208:211], v[40:43], a[224:227], v[208:211]
ds_read_b64_tr_b16 v[34:35], v21 offset:32768
v_mfma_f32_16x16x32_bf16 v[208:211], v[44:47], a[228:231], v[208:211]
ds_read_b64_tr_b16 v[36:37], v21 offset:38912
v_mfma_f32_16x16x32_bf16 v[212:215], v[40:43], a[232:235], v[212:215]
ds_read_b64_tr_b16 v[38:39], v21 offset:45056
v_mfma_f32_16x16x32_bf16 v[212:215], v[44:47], a[236:239], v[212:215]
s_add_u32 m0, s82, 3072
s_add_u32 s64, s64, s66
v_mfma_f32_16x16x32_bf16 v[216:219], v[40:43], a[240:243], v[216:219]
v_mfma_f32_16x16x32_bf16 v[216:219], v[44:47], a[244:247], v[216:219]
v_mfma_f32_16x16x32_bf16 v[220:223], v[40:43], a[248:251], v[220:223]
buffer_load_dwordx4 v28, s[52:55], s64 offen lds
v_mfma_f32_16x16x32_bf16 v[220:223], v[44:47], a[252:255], v[220:223]
s_waitcnt lgkmcnt(0)
ds_read_b64_tr_b16 v[40:41], v21 offset:26632
v_mfma_f32_16x16x32_bf16 v[224:227], v[32:35], a[224:227], v[224:227]
ds_read_b64_tr_b16 v[42:43], v21 offset:32776
v_mfma_f32_16x16x32_bf16 v[224:227], v[36:39], a[228:231], v[224:227]
ds_read_b64_tr_b16 v[44:45], v21 offset:38920
v_mfma_f32_16x16x32_bf16 v[228:231], v[32:35], a[232:235], v[228:231]
ds_read_b64_tr_b16 v[46:47], v21 offset:45064
v_mfma_f32_16x16x32_bf16 v[228:231], v[36:39], a[236:239], v[228:231]
v_mfma_f32_16x16x32_bf16 v[232:235], v[32:35], a[240:243], v[232:235]
v_mfma_f32_16x16x32_bf16 v[232:235], v[36:39], a[244:247], v[232:235]
v_mfma_f32_16x16x32_bf16 v[236:239], v[32:35], a[248:251], v[236:239]
v_mfma_f32_16x16x32_bf16 v[236:239], v[36:39], a[252:255], v[236:239]
s_waitcnt lgkmcnt(0)
s_waitcnt vmcnt(10)
s_barrier
v_mfma_f32_16x16x32_bf16 v[240:243], v[40:43], a[224:227], v[240:243]
ds_read_b64_tr_b16 v[32:33], v22 offset:0
v_mfma_f32_16x16x32_bf16 v[240:243], v[44:47], a[228:231], v[240:243]
ds_read_b64_tr_b16 v[34:35], v22 offset:6144
v_mfma_f32_16x16x32_bf16 v[244:247], v[40:43], a[232:235], v[244:247]
ds_read_b64_tr_b16 v[36:37], v22 offset:12288
v_mfma_f32_16x16x32_bf16 v[244:247], v[44:47], a[236:239], v[244:247]
ds_read_b64_tr_b16 v[38:39], v22 offset:18432
v_mfma_f32_16x16x32_bf16 v[248:251], v[40:43], a[240:243], v[248:251]
v_mfma_f32_16x16x32_bf16 v[248:251], v[44:47], a[244:247], v[248:251]
v_mfma_f32_16x16x32_bf16 v[252:255], v[40:43], a[248:251], v[252:255]
v_mfma_f32_16x16x32_bf16 v[252:255], v[44:47], a[252:255], v[252:255]
s_waitcnt lgkmcnt(0)
v_mfma_f32_16x16x32_bf16 v[64:67], v[32:35], a[0:3], v[64:67]
s_add_u32 s32, s32, 24576
s_add_u32 s33, s33, 24576
s_add_u32 m0, s29, 24576
v_mfma_f32_16x16x32_bf16 v[64:67], v[36:39], a[4:7], v[64:67]
ds_read_b64_tr_b16 v[40:41], v22 offset:8
v_mfma_f32_16x16x32_bf16 v[68:71], v[32:35], a[8:11], v[68:71]
ds_read_b64_tr_b16 v[42:43], v22 offset:6152
v_mfma_f32_16x16x32_bf16 v[68:71], v[36:39], a[12:15], v[68:71]
ds_read_b64_tr_b16 v[44:45], v22 offset:12296
v_mfma_f32_16x16x32_bf16 v[72:75], v[32:35], a[16:19], v[72:75]
buffer_load_dwordx4 v8, s[16:19], s32 offen offset:0 nt lds
v_mfma_f32_16x16x32_bf16 v[72:75], v[36:39], a[20:23], v[72:75]
ds_read_b64_tr_b16 v[46:47], v22 offset:18440
v_mfma_f32_16x16x32_bf16 v[76:79], v[32:35], a[24:27], v[76:79]
v_mfma_f32_16x16x32_bf16 v[76:79], v[36:39], a[28:31], v[76:79]
s_waitcnt lgkmcnt(0)
ds_read_b64_tr_b16 v[32:33], v23 offset:0
v_mfma_f32_16x16x32_bf16 v[80:83], v[40:43], a[0:3], v[80:83]
s_add_u32 m0, s29, 25472
ds_read_b64_tr_b16 v[34:35], v23 offset:6144
v_mfma_f32_16x16x32_bf16 v[80:83], v[44:47], a[4:7], v[80:83]
ds_read_b64_tr_b16 v[36:37], v23 offset:12288
v_mfma_f32_16x16x32_bf16 v[84:87], v[40:43], a[8:11], v[84:87]
ds_read_b64_tr_b16 v[38:39], v23 offset:18432
v_mfma_f32_16x16x32_bf16 v[84:87], v[44:47], a[12:15], v[84:87]
v_mfma_f32_16x16x32_bf16 v[88:91], v[40:43], a[16:19], v[88:91]
buffer_load_dwordx4 v8, s[16:19], s32 offen offset:128 nt lds
v_mfma_f32_16x16x32_bf16 v[88:91], v[44:47], a[20:23], v[88:91]
v_mfma_f32_16x16x32_bf16 v[92:95], v[40:43], a[24:27], v[92:95]
v_mfma_f32_16x16x32_bf16 v[92:95], v[44:47], a[28:31], v[92:95]
s_waitcnt lgkmcnt(0)
ds_read_b64_tr_b16 v[40:41], v23 offset:8
v_mfma_f32_16x16x32_bf16 v[96:99], v[32:35], a[0:3], v[96:99]
s_add_u32 m0, s29, 26368
ds_read_b64_tr_b16 v[42:43], v23 offset:6152
v_mfma_f32_16x16x32_bf16 v[96:99], v[36:39], a[4:7], v[96:99]
ds_read_b64_tr_b16 v[44:45], v23 offset:12296
v_mfma_f32_16x16x32_bf16 v[100:103], v[32:35], a[8:11], v[100:103]
ds_read_b64_tr_b16 v[46:47], v23 offset:18440
v_mfma_f32_16x16x32_bf16 v[100:103], v[36:39], a[12:15], v[100:103]
v_mfma_f32_16x16x32_bf16 v[104:107], v[32:35], a[16:19], v[104:107]
buffer_load_dwordx4 v8, s[16:19], s32 offen offset:256 nt lds
v_mfma_f32_16x16x32_bf16 v[104:107], v[36:39], a[20:23], v[104:107]
v_mfma_f32_16x16x32_bf16 v[108:111], v[32:35], a[24:27], v[108:111]
v_mfma_f32_16x16x32_bf16 v[108:111], v[36:39], a[28:31], v[108:111]
s_waitcnt lgkmcnt(0)
ds_read_b64_tr_b16 v[32:33], v22 offset:1024
v_mfma_f32_16x16x32_bf16 v[112:115], v[40:43], a[0:3], v[112:115]
s_add_u32 m0, s29, 36864
ds_read_b64_tr_b16 v[34:35], v22 offset:7168
v_mfma_f32_16x16x32_bf16 v[112:115], v[44:47], a[4:7], v[112:115]
ds_read_b64_tr_b16 v[36:37], v22 offset:13312
v_mfma_f32_16x16x32_bf16 v[116:119], v[40:43], a[8:11], v[116:119]
ds_read_b64_tr_b16 v[38:39], v22 offset:19456
v_mfma_f32_16x16x32_bf16 v[116:119], v[44:47], a[12:15], v[116:119]
v_mfma_f32_16x16x32_bf16 v[120:123], v[40:43], a[16:19], v[120:123]
buffer_load_dwordx4 v8, s[16:19], s33 offen offset:0 nt lds
v_mfma_f32_16x16x32_bf16 v[120:123], v[44:47], a[20:23], v[120:123]
v_mfma_f32_16x16x32_bf16 v[124:127], v[40:43], a[24:27], v[124:127]
v_mfma_f32_16x16x32_bf16 v[124:127], v[44:47], a[28:31], v[124:127]
s_waitcnt lgkmcnt(0)
ds_read_b64_tr_b16 v[40:41], v22 offset:1032
v_mfma_f32_16x16x32_bf16 v[128:131], v[32:35], a[0:3], v[128:131]
s_add_u32 m0, s29, 37760
ds_read_b64_tr_b16 v[42:43], v22 offset:7176
v_mfma_f32_16x16x32_bf16 v[128:131], v[36:39], a[4:7], v[128:131]
ds_read_b64_tr_b16 v[44:45], v22 offset:13320
v_mfma_f32_16x16x32_bf16 v[132:135], v[32:35], a[8:11], v[132:135]
ds_read_b64_tr_b16 v[46:47], v22 offset:19464
v_mfma_f32_16x16x32_bf16 v[132:135], v[36:39], a[12:15], v[132:135]
v_mfma_f32_16x16x32_bf16 v[136:139], v[32:35], a[16:19], v[136:139]
buffer_load_dwordx4 v8, s[16:19], s33 offen offset:128 nt lds
v_mfma_f32_16x16x32_bf16 v[136:139], v[36:39], a[20:23], v[136:139]
v_mfma_f32_16x16x32_bf16 v[140:143], v[32:35], a[24:27], v[140:143]
v_mfma_f32_16x16x32_bf16 v[140:143], v[36:39], a[28:31], v[140:143]
s_waitcnt lgkmcnt(0)
ds_read_b64_tr_b16 v[32:33], v23 offset:1024
v_mfma_f32_16x16x32_bf16 v[144:147], v[40:43], a[0:3], v[144:147]
s_add_u32 m0, s29, 38656
ds_read_b64_tr_b16 v[34:35], v23 offset:7168
v_mfma_f32_16x16x32_bf16 v[144:147], v[44:47], a[4:7], v[144:147]
ds_read_b64_tr_b16 v[36:37], v23 offset:13312
v_mfma_f32_16x16x32_bf16 v[148:151], v[40:43], a[8:11], v[148:151]
ds_read_b64_tr_b16 v[38:39], v23 offset:19456
v_mfma_f32_16x16x32_bf16 v[148:151], v[44:47], a[12:15], v[148:151]
v_mfma_f32_16x16x32_bf16 v[152:155], v[40:43], a[16:19], v[152:155]
buffer_load_dwordx4 v8, s[16:19], s33 offen offset:256 nt lds
v_mfma_f32_16x16x32_bf16 v[152:155], v[44:47], a[20:23], v[152:155]
v_mfma_f32_16x16x32_bf16 v[156:159], v[40:43], a[24:27], v[156:159]
v_mfma_f32_16x16x32_bf16 v[156:159], v[44:47], a[28:31], v[156:159]
s_waitcnt lgkmcnt(0)
ds_read_b64_tr_b16 v[40:41], v23 offset:1032
v_mfma_f32_16x16x32_bf16 v[160:163], v[32:35], a[0:3], v[160:163]
s_waitcnt vmcnt(6)
ds_read_b64_tr_b16 v[42:43], v23 offset:7176
v_mfma_f32_16x16x32_bf16 v[160:163], v[36:39], a[4:7], v[160:163]
ds_read_b64_tr_b16 a[64:65], v30 offset:0
v_mfma_f32_16x16x32_bf16 v[164:167], v[32:35], a[8:11], v[164:167]
ds_read_b64_tr_b16 v[44:45], v23 offset:13320
v_mfma_f32_16x16x32_bf16 v[164:167], v[36:39], a[12:15], v[164:167]
ds_read_b64_tr_b16 v[46:47], v23 offset:19464
v_mfma_f32_16x16x32_bf16 v[168:171], v[32:35], a[16:19], v[168:171]
ds_read_b64_tr_b16 a[66:67], v30 offset:2048
v_mfma_f32_16x16x32_bf16 v[168:171], v[36:39], a[20:23], v[168:171]
ds_read_b64_tr_b16 a[68:69], v30 offset:32
v_mfma_f32_16x16x32_bf16 v[172:175], v[32:35], a[24:27], v[172:175]
ds_read_b64_tr_b16 a[70:71], v30 offset:2080
v_mfma_f32_16x16x32_bf16 v[172:175], v[36:39], a[28:31], v[172:175]
s_waitcnt lgkmcnt(3)
ds_read_b64_tr_b16 v[32:33], v22 offset:2048
v_mfma_f32_16x16x32_bf16 v[176:179], v[40:43], a[0:3], v[176:179]
ds_read_b64_tr_b16 v[34:35], v22 offset:8192
v_mfma_f32_16x16x32_bf16 v[176:179], v[44:47], a[4:7], v[176:179]
ds_read_b64_tr_b16 v[36:37], v22 offset:14336
v_mfma_f32_16x16x32_bf16 v[180:183], v[40:43], a[8:11], v[180:183]
ds_read_b64_tr_b16 v[38:39], v22 offset:20480
v_mfma_f32_16x16x32_bf16 v[180:183], v[44:47], a[12:15], v[180:183]
ds_read_b64_tr_b16 a[72:73], v30 offset:64
v_mfma_f32_16x16x32_bf16 v[184:187], v[40:43], a[16:19], v[184:187]
ds_read_b64_tr_b16 a[74:75], v30 offset:2112
v_mfma_f32_16x16x32_bf16 v[184:187], v[44:47], a[20:23], v[184:187]
ds_read_b64_tr_b16 a[76:77], v30 offset:96
v_mfma_f32_16x16x32_bf16 v[188:191], v[40:43], a[24:27], v[188:191]
ds_read_b64_tr_b16 a[78:79], v30 offset:2144
v_mfma_f32_16x16x32_bf16 v[188:191], v[44:47], a[28:31], v[188:191]
s_waitcnt lgkmcnt(4)
ds_read_b64_tr_b16 v[40:41], v22 offset:2056
v_mfma_f32_16x16x32_bf16 v[192:195], v[32:35], a[0:3], v[192:195]
ds_read_b64_tr_b16 v[42:43], v22 offset:8200
v_mfma_f32_16x16x32_bf16 v[192:195], v[36:39], a[4:7], v[192:195]
ds_read_b64_tr_b16 v[44:45], v22 offset:14344
v_mfma_f32_16x16x32_bf16 v[196:199], v[32:35], a[8:11], v[196:199]
ds_read_b64_tr_b16 v[46:47], v22 offset:20488
v_mfma_f32_16x16x32_bf16 v[196:199], v[36:39], a[12:15], v[196:199]
v_mfma_f32_16x16x32_bf16 v[200:203], v[32:35], a[16:19], v[200:203]
v_mfma_f32_16x16x32_bf16 v[200:203], v[36:39], a[20:23], v[200:203]
v_mfma_f32_16x16x32_bf16 v[204:207], v[32:35], a[24:27], v[204:207]
v_mfma_f32_16x16x32_bf16 v[204:207], v[36:39], a[28:31], v[204:207]
s_waitcnt lgkmcnt(0)
ds_read_b64_tr_b16 v[32:33], v23 offset:2048
v_mfma_f32_16x16x32_bf16 v[208:211], v[40:43], a[0:3], v[208:211]
ds_read_b64_tr_b16 v[34:35], v23 offset:8192
v_mfma_f32_16x16x32_bf16 v[208:211], v[44:47], a[4:7], v[208:211]
ds_read_b64_tr_b16 v[36:37], v23 offset:14336
v_mfma_f32_16x16x32_bf16 v[212:215], v[40:43], a[8:11], v[212:215]
ds_read_b64_tr_b16 v[38:39], v23 offset:20480
v_mfma_f32_16x16x32_bf16 v[212:215], v[44:47], a[12:15], v[212:215]
v_mfma_f32_16x16x32_bf16 v[216:219], v[40:43], a[16:19], v[216:219]
v_mfma_f32_16x16x32_bf16 v[216:219], v[44:47], a[20:23], v[216:219]
v_mfma_f32_16x16x32_bf16 v[220:223], v[40:43], a[24:27], v[220:223]
v_mfma_f32_16x16x32_bf16 v[220:223], v[44:47], a[28:31], v[220:223]
s_waitcnt lgkmcnt(0)
ds_read_b64_tr_b16 v[40:41], v23 offset:2056
v_mfma_f32_16x16x32_bf16 v[224:227], v[32:35], a[0:3], v[224:227]
ds_read_b64_tr_b16 v[42:43], v23 offset:8200
buffer_store_dwordx4 a[64:67], v11, s[60:63], s72 offen sc1
v_mfma_f32_16x16x32_bf16 v[224:227], v[36:39], a[4:7], v[224:227]
ds_read_b64_tr_b16 v[44:45], v23 offset:14344
v_mfma_f32_16x16x32_bf16 v[228:231], v[32:35], a[8:11], v[228:231]
buffer_store_dwordx4 a[68:71], v11, s[60:63], s73 offen sc1
v_mfma_f32_16x16x32_bf16 v[228:231], v[36:39], a[12:15], v[228:231]
ds_read_b64_tr_b16 v[46:47], v23 offset:20488
v_mfma_f32_16x16x32_bf16 v[232:235], v[32:35], a[16:19], v[232:235]
v_mfma_f32_16x16x32_bf16 v[232:235], v[36:39], a[20:23], v[232:235]
v_mfma_f32_16x16x32_bf16 v[236:239], v[32:35], a[24:27], v[236:239]
buffer_store_dwordx4 a[72:75], v11, s[60:63], s74 offen sc1
v_mfma_f32_16x16x32_bf16 v[236:239], v[36:39], a[28:31], v[236:239]
s_waitcnt lgkmcnt(0)
ds_read_b64_tr_b16 v[32:33], v22 offset:24576
v_mfma_f32_16x16x32_bf16 v[240:243], v[40:43], a[0:3], v[240:243]
ds_read_b64_tr_b16 v[34:35], v22 offset:30720
v_mfma_f32_16x16x32_bf16 v[240:243], v[44:47], a[4:7], v[240:243]
ds_read_b64_tr_b16 v[36:37], v22 offset:36864
v_mfma_f32_16x16x32_bf16 v[244:247], v[40:43], a[8:11], v[244:247]
buffer_store_dwordx4 a[76:79], v11, s[60:63], s75 offen sc1
v_mfma_f32_16x16x32_bf16 v[244:247], v[44:47], a[12:15], v[244:247]
ds_read_b64_tr_b16 v[38:39], v22 offset:43008
v_mfma_f32_16x16x32_bf16 v[248:251], v[40:43], a[16:19], v[248:251]
v_mfma_f32_16x16x32_bf16 v[248:251], v[44:47], a[20:23], v[248:251]
v_mfma_f32_16x16x32_bf16 v[252:255], v[40:43], a[24:27], v[252:255]
v_mfma_f32_16x16x32_bf16 v[252:255], v[44:47], a[28:31], v[252:255]
s_waitcnt lgkmcnt(0)
v_mfma_f32_16x16x32_bf16 v[64:67], v[32:35], a[32:35], v[64:67]
ds_read_b64_tr_b16 v[40:41], v22 offset:24584
v_mfma_f32_16x16x32_bf16 v[64:67], v[36:39], a[36:39], v[64:67]
ds_read_b64_tr_b16 v[42:43], v22 offset:30728
v_mfma_f32_16x16x32_bf16 v[68:71], v[32:35], a[40:43], v[68:71]
ds_read_b64_tr_b16 v[44:45], v22 offset:36872
v_mfma_f32_16x16x32_bf16 v[68:71], v[36:39], a[44:47], v[68:71]
s_add_u32 m0, s29, 73728
ds_read_b64_tr_b16 v[46:47], v22 offset:43016
v_mfma_f32_16x16x32_bf16 v[72:75], v[32:35], a[48:51], v[72:75]
s_waitcnt lgkmcnt(0)
s_barrier
v_mfma_f32_16x16x32_bf16 v[72:75], v[36:39], a[52:55], v[72:75]
v_mfma_f32_16x16x32_bf16 v[76:79], v[32:35], a[56:59], v[76:79]
v_mfma_f32_16x16x32_bf16 v[76:79], v[36:39], a[60:63], v[76:79]
buffer_load_dwordx4 v9, s[20:23], s34 offen offset:0 nt lds
v_mfma_f32_16x16x32_bf16 v[80:83], v[40:43], a[32:35], v[80:83]
ds_read_b64_tr_b16 v[32:33], v23 offset:24576
v_mfma_f32_16x16x32_bf16 v[80:83], v[44:47], a[36:39], v[80:83]
ds_read_b64_tr_b16 v[34:35], v23 offset:30720
v_mfma_f32_16x16x32_bf16 v[84:87], v[40:43], a[40:43], v[84:87]
ds_read_b64_tr_b16 v[36:37], v23 offset:36864
v_mfma_f32_16x16x32_bf16 v[84:87], v[44:47], a[44:47], v[84:87]
s_add_u32 m0, s29, 74624
ds_read_b64_tr_b16 v[38:39], v23 offset:43008
v_mfma_f32_16x16x32_bf16 v[88:91], v[40:43], a[48:51], v[88:91]
v_mfma_f32_16x16x32_bf16 v[88:91], v[44:47], a[52:55], v[88:91]
v_cvt_pk_bf16_f32 v64, v64, v65
v_cvt_pk_bf16_f32 v65, v66, v67
v_mfma_f32_16x16x32_bf16 v[92:95], v[40:43], a[56:59], v[92:95]
v_cvt_pk_bf16_f32 v66, v80, v81
v_cvt_pk_bf16_f32 v67, v82, v83
v_mfma_f32_16x16x32_bf16 v[92:95], v[44:47], a[60:63], v[92:95]
s_waitcnt lgkmcnt(0)
ds_read_b64_tr_b16 v[40:41], v23 offset:24584
v_mfma_f32_16x16x32_bf16 v[96:99], v[32:35], a[32:35], v[96:99]
buffer_load_dwordx4 v9, s[20:23], s34 offen offset:128 nt lds
v_mfma_f32_16x16x32_bf16 v[96:99], v[36:39], a[36:39], v[96:99]
ds_read_b64_tr_b16 v[42:43], v23 offset:30728
v_cvt_pk_bf16_f32 v68, v68, v69
v_mfma_f32_16x16x32_bf16 v[100:103], v[32:35], a[40:43], v[100:103]
ds_read_b64_tr_b16 v[44:45], v23 offset:36872
v_cvt_pk_bf16_f32 v69, v70, v71
v_mfma_f32_16x16x32_bf16 v[100:103], v[36:39], a[44:47], v[100:103]
s_add_u32 m0, s29, 75520
ds_read_b64_tr_b16 v[46:47], v23 offset:43016
v_mfma_f32_16x16x32_bf16 v[104:107], v[32:35], a[48:51], v[104:107]
v_cvt_pk_bf16_f32 v70, v84, v85
v_cvt_pk_bf16_f32 v71, v86, v87
v_mfma_f32_16x16x32_bf16 v[104:107], v[36:39], a[52:55], v[104:107]
v_cvt_pk_bf16_f32 v72, v72, v73
v_cvt_pk_bf16_f32 v73, v74, v75
v_mfma_f32_16x16x32_bf16 v[108:111], v[32:35], a[56:59], v[108:111]
v_cvt_pk_bf16_f32 v74, v88, v89
v_cvt_pk_bf16_f32 v75, v90, v91
v_mfma_f32_16x16x32_bf16 v[108:111], v[36:39], a[60:63], v[108:111]
s_waitcnt lgkmcnt(0)
ds_read_b64_tr_b16 v[32:33], v22 offset:25600
v_mfma_f32_16x16x32_bf16 v[112:115], v[40:43], a[32:35], v[112:115]
buffer_load_dwordx4 v9, s[20:23], s34 offen offset:256 nt lds
v_mfma_f32_16x16x32_bf16 v[112:115], v[44:47], a[36:39], v[112:115]
ds_read_b64_tr_b16 v[34:35], v22 offset:31744
v_cvt_pk_bf16_f32 v76, v76, v77
v_mfma_f32_16x16x32_bf16 v[116:119], v[40:43], a[40:43], v[116:119]
ds_read_b64_tr_b16 v[36:37], v22 offset:37888
v_cvt_pk_bf16_f32 v77, v78, v79
v_mfma_f32_16x16x32_bf16 v[116:119], v[44:47], a[44:47], v[116:119]
s_add_u32 m0, s29, 86016
ds_read_b64_tr_b16 v[38:39], v22 offset:44032
v_mfma_f32_16x16x32_bf16 v[120:123], v[40:43], a[48:51], v[120:123]
v_cvt_pk_bf16_f32 v78, v92, v93
v_cvt_pk_bf16_f32 v79, v94, v95
v_mfma_f32_16x16x32_bf16 v[120:123], v[44:47], a[52:55], v[120:123]
v_cvt_pk_bf16_f32 v96, v96, v97
v_cvt_pk_bf16_f32 v97, v98, v99
v_mfma_f32_16x16x32_bf16 v[124:127], v[40:43], a[56:59], v[124:127]
v_cvt_pk_bf16_f32 v98, v112, v113
v_cvt_pk_bf16_f32 v99, v114, v115
v_mfma_f32_16x16x32_bf16 v[124:127], v[44:47], a[60:63], v[124:127]
s_waitcnt lgkmcnt(0)
ds_read_b64_tr_b16 v[40:41], v22 offset:25608
v_mfma_f32_16x16x32_bf16 v[128:131], v[32:35], a[32:35], v[128:131]
buffer_load_dwordx4 v9, s[20:23], s35 offen offset:0 nt lds
v_mfma_f32_16x16x32_bf16 v[128:131], v[36:39], a[36:39], v[128:131]
ds_read_b64_tr_b16 v[42:43], v22 offset:31752
v_cvt_pk_bf16_f32 v100, v100, v101
v_mfma_f32_16x16x32_bf16 v[132:135], v[32:35], a[40:43], v[132:135]
ds_read_b64_tr_b16 v[44:45], v22 offset:37896
v_cvt_pk_bf16_f32 v101, v102, v103
v_mfma_f32_16x16x32_bf16 v[132:135], v[36:39], a[44:47], v[132:135]
s_add_u32 m0, s29, 86912
ds_read_b64_tr_b16 v[46:47], v22 offset:44040
v_mfma_f32_16x16x32_bf16 v[136:139], v[32:35], a[48:51], v[136:139]
v_cvt_pk_bf16_f32 v102, v116, v117
v_cvt_pk_bf16_f32 v103, v118, v119
v_mfma_f32_16x16x32_bf16 v[136:139], v[36:39], a[52:55], v[136:139]
v_cvt_pk_bf16_f32 v104, v104, v105
v_cvt_pk_bf16_f32 v105, v106, v107
v_mfma_f32_16x16x32_bf16 v[140:143], v[32:35], a[56:59], v[140:143]
v_cvt_pk_bf16_f32 v106, v120, v121
v_cvt_pk_bf16_f32 v107, v122, v123
v_mfma_f32_16x16x32_bf16 v[140:143], v[36:39], a[60:63], v[140:143]
s_waitcnt lgkmcnt(0)
ds_read_b64_tr_b16 v[32:33], v23 offset:25600
v_mfma_f32_16x16x32_bf16 v[144:147], v[40:43], a[32:35], v[144:147]
buffer_load_dwordx4 v9, s[20:23], s35 offen offset:128 nt lds
v_mfma_f32_16x16x32_bf16 v[144:147], v[44:47], a[36:39], v[144:147]
ds_read_b64_tr_b16 v[34:35], v23 offset:31744
v_cvt_pk_bf16_f32 v108, v108, v109
v_mfma_f32_16x16x32_bf16 v[148:151], v[40:43], a[40:43], v[148:151]
ds_read_b64_tr_b16 v[36:37], v23 offset:37888
v_cvt_pk_bf16_f32 v109, v110, v111
v_mfma_f32_16x16x32_bf16 v[148:151], v[44:47], a[44:47], v[148:151]
s_add_u32 m0, s29, 87808
ds_read_b64_tr_b16 v[38:39], v23 offset:44032
v_mfma_f32_16x16x32_bf16 v[152:155], v[40:43], a[48:51], v[152:155]
v_cvt_pk_bf16_f32 v110, v124, v125
v_cvt_pk_bf16_f32 v111, v126, v127
v_mfma_f32_16x16x32_bf16 v[152:155], v[44:47], a[52:55], v[152:155]
v_cvt_pk_bf16_f32 v128, v128, v129
v_cvt_pk_bf16_f32 v129, v130, v131
v_mfma_f32_16x16x32_bf16 v[156:159], v[40:43], a[56:59], v[156:159]
v_cvt_pk_bf16_f32 v130, v144, v145
v_cvt_pk_bf16_f32 v131, v146, v147
v_mfma_f32_16x16x32_bf16 v[156:159], v[44:47], a[60:63], v[156:159]
s_waitcnt lgkmcnt(0)
ds_read_b64_tr_b16 v[40:41], v23 offset:25608
v_mfma_f32_16x16x32_bf16 v[160:163], v[32:35], a[32:35], v[160:163]
buffer_load_dwordx4 v9, s[20:23], s35 offen offset:256 nt lds
v_mfma_f32_16x16x32_bf16 v[160:163], v[36:39], a[36:39], v[160:163]
ds_read_b64_tr_b16 v[42:43], v23 offset:31752
v_cvt_pk_bf16_f32 v132, v132, v133
v_mfma_f32_16x16x32_bf16 v[164:167], v[32:35], a[40:43], v[164:167]
ds_read_b64_tr_b16 v[44:45], v23 offset:37896
v_cvt_pk_bf16_f32 v133, v134, v135
v_mfma_f32_16x16x32_bf16 v[164:167], v[36:39], a[44:47], v[164:167]
ds_read_b64_tr_b16 v[46:47], v23 offset:44040
v_cvt_pk_bf16_f32 v134, v148, v149
v_mfma_f32_16x16x32_bf16 v[168:171], v[32:35], a[48:51], v[168:171]
v_cvt_pk_bf16_f32 v135, v150, v151
v_cvt_pk_bf16_f32 v136, v136, v137
v_mfma_f32_16x16x32_bf16 v[168:171], v[36:39], a[52:55], v[168:171]
v_cvt_pk_bf16_f32 v137, v138, v139
v_cvt_pk_bf16_f32 v138, v152, v153
v_mfma_f32_16x16x32_bf16 v[172:175], v[32:35], a[56:59], v[172:175]
v_cvt_pk_bf16_f32 v139, v154, v155
v_cvt_pk_bf16_f32 v140, v140, v141
v_mfma_f32_16x16x32_bf16 v[172:175], v[36:39], a[60:63], v[172:175]
s_waitcnt lgkmcnt(0)
ds_read_b64_tr_b16 v[32:33], v22 offset:26624
v_mfma_f32_16x16x32_bf16 v[176:179], v[40:43], a[32:35], v[176:179]
ds_read_b64_tr_b16 v[34:35], v22 offset:32768
v_cvt_pk_bf16_f32 v141, v142, v143
v_mfma_f32_16x16x32_bf16 v[176:179], v[44:47], a[36:39], v[176:179]
ds_read_b64_tr_b16 v[36:37], v22 offset:38912
s_add_u32 s32, s32, 24576
s_add_u32 s33, s33, 24576
s_add_u32 s34, s34, 24576
s_add_u32 s35, s35, 24576
s_add_u32 m0, s82, 0
s_nop 0
v_cvt_pk_bf16_f32 v142, v156, v157
v_mfma_f32_16x16x32_bf16 v[180:183], v[40:43], a[40:43], v[180:183]
buffer_load_dwordx4 v29, s[56:59], s65 offen lds
v_mfma_f32_16x16x32_bf16 v[180:183], v[44:47], a[44:47], v[180:183]
ds_read_b64_tr_b16 v[38:39], v22 offset:45056
v_cvt_pk_bf16_f32 v143, v158, v159
v_mfma_f32_16x16x32_bf16 v[184:187], v[40:43], a[48:51], v[184:187]
v_cvt_pk_bf16_f32 v160, v160, v161
v_cvt_pk_bf16_f32 v161, v162, v163
v_mfma_f32_16x16x32_bf16 v[184:187], v[44:47], a[52:55], v[184:187]
v_cvt_pk_bf16_f32 v162, v176, v177
v_cvt_pk_bf16_f32 v163, v178, v179
v_mfma_f32_16x16x32_bf16 v[188:191], v[40:43], a[56:59], v[188:191]
v_cvt_pk_bf16_f32 v164, v164, v165
v_cvt_pk_bf16_f32 v165, v166, v167
v_mfma_f32_16x16x32_bf16 v[188:191], v[44:47], a[60:63], v[188:191]
s_waitcnt lgkmcnt(0)
ds_read_b64_tr_b16 v[40:41], v22 offset:26632
v_mfma_f32_16x16x32_bf16 v[192:195], v[32:35], a[32:35], v[192:195]
ds_read_b64_tr_b16 v[42:43], v22 offset:32776
v_cvt_pk_bf16_f32 v166, v180, v181
v_mfma_f32_16x16x32_bf16 v[192:195], v[36:39], a[36:39], v[192:195]
s_add_u32 m0, s82, 1024
s_add_u32 s65, s65, s67
v_cvt_pk_bf16_f32 v167, v182, v183
v_mfma_f32_16x16x32_bf16 v[196:199], v[32:35], a[40:43], v[196:199]
buffer_load_dwordx4 v29, s[56:59], s65 offen lds
v_mfma_f32_16x16x32_bf16 v[196:199], v[36:39], a[44:47], v[196:199]
ds_read_b64_tr_b16 v[44:45], v22 offset:38920
v_cvt_pk_bf16_f32 v168, v168, v169
v_mfma_f32_16x16x32_bf16 v[200:203], v[32:35], a[48:51], v[200:203]
ds_read_b64_tr_b16 v[46:47], v22 offset:45064
v_cvt_pk_bf16_f32 v169, v170, v171
v_mfma_f32_16x16x32_bf16 v[200:203], v[36:39], a[52:55], v[200:203]
v_cvt_pk_bf16_f32 v170, v184, v185
v_cvt_pk_bf16_f32 v171, v186, v187
v_mfma_f32_16x16x32_bf16 v[204:207], v[32:35], a[56:59], v[204:207]
v_cvt_pk_bf16_f32 v172, v172, v173
v_cvt_pk_bf16_f32 v173, v174, v175
v_mfma_f32_16x16x32_bf16 v[204:207], v[36:39], a[60:63], v[204:207]
s_waitcnt lgkmcnt(0)
ds_read_b64_tr_b16 v[32:33], v23 offset:26624
v_mfma_f32_16x16x32_bf16 v[208:211], v[40:43], a[32:35], v[208:211]
ds_read_b64_tr_b16 v[34:35], v23 offset:32768
v_cvt_pk_bf16_f32 v174, v188, v189
v_mfma_f32_16x16x32_bf16 v[208:211], v[44:47], a[36:39], v[208:211]
s_add_u32 m0, s82, 2048
s_add_u32 s65, s65, s67
v_cvt_pk_bf16_f32 v175, v190, v191
v_mfma_f32_16x16x32_bf16 v[212:215], v[40:43], a[40:43], v[212:215]
buffer_load_dwordx4 v29, s[56:59], s65 offen lds
v_mfma_f32_16x16x32_bf16 v[212:215], v[44:47], a[44:47], v[212:215]
ds_read_b64_tr_b16 v[36:37], v23 offset:38912
v_mfma_f32_16x16x32_bf16 v[216:219], v[40:43], a[48:51], v[216:219]
ds_read_b64_tr_b16 v[38:39], v23 offset:45056
v_mfma_f32_16x16x32_bf16 v[216:219], v[44:47], a[52:55], v[216:219]
ds_read_b128 a[192:195], v2 offset:0
v_mfma_f32_16x16x32_bf16 v[220:223], v[40:43], a[56:59], v[220:223]
ds_read_b128 a[196:199], v3 offset:0
v_mfma_f32_16x16x32_bf16 v[220:223], v[44:47], a[60:63], v[220:223]
s_waitcnt lgkmcnt(2)
ds_read_b64_tr_b16 v[40:41], v23 offset:26632
v_mfma_f32_16x16x32_bf16 v[224:227], v[32:35], a[32:35], v[224:227]
ds_read_b64_tr_b16 v[42:43], v23 offset:32776
v_mfma_f32_16x16x32_bf16 v[224:227], v[36:39], a[36:39], v[224:227]
s_add_u32 m0, s82, 3072
s_add_u32 s65, s65, s67
v_mfma_f32_16x16x32_bf16 v[228:231], v[32:35], a[40:43], v[228:231]
buffer_load_dwordx4 v29, s[56:59], s65 offen lds
v_mfma_f32_16x16x32_bf16 v[228:231], v[36:39], a[44:47], v[228:231]
ds_read_b64_tr_b16 v[44:45], v23 offset:38920
v_mfma_f32_16x16x32_bf16 v[232:235], v[32:35], a[48:51], v[232:235]
ds_read_b64_tr_b16 v[46:47], v23 offset:45064
v_mfma_f32_16x16x32_bf16 v[232:235], v[36:39], a[52:55], v[232:235]
ds_read_b128 a[200:203], v2 offset:1024
v_mfma_f32_16x16x32_bf16 v[236:239], v[32:35], a[56:59], v[236:239]
ds_read_b128 a[204:207], v3 offset:1024
v_mfma_f32_16x16x32_bf16 v[236:239], v[36:39], a[60:63], v[236:239]
s_waitcnt lgkmcnt(2)
ds_read_b128 a[208:211], v2 offset:2048
v_mfma_f32_16x16x32_bf16 v[240:243], v[40:43], a[32:35], v[240:243]
ds_read_b128 a[212:215], v3 offset:2048
v_cvt_pk_bf16_f32 v192, v192, v193
v_mfma_f32_16x16x32_bf16 v[240:243], v[44:47], a[36:39], v[240:243]
v_cvt_pk_bf16_f32 v193, v194, v195
v_cvt_pk_bf16_f32 v194, v208, v209
v_mfma_f32_16x16x32_bf16 v[244:247], v[40:43], a[40:43], v[244:247]
v_cvt_pk_bf16_f32 v195, v210, v211
v_cvt_pk_bf16_f32 v196, v196, v197
v_mfma_f32_16x16x32_bf16 v[244:247], v[44:47], a[44:47], v[244:247]
v_cvt_pk_bf16_f32 v197, v198, v199
v_cvt_pk_bf16_f32 v198, v212, v213
v_mfma_f32_16x16x32_bf16 v[248:251], v[40:43], a[48:51], v[248:251]
v_cvt_pk_bf16_f32 v199, v214, v215
v_cvt_pk_bf16_f32 v200, v200, v201
v_mfma_f32_16x16x32_bf16 v[248:251], v[44:47], a[52:55], v[248:251]
v_cvt_pk_bf16_f32 v201, v202, v203
v_cvt_pk_bf16_f32 v202, v216, v217
v_mfma_f32_16x16x32_bf16 v[252:255], v[40:43], a[56:59], v[252:255]
v_cvt_pk_bf16_f32 v203, v218, v219
v_cvt_pk_bf16_f32 v204, v204, v205
v_mfma_f32_16x16x32_bf16 v[252:255], v[44:47], a[60:63], v[252:255]
v_cvt_pk_bf16_f32 v205, v206, v207
v_cvt_pk_bf16_f32 v206, v220, v221
v_cvt_pk_bf16_f32 v207, v222, v223
v_cvt_pk_bf16_f32 v224, v224, v225
v_cvt_pk_bf16_f32 v225, v226, v227
v_cvt_pk_bf16_f32 v226, v240, v241
v_cvt_pk_bf16_f32 v227, v242, v243
v_cvt_pk_bf16_f32 v228, v228, v229
v_cvt_pk_bf16_f32 v229, v230, v231
v_cvt_pk_bf16_f32 v230, v244, v245
v_cvt_pk_bf16_f32 v231, v246, v247
v_cvt_pk_bf16_f32 v232, v232, v233
v_cvt_pk_bf16_f32 v233, v234, v235
v_cvt_pk_bf16_f32 v234, v248, v249
v_cvt_pk_bf16_f32 v235, v250, v251
v_cvt_pk_bf16_f32 v236, v236, v237
v_cvt_pk_bf16_f32 v237, v238, v239
v_cvt_pk_bf16_f32 v238, v252, v253
v_cvt_pk_bf16_f32 v239, v254, v255
v_mov_b32 v12, 0
v_mov_b32 v13, 0
v_mov_b32 v14, 0
v_mov_b32 v15, 0
v_add_u32 v4, 24576, v4
v_add_u32 v5, 24576, v5
v_add_u32 v6, 24576, v6
v_add_u32 v7, 24576, v7
s_nop 1
v_mfma_f32_16x16x32_bf16 v[48:51], a[192:195], v[64:67], 0
ds_read_b128 a[216:219], v2 offset:6144
v_mfma_f32_16x16x32_bf16 v[48:51], a[196:199], v[96:99], v[48:51]
ds_read_b128 a[220:223], v3 offset:6144
s_waitcnt lgkmcnt(5)
v_mfma_f32_16x16x32_bf16 v[48:51], a[200:203], v[128:131], v[48:51]
ds_read_b128 a[224:227], v2 offset:7168
s_waitcnt lgkmcnt(5)
v_mfma_f32_16x16x32_bf16 v[48:51], a[204:207], v[160:163], v[48:51]
ds_read_b128 a[228:231], v3 offset:7168
s_waitcnt lgkmcnt(5)
v_mfma_f32_16x16x32_bf16 v[48:51], a[208:211], v[192:195], v[48:51]
ds_read_b128 a[232:235], v2 offset:8192
s_waitcnt lgkmcnt(5)
v_mfma_f32_16x16x32_bf16 v[48:51], a[212:215], v[224:227], v[48:51]
ds_read_b128 a[236:239], v3 offset:8192
v_mfma_f32_16x16x32_bf16 v[52:55], a[192:195], v[68:71], 0
v_mfma_f32_16x16x32_bf16 v[52:55], a[196:199], v[100:103], v[52:55]
v_mfma_f32_16x16x32_bf16 v[52:55], a[200:203], v[132:135], v[52:55]
v_mfma_f32_16x16x32_bf16 v[52:55], a[204:207], v[164:167], v[52:55]
v_mfma_f32_16x16x32_bf16 v[52:55], a[208:211], v[196:199], v[52:55]
v_mfma_f32_16x16x32_bf16 v[52:55], a[212:215], v[228:231], v[52:55]
v_mfma_f32_16x16x32_bf16 v[56:59], a[192:195], v[72:75], 0
v_mfma_f32_16x16x32_bf16 v[56:59], a[196:199], v[104:107], v[56:59]
v_mfma_f32_16x16x32_bf16 v[56:59], a[200:203], v[136:139], v[56:59]
v_mfma_f32_16x16x32_bf16 v[56:59], a[204:207], v[168:171], v[56:59]
v_mfma_f32_16x16x32_bf16 v[56:59], a[208:211], v[200:203], v[56:59]
v_mfma_f32_16x16x32_bf16 v[56:59], a[212:215], v[232:235], v[56:59]
v_mfma_f32_16x16x32_bf16 v[60:63], a[192:195], v[76:79], 0
v_mfma_f32_16x16x32_bf16 v[60:63], a[196:199], v[108:111], v[60:63]
v_mfma_f32_16x16x32_bf16 v[60:63], a[200:203], v[140:143], v[60:63]
v_mfma_f32_16x16x32_bf16 v[60:63], a[204:207], v[172:175], v[60:63]
v_mfma_f32_16x16x32_bf16 v[60:63], a[208:211], v[204:207], v[60:63]
v_mfma_f32_16x16x32_bf16 v[60:63], a[212:215], v[236:239], v[60:63]
s_nop 7
v_max3_f32 v240, v48, v49, v50
v_max_f32 v240, v240, v51
v_max3_f32 v241, v52, v53, v54
v_max_f32 v241, v241, v55
v_max3_f32 v242, v56, v57, v58
v_max_f32 v242, v242, v59
v_max3_f32 v243, v60, v61, v62
v_max_f32 v243, v243, v63
v_mov_b32 v244, v240
v_mov_b32 v245, v241
v_mov_b32 v246, v242
v_mov_b32 v247, v243
v_permlane32_swap_b32 v240, v244
v_permlane32_swap_b32 v241, v245
v_permlane32_swap_b32 v242, v246
v_permlane32_swap_b32 v243, v247
v_max_f32 v240, v240, v244
v_max_f32 v241, v241, v245
v_max_f32 v242, v242, v246
v_max_f32 v243, v243, v247
v_mov_b32 v244, v240
v_mov_b32 v245, v241
v_mov_b32 v246, v242
v_mov_b32 v247, v243
v_permlane16_swap_b32 v240, v244
v_permlane16_swap_b32 v241, v245
v_permlane16_swap_b32 v242, v246
v_permlane16_swap_b32 v243, v247
v_max_f32 v240, v240, v244
v_max_f32 v241, v241, v245
v_max_f32 v242, v242, v246
v_max_f32 v243, v243, v247
v_sub_f32 v32, 0, v240
v_sub_f32 v48, v48, v240
v_sub_f32 v33, 0, v240
v_sub_f32 v49, v49, v240
v_sub_f32 v34, 0, v240
v_sub_f32 v50, v50, v240
v_sub_f32 v35, 0, v240
v_sub_f32 v51, v51, v240
v_sub_f32 v36, 0, v241
v_sub_f32 v52, v52, v241
v_sub_f32 v37, 0, v241
v_sub_f32 v53, v53, v241
v_sub_f32 v38, 0, v241
v_sub_f32 v54, v54, v241
v_sub_f32 v39, 0, v241
v_sub_f32 v55, v55, v241
v_sub_f32 v40, 0, v242
v_sub_f32 v56, v56, v242
v_sub_f32 v41, 0, v242
v_sub_f32 v57, v57, v242
v_sub_f32 v42, 0, v242
v_sub_f32 v58, v58, v242
v_sub_f32 v43, 0, v242
v_sub_f32 v59, v59, v242
v_sub_f32 v44, 0, v243
v_sub_f32 v60, v60, v243
v_sub_f32 v45, 0, v243
v_sub_f32 v61, v61, v243
v_sub_f32 v46, 0, v243
v_sub_f32 v62, v62, v243
v_sub_f32 v47, 0, v243
v_sub_f32 v63, v63, v243
s_nop 1
s_waitcnt lgkmcnt(5)
v_mfma_f32_16x16x32_bf16 v[144:147], a[216:219], v[64:67], v[32:35]
s_waitcnt lgkmcnt(4)
s_add_u32 m0, s29, 49152
ds_read_b128 a[192:195], v2 offset:12288
v_mfma_f32_16x16x32_bf16 v[144:147], a[220:223], v[96:99], v[144:147]
s_waitcnt lgkmcnt(4)
v_exp_f32 v48, v48
v_mfma_f32_16x16x32_bf16 v[144:147], a[224:227], v[128:131], v[144:147]
s_waitcnt lgkmcnt(3)
ds_read_b128 a[196:199], v3 offset:12288
v_mfma_f32_16x16x32_bf16 v[144:147], a[228:231], v[160:163], v[144:147]
s_waitcnt lgkmcnt(3)
v_exp_f32 v49, v49
v_mfma_f32_16x16x32_bf16 v[144:147], a[232:235], v[192:195], v[144:147]
s_waitcnt lgkmcnt(2)
buffer_load_dwordx4 v8, s[16:19], s32 offen offset:0 nt lds
v_mfma_f32_16x16x32_bf16 v[144:147], a[236:239], v[224:227], v[144:147]
s_add_u32 m0, s29, 50048
v_exp_f32 v50, v50
v_add_f32 v16, v48, v49
v_mfma_f32_16x16x32_bf16 v[148:151], a[216:219], v[68:71], v[36:39]
ds_read_b128 a[200:203], v2 offset:13312
ds_read_b128 a[204:207], v3 offset:13312
v_mfma_f32_16x16x32_bf16 v[148:151], a[220:223], v[100:103], v[148:151]
v_cvt_pk_bf16_f32 v80, v48, v49
v_exp_f32 v51, v51
v_mfma_f32_16x16x32_bf16 v[148:151], a[224:227], v[132:135], v[148:151]
ds_read_b128 a[208:211], v2 offset:14336
v_add_f32 v16, v16, v50
v_add_f32 v16, v16, v51
v_mfma_f32_16x16x32_bf16 v[148:151], a[228:231], v[164:167], v[148:151]
buffer_load_dwordx4 v8, s[16:19], s32 offen offset:128 nt lds
v_cvt_pk_bf16_f32 v81, v50, v51
v_mfma_f32_16x16x32_bf16 v[148:151], a[232:235], v[196:199], v[148:151]
s_add_u32 m0, s29, 50944
ds_read_b128 a[212:215], v3 offset:14336
v_mfma_f32_16x16x32_bf16 v[148:151], a[236:239], v[228:231], v[148:151]
v_exp_f32 v52, v52
v_mfma_f32_16x16x32_bf16 v[152:155], a[216:219], v[72:75], v[40:43]
v_exp_f32 v53, v53
v_mfma_f32_16x16x32_bf16 v[152:155], a[220:223], v[104:107], v[152:155]
v_exp_f32 v54, v54
v_add_f32 v17, v52, v53
v_mfma_f32_16x16x32_bf16 v[152:155], a[224:227], v[136:139], v[152:155]
buffer_load_dwordx4 v8, s[16:19], s32 offen offset:256 nt lds
v_cvt_pk_bf16_f32 v88, v52, v53
v_mfma_f32_16x16x32_bf16 v[152:155], a[228:231], v[168:171], v[152:155]
s_add_u32 m0, s29, 61440
v_exp_f32 v55, v55
v_add_f32 v17, v17, v54
v_mfma_f32_16x16x32_bf16 v[152:155], a[232:235], v[200:203], v[152:155]
v_add_f32 v17, v17, v55
v_cvt_pk_bf16_f32 v89, v54, v55
v_mfma_f32_16x16x32_bf16 v[152:155], a[236:239], v[232:235], v[152:155]
v_exp_f32 v56, v56
v_mfma_f32_16x16x32_bf16 v[156:159], a[216:219], v[76:79], v[44:47]
v_exp_f32 v57, v57
v_mfma_f32_16x16x32_bf16 v[156:159], a[220:223], v[108:111], v[156:159]
buffer_load_dwordx4 v8, s[16:19], s33 offen offset:0 nt lds
v_mfma_f32_16x16x32_bf16 v[156:159], a[224:227], v[140:143], v[156:159]
s_add_u32 m0, s29, 62336
v_exp_f32 v58, v58
v_add_f32 v18, v56, v57
v_mfma_f32_16x16x32_bf16 v[156:159], a[228:231], v[172:175], v[156:159]
v_cvt_pk_bf16_f32 v112, v56, v57
v_exp_f32 v59, v59
v_mfma_f32_16x16x32_bf16 v[156:159], a[232:235], v[204:207], v[156:159]
v_add_f32 v18, v18, v58
v_add_f32 v18, v18, v59
v_cvt_pk_bf16_f32 v113, v58, v59
v_mfma_f32_16x16x32_bf16 v[156:159], a[236:239], v[236:239], v[156:159]
s_waitcnt lgkmcnt(5)
v_exp_f32 v60, v60
v_mfma_f32_16x16x32_bf16 v[48:51], a[192:195], v[64:67], v[32:35]
s_waitcnt lgkmcnt(4)
buffer_load_dwordx4 v8, s[16:19], s33 offen offset:128 nt lds
v_mfma_f32_16x16x32_bf16 v[48:51], a[196:199], v[96:99], v[48:51]
s_waitcnt lgkmcnt(3)
s_add_u32 m0, s29, 63232
v_exp_f32 v61, v61
v_mfma_f32_16x16x32_bf16 v[48:51], a[200:203], v[128:131], v[48:51]
s_waitcnt lgkmcnt(2)
v_exp_f32 v62, v62
v_add_f32 v19, v60, v61
v_mfma_f32_16x16x32_bf16 v[48:51], a[204:207], v[160:163], v[48:51]
s_waitcnt lgkmcnt(1)
ds_read_b128 a[216:219], v2 offset:18432
v_cvt_pk_bf16_f32 v120, v60, v61
v_mfma_f32_16x16x32_bf16 v[48:51], a[208:211], v[192:195], v[48:51]
s_waitcnt lgkmcnt(1)
v_exp_f32 v63, v63
v_add_f32 v19, v19, v62
v_mfma_f32_16x16x32_bf16 v[48:51], a[212:215], v[224:227], v[48:51]
buffer_load_dwordx4 v8, s[16:19], s33 offen offset:256 nt lds
v_add_f32 v19, v19, v63
v_mfma_f32_16x16x32_bf16 v[52:55], a[192:195], v[68:71], v[36:39]
s_add_u32 m0, s29, 98304
ds_read_b128 a[220:223], v3 offset:18432
v_cvt_pk_bf16_f32 v121, v62, v63
v_mfma_f32_16x16x32_bf16 v[52:55], a[196:199], v[100:103], v[52:55]
ds_read_b128 a[224:227], v2 offset:19456
ds_read_b128 a[228:231], v3 offset:19456
v_mfma_f32_16x16x32_bf16 v[52:55], a[200:203], v[132:135], v[52:55]
ds_read_b128 a[232:235], v2 offset:20480
v_exp_f32 v144, v144
v_mfma_f32_16x16x32_bf16 v[52:55], a[204:207], v[164:167], v[52:55]
ds_read_b128 a[236:239], v3 offset:20480
v_exp_f32 v145, v145
v_mfma_f32_16x16x32_bf16 v[52:55], a[208:211], v[196:199], v[52:55]
buffer_load_dwordx4 v9, s[20:23], s34 offen offset:0 nt lds
v_add_f32 v16, v16, v144
v_mfma_f32_16x16x32_bf16 v[52:55], a[212:215], v[228:231], v[52:55]
s_add_u32 m0, s29, 99200
v_exp_f32 v146, v146
v_add_f32 v16, v16, v145
v_mfma_f32_16x16x32_bf16 v[56:59], a[192:195], v[72:75], v[40:43]
v_cvt_pk_bf16_f32 v82, v144, v145
v_exp_f32 v147, v147
v_mfma_f32_16x16x32_bf16 v[56:59], a[196:199], v[104:107], v[56:59]
v_add_f32 v16, v16, v146
v_add_f32 v16, v16, v147
v_cvt_pk_bf16_f32 v83, v146, v147
v_mfma_f32_16x16x32_bf16 v[56:59], a[200:203], v[136:139], v[56:59]
v_exp_f32 v148, v148
v_mfma_f32_16x16x32_bf16 v[56:59], a[204:207], v[168:171], v[56:59]
buffer_load_dwordx4 v9, s[20:23], s34 offen offset:128 nt lds
v_mfma_f32_16x16x32_bf16 v[56:59], a[208:211], v[200:203], v[56:59]
s_add_u32 m0, s29, 100096
v_exp_f32 v149, v149
v_add_f32 v17, v17, v148
v_mfma_f32_16x16x32_bf16 v[56:59], a[212:215], v[232:235], v[56:59]
v_exp_f32 v150, v150
v_add_f32 v17, v17, v149
v_mfma_f32_16x16x32_bf16 v[60:63], a[192:195], v[76:79], v[44:47]
v_cvt_pk_bf16_f32 v90, v148, v149
v_exp_f32 v151, v151
v_mfma_f32_16x16x32_bf16 v[60:63], a[196:199], v[108:111], v[60:63]
v_add_f32 v17, v17, v150
v_add_f32 v17, v17, v151
v_cvt_pk_bf16_f32 v91, v150, v151
v_mfma_f32_16x16x32_bf16 v[60:63], a[200:203], v[140:143], v[60:63]
buffer_load_dwordx4 v9, s[20:23], s34 offen offset:256 nt lds
v_mfma_f32_16x16x32_bf16 v[60:63], a[204:207], v[172:175], v[60:63]
s_add_u32 m0, s29, 110592
v_exp_f32 v152, v152
v_mfma_f32_16x16x32_bf16 v[60:63], a[208:211], v[204:207], v[60:63]
v_exp_f32 v153, v153
v_add_f32 v18, v18, v152
v_mfma_f32_16x16x32_bf16 v[60:63], a[212:215], v[236:239], v[60:63]
s_waitcnt lgkmcnt(5)
v_exp_f32 v154, v154
v_add_f32 v18, v18, v153
v_mfma_f32_16x16x32_bf16 v[144:147], a[216:219], v[64:67], v[32:35]
s_waitcnt lgkmcnt(4)
v_cvt_pk_bf16_f32 v114, v152, v153
v_exp_f32 v155, v155
v_mfma_f32_16x16x32_bf16 v[144:147], a[220:223], v[96:99], v[144:147]
s_waitcnt lgkmcnt(3)
buffer_load_dwordx4 v9, s[20:23], s35 offen offset:0 nt lds
v_mfma_f32_16x16x32_bf16 v[144:147], a[224:227], v[128:131], v[144:147]
s_waitcnt lgkmcnt(2)
s_add_u32 m0, s29, 111488
v_add_f32 v18, v18, v154
v_add_f32 v18, v18, v155
v_mfma_f32_16x16x32_bf16 v[144:147], a[228:231], v[160:163], v[144:147]
s_waitcnt lgkmcnt(1)
v_cvt_pk_bf16_f32 v115, v154, v155
v_exp_f32 v156, v156
v_mfma_f32_16x16x32_bf16 v[144:147], a[232:235], v[192:195], v[144:147]
s_waitcnt lgkmcnt(0)
v_exp_f32 v157, v157
v_add_f32 v19, v19, v156
v_mfma_f32_16x16x32_bf16 v[144:147], a[236:239], v[224:227], v[144:147]
v_exp_f32 v158, v158
v_add_f32 v19, v19, v157
v_mfma_f32_16x16x32_bf16 v[148:151], a[216:219], v[68:71], v[36:39]
buffer_load_dwordx4 v9, s[20:23], s35 offen offset:128 nt lds
v_cvt_pk_bf16_f32 v122, v156, v157
v_mfma_f32_16x16x32_bf16 v[148:151], a[220:223], v[100:103], v[148:151]
s_add_u32 m0, s29, 112384
v_exp_f32 v159, v159
v_add_f32 v19, v19, v158
v_mfma_f32_16x16x32_bf16 v[148:151], a[224:227], v[132:135], v[148:151]
v_add_f32 v19, v19, v159
v_cvt_pk_bf16_f32 v123, v158, v159
v_mfma_f32_16x16x32_bf16 v[148:151], a[228:231], v[164:167], v[148:151]
v_exp_f32 v48, v48
v_mfma_f32_16x16x32_bf16 v[148:151], a[232:235], v[196:199], v[148:151]
v_exp_f32 v49, v49
v_add_f32 v16, v16, v48
v_mfma_f32_16x16x32_bf16 v[148:151], a[236:239], v[228:231], v[148:151]
buffer_load_dwordx4 v9, s[20:23], s35 offen offset:256 nt lds
s_add_u32 s32, s32, 24576
v_mfma_f32_16x16x32_bf16 v[152:155], a[216:219], v[72:75], v[40:43]
s_add_u32 s33, s33, 24576
s_add_u32 s34, s34, 24576
s_add_u32 s35, s35, 24576
v_mfma_f32_16x16x32_bf16 v[152:155], a[220:223], v[104:107], v[152:155]
v_exp_f32 v50, v50
v_add_f32 v16, v16, v49
v_mfma_f32_16x16x32_bf16 v[152:155], a[224:227], v[136:139], v[152:155]
v_cvt_pk_bf16_f32 v84, v48, v49
v_exp_f32 v51, v51
v_mfma_f32_16x16x32_bf16 v[152:155], a[228:231], v[168:171], v[152:155]
v_add_f32 v16, v16, v50
v_add_f32 v16, v16, v51
v_cvt_pk_bf16_f32 v85, v50, v51
v_mfma_f32_16x16x32_bf16 v[152:155], a[232:235], v[200:203], v[152:155]
v_exp_f32 v52, v52
v_mfma_f32_16x16x32_bf16 v[152:155], a[236:239], v[232:235], v[152:155]
v_exp_f32 v53, v53
v_add_f32 v17, v17, v52
v_mfma_f32_16x16x32_bf16 v[156:159], a[216:219], v[76:79], v[44:47]
v_exp_f32 v54, v54
v_add_f32 v17, v17, v53
v_mfma_f32_16x16x32_bf16 v[156:159], a[220:223], v[108:111], v[156:159]
v_cvt_pk_bf16_f32 v92, v52, v53
v_exp_f32 v55, v55
v_mfma_f32_16x16x32_bf16 v[156:159], a[224:227], v[140:143], v[156:159]
v_add_f32 v17, v17, v54
v_add_f32 v17, v17, v55
v_cvt_pk_bf16_f32 v93, v54, v55
v_mfma_f32_16x16x32_bf16 v[156:159], a[228:231], v[172:175], v[156:159]
v_exp_f32 v56, v56
v_mfma_f32_16x16x32_bf16 v[156:159], a[232:235], v[204:207], v[156:159]
v_exp_f32 v57, v57
v_add_f32 v18, v18, v56
v_mfma_f32_16x16x32_bf16 v[156:159], a[236:239], v[236:239], v[156:159]
v_exp_f32 v58, v58
v_add_f32 v18, v18, v57
v_cvt_pk_bf16_f32 v116, v56, v57
v_exp_f32 v59, v59
v_add_f32 v18, v18, v58
v_add_f32 v18, v18, v59
v_cvt_pk_bf16_f32 v117, v58, v59
v_exp_f32 v60, v60
v_exp_f32 v61, v61
v_add_f32 v19, v19, v60
v_exp_f32 v62, v62
v_add_f32 v19, v19, v61
v_cvt_pk_bf16_f32 v124, v60, v61
v_exp_f32 v63, v63
v_add_f32 v19, v19, v62
v_add_f32 v19, v19, v63
v_cvt_pk_bf16_f32 v125, v62, v63
v_exp_f32 v144, v144
v_exp_f32 v145, v145
v_add_f32 v16, v16, v144
v_exp_f32 v146, v146
v_add_f32 v16, v16, v145
v_cvt_pk_bf16_f32 v86, v144, v145
v_exp_f32 v147, v147
v_add_f32 v16, v16, v146
v_add_f32 v16, v16, v147
v_cvt_pk_bf16_f32 v87, v146, v147
v_exp_f32 v148, v148
v_exp_f32 v149, v149
v_add_f32 v17, v17, v148
v_exp_f32 v150, v150
v_add_f32 v17, v17, v149
v_cvt_pk_bf16_f32 v94, v148, v149
v_exp_f32 v151, v151
v_add_f32 v17, v17, v150
v_add_f32 v17, v17, v151
v_cvt_pk_bf16_f32 v95, v150, v151
v_exp_f32 v152, v152
v_exp_f32 v153, v153
v_add_f32 v18, v18, v152
v_exp_f32 v154, v154
v_add_f32 v18, v18, v153
v_cvt_pk_bf16_f32 v118, v152, v153
v_exp_f32 v155, v155
v_add_f32 v18, v18, v154
v_add_f32 v18, v18, v155
v_cvt_pk_bf16_f32 v119, v154, v155
v_exp_f32 v156, v156
v_exp_f32 v157, v157
v_add_f32 v19, v19, v156
v_exp_f32 v158, v158
v_add_f32 v19, v19, v157
v_cvt_pk_bf16_f32 v126, v156, v157
v_exp_f32 v159, v159
v_add_f32 v19, v19, v158
v_add_f32 v19, v19, v159
v_cvt_pk_bf16_f32 v127, v158, v159
v_max3_f32 v240, v16, v17, v18
v_max_f32 v240, v240, v19
v_cmp_lt_f32 vcc, s36, v240
s_waitcnt vmcnt(16)
s_barrier
v_add_u32 v2, 24576, v2
v_add_u32 v3, 24576, v3
s_mov_b32 s40, s29
s_add_u32 s41, s29, 24576
s_add_u32 s47, s29, 49152
ds_read_b128 a[192:195], v2 offset:0
ds_read_b128 a[196:199], v3 offset:0
ds_read_b128 a[200:203], v2 offset:1024
ds_read_b128 a[204:207], v3 offset:1024
ds_read_b128 a[208:211], v2 offset:2048
ds_read_b128 a[212:215], v3 offset:2048
ds_read_b64_tr_b16 a[240:241], v4 offset:0
ds_read_b64_tr_b16 a[242:243], v4 offset:6144
ds_read_b64_tr_b16 a[244:245], v4 offset:12288
ds_read_b64_tr_b16 a[246:247], v4 offset:18432
s_cbranch_vccnz L_stub_pre
L_ret_pre:
s_waitcnt lgkmcnt(7)
v_mfma_f32_16x16x32_bf16 v[48:51], a[192:195], v[64:67], v[32:35]
s_add_u32 m0, s40, 0
v_add_f32 v12, v12, v16
v_add_f32 v13, v13, v17
v_mfma_f32_16x16x32_bf16 v[48:51], a[196:199], v[96:99], v[48:51]
s_sub_u32 s38, s47, s41
v_add_f32 v14, v14, v18
v_add_f32 v15, v15, v19
v_mfma_f32_16x16x32_bf16 v[48:51], a[200:203], v[128:131], v[48:51]
s_waitcnt lgkmcnt(4)
ds_read_b128 a[216:219], v2 offset:6144
v_mfma_f32_16x16x32_bf16 v[48:51], a[204:207], v[160:163], v[48:51]
buffer_load_dwordx4 v8, s[16:19], s32 offen offset:0 nt lds
v_mfma_f32_16x16x32_bf16 v[48:51], a[208:211], v[192:195], v[48:51]
s_sub_u32 s39, s41, s40
ds_read_b128 a[220:223], v3 offset:6144
v_mfma_f32_16x16x32_bf16 v[48:51], a[212:215], v[224:227], v[48:51]
ds_read_b64_tr_b16 a[248:249], v5 offset:0
v_mfma_f32_16x16x32_bf16 v[52:55], a[192:195], v[68:71], v[36:39]
s_waitcnt vmcnt(13)
ds_read_b64_tr_b16 a[160:161], v30 offset:0
v_mfma_f32_16x16x32_bf16 v[52:55], a[196:199], v[100:103], v[52:55]
ds_read_b64_tr_b16 a[162:163], v30 offset:2048
v_mfma_f32_16x16x32_bf16 v[52:55], a[200:203], v[132:135], v[52:55]
ds_read_b64_tr_b16 a[164:165], v30 offset:32
v_mfma_f32_16x16x32_bf16 v[52:55], a[204:207], v[164:167], v[52:55]
ds_read_b64_tr_b16 a[166:167], v30 offset:2080
v_mfma_f32_16x16x32_bf16 v[52:55], a[208:211], v[196:199], v[52:55]
ds_read_b128 a[224:227], v2 offset:7168
v_mfma_f32_16x16x32_bf16 v[52:55], a[212:215], v[228:231], v[52:55]
ds_read_b128 a[228:231], v3 offset:7168
v_mfma_f32_16x16x32_bf16 v[56:59], a[192:195], v[72:75], v[40:43]
ds_read_b128 a[232:235], v2 offset:8192
v_mfma_f32_16x16x32_bf16 v[56:59], a[196:199], v[104:107], v[56:59]
ds_read_b64_tr_b16 a[168:169], v30 offset:64
v_mfma_f32_16x16x32_bf16 v[56:59], a[200:203], v[136:139], v[56:59]
s_add_u32 m0, s40, 896
v_exp_f32 v48, v48
v_mfma_f32_16x16x32_bf16 v[56:59], a[204:207], v[168:171], v[56:59]
ds_read_b128 a[236:239], v3 offset:8192
v_mfma_f32_16x16x32_bf16 v[56:59], a[208:211], v[200:203], v[56:59]
v_exp_f32 v49, v49
v_mfma_f32_16x16x32_bf16 v[56:59], a[212:215], v[232:235], v[56:59]
ds_read_b64_tr_b16 a[170:171], v30 offset:2112
v_add_f32 v16, v48, v49
v_mfma_f32_16x16x32_bf16 v[60:63], a[192:195], v[76:79], v[44:47]
buffer_load_dwordx4 v8, s[16:19], s32 offen offset:128 nt lds
v_mfma_f32_16x16x32_bf16 v[60:63], a[196:199], v[108:111], v[60:63]
ds_read_b64_tr_b16 a[172:173], v30 offset:96
v_cvt_pk_bf16_f32 v144, v48, v49
v_mfma_f32_16x16x32_bf16 v[60:63], a[200:203], v[140:143], v[60:63]
v_exp_f32 v50, v50
v_mfma_f32_16x16x32_bf16 v[60:63], a[204:207], v[172:175], v[60:63]
v_exp_f32 v51, v51
v_mfma_f32_16x16x32_bf16 v[60:63], a[208:211], v[204:207], v[60:63]
ds_read_b64_tr_b16 a[250:251], v5 offset:6144
v_add_f32 v16, v16, v50
v_mfma_f32_16x16x32_bf16 v[60:63], a[212:215], v[236:239], v[60:63]
s_waitcnt lgkmcnt(15)
v_add_f32 v16, v16, v51
v_cvt_pk_bf16_f32 v145, v50, v51
v_mfma_f32_16x16x32_bf16 a[0:3], a[240:243], v[80:83], 0
ds_read_b64_tr_b16 a[174:175], v30 offset:2144
v_mfma_f32_16x16x32_bf16 a[0:3], a[244:247], v[84:87], a[0:3]
ds_read_b64_tr_b16 a[252:253], v5 offset:12288
v_mfma_f32_16x16x32_bf16 a[4:7], a[240:243], v[88:91], 0
ds_read_b64_tr_b16 a[254:255], v5 offset:18432
v_mfma_f32_16x16x32_bf16 a[4:7], a[244:247], v[92:95], a[4:7]
v_exp_f32 v52, v52
v_mfma_f32_16x16x32_bf16 a[8:11], a[240:243], v[112:115], 0
v_exp_f32 v53, v53
v_mfma_f32_16x16x32_bf16 a[8:11], a[244:247], v[116:119], a[8:11]
s_waitcnt lgkmcnt(10)
s_add_u32 m0, s40, 1792
v_add_f32 v17, v52, v53
v_mfma_f32_16x16x32_bf16 v[48:51], a[216:219], v[64:67], v[32:35]
ds_read_b64_tr_b16 v[216:217], v6 offset:0
v_cvt_pk_bf16_f32 v152, v52, v53
v_mfma_f32_16x16x32_bf16 v[48:51], a[220:223], v[96:99], v[48:51]
v_exp_f32 v54, v54
v_mfma_f32_16x16x32_bf16 v[48:51], a[224:227], v[128:131], v[48:51]
s_waitcnt lgkmcnt(7)
v_exp_f32 v55, v55
v_mfma_f32_16x16x32_bf16 v[48:51], a[228:231], v[160:163], v[48:51]
buffer_load_dwordx4 v8, s[16:19], s32 offen offset:256 nt lds
v_mfma_f32_16x16x32_bf16 v[48:51], a[232:235], v[192:195], v[48:51]
ds_read_b64_tr_b16 v[218:219], v6 offset:6144
v_add_f32 v17, v17, v54
v_mfma_f32_16x16x32_bf16 v[48:51], a[236:239], v[224:227], v[48:51]
ds_read_b64_tr_b16 v[220:221], v6 offset:12288
v_add_f32 v17, v17, v55
v_mfma_f32_16x16x32_bf16 a[12:15], a[240:243], v[120:123], 0
ds_read_b64_tr_b16 v[222:223], v6 offset:18432
v_cvt_pk_bf16_f32 v153, v54, v55
v_mfma_f32_16x16x32_bf16 a[12:15], a[244:247], v[124:127], a[12:15]
s_waitcnt lgkmcnt(4)
v_exp_f32 v56, v56
v_mfma_f32_16x16x32_bf16 a[16:19], a[248:251], v[80:83], 0
buffer_store_dwordx4 a[160:163], v11, s[60:63], s76 offen sc1
v_exp_f32 v57, v57
v_mfma_f32_16x16x32_bf16 a[16:19], a[252:255], v[84:87], a[16:19]
ds_read_b64_tr_b16 a[240:241], v7 offset:0
v_add_f32 v18, v56, v57
v_mfma_f32_16x16x32_bf16 a[20:23], a[248:251], v[88:91], 0
v_exp_f32 v58, v58
v_mfma_f32_16x16x32_bf16 a[20:23], a[252:255], v[92:95], a[20:23]
v_exp_f32 v59, v59
v_mfma_f32_16x16x32_bf16 v[52:55], a[216:219], v[68:71], v[36:39]
ds_read_b64_tr_b16 a[242:243], v7 offset:6144
v_cvt_pk_bf16_f32 v176, v56, v57
v_mfma_f32_16x16x32_bf16 v[52:55], a[220:223], v[100:103], v[52:55]
ds_read_b128 a[192:195], v2 offset:12288
v_add_f32 v18, v18, v58
v_mfma_f32_16x16x32_bf16 v[52:55], a[224:227], v[132:135], v[52:55]
buffer_store_dwordx4 a[164:167], v11, s[60:63], s77 offen sc1
v_mfma_f32_16x16x32_bf16 v[52:55], a[228:231], v[164:167], v[52:55]
s_add_u32 m0, s40, 12288
v_add_f32 v18, v18, v59
v_cvt_pk_bf16_f32 v177, v58, v59
v_mfma_f32_16x16x32_bf16 v[52:55], a[232:235], v[196:199], v[52:55]
v_exp_f32 v60, v60
v_mfma_f32_16x16x32_bf16 v[52:55], a[236:239], v[228:231], v[52:55]
v_exp_f32 v61, v61
v_mfma_f32_16x16x32_bf16 a[24:27], a[248:251], v[112:115], 0
buffer_load_dwordx4 v8, s[16:19], s33 offen offset:0 nt lds
v_mfma_f32_16x16x32_bf16 a[24:27], a[252:255], v[116:119], a[24:27]
ds_read_b64_tr_b16 a[244:245], v7 offset:12288
v_add_f32 v19, v60, v61
v_mfma_f32_16x16x32_bf16 a[28:31], a[248:251], v[120:123], 0
ds_read_b128 a[196:199], v3 offset:12288
v_cvt_pk_bf16_f32 v184, v60, v61
v_mfma_f32_16x16x32_bf16 a[28:31], a[252:255], v[124:127], a[28:31]
s_waitcnt lgkmcnt(5)
v_exp_f32 v62, v62
v_mfma_f32_16x16x32_bf16 a[32:35], v[216:219], v[80:83], 0
buffer_store_dwordx4 a[168:171], v11, s[60:63], s78 offen sc1
v_mfma_f32_16x16x32_bf16 a[32:35], v[220:223], v[84:87], a[32:35]
ds_read_b64_tr_b16 a[246:247], v7 offset:18432
v_add_f32 v19, v19, v62
v_mfma_f32_16x16x32_bf16 v[56:59], a[216:219], v[72:75], v[40:43]
v_exp_f32 v63, v63
v_mfma_f32_16x16x32_bf16 v[56:59], a[220:223], v[104:107], v[56:59]
ds_read_b128 a[200:203], v2 offset:13312
v_add_f32 v19, v19, v63
v_mfma_f32_16x16x32_bf16 v[56:59], a[224:227], v[136:139], v[56:59]
ds_read_b128 a[204:207], v3 offset:13312
v_cvt_pk_bf16_f32 v185, v62, v63
v_mfma_f32_16x16x32_bf16 v[56:59], a[228:231], v[168:171], v[56:59]
ds_read_b128 a[208:211], v2 offset:14336
v_mfma_f32_16x16x32_bf16 v[56:59], a[232:235], v[200:203], v[56:59]
v_exp_f32 v48, v48
v_mfma_f32_16x16x32_bf16 v[56:59], a[236:239], v[232:235], v[56:59]
s_add_u32 m0, s40, 13184
ds_read_b128 a[212:215], v3 offset:14336
v_mfma_f32_16x16x32_bf16 a[36:39], v[216:219], v[88:91], 0
buffer_store_dwordx4 a[172:175], v11, s[60:63], s79 offen sc1
v_mfma_f32_16x16x32_bf16 a[36:39], v[220:223], v[92:95], a[36:39]
ds_read_b64_tr_b16 a[248:249], v4 offset:1024
v_add_f32 v16, v16, v48
v_mfma_f32_16x16x32_bf16 a[40:43], v[216:219], v[112:115], 0
ds_read_b64_tr_b16 a[250:251], v4 offset:7168
v_mov_b32 v244, 0
v_mfma_f32_16x16x32_bf16 a[40:43], v[220:223], v[116:119], a[40:43]
buffer_load_dwordx4 v8, s[16:19], s33 offen offset:128 nt lds
v_mfma_f32_16x16x32_bf16 a[44:47], v[216:219], v[120:123], 0
v_exp_f32 v49, v49
v_mfma_f32_16x16x32_bf16 a[44:47], v[220:223], v[124:127], a[44:47]
ds_read_b64_tr_b16 a[252:253], v4 offset:13312
v_add_f32 v16, v16, v49
v_mfma_f32_16x16x32_bf16 v[60:63], a[216:219], v[76:79], v[44:47]
v_exp_f32 v50, v50
v_mfma_f32_16x16x32_bf16 v[60:63], a[220:223], v[108:111], v[60:63]
ds_read_b64_tr_b16 a[254:255], v4 offset:19456
v_cvt_pk_bf16_f32 v146, v48, v49
v_mfma_f32_16x16x32_bf16 v[60:63], a[224:227], v[140:143], v[60:63]
v_exp_f32 v51, v51
v_mfma_f32_16x16x32_bf16 v[60:63], a[228:231], v[172:175], v[60:63]
ds_read_b64_tr_b16 v[216:217], v5 offset:1024
v_add_f32 v16, v16, v50
v_mfma_f32_16x16x32_bf16 v[60:63], a[232:235], v[204:207], v[60:63]
ds_read_b64_tr_b16 v[218:219], v5 offset:7168
v_add_f32 v16, v16, v51
v_mfma_f32_16x16x32_bf16 v[60:63], a[236:239], v[236:239], v[60:63]
s_waitcnt lgkmcnt(10)
v_mov_b32 v245, 0
v_cvt_pk_bf16_f32 v147, v50, v51
v_mfma_f32_16x16x32_bf16 a[48:51], a[240:243], v[80:83], 0
v_mov_b32 v246, 0
v_mov_b32 v247, 0
v_mfma_f32_16x16x32_bf16 a[48:51], a[244:247], v[84:87], a[48:51]
ds_read_b64_tr_b16 v[220:221], v5 offset:13312
v_and_b32 v248, 0x70, v11
v_mfma_f32_16x16x32_bf16 a[52:55], a[240:243], v[88:91], 0
s_add_u32 m0, s40, 14080
v_exp_f32 v52, v52
v_mfma_f32_16x16x32_bf16 a[52:55], a[244:247], v[92:95], a[52:55]
ds_read_b64_tr_b16 v[222:223], v5 offset:19456
v_add_f32 v17, v17, v52
v_mfma_f32_16x16x32_bf16 a[56:59], a[240:243], v[112:115], 0
v_exp_f32 v53, v53
v_mfma_f32_16x16x32_bf16 a[56:59], a[244:247], v[116:119], a[56:59]
s_waitcnt lgkmcnt(11)
v_exp_f32 v54, v54
v_mfma_f32_16x16x32_bf16 v[48:51], a[192:195], v[64:67], v[32:35]
buffer_load_dwordx4 v8, s[16:19], s33 offen offset:256 nt lds
v_mfma_f32_16x16x32_bf16 v[48:51], a[196:199], v[96:99], v[48:51]
v_exp_f32 v55, v55
v_mfma_f32_16x16x32_bf16 v[48:51], a[200:203], v[128:131], v[48:51]
s_waitcnt lgkmcnt(8)
v_add_f32 v17, v17, v53
v_cvt_pk_bf16_f32 v154, v52, v53
v_mfma_f32_16x16x32_bf16 v[48:51], a[204:207], v[160:163], v[48:51]
v_add_f32 v17, v17, v54
v_add_f32 v17, v17, v55
v_mfma_f32_16x16x32_bf16 v[48:51], a[208:211], v[192:195], v[48:51]
ds_read_b128 a[216:219], v2 offset:18432
s_lshl_b32 s7, s2, 2
s_add_u32 s7, s7, s28
s_lshl_b32 s7, s7, 7
s_add_u32 s7, s7, 98304
buffer_store_dwordx4 v[244:247], v248, s[68:71], s7 offen sc1
v_cvt_pk_bf16_f32 v155, v54, v55
v_mfma_f32_16x16x32_bf16 v[48:51], a[212:215], v[224:227], v[48:51]
v_exp_f32 v56, v56
v_mfma_f32_16x16x32_bf16 a[60:63], a[240:243], v[120:123], 0
ds_read_b128 a[220:223], v3 offset:18432
v_add_f32 v18, v18, v56
v_mfma_f32_16x16x32_bf16 a[60:63], a[244:247], v[124:127], a[60:63]
s_waitcnt lgkmcnt(6)
v_exp_f32 v57, v57
v_mfma_f32_16x16x32_bf16 a[64:67], a[248:251], v[80:83], 0
ds_read_b64_tr_b16 a[240:241], v6 offset:1024
v_add_f32 v18, v18, v57
v_mfma_f32_16x16x32_bf16 a[64:67], a[252:255], v[84:87], a[64:67]
ds_read_b64_tr_b16 a[242:243], v6 offset:7168
v_cvt_pk_bf16_f32 v178, v56, v57
v_mfma_f32_16x16x32_bf16 a[68:71], a[248:251], v[88:91], 0
v_exp_f32 v58, v58
v_mfma_f32_16x16x32_bf16 a[68:71], a[252:255], v[92:95], a[68:71]
s_add_u32 m0, s47, 73728
v_exp_f32 v59, v59
v_mfma_f32_16x16x32_bf16 v[52:55], a[192:195], v[68:71], v[36:39]
ds_read_b64_tr_b16 a[244:245], v6 offset:13312
v_add_f32 v18, v18, v58
v_mfma_f32_16x16x32_bf16 v[52:55], a[196:199], v[100:103], v[52:55]
ds_read_b64_tr_b16 a[246:247], v6 offset:19456
v_add_f32 v18, v18, v59
v_mfma_f32_16x16x32_bf16 v[52:55], a[200:203], v[132:135], v[52:55]
ds_read_b128 a[224:227], v2 offset:19456
s_lshl_b32 s7, s2, 2
s_add_u32 s7, s7, s28
s_cmp_lt_u32 s7, 32
s_cselect_b32 s7, s7, 0x400000
s_lshl_b32 s7, s7, 7
s_add_u32 s7, s7, 65536
buffer_store_dwordx4 v[244:247], v248, s[68:71], s7 offen sc1
v_cvt_pk_bf16_f32 v179, v58, v59
v_mfma_f32_16x16x32_bf16 v[52:55], a[204:207], v[164:167], v[52:55]
buffer_load_dwordx4 v9, s[20:23], s34 offen offset:0 nt lds
v_mfma_f32_16x16x32_bf16 v[52:55], a[208:211], v[196:199], v[52:55]
v_exp_f32 v60, v60
v_mfma_f32_16x16x32_bf16 v[52:55], a[212:215], v[228:231], v[52:55]
ds_read_b128 a[228:231], v3 offset:19456
v_add_f32 v19, v19, v60
v_mfma_f32_16x16x32_bf16 a[72:75], a[248:251], v[112:115], 0
v_exp_f32 v61, v61
v_mfma_f32_16x16x32_bf16 a[72:75], a[252:255], v[116:119], a[72:75]
ds_read_b128 a[232:235], v2 offset:20480
v_add_f32 v19, v19, v61
v_mfma_f32_16x16x32_bf16 a[76:79], a[248:251], v[120:123], 0
v_exp_f32 v62, v62
v_mfma_f32_16x16x32_bf16 a[76:79], a[252:255], v[124:127], a[76:79]
s_waitcnt lgkmcnt(9)
v_exp_f32 v63, v63
v_mfma_f32_16x16x32_bf16 a[80:83], v[216:219], v[80:83], 0
ds_read_b64_tr_b16 a[248:249], v7 offset:1024
v_cvt_pk_bf16_f32 v186, v60, v61
v_mfma_f32_16x16x32_bf16 a[80:83], v[220:223], v[84:87], a[80:83]
ds_read_b128 a[236:239], v3 offset:20480
v_add_f32 v19, v19, v62
v_mfma_f32_16x16x32_bf16 v[56:59], a[192:195], v[72:75], v[40:43]
ds_read_b64_tr_b16 a[250:251], v7 offset:7168
v_add_f32 v19, v19, v63
v_mfma_f32_16x16x32_bf16 v[56:59], a[196:199], v[104:107], v[56:59]
ds_read_b64_tr_b16 a[252:253], v7 offset:13312
v_cvt_pk_bf16_f32 v187, v62, v63
v_mfma_f32_16x16x32_bf16 v[56:59], a[200:203], v[136:139], v[56:59]
s_add_u32 m0, s47, 74624
v_exp_f32 v48, v48
v_mfma_f32_16x16x32_bf16 v[56:59], a[204:207], v[168:171], v[56:59]
ds_read_b64_tr_b16 a[254:255], v7 offset:19456
v_add_f32 v16, v16, v48
v_mfma_f32_16x16x32_bf16 v[56:59], a[208:211], v[200:203], v[56:59]
v_exp_f32 v49, v49
v_mfma_f32_16x16x32_bf16 v[56:59], a[212:215], v[232:235], v[56:59]
v_exp_f32 v50, v50
v_mfma_f32_16x16x32_bf16 a[84:87], v[216:219], v[88:91], 0
buffer_load_dwordx4 v9, s[20:23], s34 offen offset:128 nt lds
v_mfma_f32_16x16x32_bf16 a[84:87], v[220:223], v[92:95], a[84:87]
v_exp_f32 v51, v51
v_mfma_f32_16x16x32_bf16 a[88:91], v[216:219], v[112:115], 0
v_add_f32 v16, v16, v49
v_cvt_pk_bf16_f32 v148, v48, v49
v_mfma_f32_16x16x32_bf16 a[88:91], v[220:223], v[116:119], a[88:91]
v_add_f32 v16, v16, v50
v_add_f32 v16, v16, v51
v_mfma_f32_16x16x32_bf16 a[92:95], v[216:219], v[120:123], 0
v_exp_f32 v52, v52
v_mfma_f32_16x16x32_bf16 a[92:95], v[220:223], v[124:127], a[92:95]
ds_read_b64_tr_b16 v[216:217], v4 offset:2048
v_cvt_pk_bf16_f32 v149, v50, v51
v_mfma_f32_16x16x32_bf16 v[60:63], a[192:195], v[76:79], v[44:47]
ds_read_b64_tr_b16 v[218:219], v4 offset:8192
v_add_f32 v17, v17, v52
v_mfma_f32_16x16x32_bf16 v[60:63], a[196:199], v[108:111], v[60:63]
v_exp_f32 v53, v53
v_mfma_f32_16x16x32_bf16 v[60:63], a[200:203], v[140:143], v[60:63]
ds_read_b64_tr_b16 v[220:221], v4 offset:14336
v_add_f32 v17, v17, v53
v_mfma_f32_16x16x32_bf16 v[60:63], a[204:207], v[172:175], v[60:63]
ds_read_b64_tr_b16 v[222:223], v4 offset:20480
v_cvt_pk_bf16_f32 v156, v52, v53
v_mfma_f32_16x16x32_bf16 v[60:63], a[208:211], v[204:207], v[60:63]
v_exp_f32 v54, v54
v_mfma_f32_16x16x32_bf16 v[60:63], a[212:215], v[236:239], v[60:63]
s_waitcnt lgkmcnt(12)
s_add_u32 m0, s47, 75520
v_add_f32 v17, v17, v54
v_mfma_f32_16x16x32_bf16 a[96:99], a[240:243], v[80:83], 0
v_exp_f32 v55, v55
v_mfma_f32_16x16x32_bf16 a[96:99], a[244:247], v[84:87], a[96:99]
v_add_f32 v17, v17, v55
v_cvt_pk_bf16_f32 v157, v54, v55
v_mfma_f32_16x16x32_bf16 a[100:103], a[240:243], v[88:91], 0
v_exp_f32 v56, v56
v_mfma_f32_16x16x32_bf16 a[100:103], a[244:247], v[92:95], a[100:103]
buffer_load_dwordx4 v9, s[20:23], s34 offen offset:256 nt lds
v_mfma_f32_16x16x32_bf16 a[104:107], a[240:243], v[112:115], 0
v_exp_f32 v57, v57
v_mfma_f32_16x16x32_bf16 a[104:107], a[244:247], v[116:119], a[104:107]
s_waitcnt lgkmcnt(11)
v_exp_f32 v58, v58
v_mfma_f32_16x16x32_bf16 v[48:51], a[216:219], v[64:67], v[32:35]
v_exp_f32 v59, v59
v_mfma_f32_16x16x32_bf16 v[48:51], a[220:223], v[96:99], v[48:51]
v_add_f32 v18, v18, v56
v_add_f32 v18, v18, v57
v_mfma_f32_16x16x32_bf16 v[48:51], a[224:227], v[128:131], v[48:51]
s_waitcnt lgkmcnt(7)
v_cvt_pk_bf16_f32 v180, v56, v57
v_add_f32 v18, v18, v58
v_mfma_f32_16x16x32_bf16 v[48:51], a[228:231], v[160:163], v[48:51]
v_add_f32 v18, v18, v59
v_cvt_pk_bf16_f32 v181, v58, v59
v_mfma_f32_16x16x32_bf16 v[48:51], a[232:235], v[192:195], v[48:51]
v_exp_f32 v60, v60
v_mfma_f32_16x16x32_bf16 v[48:51], a[236:239], v[224:227], v[48:51]
v_exp_f32 v61, v61
v_mfma_f32_16x16x32_bf16 a[108:111], a[240:243], v[120:123], 0
v_exp_f32 v62, v62
v_mfma_f32_16x16x32_bf16 a[108:111], a[244:247], v[124:127], a[108:111]
s_waitcnt lgkmcnt(4)
v_exp_f32 v63, v63
v_mfma_f32_16x16x32_bf16 a[112:115], a[248:251], v[80:83], 0
ds_read_b64_tr_b16 a[240:241], v5 offset:2048
s_add_u32 m0, s47, 86016
v_mfma_f32_16x16x32_bf16 a[112:115], a[252:255], v[84:87], a[112:115]
ds_read_b64_tr_b16 a[242:243], v5 offset:8192
v_add_f32 v19, v19, v60
v_mfma_f32_16x16x32_bf16 a[116:119], a[248:251], v[88:91], 0
ds_read_b64_tr_b16 a[244:245], v5 offset:14336
v_add_f32 v19, v19, v61
v_mfma_f32_16x16x32_bf16 a[116:119], a[252:255], v[92:95], a[116:119]
ds_read_b64_tr_b16 a[246:247], v5 offset:20480
v_cvt_pk_bf16_f32 v188, v60, v61
v_mfma_f32_16x16x32_bf16 v[52:55], a[216:219], v[68:71], v[36:39]
buffer_load_dwordx4 v9, s[20:23], s35 offen offset:0 nt lds
v_mfma_f32_16x16x32_bf16 v[52:55], a[220:223], v[100:103], v[52:55]
v_add_f32 v19, v19, v62
v_add_f32 v19, v19, v63
v_mfma_f32_16x16x32_bf16 v[52:55], a[224:227], v[132:135], v[52:55]
v_exp_f32 v48, v48
v_mfma_f32_16x16x32_bf16 v[52:55], a[228:231], v[164:167], v[52:55]
v_cvt_pk_bf16_f32 v189, v62, v63
v_add_f32 v16, v16, v48
v_mfma_f32_16x16x32_bf16 v[52:55], a[232:235], v[196:199], v[52:55]
v_exp_f32 v49, v49
v_mfma_f32_16x16x32_bf16 v[52:55], a[236:239], v[228:231], v[52:55]
v_exp_f32 v50, v50
v_mfma_f32_16x16x32_bf16 a[120:123], a[248:251], v[112:115], 0
v_exp_f32 v51, v51
v_mfma_f32_16x16x32_bf16 a[120:123], a[252:255], v[116:119], a[120:123]
v_add_f32 v16, v16, v49
v_cvt_pk_bf16_f32 v150, v48, v49
v_mfma_f32_16x16x32_bf16 a[124:127], a[248:251], v[120:123], 0
v_add_f32 v16, v16, v50
v_add_f32 v16, v16, v51
v_mfma_f32_16x16x32_bf16 a[124:127], a[252:255], v[124:127], a[124:127]
s_waitcnt lgkmcnt(4)
ds_read_b64_tr_b16 a[248:249], v6 offset:2048
v_mfma_f32_16x16x32_bf16 a[128:131], v[216:219], v[80:83], 0
ds_read_b64_tr_b16 a[250:251], v6 offset:8192
v_cvt_pk_bf16_f32 v151, v50, v51
v_mfma_f32_16x16x32_bf16 a[128:131], v[220:223], v[84:87], a[128:131]
ds_read_b64_tr_b16 a[252:253], v6 offset:14336
s_add_u32 m0, s47, 86912
v_mfma_f32_16x16x32_bf16 v[56:59], a[216:219], v[72:75], v[40:43]
ds_read_b64_tr_b16 a[254:255], v6 offset:20480
v_mfma_f32_16x16x32_bf16 v[56:59], a[220:223], v[104:107], v[56:59]
v_exp_f32 v52, v52
v_mfma_f32_16x16x32_bf16 v[56:59], a[224:227], v[136:139], v[56:59]
v_exp_f32 v53, v53
v_mfma_f32_16x16x32_bf16 v[56:59], a[228:231], v[168:171], v[56:59]
buffer_load_dwordx4 v9, s[20:23], s35 offen offset:128 nt lds
v_mfma_f32_16x16x32_bf16 v[56:59], a[232:235], v[200:203], v[56:59]
v_exp_f32 v54, v54
v_mfma_f32_16x16x32_bf16 v[56:59], a[236:239], v[232:235], v[56:59]
v_exp_f32 v55, v55
v_mfma_f32_16x16x32_bf16 a[132:135], v[216:219], v[88:91], 0
v_add_f32 v17, v17, v52
v_add_f32 v17, v17, v53
v_mfma_f32_16x16x32_bf16 a[132:135], v[220:223], v[92:95], a[132:135]
v_cvt_pk_bf16_f32 v158, v52, v53
v_add_f32 v17, v17, v54
v_mfma_f32_16x16x32_bf16 a[136:139], v[216:219], v[112:115], 0
v_exp_f32 v56, v56
v_mfma_f32_16x16x32_bf16 a[136:139], v[220:223], v[116:119], a[136:139]
v_exp_f32 v57, v57
v_mfma_f32_16x16x32_bf16 a[140:143], v[216:219], v[120:123], 0
v_exp_f32 v58, v58
v_mfma_f32_16x16x32_bf16 a[140:143], v[220:223], v[124:127], a[140:143]
ds_read_b64_tr_b16 v[216:217], v7 offset:2048
v_add_f32 v17, v17, v55
v_mfma_f32_16x16x32_bf16 v[60:63], a[216:219], v[76:79], v[44:47]
ds_read_b64_tr_b16 v[218:219], v7 offset:8192
v_cvt_pk_bf16_f32 v159, v54, v55
v_mfma_f32_16x16x32_bf16 v[60:63], a[220:223], v[108:111], v[60:63]
ds_read_b64_tr_b16 v[220:221], v7 offset:14336
v_add_f32 v18, v18, v56
v_mfma_f32_16x16x32_bf16 v[60:63], a[224:227], v[140:143], v[60:63]
ds_read_b64_tr_b16 v[222:223], v7 offset:20480
s_add_u32 m0, s47, 87808
v_mfma_f32_16x16x32_bf16 v[60:63], a[228:231], v[172:175], v[60:63]
v_exp_f32 v59, v59
v_mfma_f32_16x16x32_bf16 v[60:63], a[232:235], v[204:207], v[60:63]
v_add_f32 v18, v18, v57
v_cvt_pk_bf16_f32 v182, v56, v57
v_mfma_f32_16x16x32_bf16 v[60:63], a[236:239], v[236:239], v[60:63]
s_waitcnt lgkmcnt(8)
v_add_f32 v18, v18, v58
v_add_f32 v18, v18, v59
v_mfma_f32_16x16x32_bf16 a[144:147], a[240:243], v[80:83], 0
buffer_load_dwordx4 v9, s[20:23], s35 offen offset:256 nt lds
v_mfma_f32_16x16x32_bf16 a[144:147], a[244:247], v[84:87], a[144:147]
s_add_u32 s32, s32, 24576
s_add_u32 s33, s33, 24576
s_add_u32 s34, s34, 24576
v_mfma_f32_16x16x32_bf16 a[148:151], a[240:243], v[88:91], 0
s_add_u32 s35, s35, 24576
v_exp_f32 v60, v60
v_mfma_f32_16x16x32_bf16 a[148:151], a[244:247], v[92:95], a[148:151]
s_mov_b32 s6, s40
v_exp_f32 v61, v61
v_mfma_f32_16x16x32_bf16 a[152:155], a[240:243], v[112:115], 0
s_mov_b32 s40, s41
v_exp_f32 v62, v62
v_mfma_f32_16x16x32_bf16 a[152:155], a[244:247], v[116:119], a[152:155]
s_waitcnt vmcnt(6) lgkmcnt(0)
v_exp_f32 v63, v63
v_mfma_f32_16x16x32_bf16 a[156:159], a[240:243], v[120:123], 0
s_mov_b32 s41, s47
v_cvt_pk_bf16_f32 v183, v58, v59
v_add_f32 v19, v19, v60
v_mfma_f32_16x16x32_bf16 a[156:159], a[244:247], v[124:127], a[156:159]
s_barrier
v_mfma_f32_16x16x32_bf16 a[160:163], a[248:251], v[80:83], 0
s_mov_b32 s47, s6
v_add_u32 v2, s38, v2
v_add_u32 v3, s38, v3
v_mfma_f32_16x16x32_bf16 a[160:163], a[252:255], v[84:87], a[160:163]
ds_read_b128 a[192:195], v2 offset:0
v_add_u32 v4, s39, v4
v_mfma_f32_16x16x32_bf16 a[164:167], a[248:251], v[88:91], 0
ds_read_b128 a[196:199], v3 offset:0
v_add_f32 v19, v19, v61
v_mfma_f32_16x16x32_bf16 a[164:167], a[252:255], v[92:95], a[164:167]
ds_read_b128 a[200:203], v2 offset:1024
v_cvt_pk_bf16_f32 v190, v60, v61
v_mfma_f32_16x16x32_bf16 a[168:171], a[248:251], v[112:115], 0
ds_read_b128 a[204:207], v3 offset:1024
v_add_f32 v19, v19, v62
v_mfma_f32_16x16x32_bf16 a[168:171], a[252:255], v[116:119], a[168:171]
ds_read_b128 a[208:211], v2 offset:2048
v_add_f32 v19, v19, v63
v_mfma_f32_16x16x32_bf16 a[172:175], a[248:251], v[120:123], 0
ds_read_b128 a[212:215], v3 offset:2048
v_cvt_pk_bf16_f32 v191, v62, v63
v_mfma_f32_16x16x32_bf16 a[172:175], a[252:255], v[124:127], a[172:175]
ds_read_b64_tr_b16 a[240:241], v4 offset:0
v_add_u32 v5, s39, v5
v_mfma_f32_16x16x32_bf16 a[176:179], v[216:219], v[80:83], 0
ds_read_b64_tr_b16 a[242:243], v4 offset:6144
v_max3_f32 v240, v16, v17, v18
v_mfma_f32_16x16x32_bf16 a[176:179], v[220:223], v[84:87], a[176:179]
ds_read_b64_tr_b16 a[244:245], v4 offset:12288
v_add_u32 v6, s39, v6
v_mfma_f32_16x16x32_bf16 a[180:183], v[216:219], v[88:91], 0
ds_read_b64_tr_b16 a[246:247], v4 offset:18432
v_max_f32 v240, v240, v19
v_mfma_f32_16x16x32_bf16 a[180:183], v[220:223], v[92:95], a[180:183]
v_add_u32 v7, s39, v7
v_cmp_lt_f32 vcc, s36, v240
v_mfma_f32_16x16x32_bf16 a[184:187], v[216:219], v[112:115], 0
v_mfma_f32_16x16x32_bf16 a[184:187], v[220:223], v[116:119], a[184:187]
v_mfma_f32_16x16x32_bf16 a[188:191], v[216:219], v[120:123], 0
v_mfma_f32_16x16x32_bf16 a[188:191], v[220:223], v[124:127], a[188:191]
s_cbranch_vccnz L_stub_s0
L_ret_s0:
s_cmp_lg_u32 s28, 0
s_cbranch_scc1 L_norp
s_mov_b32 s7, 16384
s_mov_b64 exec, 1
buffer_atomic_add v31, off, s[68:71], s7 sc1
s_mov_b64 exec, -1
L_norp:
s_mov_b32 s37, 14
.p2align 3
L_attn_loop:
s_waitcnt lgkmcnt(7)
v_mfma_f32_16x16x32_bf16 v[48:51], a[192:195], v[64:67], v[32:35]
s_add_u32 m0, s40, 0
v_add_f32 v12, v12, v16
v_add_f32 v13, v13, v17
v_mfma_f32_16x16x32_bf16 v[48:51], a[196:199], v[96:99], v[48:51]
s_sub_u32 s38, s47, s41
v_add_f32 v14, v14, v18
v_add_f32 v15, v15, v19
v_mfma_f32_16x16x32_bf16 v[48:51], a[200:203], v[128:131], v[48:51]
s_waitcnt lgkmcnt(4)
ds_read_b128 a[216:219], v2 offset:6144
v_mfma_f32_16x16x32_bf16 v[48:51], a[204:207], v[160:163], v[48:51]
buffer_load_dwordx4 v8, s[16:19], s32 offen offset:0 nt lds
v_mfma_f32_16x16x32_bf16 v[48:51], a[208:211], v[192:195], v[48:51]
s_sub_u32 s39, s41, s40
ds_read_b128 a[220:223], v3 offset:6144
v_mfma_f32_16x16x32_bf16 v[48:51], a[212:215], v[224:227], v[48:51]
ds_read_b64_tr_b16 a[248:249], v5 offset:0
v_mfma_f32_16x16x32_bf16 v[52:55], a[192:195], v[68:71], v[36:39]
ds_read_b128 a[224:227], v2 offset:7168
v_mfma_f32_16x16x32_bf16 v[52:55], a[196:199], v[100:103], v[52:55]
ds_read_b64_tr_b16 a[250:251], v5 offset:6144
v_mfma_f32_16x16x32_bf16 v[52:55], a[200:203], v[132:135], v[52:55]
ds_read_b64_tr_b16 a[252:253], v5 offset:12288
v_mfma_f32_16x16x32_bf16 v[52:55], a[204:207], v[164:167], v[52:55]
ds_read_b128 a[228:231], v3 offset:7168
v_mfma_f32_16x16x32_bf16 v[52:55], a[208:211], v[196:199], v[52:55]
v_exp_f32 v48, v48
v_mfma_f32_16x16x32_bf16 v[52:55], a[212:215], v[228:231], v[52:55]
v_exp_f32 v49, v49
v_mfma_f32_16x16x32_bf16 v[56:59], a[192:195], v[72:75], v[40:43]
ds_read_b128 a[232:235], v2 offset:8192
v_add_f32 v16, v48, v49
v_mfma_f32_16x16x32_bf16 v[56:59], a[196:199], v[104:107], v[56:59]
ds_read_b64_tr_b16 a[254:255], v5 offset:18432
v_cvt_pk_bf16_f32 v80, v48, v49
v_mfma_f32_16x16x32_bf16 v[56:59], a[200:203], v[136:139], v[56:59]
s_add_u32 m0, s40, 896
v_exp_f32 v50, v50
v_mfma_f32_16x16x32_bf16 v[56:59], a[204:207], v[168:171], v[56:59]
ds_read_b128 a[236:239], v3 offset:8192
v_add_f32 v16, v16, v50
v_mfma_f32_16x16x32_bf16 v[56:59], a[208:211], v[200:203], v[56:59]
v_exp_f32 v51, v51
v_mfma_f32_16x16x32_bf16 v[56:59], a[212:215], v[232:235], v[56:59]
ds_read_b64_tr_b16 v[216:217], v6 offset:0
v_add_f32 v16, v16, v51
v_mfma_f32_16x16x32_bf16 v[60:63], a[192:195], v[76:79], v[44:47]
buffer_load_dwordx4 v8, s[16:19], s32 offen offset:128 nt lds
v_mfma_f32_16x16x32_bf16 v[60:63], a[196:199], v[108:111], v[60:63]
ds_read_b64_tr_b16 v[218:219], v6 offset:6144
v_cvt_pk_bf16_f32 v81, v50, v51
v_mfma_f32_16x16x32_bf16 v[60:63], a[200:203], v[140:143], v[60:63]
v_exp_f32 v52, v52
v_mfma_f32_16x16x32_bf16 v[60:63], a[204:207], v[172:175], v[60:63]
v_exp_f32 v53, v53
v_mfma_f32_16x16x32_bf16 v[60:63], a[208:211], v[204:207], v[60:63]
ds_read_b64_tr_b16 v[220:221], v6 offset:12288
v_add_f32 v17, v52, v53
v_mfma_f32_16x16x32_bf16 v[60:63], a[212:215], v[236:239], v[60:63]
s_waitcnt lgkmcnt(13)
v_exp_f32 v54, v54
v_mfma_f32_16x16x32_bf16 a[0:3], a[240:243], v[144:147], a[0:3]
ds_read_b64_tr_b16 v[222:223], v6 offset:18432
v_cvt_pk_bf16_f32 v88, v52, v53
v_mfma_f32_16x16x32_bf16 a[0:3], a[244:247], v[148:151], a[0:3]
ds_read_b128 a[192:195], v2 offset:12288
v_add_f32 v17, v17, v54
v_mfma_f32_16x16x32_bf16 a[4:7], a[240:243], v[152:155], a[4:7]
v_exp_f32 v55, v55
v_mfma_f32_16x16x32_bf16 a[4:7], a[244:247], v[156:159], a[4:7]
v_add_f32 v17, v17, v55
v_cvt_pk_bf16_f32 v89, v54, v55
v_mfma_f32_16x16x32_bf16 a[8:11], a[240:243], v[176:179], a[8:11]
v_exp_f32 v56, v56
v_mfma_f32_16x16x32_bf16 a[8:11], a[244:247], v[180:183], a[8:11]
s_waitcnt lgkmcnt(11)
s_add_u32 m0, s40, 1792
v_mfma_f32_16x16x32_bf16 v[48:51], a[216:219], v[64:67], v[32:35]
v_exp_f32 v57, v57
v_mfma_f32_16x16x32_bf16 v[48:51], a[220:223], v[96:99], v[48:51]
ds_read_b128 a[196:199], v3 offset:12288
v_add_f32 v18, v56, v57
v_mfma_f32_16x16x32_bf16 v[48:51], a[224:227], v[128:131], v[48:51]
s_waitcnt lgkmcnt(6)
v_exp_f32 v58, v58
v_mfma_f32_16x16x32_bf16 v[48:51], a[228:231], v[160:163], v[48:51]
buffer_load_dwordx4 v8, s[16:19], s32 offen offset:256 nt lds
v_mfma_f32_16x16x32_bf16 v[48:51], a[232:235], v[192:195], v[48:51]
v_exp_f32 v59, v59
v_mfma_f32_16x16x32_bf16 v[48:51], a[236:239], v[224:227], v[48:51]
ds_read_b128 a[200:203], v2 offset:13312
v_cvt_pk_bf16_f32 v112, v56, v57
v_mfma_f32_16x16x32_bf16 a[12:15], a[240:243], v[184:187], a[12:15]
v_add_f32 v18, v18, v58
v_add_f32 v18, v18, v59
v_mfma_f32_16x16x32_bf16 a[12:15], a[244:247], v[188:191], a[12:15]
ds_read_b64_tr_b16 a[240:241], v7 offset:0
v_cvt_pk_bf16_f32 v113, v58, v59
v_mfma_f32_16x16x32_bf16 a[16:19], a[248:251], v[144:147], a[16:19]
v_exp_f32 v60, v60
v_mfma_f32_16x16x32_bf16 a[16:19], a[252:255], v[148:151], a[16:19]
v_exp_f32 v61, v61
v_mfma_f32_16x16x32_bf16 a[20:23], a[248:251], v[152:155], a[20:23]
ds_read_b64_tr_b16 a[242:243], v7 offset:6144
v_add_f32 v19, v60, v61
v_mfma_f32_16x16x32_bf16 a[20:23], a[252:255], v[156:159], a[20:23]
ds_read_b64_tr_b16 a[244:245], v7 offset:12288
v_cvt_pk_bf16_f32 v120, v60, v61
v_mfma_f32_16x16x32_bf16 v[52:55], a[216:219], v[68:71], v[36:39]
v_exp_f32 v62, v62
v_mfma_f32_16x16x32_bf16 v[52:55], a[220:223], v[100:103], v[52:55]
ds_read_b64_tr_b16 a[246:247], v7 offset:18432
v_add_f32 v19, v19, v62
v_mfma_f32_16x16x32_bf16 v[52:55], a[224:227], v[132:135], v[52:55]
s_add_u32 m0, s40, 12288
v_exp_f32 v63, v63
v_mfma_f32_16x16x32_bf16 v[52:55], a[228:231], v[164:167], v[52:55]
ds_read_b128 a[204:207], v3 offset:13312
v_add_f32 v19, v19, v63
v_mfma_f32_16x16x32_bf16 v[52:55], a[232:235], v[196:199], v[52:55]
v_exp_f32 v48, v48
v_mfma_f32_16x16x32_bf16 v[52:55], a[236:239], v[228:231], v[52:55]
ds_read_b128 a[208:211], v2 offset:14336
v_cvt_pk_bf16_f32 v121, v62, v63
v_mfma_f32_16x16x32_bf16 a[24:27], a[248:251], v[176:179], a[24:27]
buffer_load_dwordx4 v8, s[16:19], s33 offen offset:0 nt lds
v_mfma_f32_16x16x32_bf16 a[24:27], a[252:255], v[180:183], a[24:27]
v_exp_f32 v49, v49
v_mfma_f32_16x16x32_bf16 a[28:31], a[248:251], v[184:187], a[28:31]
v_exp_f32 v50, v50
v_mfma_f32_16x16x32_bf16 a[28:31], a[252:255], v[188:191], a[28:31]
s_waitcnt lgkmcnt(9)
v_exp_f32 v51, v51
v_mfma_f32_16x16x32_bf16 a[32:35], v[216:219], v[144:147], a[32:35]
ds_read_b64_tr_b16 a[248:249], v4 offset:1024
v_add_f32 v16, v16, v48
v_mfma_f32_16x16x32_bf16 a[32:35], v[220:223], v[148:151], a[32:35]
ds_read_b128 a[212:215], v3 offset:14336
v_add_f32 v16, v16, v49
v_mfma_f32_16x16x32_bf16 v[56:59], a[216:219], v[72:75], v[40:43]
ds_read_b64_tr_b16 a[250:251], v4 offset:7168
v_cvt_pk_bf16_f32 v82, v48, v49
v_mfma_f32_16x16x32_bf16 v[56:59], a[220:223], v[104:107], v[56:59]
ds_read_b64_tr_b16 a[252:253], v4 offset:13312
v_add_f32 v16, v16, v50
v_mfma_f32_16x16x32_bf16 v[56:59], a[224:227], v[136:139], v[56:59]
ds_read_b64_tr_b16 a[254:255], v4 offset:19456
v_add_f32 v16, v16, v51
v_mfma_f32_16x16x32_bf16 v[56:59], a[228:231], v[168:171], v[56:59]
v_exp_f32 v52, v52
v_mfma_f32_16x16x32_bf16 v[56:59], a[232:235], v[200:203], v[56:59]
v_cvt_pk_bf16_f32 v83, v50, v51
v_add_f32 v17, v17, v52
v_mfma_f32_16x16x32_bf16 v[56:59], a[236:239], v[232:235], v[56:59]
s_add_u32 m0, s40, 13184
v_exp_f32 v53, v53
v_mfma_f32_16x16x32_bf16 a[36:39], v[216:219], v[152:155], a[36:39]
v_exp_f32 v54, v54
v_mfma_f32_16x16x32_bf16 a[36:39], v[220:223], v[156:159], a[36:39]
v_exp_f32 v55, v55
v_mfma_f32_16x16x32_bf16 a[40:43], v[216:219], v[176:179], a[40:43]
v_add_f32 v17, v17, v53
v_cvt_pk_bf16_f32 v90, v52, v53
v_mfma_f32_16x16x32_bf16 a[40:43], v[220:223], v[180:183], a[40:43]
buffer_load_dwordx4 v8, s[16:19], s33 offen offset:128 nt lds
v_mfma_f32_16x16x32_bf16 a[44:47], v[216:219], v[184:187], a[44:47]
v_add_f32 v17, v17, v54
v_add_f32 v17, v17, v55
v_mfma_f32_16x16x32_bf16 a[44:47], v[220:223], v[188:191], a[44:47]
ds_read_b64_tr_b16 v[216:217], v5 offset:1024
v_cvt_pk_bf16_f32 v91, v54, v55
v_mfma_f32_16x16x32_bf16 v[60:63], a[216:219], v[76:79], v[44:47]
ds_read_b64_tr_b16 v[218:219], v5 offset:7168
v_mfma_f32_16x16x32_bf16 v[60:63], a[220:223], v[108:111], v[60:63]
ds_read_b64_tr_b16 v[220:221], v5 offset:13312
v_mfma_f32_16x16x32_bf16 v[60:63], a[224:227], v[140:143], v[60:63]
v_exp_f32 v56, v56
v_mfma_f32_16x16x32_bf16 v[60:63], a[228:231], v[172:175], v[60:63]
ds_read_b64_tr_b16 v[222:223], v5 offset:19456
v_add_f32 v18, v18, v56
v_mfma_f32_16x16x32_bf16 v[60:63], a[232:235], v[204:207], v[60:63]
v_exp_f32 v57, v57
v_mfma_f32_16x16x32_bf16 v[60:63], a[236:239], v[236:239], v[60:63]
s_waitcnt lgkmcnt(11)
v_exp_f32 v58, v58
v_mfma_f32_16x16x32_bf16 a[48:51], a[240:243], v[144:147], a[48:51]
ds_read_b128 a[216:219], v2 offset:18432
v_add_f32 v18, v18, v57
v_mfma_f32_16x16x32_bf16 a[48:51], a[244:247], v[148:151], a[48:51]
v_exp_f32 v59, v59
v_mfma_f32_16x16x32_bf16 a[52:55], a[240:243], v[152:155], a[52:55]
s_add_u32 m0, s40, 14080
v_cvt_pk_bf16_f32 v114, v56, v57
v_add_f32 v18, v18, v58
v_mfma_f32_16x16x32_bf16 a[52:55], a[244:247], v[156:159], a[52:55]
v_add_f32 v18, v18, v59
v_cvt_pk_bf16_f32 v115, v58, v59
v_mfma_f32_16x16x32_bf16 a[56:59], a[240:243], v[176:179], a[56:59]
v_exp_f32 v60, v60
v_mfma_f32_16x16x32_bf16 a[56:59], a[244:247], v[180:183], a[56:59]
ds_read_b128 a[220:223], v3 offset:18432
v_add_f32 v19, v19, v60
v_mfma_f32_16x16x32_bf16 v[48:51], a[192:195], v[64:67], v[32:35]
buffer_load_dwordx4 v8, s[16:19], s33 offen offset:256 nt lds
v_mfma_f32_16x16x32_bf16 v[48:51], a[196:199], v[96:99], v[48:51]
v_exp_f32 v61, v61
v_mfma_f32_16x16x32_bf16 v[48:51], a[200:203], v[128:131], v[48:51]
s_waitcnt lgkmcnt(9)
v_exp_f32 v62, v62
v_mfma_f32_16x16x32_bf16 v[48:51], a[204:207], v[160:163], v[48:51]
v_exp_f32 v63, v63
v_mfma_f32_16x16x32_bf16 v[48:51], a[208:211], v[192:195], v[48:51]
v_add_f32 v19, v19, v61
v_cvt_pk_bf16_f32 v122, v60, v61
v_mfma_f32_16x16x32_bf16 v[48:51], a[212:215], v[224:227], v[48:51]
ds_read_b128 a[224:227], v2 offset:19456
v_add_f32 v19, v19, v62
v_mfma_f32_16x16x32_bf16 a[60:63], a[240:243], v[184:187], a[60:63]
v_add_f32 v19, v19, v63
v_cvt_pk_bf16_f32 v123, v62, v63
v_mfma_f32_16x16x32_bf16 a[60:63], a[244:247], v[188:191], a[60:63]
s_waitcnt lgkmcnt(7)
ds_read_b64_tr_b16 a[240:241], v6 offset:1024
v_mfma_f32_16x16x32_bf16 a[64:67], a[248:251], v[144:147], a[64:67]
ds_read_b64_tr_b16 a[242:243], v6 offset:7168
v_mfma_f32_16x16x32_bf16 a[64:67], a[252:255], v[148:151], a[64:67]
ds_read_b64_tr_b16 a[244:245], v6 offset:13312
v_mfma_f32_16x16x32_bf16 a[68:71], a[248:251], v[152:155], a[68:71]
ds_read_b64_tr_b16 a[246:247], v6 offset:19456
v_mfma_f32_16x16x32_bf16 a[68:71], a[252:255], v[156:159], a[68:71]
s_add_u32 m0, s47, 73728
ds_read_b128 a[228:231], v3 offset:19456
v_mfma_f32_16x16x32_bf16 v[52:55], a[192:195], v[68:71], v[36:39]
v_exp_f32 v48, v48
v_mfma_f32_16x16x32_bf16 v[52:55], a[196:199], v[100:103], v[52:55]
v_exp_f32 v49, v49
v_mfma_f32_16x16x32_bf16 v[52:55], a[200:203], v[132:135], v[52:55]
v_exp_f32 v50, v50
v_mfma_f32_16x16x32_bf16 v[52:55], a[204:207], v[164:167], v[52:55]
buffer_load_dwordx4 v9, s[20:23], s34 offen offset:0 nt lds
v_mfma_f32_16x16x32_bf16 v[52:55], a[208:211], v[196:199], v[52:55]
v_exp_f32 v51, v51
v_mfma_f32_16x16x32_bf16 v[52:55], a[212:215], v[228:231], v[52:55]
ds_read_b128 a[232:235], v2 offset:20480
v_add_f32 v16, v16, v48
v_mfma_f32_16x16x32_bf16 a[72:75], a[248:251], v[176:179], a[72:75]
v_add_f32 v16, v16, v49
v_cvt_pk_bf16_f32 v84, v48, v49
v_mfma_f32_16x16x32_bf16 a[72:75], a[252:255], v[180:183], a[72:75]
v_add_f32 v16, v16, v50
v_add_f32 v16, v16, v51
v_mfma_f32_16x16x32_bf16 a[76:79], a[248:251], v[184:187], a[76:79]
v_exp_f32 v52, v52
v_mfma_f32_16x16x32_bf16 a[76:79], a[252:255], v[188:191], a[76:79]
s_waitcnt lgkmcnt(9)
ds_read_b64_tr_b16 a[248:249], v7 offset:1024
v_mfma_f32_16x16x32_bf16 a[80:83], v[216:219], v[144:147], a[80:83]
ds_read_b64_tr_b16 a[250:251], v7 offset:7168
v_cvt_pk_bf16_f32 v85, v50, v51
v_mfma_f32_16x16x32_bf16 a[80:83], v[220:223], v[148:151], a[80:83]
ds_read_b128 a[236:239], v3 offset:20480
v_add_f32 v17, v17, v52
v_mfma_f32_16x16x32_bf16 v[56:59], a[192:195], v[72:75], v[40:43]
ds_read_b64_tr_b16 a[252:253], v7 offset:13312
v_mfma_f32_16x16x32_bf16 v[56:59], a[196:199], v[104:107], v[56:59]
ds_read_b64_tr_b16 a[254:255], v7 offset:19456
v_mfma_f32_16x16x32_bf16 v[56:59], a[200:203], v[136:139], v[56:59]
s_add_u32 m0, s47, 74624
v_exp_f32 v53, v53
v_mfma_f32_16x16x32_bf16 v[56:59], a[204:207], v[168:171], v[56:59]
v_exp_f32 v54, v54
v_mfma_f32_16x16x32_bf16 v[56:59], a[208:211], v[200:203], v[56:59]
v_exp_f32 v55, v55
v_mfma_f32_16x16x32_bf16 v[56:59], a[212:215], v[232:235], v[56:59]
v_add_f32 v17, v17, v53
v_cvt_pk_bf16_f32 v92, v52, v53
v_mfma_f32_16x16x32_bf16 a[84:87], v[216:219], v[152:155], a[84:87]
buffer_load_dwordx4 v9, s[20:23], s34 offen offset:128 nt lds
v_mfma_f32_16x16x32_bf16 a[84:87], v[220:223], v[156:159], a[84:87]
v_add_f32 v17, v17, v54
v_add_f32 v17, v17, v55
v_mfma_f32_16x16x32_bf16 a[88:91], v[216:219], v[176:179], a[88:91]
v_exp_f32 v56, v56
v_mfma_f32_16x16x32_bf16 a[88:91], v[220:223], v[180:183], a[88:91]
v_cvt_pk_bf16_f32 v93, v54, v55
v_add_f32 v18, v18, v56
v_mfma_f32_16x16x32_bf16 a[92:95], v[216:219], v[184:187], a[92:95]
v_exp_f32 v57, v57
v_mfma_f32_16x16x32_bf16 a[92:95], v[220:223], v[188:191], a[92:95]
ds_read_b64_tr_b16 v[216:217], v4 offset:2048
v_add_f32 v18, v18, v57
v_mfma_f32_16x16x32_bf16 v[60:63], a[192:195], v[76:79], v[44:47]
ds_read_b64_tr_b16 v[218:219], v4 offset:8192
v_cvt_pk_bf16_f32 v116, v56, v57
v_mfma_f32_16x16x32_bf16 v[60:63], a[196:199], v[108:111], v[60:63]
ds_read_b64_tr_b16 v[220:221], v4 offset:14336
v_mfma_f32_16x16x32_bf16 v[60:63], a[200:203], v[140:143], v[60:63]
ds_read_b64_tr_b16 v[222:223], v4 offset:20480
v_mfma_f32_16x16x32_bf16 v[60:63], a[204:207], v[172:175], v[60:63]
v_exp_f32 v58, v58
v_mfma_f32_16x16x32_bf16 v[60:63], a[208:211], v[204:207], v[60:63]
v_exp_f32 v59, v59
v_mfma_f32_16x16x32_bf16 v[60:63], a[212:215], v[236:239], v[60:63]
s_waitcnt lgkmcnt(11)
s_add_u32 m0, s47, 75520
v_add_f32 v18, v18, v58
v_mfma_f32_16x16x32_bf16 a[96:99], a[240:243], v[144:147], a[96:99]
v_add_f32 v18, v18, v59
v_cvt_pk_bf16_f32 v117, v58, v59
v_mfma_f32_16x16x32_bf16 a[96:99], a[244:247], v[148:151], a[96:99]
v_mfma_f32_16x16x32_bf16 a[100:103], a[240:243], v[152:155], a[100:103]
v_exp_f32 v60, v60
v_mfma_f32_16x16x32_bf16 a[100:103], a[244:247], v[156:159], a[100:103]
buffer_load_dwordx4 v9, s[20:23], s34 offen offset:256 nt lds
v_mfma_f32_16x16x32_bf16 a[104:107], a[240:243], v[176:179], a[104:107]
v_exp_f32 v61, v61
v_mfma_f32_16x16x32_bf16 a[104:107], a[244:247], v[180:183], a[104:107]
v_exp_f32 v62, v62
v_mfma_f32_16x16x32_bf16 v[48:51], a[216:219], v[64:67], v[32:35]
v_exp_f32 v63, v63
v_mfma_f32_16x16x32_bf16 v[48:51], a[220:223], v[96:99], v[48:51]
v_add_f32 v19, v19, v60
v_add_f32 v19, v19, v61
v_mfma_f32_16x16x32_bf16 v[48:51], a[224:227], v[128:131], v[48:51]
s_waitcnt lgkmcnt(6)
v_cvt_pk_bf16_f32 v124, v60, v61
v_add_f32 v19, v19, v62
v_mfma_f32_16x16x32_bf16 v[48:51], a[228:231], v[160:163], v[48:51]
v_add_f32 v19, v19, v63
v_cvt_pk_bf16_f32 v125, v62, v63
v_mfma_f32_16x16x32_bf16 v[48:51], a[232:235], v[192:195], v[48:51]
v_mfma_f32_16x16x32_bf16 v[48:51], a[236:239], v[224:227], v[48:51]
v_mfma_f32_16x16x32_bf16 a[108:111], a[240:243], v[184:187], a[108:111]
v_mfma_f32_16x16x32_bf16 a[108:111], a[244:247], v[188:191], a[108:111]
s_waitcnt lgkmcnt(4)
ds_read_b64_tr_b16 a[240:241], v5 offset:2048
v_mfma_f32_16x16x32_bf16 a[112:115], a[248:251], v[144:147], a[112:115]
ds_read_b64_tr_b16 a[242:243], v5 offset:8192
s_add_u32 m0, s47, 86016
v_mfma_f32_16x16x32_bf16 a[112:115], a[252:255], v[148:151], a[112:115]
ds_read_b64_tr_b16 a[244:245], v5 offset:14336
v_mfma_f32_16x16x32_bf16 a[116:119], a[248:251], v[152:155], a[116:119]
ds_read_b64_tr_b16 a[246:247], v5 offset:20480
v_mfma_f32_16x16x32_bf16 a[116:119], a[252:255], v[156:159], a[116:119]
v_exp_f32 v48, v48
v_mfma_f32_16x16x32_bf16 v[52:55], a[216:219], v[68:71], v[36:39]
buffer_load_dwordx4 v9, s[20:23], s35 offen offset:0 nt lds
v_mfma_f32_16x16x32_bf16 v[52:55], a[220:223], v[100:103], v[52:55]
v_exp_f32 v49, v49
v_mfma_f32_16x16x32_bf16 v[52:55], a[224:227], v[132:135], v[52:55]
v_exp_f32 v50, v50
v_mfma_f32_16x16x32_bf16 v[52:55], a[228:231], v[164:167], v[52:55]
v_exp_f32 v51, v51
v_mfma_f32_16x16x32_bf16 v[52:55], a[232:235], v[196:199], v[52:55]
v_add_f32 v16, v16, v48
v_add_f32 v16, v16, v49
v_mfma_f32_16x16x32_bf16 v[52:55], a[236:239], v[228:231], v[52:55]
v_cvt_pk_bf16_f32 v86, v48, v49
v_add_f32 v16, v16, v50
v_mfma_f32_16x16x32_bf16 a[120:123], a[248:251], v[176:179], a[120:123]
v_add_f32 v16, v16, v51
v_cvt_pk_bf16_f32 v87, v50, v51
v_mfma_f32_16x16x32_bf16 a[120:123], a[252:255], v[180:183], a[120:123]
v_mfma_f32_16x16x32_bf16 a[124:127], a[248:251], v[184:187], a[124:127]
v_mfma_f32_16x16x32_bf16 a[124:127], a[252:255], v[188:191], a[124:127]
s_waitcnt lgkmcnt(4)
ds_read_b64_tr_b16 a[248:249], v6 offset:2048
v_mfma_f32_16x16x32_bf16 a[128:131], v[216:219], v[144:147], a[128:131]
ds_read_b64_tr_b16 a[250:251], v6 offset:8192
v_mfma_f32_16x16x32_bf16 a[128:131], v[220:223], v[148:151], a[128:131]
ds_read_b64_tr_b16 a[252:253], v6 offset:14336
s_add_u32 m0, s47, 86912
v_mfma_f32_16x16x32_bf16 v[56:59], a[216:219], v[72:75], v[40:43]
ds_read_b64_tr_b16 a[254:255], v6 offset:20480
v_mfma_f32_16x16x32_bf16 v[56:59], a[220:223], v[104:107], v[56:59]
v_exp_f32 v52, v52
v_mfma_f32_16x16x32_bf16 v[56:59], a[224:227], v[136:139], v[56:59]
v_exp_f32 v53, v53
v_mfma_f32_16x16x32_bf16 v[56:59], a[228:231], v[168:171], v[56:59]
buffer_load_dwordx4 v9, s[20:23], s35 offen offset:128 nt lds
v_mfma_f32_16x16x32_bf16 v[56:59], a[232:235], v[200:203], v[56:59]
v_exp_f32 v54, v54
v_mfma_f32_16x16x32_bf16 v[56:59], a[236:239], v[232:235], v[56:59]
v_exp_f32 v55, v55
v_mfma_f32_16x16x32_bf16 a[132:135], v[216:219], v[152:155], a[132:135]
v_add_f32 v17, v17, v52
v_add_f32 v17, v17, v53
v_mfma_f32_16x16x32_bf16 a[132:135], v[220:223], v[156:159], a[132:135]
v_cvt_pk_bf16_f32 v94, v52, v53
v_add_f32 v17, v17, v54
v_mfma_f32_16x16x32_bf16 a[136:139], v[216:219], v[176:179], a[136:139]
v_exp_f32 v56, v56
v_mfma_f32_16x16x32_bf16 a[136:139], v[220:223], v[180:183], a[136:139]
v_exp_f32 v57, v57
v_mfma_f32_16x16x32_bf16 a[140:143], v[216:219], v[184:187], a[140:143]
v_exp_f32 v58, v58
v_mfma_f32_16x16x32_bf16 a[140:143], v[220:223], v[188:191], a[140:143]
ds_read_b64_tr_b16 v[216:217], v7 offset:2048
v_add_f32 v17, v17, v55
v_mfma_f32_16x16x32_bf16 v[60:63], a[216:219], v[76:79], v[44:47]
ds_read_b64_tr_b16 v[218:219], v7 offset:8192
v_cvt_pk_bf16_f32 v95, v54, v55
v_mfma_f32_16x16x32_bf16 v[60:63], a[220:223], v[108:111], v[60:63]
ds_read_b64_tr_b16 v[220:221], v7 offset:14336
v_add_f32 v18, v18, v56
v_mfma_f32_16x16x32_bf16 v[60:63], a[224:227], v[140:143], v[60:63]
ds_read_b64_tr_b16 v[222:223], v7 offset:20480
s_add_u32 m0, s47, 87808
v_mfma_f32_16x16x32_bf16 v[60:63], a[228:231], v[172:175], v[60:63]
v_exp_f32 v59, v59
v_mfma_f32_16x16x32_bf16 v[60:63], a[232:235], v[204:207], v[60:63]
v_add_f32 v18, v18, v57
v_cvt_pk_bf16_f32 v118, v56, v57
v_mfma_f32_16x16x32_bf16 v[60:63], a[236:239], v[236:239], v[60:63]
s_waitcnt lgkmcnt(8)
v_add_f32 v18, v18, v58
v_add_f32 v18, v18, v59
v_mfma_f32_16x16x32_bf16 a[144:147], a[240:243], v[144:147], a[144:147]
buffer_load_dwordx4 v9, s[20:23], s35 offen offset:256 nt lds
v_mfma_f32_16x16x32_bf16 a[144:147], a[244:247], v[148:151], a[144:147]
s_add_u32 s32, s32, 24576
s_add_u32 s33, s33, 24576
s_add_u32 s34, s34, 24576
v_mfma_f32_16x16x32_bf16 a[148:151], a[240:243], v[152:155], a[148:151]
s_add_u32 s35, s35, 24576
v_exp_f32 v60, v60
v_mfma_f32_16x16x32_bf16 a[148:151], a[244:247], v[156:159], a[148:151]
s_mov_b32 s6, s40
v_exp_f32 v61, v61
v_mfma_f32_16x16x32_bf16 a[152:155], a[240:243], v[176:179], a[152:155]
s_mov_b32 s40, s41
v_exp_f32 v62, v62
v_mfma_f32_16x16x32_bf16 a[152:155], a[244:247], v[180:183], a[152:155]
s_waitcnt vmcnt(12) lgkmcnt(0)
v_exp_f32 v63, v63
v_mfma_f32_16x16x32_bf16 a[156:159], a[240:243], v[184:187], a[156:159]
s_mov_b32 s41, s47
v_cvt_pk_bf16_f32 v119, v58, v59
v_add_f32 v19, v19, v60
v_mfma_f32_16x16x32_bf16 a[156:159], a[244:247], v[188:191], a[156:159]
s_barrier
v_mfma_f32_16x16x32_bf16 a[160:163], a[248:251], v[144:147], a[160:163]
s_mov_b32 s47, s6
v_add_u32 v2, s38, v2
v_add_u32 v3, s38, v3
v_mfma_f32_16x16x32_bf16 a[160:163], a[252:255], v[148:151], a[160:163]
ds_read_b128 a[192:195], v2 offset:0
v_add_u32 v4, s39, v4
v_mfma_f32_16x16x32_bf16 a[164:167], a[248:251], v[152:155], a[164:167]
ds_read_b128 a[196:199], v3 offset:0
v_add_f32 v19, v19, v61
v_mfma_f32_16x16x32_bf16 a[164:167], a[252:255], v[156:159], a[164:167]
ds_read_b128 a[200:203], v2 offset:1024
v_cvt_pk_bf16_f32 v126, v60, v61
v_mfma_f32_16x16x32_bf16 a[168:171], a[248:251], v[176:179], a[168:171]
ds_read_b128 a[204:207], v3 offset:1024
v_add_f32 v19, v19, v62
v_mfma_f32_16x16x32_bf16 a[168:171], a[252:255], v[180:183], a[168:171]
ds_read_b128 a[208:211], v2 offset:2048
v_add_f32 v19, v19, v63
v_mfma_f32_16x16x32_bf16 a[172:175], a[248:251], v[184:187], a[172:175]
ds_read_b128 a[212:215], v3 offset:2048
v_cvt_pk_bf16_f32 v127, v62, v63
v_mfma_f32_16x16x32_bf16 a[172:175], a[252:255], v[188:191], a[172:175]
ds_read_b64_tr_b16 a[240:241], v4 offset:0
v_add_u32 v5, s39, v5
v_mfma_f32_16x16x32_bf16 a[176:179], v[216:219], v[144:147], a[176:179]
ds_read_b64_tr_b16 a[242:243], v4 offset:6144
v_max3_f32 v240, v16, v17, v18
v_mfma_f32_16x16x32_bf16 a[176:179], v[220:223], v[148:151], a[176:179]
ds_read_b64_tr_b16 a[244:245], v4 offset:12288
v_add_u32 v6, s39, v6
v_mfma_f32_16x16x32_bf16 a[180:183], v[216:219], v[152:155], a[180:183]
ds_read_b64_tr_b16 a[246:247], v4 offset:18432
v_max_f32 v240, v240, v19
v_mfma_f32_16x16x32_bf16 a[180:183], v[220:223], v[156:159], a[180:183]
v_add_u32 v7, s39, v7
v_cmp_lt_f32 vcc, s36, v240
v_mfma_f32_16x16x32_bf16 a[184:187], v[216:219], v[176:179], a[184:187]
v_mfma_f32_16x16x32_bf16 a[184:187], v[220:223], v[180:183], a[184:187]
v_mfma_f32_16x16x32_bf16 a[188:191], v[216:219], v[184:187], a[188:191]
v_mfma_f32_16x16x32_bf16 a[188:191], v[220:223], v[188:191], a[188:191]
s_cbranch_vccnz L_stub_l1
L_ret_l1:
s_waitcnt lgkmcnt(7)
v_mfma_f32_16x16x32_bf16 v[48:51], a[192:195], v[64:67], v[32:35]
s_add_u32 m0, s40, 0
v_add_f32 v12, v12, v16
v_add_f32 v13, v13, v17
v_mfma_f32_16x16x32_bf16 v[48:51], a[196:199], v[96:99], v[48:51]
s_sub_u32 s38, s47, s41
v_add_f32 v14, v14, v18
v_add_f32 v15, v15, v19
v_mfma_f32_16x16x32_bf16 v[48:51], a[200:203], v[128:131], v[48:51]
s_waitcnt lgkmcnt(4)
ds_read_b128 a[216:219], v2 offset:6144
v_mfma_f32_16x16x32_bf16 v[48:51], a[204:207], v[160:163], v[48:51]
buffer_load_dwordx4 v8, s[16:19], s32 offen offset:0 nt lds
v_mfma_f32_16x16x32_bf16 v[48:51], a[208:211], v[192:195], v[48:51]
s_sub_u32 s39, s41, s40
ds_read_b128 a[220:223], v3 offset:6144
v_mfma_f32_16x16x32_bf16 v[48:51], a[212:215], v[224:227], v[48:51]
ds_read_b64_tr_b16 a[248:249], v5 offset:0
v_mfma_f32_16x16x32_bf16 v[52:55], a[192:195], v[68:71], v[36:39]
ds_read_b128 a[224:227], v2 offset:7168
v_mfma_f32_16x16x32_bf16 v[52:55], a[196:199], v[100:103], v[52:55]
ds_read_b64_tr_b16 a[250:251], v5 offset:6144
v_mfma_f32_16x16x32_bf16 v[52:55], a[200:203], v[132:135], v[52:55]
ds_read_b64_tr_b16 a[252:253], v5 offset:12288
v_mfma_f32_16x16x32_bf16 v[52:55], a[204:207], v[164:167], v[52:55]
ds_read_b128 a[228:231], v3 offset:7168
v_mfma_f32_16x16x32_bf16 v[52:55], a[208:211], v[196:199], v[52:55]
v_exp_f32 v48, v48
v_mfma_f32_16x16x32_bf16 v[52:55], a[212:215], v[228:231], v[52:55]
v_exp_f32 v49, v49
v_mfma_f32_16x16x32_bf16 v[56:59], a[192:195], v[72:75], v[40:43]
ds_read_b128 a[232:235], v2 offset:8192
v_add_f32 v16, v48, v49
v_mfma_f32_16x16x32_bf16 v[56:59], a[196:199], v[104:107], v[56:59]
ds_read_b64_tr_b16 a[254:255], v5 offset:18432
v_cvt_pk_bf16_f32 v144, v48, v49
v_mfma_f32_16x16x32_bf16 v[56:59], a[200:203], v[136:139], v[56:59]
s_add_u32 m0, s40, 896
v_exp_f32 v50, v50
v_mfma_f32_16x16x32_bf16 v[56:59], a[204:207], v[168:171], v[56:59]
ds_read_b128 a[236:239], v3 offset:8192
v_add_f32 v16, v16, v50
v_mfma_f32_16x16x32_bf16 v[56:59], a[208:211], v[200:203], v[56:59]
v_exp_f32 v51, v51
v_mfma_f32_16x16x32_bf16 v[56:59], a[212:215], v[232:235], v[56:59]
ds_read_b64_tr_b16 v[216:217], v6 offset:0
v_add_f32 v16, v16, v51
v_mfma_f32_16x16x32_bf16 v[60:63], a[192:195], v[76:79], v[44:47]
buffer_load_dwordx4 v8, s[16:19], s32 offen offset:128 nt lds
v_mfma_f32_16x16x32_bf16 v[60:63], a[196:199], v[108:111], v[60:63]
ds_read_b64_tr_b16 v[218:219], v6 offset:6144
v_cvt_pk_bf16_f32 v145, v50, v51
v_mfma_f32_16x16x32_bf16 v[60:63], a[200:203], v[140:143], v[60:63]
v_exp_f32 v52, v52
v_mfma_f32_16x16x32_bf16 v[60:63], a[204:207], v[172:175], v[60:63]
v_exp_f32 v53, v53
v_mfma_f32_16x16x32_bf16 v[60:63], a[208:211], v[204:207], v[60:63]
ds_read_b64_tr_b16 v[220:221], v6 offset:12288
v_add_f32 v17, v52, v53
v_mfma_f32_16x16x32_bf16 v[60:63], a[212:215], v[236:239], v[60:63]
s_waitcnt lgkmcnt(13)
v_exp_f32 v54, v54
v_mfma_f32_16x16x32_bf16 a[0:3], a[240:243], v[80:83], a[0:3]
ds_read_b64_tr_b16 v[222:223], v6 offset:18432
v_cvt_pk_bf16_f32 v152, v52, v53
v_mfma_f32_16x16x32_bf16 a[0:3], a[244:247], v[84:87], a[0:3]
ds_read_b128 a[192:195], v2 offset:12288
v_add_f32 v17, v17, v54
v_mfma_f32_16x16x32_bf16 a[4:7], a[240:243], v[88:91], a[4:7]
v_exp_f32 v55, v55
v_mfma_f32_16x16x32_bf16 a[4:7], a[244:247], v[92:95], a[4:7]
v_add_f32 v17, v17, v55
v_cvt_pk_bf16_f32 v153, v54, v55
v_mfma_f32_16x16x32_bf16 a[8:11], a[240:243], v[112:115], a[8:11]
v_exp_f32 v56, v56
v_mfma_f32_16x16x32_bf16 a[8:11], a[244:247], v[116:119], a[8:11]
s_waitcnt lgkmcnt(11)
s_add_u32 m0, s40, 1792
v_mfma_f32_16x16x32_bf16 v[48:51], a[216:219], v[64:67], v[32:35]
v_exp_f32 v57, v57
v_mfma_f32_16x16x32_bf16 v[48:51], a[220:223], v[96:99], v[48:51]
ds_read_b128 a[196:199], v3 offset:12288
v_add_f32 v18, v56, v57
v_mfma_f32_16x16x32_bf16 v[48:51], a[224:227], v[128:131], v[48:51]
s_waitcnt lgkmcnt(6)
v_exp_f32 v58, v58
v_mfma_f32_16x16x32_bf16 v[48:51], a[228:231], v[160:163], v[48:51]
buffer_load_dwordx4 v8, s[16:19], s32 offen offset:256 nt lds
v_mfma_f32_16x16x32_bf16 v[48:51], a[232:235], v[192:195], v[48:51]
v_exp_f32 v59, v59
v_mfma_f32_16x16x32_bf16 v[48:51], a[236:239], v[224:227], v[48:51]
ds_read_b128 a[200:203], v2 offset:13312
v_cvt_pk_bf16_f32 v176, v56, v57
v_mfma_f32_16x16x32_bf16 a[12:15], a[240:243], v[120:123], a[12:15]
v_add_f32 v18, v18, v58
v_add_f32 v18, v18, v59
v_mfma_f32_16x16x32_bf16 a[12:15], a[244:247], v[124:127], a[12:15]
ds_read_b64_tr_b16 a[240:241], v7 offset:0
v_cvt_pk_bf16_f32 v177, v58, v59
v_mfma_f32_16x16x32_bf16 a[16:19], a[248:251], v[80:83], a[16:19]
v_exp_f32 v60, v60
v_mfma_f32_16x16x32_bf16 a[16:19], a[252:255], v[84:87], a[16:19]
v_exp_f32 v61, v61
v_mfma_f32_16x16x32_bf16 a[20:23], a[248:251], v[88:91], a[20:23]
ds_read_b64_tr_b16 a[242:243], v7 offset:6144
v_add_f32 v19, v60, v61
v_mfma_f32_16x16x32_bf16 a[20:23], a[252:255], v[92:95], a[20:23]
ds_read_b64_tr_b16 a[244:245], v7 offset:12288
v_cvt_pk_bf16_f32 v184, v60, v61
v_mfma_f32_16x16x32_bf16 v[52:55], a[216:219], v[68:71], v[36:39]
v_exp_f32 v62, v62
v_mfma_f32_16x16x32_bf16 v[52:55], a[220:223], v[100:103], v[52:55]
ds_read_b64_tr_b16 a[246:247], v7 offset:18432
v_add_f32 v19, v19, v62
v_mfma_f32_16x16x32_bf16 v[52:55], a[224:227], v[132:135], v[52:55]
s_add_u32 m0, s40, 12288
v_exp_f32 v63, v63
v_mfma_f32_16x16x32_bf16 v[52:55], a[228:231], v[164:167], v[52:55]
ds_read_b128 a[204:207], v3 offset:13312
v_add_f32 v19, v19, v63
v_mfma_f32_16x16x32_bf16 v[52:55], a[232:235], v[196:199], v[52:55]
v_exp_f32 v48, v48
v_mfma_f32_16x16x32_bf16 v[52:55], a[236:239], v[228:231], v[52:55]
ds_read_b128 a[208:211], v2 offset:14336
v_cvt_pk_bf16_f32 v185, v62, v63
v_mfma_f32_16x16x32_bf16 a[24:27], a[248:251], v[112:115], a[24:27]
buffer_load_dwordx4 v8, s[16:19], s33 offen offset:0 nt lds
v_mfma_f32_16x16x32_bf16 a[24:27], a[252:255], v[116:119], a[24:27]
v_exp_f32 v49, v49
v_mfma_f32_16x16x32_bf16 a[28:31], a[248:251], v[120:123], a[28:31]
v_exp_f32 v50, v50
v_mfma_f32_16x16x32_bf16 a[28:31], a[252:255], v[124:127], a[28:31]
s_waitcnt lgkmcnt(9)
v_exp_f32 v51, v51
v_mfma_f32_16x16x32_bf16 a[32:35], v[216:219], v[80:83], a[32:35]
ds_read_b64_tr_b16 a[248:249], v4 offset:1024
v_add_f32 v16, v16, v48
v_mfma_f32_16x16x32_bf16 a[32:35], v[220:223], v[84:87], a[32:35]
ds_read_b128 a[212:215], v3 offset:14336
v_add_f32 v16, v16, v49
v_mfma_f32_16x16x32_bf16 v[56:59], a[216:219], v[72:75], v[40:43]
ds_read_b64_tr_b16 a[250:251], v4 offset:7168
v_cvt_pk_bf16_f32 v146, v48, v49
v_mfma_f32_16x16x32_bf16 v[56:59], a[220:223], v[104:107], v[56:59]
ds_read_b64_tr_b16 a[252:253], v4 offset:13312
v_add_f32 v16, v16, v50
v_mfma_f32_16x16x32_bf16 v[56:59], a[224:227], v[136:139], v[56:59]
ds_read_b64_tr_b16 a[254:255], v4 offset:19456
v_add_f32 v16, v16, v51
v_mfma_f32_16x16x32_bf16 v[56:59], a[228:231], v[168:171], v[56:59]
v_exp_f32 v52, v52
v_mfma_f32_16x16x32_bf16 v[56:59], a[232:235], v[200:203], v[56:59]
v_cvt_pk_bf16_f32 v147, v50, v51
v_add_f32 v17, v17, v52
v_mfma_f32_16x16x32_bf16 v[56:59], a[236:239], v[232:235], v[56:59]
s_add_u32 m0, s40, 13184
v_exp_f32 v53, v53
v_mfma_f32_16x16x32_bf16 a[36:39], v[216:219], v[88:91], a[36:39]
v_exp_f32 v54, v54
v_mfma_f32_16x16x32_bf16 a[36:39], v[220:223], v[92:95], a[36:39]
v_exp_f32 v55, v55
v_mfma_f32_16x16x32_bf16 a[40:43], v[216:219], v[112:115], a[40:43]
v_add_f32 v17, v17, v53
v_cvt_pk_bf16_f32 v154, v52, v53
v_mfma_f32_16x16x32_bf16 a[40:43], v[220:223], v[116:119], a[40:43]
buffer_load_dwordx4 v8, s[16:19], s33 offen offset:128 nt lds
v_mfma_f32_16x16x32_bf16 a[44:47], v[216:219], v[120:123], a[44:47]
v_add_f32 v17, v17, v54
v_add_f32 v17, v17, v55
v_mfma_f32_16x16x32_bf16 a[44:47], v[220:223], v[124:127], a[44:47]
ds_read_b64_tr_b16 v[216:217], v5 offset:1024
v_cvt_pk_bf16_f32 v155, v54, v55
v_mfma_f32_16x16x32_bf16 v[60:63], a[216:219], v[76:79], v[44:47]
ds_read_b64_tr_b16 v[218:219], v5 offset:7168
v_mfma_f32_16x16x32_bf16 v[60:63], a[220:223], v[108:111], v[60:63]
ds_read_b64_tr_b16 v[220:221], v5 offset:13312
v_mfma_f32_16x16x32_bf16 v[60:63], a[224:227], v[140:143], v[60:63]
v_exp_f32 v56, v56
v_mfma_f32_16x16x32_bf16 v[60:63], a[228:231], v[172:175], v[60:63]
ds_read_b64_tr_b16 v[222:223], v5 offset:19456
v_add_f32 v18, v18, v56
v_mfma_f32_16x16x32_bf16 v[60:63], a[232:235], v[204:207], v[60:63]
v_exp_f32 v57, v57
v_mfma_f32_16x16x32_bf16 v[60:63], a[236:239], v[236:239], v[60:63]
s_waitcnt lgkmcnt(11)
v_exp_f32 v58, v58
v_mfma_f32_16x16x32_bf16 a[48:51], a[240:243], v[80:83], a[48:51]
ds_read_b128 a[216:219], v2 offset:18432
v_add_f32 v18, v18, v57
v_mfma_f32_16x16x32_bf16 a[48:51], a[244:247], v[84:87], a[48:51]
v_exp_f32 v59, v59
v_mfma_f32_16x16x32_bf16 a[52:55], a[240:243], v[88:91], a[52:55]
s_add_u32 m0, s40, 14080
v_cvt_pk_bf16_f32 v178, v56, v57
v_add_f32 v18, v18, v58
v_mfma_f32_16x16x32_bf16 a[52:55], a[244:247], v[92:95], a[52:55]
v_add_f32 v18, v18, v59
v_cvt_pk_bf16_f32 v179, v58, v59
v_mfma_f32_16x16x32_bf16 a[56:59], a[240:243], v[112:115], a[56:59]
v_exp_f32 v60, v60
v_mfma_f32_16x16x32_bf16 a[56:59], a[244:247], v[116:119], a[56:59]
ds_read_b128 a[220:223], v3 offset:18432
v_add_f32 v19, v19, v60
v_mfma_f32_16x16x32_bf16 v[48:51], a[192:195], v[64:67], v[32:35]
buffer_load_dwordx4 v8, s[16:19], s33 offen offset:256 nt lds
v_mfma_f32_16x16x32_bf16 v[48:51], a[196:199], v[96:99], v[48:51]
v_exp_f32 v61, v61
v_mfma_f32_16x16x32_bf16 v[48:51], a[200:203], v[128:131], v[48:51]
s_waitcnt lgkmcnt(9)
v_exp_f32 v62, v62
v_mfma_f32_16x16x32_bf16 v[48:51], a[204:207], v[160:163], v[48:51]
v_exp_f32 v63, v63
v_mfma_f32_16x16x32_bf16 v[48:51], a[208:211], v[192:195], v[48:51]
v_add_f32 v19, v19, v61
v_cvt_pk_bf16_f32 v186, v60, v61
v_mfma_f32_16x16x32_bf16 v[48:51], a[212:215], v[224:227], v[48:51]
ds_read_b128 a[224:227], v2 offset:19456
v_add_f32 v19, v19, v62
v_mfma_f32_16x16x32_bf16 a[60:63], a[240:243], v[120:123], a[60:63]
v_add_f32 v19, v19, v63
v_cvt_pk_bf16_f32 v187, v62, v63
v_mfma_f32_16x16x32_bf16 a[60:63], a[244:247], v[124:127], a[60:63]
s_waitcnt lgkmcnt(7)
ds_read_b64_tr_b16 a[240:241], v6 offset:1024
v_mfma_f32_16x16x32_bf16 a[64:67], a[248:251], v[80:83], a[64:67]
ds_read_b64_tr_b16 a[242:243], v6 offset:7168
v_mfma_f32_16x16x32_bf16 a[64:67], a[252:255], v[84:87], a[64:67]
ds_read_b64_tr_b16 a[244:245], v6 offset:13312
v_mfma_f32_16x16x32_bf16 a[68:71], a[248:251], v[88:91], a[68:71]
ds_read_b64_tr_b16 a[246:247], v6 offset:19456
v_mfma_f32_16x16x32_bf16 a[68:71], a[252:255], v[92:95], a[68:71]
s_add_u32 m0, s47, 73728
ds_read_b128 a[228:231], v3 offset:19456
v_mfma_f32_16x16x32_bf16 v[52:55], a[192:195], v[68:71], v[36:39]
v_exp_f32 v48, v48
v_mfma_f32_16x16x32_bf16 v[52:55], a[196:199], v[100:103], v[52:55]
v_exp_f32 v49, v49
v_mfma_f32_16x16x32_bf16 v[52:55], a[200:203], v[132:135], v[52:55]
v_exp_f32 v50, v50
v_mfma_f32_16x16x32_bf16 v[52:55], a[204:207], v[164:167], v[52:55]
buffer_load_dwordx4 v9, s[20:23], s34 offen offset:0 nt lds
v_mfma_f32_16x16x32_bf16 v[52:55], a[208:211], v[196:199], v[52:55]
v_exp_f32 v51, v51
v_mfma_f32_16x16x32_bf16 v[52:55], a[212:215], v[228:231], v[52:55]
ds_read_b128 a[232:235], v2 offset:20480
v_add_f32 v16, v16, v48
v_mfma_f32_16x16x32_bf16 a[72:75], a[248:251], v[112:115], a[72:75]
v_add_f32 v16, v16, v49
v_cvt_pk_bf16_f32 v148, v48, v49
v_mfma_f32_16x16x32_bf16 a[72:75], a[252:255], v[116:119], a[72:75]
v_add_f32 v16, v16, v50
v_add_f32 v16, v16, v51
v_mfma_f32_16x16x32_bf16 a[76:79], a[248:251], v[120:123], a[76:79]
v_exp_f32 v52, v52
v_mfma_f32_16x16x32_bf16 a[76:79], a[252:255], v[124:127], a[76:79]
s_waitcnt lgkmcnt(9)
ds_read_b64_tr_b16 a[248:249], v7 offset:1024
v_mfma_f32_16x16x32_bf16 a[80:83], v[216:219], v[80:83], a[80:83]
ds_read_b64_tr_b16 a[250:251], v7 offset:7168
v_cvt_pk_bf16_f32 v149, v50, v51
v_mfma_f32_16x16x32_bf16 a[80:83], v[220:223], v[84:87], a[80:83]
ds_read_b128 a[236:239], v3 offset:20480
v_add_f32 v17, v17, v52
v_mfma_f32_16x16x32_bf16 v[56:59], a[192:195], v[72:75], v[40:43]
ds_read_b64_tr_b16 a[252:253], v7 offset:13312
v_mfma_f32_16x16x32_bf16 v[56:59], a[196:199], v[104:107], v[56:59]
ds_read_b64_tr_b16 a[254:255], v7 offset:19456
v_mfma_f32_16x16x32_bf16 v[56:59], a[200:203], v[136:139], v[56:59]
s_add_u32 m0, s47, 74624
v_exp_f32 v53, v53
v_mfma_f32_16x16x32_bf16 v[56:59], a[204:207], v[168:171], v[56:59]
v_exp_f32 v54, v54
v_mfma_f32_16x16x32_bf16 v[56:59], a[208:211], v[200:203], v[56:59]
v_exp_f32 v55, v55
v_mfma_f32_16x16x32_bf16 v[56:59], a[212:215], v[232:235], v[56:59]
v_add_f32 v17, v17, v53
v_cvt_pk_bf16_f32 v156, v52, v53
v_mfma_f32_16x16x32_bf16 a[84:87], v[216:219], v[88:91], a[84:87]
buffer_load_dwordx4 v9, s[20:23], s34 offen offset:128 nt lds
v_mfma_f32_16x16x32_bf16 a[84:87], v[220:223], v[92:95], a[84:87]
v_add_f32 v17, v17, v54
v_add_f32 v17, v17, v55
v_mfma_f32_16x16x32_bf16 a[88:91], v[216:219], v[112:115], a[88:91]
v_exp_f32 v56, v56
v_mfma_f32_16x16x32_bf16 a[88:91], v[220:223], v[116:119], a[88:91]
v_cvt_pk_bf16_f32 v157, v54, v55
v_add_f32 v18, v18, v56
v_mfma_f32_16x16x32_bf16 a[92:95], v[216:219], v[120:123], a[92:95]
v_exp_f32 v57, v57
v_mfma_f32_16x16x32_bf16 a[92:95], v[220:223], v[124:127], a[92:95]
ds_read_b64_tr_b16 v[216:217], v4 offset:2048
v_add_f32 v18, v18, v57
v_mfma_f32_16x16x32_bf16 v[60:63], a[192:195], v[76:79], v[44:47]
ds_read_b64_tr_b16 v[218:219], v4 offset:8192
v_cvt_pk_bf16_f32 v180, v56, v57
v_mfma_f32_16x16x32_bf16 v[60:63], a[196:199], v[108:111], v[60:63]
ds_read_b64_tr_b16 v[220:221], v4 offset:14336
v_mfma_f32_16x16x32_bf16 v[60:63], a[200:203], v[140:143], v[60:63]
ds_read_b64_tr_b16 v[222:223], v4 offset:20480
v_mfma_f32_16x16x32_bf16 v[60:63], a[204:207], v[172:175], v[60:63]
v_exp_f32 v58, v58
v_mfma_f32_16x16x32_bf16 v[60:63], a[208:211], v[204:207], v[60:63]
v_exp_f32 v59, v59
v_mfma_f32_16x16x32_bf16 v[60:63], a[212:215], v[236:239], v[60:63]
s_waitcnt lgkmcnt(11)
s_add_u32 m0, s47, 75520
v_add_f32 v18, v18, v58
v_mfma_f32_16x16x32_bf16 a[96:99], a[240:243], v[80:83], a[96:99]
v_add_f32 v18, v18, v59
v_cvt_pk_bf16_f32 v181, v58, v59
v_mfma_f32_16x16x32_bf16 a[96:99], a[244:247], v[84:87], a[96:99]
v_mfma_f32_16x16x32_bf16 a[100:103], a[240:243], v[88:91], a[100:103]
v_exp_f32 v60, v60
v_mfma_f32_16x16x32_bf16 a[100:103], a[244:247], v[92:95], a[100:103]
buffer_load_dwordx4 v9, s[20:23], s34 offen offset:256 nt lds
v_mfma_f32_16x16x32_bf16 a[104:107], a[240:243], v[112:115], a[104:107]
v_exp_f32 v61, v61
v_mfma_f32_16x16x32_bf16 a[104:107], a[244:247], v[116:119], a[104:107]
v_exp_f32 v62, v62
v_mfma_f32_16x16x32_bf16 v[48:51], a[216:219], v[64:67], v[32:35]
v_exp_f32 v63, v63
v_mfma_f32_16x16x32_bf16 v[48:51], a[220:223], v[96:99], v[48:51]
v_add_f32 v19, v19, v60
v_add_f32 v19, v19, v61
v_mfma_f32_16x16x32_bf16 v[48:51], a[224:227], v[128:131], v[48:51]
s_waitcnt lgkmcnt(6)
v_cvt_pk_bf16_f32 v188, v60, v61
v_add_f32 v19, v19, v62
v_mfma_f32_16x16x32_bf16 v[48:51], a[228:231], v[160:163], v[48:51]
v_add_f32 v19, v19, v63
v_cvt_pk_bf16_f32 v189, v62, v63
v_mfma_f32_16x16x32_bf16 v[48:51], a[232:235], v[192:195], v[48:51]
v_mfma_f32_16x16x32_bf16 v[48:51], a[236:239], v[224:227], v[48:51]
v_mfma_f32_16x16x32_bf16 a[108:111], a[240:243], v[120:123], a[108:111]
v_mfma_f32_16x16x32_bf16 a[108:111], a[244:247], v[124:127], a[108:111]
s_waitcnt lgkmcnt(4)
ds_read_b64_tr_b16 a[240:241], v5 offset:2048
v_mfma_f32_16x16x32_bf16 a[112:115], a[248:251], v[80:83], a[112:115]
ds_read_b64_tr_b16 a[242:243], v5 offset:8192
s_add_u32 m0, s47, 86016
v_mfma_f32_16x16x32_bf16 a[112:115], a[252:255], v[84:87], a[112:115]
ds_read_b64_tr_b16 a[244:245], v5 offset:14336
v_mfma_f32_16x16x32_bf16 a[116:119], a[248:251], v[88:91], a[116:119]
ds_read_b64_tr_b16 a[246:247], v5 offset:20480
v_mfma_f32_16x16x32_bf16 a[116:119], a[252:255], v[92:95], a[116:119]
v_exp_f32 v48, v48
v_mfma_f32_16x16x32_bf16 v[52:55], a[216:219], v[68:71], v[36:39]
buffer_load_dwordx4 v9, s[20:23], s35 offen offset:0 nt lds
v_mfma_f32_16x16x32_bf16 v[52:55], a[220:223], v[100:103], v[52:55]
v_exp_f32 v49, v49
v_mfma_f32_16x16x32_bf16 v[52:55], a[224:227], v[132:135], v[52:55]
v_exp_f32 v50, v50
v_mfma_f32_16x16x32_bf16 v[52:55], a[228:231], v[164:167], v[52:55]
v_exp_f32 v51, v51
v_mfma_f32_16x16x32_bf16 v[52:55], a[232:235], v[196:199], v[52:55]
v_add_f32 v16, v16, v48
v_add_f32 v16, v16, v49
v_mfma_f32_16x16x32_bf16 v[52:55], a[236:239], v[228:231], v[52:55]
v_cvt_pk_bf16_f32 v150, v48, v49
v_add_f32 v16, v16, v50
v_mfma_f32_16x16x32_bf16 a[120:123], a[248:251], v[112:115], a[120:123]
v_add_f32 v16, v16, v51
v_cvt_pk_bf16_f32 v151, v50, v51
v_mfma_f32_16x16x32_bf16 a[120:123], a[252:255], v[116:119], a[120:123]
v_mfma_f32_16x16x32_bf16 a[124:127], a[248:251], v[120:123], a[124:127]
v_mfma_f32_16x16x32_bf16 a[124:127], a[252:255], v[124:127], a[124:127]
s_waitcnt lgkmcnt(4)
ds_read_b64_tr_b16 a[248:249], v6 offset:2048
v_mfma_f32_16x16x32_bf16 a[128:131], v[216:219], v[80:83], a[128:131]
ds_read_b64_tr_b16 a[250:251], v6 offset:8192
v_mfma_f32_16x16x32_bf16 a[128:131], v[220:223], v[84:87], a[128:131]
ds_read_b64_tr_b16 a[252:253], v6 offset:14336
s_add_u32 m0, s47, 86912
v_mfma_f32_16x16x32_bf16 v[56:59], a[216:219], v[72:75], v[40:43]
ds_read_b64_tr_b16 a[254:255], v6 offset:20480
v_mfma_f32_16x16x32_bf16 v[56:59], a[220:223], v[104:107], v[56:59]
v_exp_f32 v52, v52
v_mfma_f32_16x16x32_bf16 v[56:59], a[224:227], v[136:139], v[56:59]
v_exp_f32 v53, v53
v_mfma_f32_16x16x32_bf16 v[56:59], a[228:231], v[168:171], v[56:59]
buffer_load_dwordx4 v9, s[20:23], s35 offen offset:128 nt lds
v_mfma_f32_16x16x32_bf16 v[56:59], a[232:235], v[200:203], v[56:59]
v_exp_f32 v54, v54
v_mfma_f32_16x16x32_bf16 v[56:59], a[236:239], v[232:235], v[56:59]
v_exp_f32 v55, v55
v_mfma_f32_16x16x32_bf16 a[132:135], v[216:219], v[88:91], a[132:135]
v_add_f32 v17, v17, v52
v_add_f32 v17, v17, v53
v_mfma_f32_16x16x32_bf16 a[132:135], v[220:223], v[92:95], a[132:135]
v_cvt_pk_bf16_f32 v158, v52, v53
v_add_f32 v17, v17, v54
v_mfma_f32_16x16x32_bf16 a[136:139], v[216:219], v[112:115], a[136:139]
v_exp_f32 v56, v56
v_mfma_f32_16x16x32_bf16 a[136:139], v[220:223], v[116:119], a[136:139]
v_exp_f32 v57, v57
v_mfma_f32_16x16x32_bf16 a[140:143], v[216:219], v[120:123], a[140:143]
v_exp_f32 v58, v58
v_mfma_f32_16x16x32_bf16 a[140:143], v[220:223], v[124:127], a[140:143]
ds_read_b64_tr_b16 v[216:217], v7 offset:2048
v_add_f32 v17, v17, v55
v_mfma_f32_16x16x32_bf16 v[60:63], a[216:219], v[76:79], v[44:47]
ds_read_b64_tr_b16 v[218:219], v7 offset:8192
v_cvt_pk_bf16_f32 v159, v54, v55
v_mfma_f32_16x16x32_bf16 v[60:63], a[220:223], v[108:111], v[60:63]
ds_read_b64_tr_b16 v[220:221], v7 offset:14336
v_add_f32 v18, v18, v56
v_mfma_f32_16x16x32_bf16 v[60:63], a[224:227], v[140:143], v[60:63]
ds_read_b64_tr_b16 v[222:223], v7 offset:20480
s_add_u32 m0, s47, 87808
v_mfma_f32_16x16x32_bf16 v[60:63], a[228:231], v[172:175], v[60:63]
v_exp_f32 v59, v59
v_mfma_f32_16x16x32_bf16 v[60:63], a[232:235], v[204:207], v[60:63]
v_add_f32 v18, v18, v57
v_cvt_pk_bf16_f32 v182, v56, v57
v_mfma_f32_16x16x32_bf16 v[60:63], a[236:239], v[236:239], v[60:63]
s_waitcnt lgkmcnt(8)
v_add_f32 v18, v18, v58
v_add_f32 v18, v18, v59
v_mfma_f32_16x16x32_bf16 a[144:147], a[240:243], v[80:83], a[144:147]
buffer_load_dwordx4 v9, s[20:23], s35 offen offset:256 nt lds
v_mfma_f32_16x16x32_bf16 a[144:147], a[244:247], v[84:87], a[144:147]
s_add_u32 s32, s32, 24576
s_add_u32 s33, s33, 24576
s_add_u32 s34, s34, 24576
v_mfma_f32_16x16x32_bf16 a[148:151], a[240:243], v[88:91], a[148:151]
s_add_u32 s35, s35, 24576
v_exp_f32 v60, v60
v_mfma_f32_16x16x32_bf16 a[148:151], a[244:247], v[92:95], a[148:151]
s_sub_u32 s37, s37, 1
v_exp_f32 v61, v61
v_mfma_f32_16x16x32_bf16 a[152:155], a[240:243], v[112:115], a[152:155]
s_mov_b32 s6, s40
v_exp_f32 v62, v62
v_mfma_f32_16x16x32_bf16 a[152:155], a[244:247], v[116:119], a[152:155]
s_waitcnt vmcnt(12) lgkmcnt(0)
v_exp_f32 v63, v63
v_mfma_f32_16x16x32_bf16 a[156:159], a[240:243], v[120:123], a[156:159]
s_mov_b32 s40, s41
v_cvt_pk_bf16_f32 v183, v58, v59
v_add_f32 v19, v19, v60
v_mfma_f32_16x16x32_bf16 a[156:159], a[244:247], v[124:127], a[156:159]
s_barrier
v_mfma_f32_16x16x32_bf16 a[160:163], a[248:251], v[80:83], a[160:163]
s_mov_b32 s41, s47
v_add_u32 v2, s38, v2
v_add_u32 v3, s38, v3
v_mfma_f32_16x16x32_bf16 a[160:163], a[252:255], v[84:87], a[160:163]
ds_read_b128 a[192:195], v2 offset:0
v_add_u32 v4, s39, v4
v_mfma_f32_16x16x32_bf16 a[164:167], a[248:251], v[88:91], a[164:167]
ds_read_b128 a[196:199], v3 offset:0
v_add_f32 v19, v19, v61
v_mfma_f32_16x16x32_bf16 a[164:167], a[252:255], v[92:95], a[164:167]
ds_read_b128 a[200:203], v2 offset:1024
v_cvt_pk_bf16_f32 v190, v60, v61
v_mfma_f32_16x16x32_bf16 a[168:171], a[248:251], v[112:115], a[168:171]
ds_read_b128 a[204:207], v3 offset:1024
v_add_f32 v19, v19, v62
v_mfma_f32_16x16x32_bf16 a[168:171], a[252:255], v[116:119], a[168:171]
ds_read_b128 a[208:211], v2 offset:2048
v_add_f32 v19, v19, v63
v_mfma_f32_16x16x32_bf16 a[172:175], a[248:251], v[120:123], a[172:175]
ds_read_b128 a[212:215], v3 offset:2048
v_cvt_pk_bf16_f32 v191, v62, v63
v_mfma_f32_16x16x32_bf16 a[172:175], a[252:255], v[124:127], a[172:175]
ds_read_b64_tr_b16 a[240:241], v4 offset:0
v_add_u32 v5, s39, v5
v_mfma_f32_16x16x32_bf16 a[176:179], v[216:219], v[80:83], a[176:179]
ds_read_b64_tr_b16 a[242:243], v4 offset:6144
v_max3_f32 v240, v16, v17, v18
v_mfma_f32_16x16x32_bf16 a[176:179], v[220:223], v[84:87], a[176:179]
ds_read_b64_tr_b16 a[244:245], v4 offset:12288
v_add_u32 v6, s39, v6
v_mfma_f32_16x16x32_bf16 a[180:183], v[216:219], v[88:91], a[180:183]
s_mov_b32 s47, s6
v_max_f32 v240, v240, v19
v_cmp_lt_f32 vcc, s36, v240
v_mfma_f32_16x16x32_bf16 a[180:183], v[220:223], v[92:95], a[180:183]
ds_read_b64_tr_b16 a[246:247], v4 offset:18432
v_add_u32 v7, s39, v7
v_mfma_f32_16x16x32_bf16 a[184:187], v[216:219], v[112:115], a[184:187]
v_mfma_f32_16x16x32_bf16 a[184:187], v[220:223], v[116:119], a[184:187]
v_mfma_f32_16x16x32_bf16 a[188:191], v[216:219], v[120:123], a[188:191]
v_mfma_f32_16x16x32_bf16 a[188:191], v[220:223], v[124:127], a[188:191]
s_cbranch_vccnz L_stub_l0
L_ret_l0:
s_cmp_lg_u32 s37, 0
s_cbranch_scc1 L_attn_loop
s_load_dwordx2 s[48:49], s[0:1], 32
s_load_dwordx4 s[52:55], s[0:1], 48
s_load_dwordx4 s[60:63], s[0:1], 64
s_load_dwordx2 s[80:81], s[0:1], 0
s_mul_i32 s6, s28, 16
s_mov_b32 s7, 1280
v_add_u32 v240, 0, v0
v_mul_u32_u24 v241, 3277, v240
v_lshrrev_b32 v241, 16, v241
v_mul_u32_u24 v242, 20, v241
v_sub_u32 v240, v240, v242
v_bfe_u32 v242, v241, 2, 1
v_lshlrev_b32 v242, 1, v242
v_xor_b32 v240, v240, v242
v_add_u32 v241, s6, v241
v_mul_lo_u32 v241, v241, s7
v_lshl_add_u32 v21, v240, 4, v241
v_add_u32 v240, 64, v0
v_mul_u32_u24 v241, 3277, v240
v_lshrrev_b32 v241, 16, v241
v_mul_u32_u24 v242, 20, v241
v_sub_u32 v240, v240, v242
v_bfe_u32 v242, v241, 2, 1
v_lshlrev_b32 v242, 1, v242
v_xor_b32 v240, v240, v242
v_add_u32 v241, s6, v241
v_mul_lo_u32 v241, v241, s7
v_lshl_add_u32 v22, v240, 4, v241
v_add_u32 v240, 128, v0
v_mul_u32_u24 v241, 3277, v240
v_lshrrev_b32 v241, 16, v241
v_mul_u32_u24 v242, 20, v241
v_sub_u32 v240, v240, v242
v_bfe_u32 v242, v241, 2, 1
v_lshlrev_b32 v242, 1, v242
v_xor_b32 v240, v240, v242
v_add_u32 v241, s6, v241
v_mul_lo_u32 v241, v241, s7
v_lshl_add_u32 v23, v240, 4, v241
v_add_u32 v240, 192, v0
v_mul_u32_u24 v241, 3277, v240
v_lshrrev_b32 v241, 16, v241
v_mul_u32_u24 v242, 20, v241
v_sub_u32 v240, v240, v242
v_bfe_u32 v242, v241, 2, 1
v_lshlrev_b32 v242, 1, v242
v_xor_b32 v240, v240, v242
v_add_u32 v241, s6, v241
v_mul_lo_u32 v241, v241, s7
v_lshl_add_u32 v24, v240, 4, v241
v_add_u32 v240, 256, v0
v_mul_u32_u24 v241, 3277, v240
v_lshrrev_b32 v241, 16, v241
v_mul_u32_u24 v242, 20, v241
v_sub_u32 v240, v240, v242
v_bfe_u32 v242, v241, 2, 1
v_lshlrev_b32 v242, 1, v242
v_xor_b32 v240, v240, v242
v_add_u32 v241, s6, v241
v_mul_lo_u32 v241, v241, s7
v_lshl_add_u32 v25, v240, 4, v241
s_mul_i32 s7, s28, 5120
v_add_u32 v26, s7, v11
v_add_u32 v27, s29, v11
s_mul_i32 s94, s28, 5120
s_lshr_b32 s6, s2, 3
s_and_b32 s6, s6, 3
s_add_u32 s7, s6, 0
s_and_b32 s7, s7, 3
s_mul_i32 s96, s7, 245760
s_add_u32 s7, s6, 1
s_and_b32 s7, s7, 3
s_mul_i32 s97, s7, 245760
s_add_u32 s7, s6, 2
s_and_b32 s7, s7, 3
s_mul_i32 s98, s7, 245760
s_add_u32 s7, s6, 3
s_and_b32 s7, s7, 3
s_mul_i32 s99, s7, 245760
s_waitcnt lgkmcnt(0)
s_mov_b32 s56, s54
s_mov_b32 s57, s55
s_mov_b32 s64, s62
s_mov_b32 s65, s63
s_and_b32 s7, s2, 7
s_mul_i32 s7, s7, 983040
s_add_u32 s48, s48, s7
s_addc_u32 s49, s49, 0
s_mov_b32 s50, 983040
s_mov_b32 s51, 0x20000
s_lshr_b32 s7, s2, 3
s_lshl_b32 s7, s7, 2
s_add_u32 s7, s7, s28
s_lshl_b32 s7, s7, 13
v_lshl_add_u32 v10, v11, 3, s7
buffer_load_dword v252, v10, s[48:51], 0 offen
s_getpc_b64 s[88:89]
L_tail_pc:
s_mov_b32 s90, L_attn_end-L_tail_pc
s_mov_b32 s91, 0x20000
buffer_load_dword v252, v10, s[88:91], 0 offen
s_mul_i32 s7, s6, 320
s_add_u32 s48, s48, s7
s_addc_u32 s49, s49, 0
s_sub_u32 s50, s50, s7
buffer_load_dword v251, off, s[68:71], s83 sc1
s_mov_b32 s95, 16384
buffer_load_dword v253, off, s[68:71], s95 sc1
v_mfma_f32_16x16x32_bf16 v[48:51], a[192:195], v[64:67], v[32:35]
s_add_u32 m0, s47, 73728
v_add_f32 v12, v12, v16
v_add_f32 v13, v13, v17
v_mfma_f32_16x16x32_bf16 v[48:51], a[196:199], v[96:99], v[48:51]
s_sub_u32 s38, s47, s41
v_add_f32 v14, v14, v18
v_add_f32 v15, v15, v19
v_mfma_f32_16x16x32_bf16 v[48:51], a[200:203], v[128:131], v[48:51]
s_sub_u32 s39, s41, s40
ds_read_b128 a[216:219], v2 offset:6144
v_mfma_f32_16x16x32_bf16 v[48:51], a[204:207], v[160:163], v[48:51]
buffer_load_dwordx4 v9, s[20:23], s34 offen offset:0 nt lds
v_mfma_f32_16x16x32_bf16 v[48:51], a[208:211], v[192:195], v[48:51]
ds_read_b128 a[220:223], v3 offset:6144
v_mfma_f32_16x16x32_bf16 v[48:51], a[212:215], v[224:227], v[48:51]
ds_read_b64_tr_b16 a[248:249], v5 offset:0
v_mfma_f32_16x16x32_bf16 v[52:55], a[192:195], v[68:71], v[36:39]
ds_read_b128 a[224:227], v2 offset:7168
v_mfma_f32_16x16x32_bf16 v[52:55], a[196:199], v[100:103], v[52:55]
ds_read_b64_tr_b16 a[250:251], v5 offset:6144
v_mfma_f32_16x16x32_bf16 v[52:55], a[200:203], v[132:135], v[52:55]
ds_read_b64_tr_b16 a[252:253], v5 offset:12288
v_mfma_f32_16x16x32_bf16 v[52:55], a[204:207], v[164:167], v[52:55]
ds_read_b128 a[228:231], v3 offset:7168
v_mfma_f32_16x16x32_bf16 v[52:55], a[208:211], v[196:199], v[52:55]
v_exp_f32 v48, v48
v_mfma_f32_16x16x32_bf16 v[52:55], a[212:215], v[228:231], v[52:55]
v_exp_f32 v49, v49
v_mfma_f32_16x16x32_bf16 v[56:59], a[192:195], v[72:75], v[40:43]
ds_read_b128 a[232:235], v2 offset:8192
v_add_f32 v16, v48, v49
v_mfma_f32_16x16x32_bf16 v[56:59], a[196:199], v[104:107], v[56:59]
ds_read_b64_tr_b16 a[254:255], v5 offset:18432
v_cvt_pk_bf16_f32 v80, v48, v49
v_mfma_f32_16x16x32_bf16 v[56:59], a[200:203], v[136:139], v[56:59]
s_add_u32 m0, s47, 74624
v_exp_f32 v50, v50
v_mfma_f32_16x16x32_bf16 v[56:59], a[204:207], v[168:171], v[56:59]
ds_read_b128 a[236:239], v3 offset:8192
v_add_f32 v16, v16, v50
v_mfma_f32_16x16x32_bf16 v[56:59], a[208:211], v[200:203], v[56:59]
v_exp_f32 v51, v51
v_mfma_f32_16x16x32_bf16 v[56:59], a[212:215], v[232:235], v[56:59]
ds_read_b64_tr_b16 v[216:217], v6 offset:0
v_add_f32 v16, v16, v51
v_mfma_f32_16x16x32_bf16 v[60:63], a[192:195], v[76:79], v[44:47]
buffer_load_dwordx4 v9, s[20:23], s34 offen offset:128 nt lds
v_mfma_f32_16x16x32_bf16 v[60:63], a[196:199], v[108:111], v[60:63]
ds_read_b64_tr_b16 v[218:219], v6 offset:6144
v_cvt_pk_bf16_f32 v81, v50, v51
v_mfma_f32_16x16x32_bf16 v[60:63], a[200:203], v[140:143], v[60:63]
v_exp_f32 v52, v52
v_mfma_f32_16x16x32_bf16 v[60:63], a[204:207], v[172:175], v[60:63]
v_exp_f32 v53, v53
v_mfma_f32_16x16x32_bf16 v[60:63], a[208:211], v[204:207], v[60:63]
ds_read_b64_tr_b16 v[220:221], v6 offset:12288
v_add_f32 v17, v52, v53
v_mfma_f32_16x16x32_bf16 v[60:63], a[212:215], v[236:239], v[60:63]
ds_read_b64_tr_b16 v[222:223], v6 offset:18432
v_cvt_pk_bf16_f32 v88, v52, v53
v_mfma_f32_16x16x32_bf16 a[0:3], a[240:243], v[144:147], a[0:3]
v_exp_f32 v54, v54
v_mfma_f32_16x16x32_bf16 a[0:3], a[244:247], v[148:151], a[0:3]
ds_read_b128 a[192:195], v2 offset:12288
v_add_f32 v17, v17, v54
v_mfma_f32_16x16x32_bf16 a[4:7], a[240:243], v[152:155], a[4:7]
v_exp_f32 v55, v55
v_mfma_f32_16x16x32_bf16 a[4:7], a[244:247], v[156:159], a[4:7]
v_add_f32 v17, v17, v55
v_cvt_pk_bf16_f32 v89, v54, v55
v_mfma_f32_16x16x32_bf16 a[8:11], a[240:243], v[176:179], a[8:11]
v_exp_f32 v56, v56
v_mfma_f32_16x16x32_bf16 a[8:11], a[244:247], v[180:183], a[8:11]
s_waitcnt lgkmcnt(11)
s_add_u32 m0, s47, 75520
v_mfma_f32_16x16x32_bf16 v[48:51], a[216:219], v[64:67], v[32:35]
v_exp_f32 v57, v57
v_mfma_f32_16x16x32_bf16 v[48:51], a[220:223], v[96:99], v[48:51]
ds_read_b128 a[196:199], v3 offset:12288
v_add_f32 v18, v56, v57
v_mfma_f32_16x16x32_bf16 v[48:51], a[224:227], v[128:131], v[48:51]
s_waitcnt lgkmcnt(6)
v_exp_f32 v58, v58
v_mfma_f32_16x16x32_bf16 v[48:51], a[228:231], v[160:163], v[48:51]
buffer_load_dwordx4 v9, s[20:23], s34 offen offset:256 nt lds
v_mfma_f32_16x16x32_bf16 v[48:51], a[232:235], v[192:195], v[48:51]
v_exp_f32 v59, v59
v_mfma_f32_16x16x32_bf16 v[48:51], a[236:239], v[224:227], v[48:51]
ds_read_b128 a[200:203], v2 offset:13312
v_cvt_pk_bf16_f32 v112, v56, v57
v_mfma_f32_16x16x32_bf16 a[12:15], a[240:243], v[184:187], a[12:15]
v_add_f32 v18, v18, v58
v_add_f32 v18, v18, v59
v_mfma_f32_16x16x32_bf16 a[12:15], a[244:247], v[188:191], a[12:15]
ds_read_b64_tr_b16 a[240:241], v7 offset:0
v_cvt_pk_bf16_f32 v113, v58, v59
v_mfma_f32_16x16x32_bf16 a[16:19], a[248:251], v[144:147], a[16:19]
v_exp_f32 v60, v60
v_mfma_f32_16x16x32_bf16 a[16:19], a[252:255], v[148:151], a[16:19]
v_exp_f32 v61, v61
v_mfma_f32_16x16x32_bf16 a[20:23], a[248:251], v[152:155], a[20:23]
ds_read_b64_tr_b16 a[242:243], v7 offset:6144
v_add_f32 v19, v60, v61
v_mfma_f32_16x16x32_bf16 a[20:23], a[252:255], v[156:159], a[20:23]
ds_read_b64_tr_b16 a[244:245], v7 offset:12288
v_cvt_pk_bf16_f32 v120, v60, v61
v_mfma_f32_16x16x32_bf16 v[52:55], a[216:219], v[68:71], v[36:39]
v_exp_f32 v62, v62
v_mfma_f32_16x16x32_bf16 v[52:55], a[220:223], v[100:103], v[52:55]
ds_read_b64_tr_b16 a[246:247], v7 offset:18432
v_add_f32 v19, v19, v62
v_mfma_f32_16x16x32_bf16 v[52:55], a[224:227], v[132:135], v[52:55]
s_add_u32 m0, s47, 86016
v_exp_f32 v63, v63
v_mfma_f32_16x16x32_bf16 v[52:55], a[228:231], v[164:167], v[52:55]
ds_read_b128 a[204:207], v3 offset:13312
v_add_f32 v19, v19, v63
v_mfma_f32_16x16x32_bf16 v[52:55], a[232:235], v[196:199], v[52:55]
v_exp_f32 v48, v48
v_mfma_f32_16x16x32_bf16 v[52:55], a[236:239], v[228:231], v[52:55]
ds_read_b128 a[208:211], v2 offset:14336
v_cvt_pk_bf16_f32 v121, v62, v63
v_mfma_f32_16x16x32_bf16 a[24:27], a[248:251], v[176:179], a[24:27]
buffer_load_dwordx4 v9, s[20:23], s35 offen offset:0 nt lds
v_mfma_f32_16x16x32_bf16 a[24:27], a[252:255], v[180:183], a[24:27]
v_exp_f32 v49, v49
v_mfma_f32_16x16x32_bf16 a[28:31], a[248:251], v[184:187], a[28:31]
v_exp_f32 v50, v50
v_mfma_f32_16x16x32_bf16 a[28:31], a[252:255], v[188:191], a[28:31]
s_waitcnt lgkmcnt(9)
v_exp_f32 v51, v51
v_mfma_f32_16x16x32_bf16 a[32:35], v[216:219], v[144:147], a[32:35]
ds_read_b64_tr_b16 a[248:249], v4 offset:1024
v_add_f32 v16, v16, v48
v_mfma_f32_16x16x32_bf16 a[32:35], v[220:223], v[148:151], a[32:35]
ds_read_b128 a[212:215], v3 offset:14336
v_add_f32 v16, v16, v49
v_mfma_f32_16x16x32_bf16 v[56:59], a[216:219], v[72:75], v[40:43]
ds_read_b64_tr_b16 a[250:251], v4 offset:7168
v_cvt_pk_bf16_f32 v82, v48, v49
v_mfma_f32_16x16x32_bf16 v[56:59], a[220:223], v[104:107], v[56:59]
ds_read_b64_tr_b16 a[252:253], v4 offset:13312
v_add_f32 v16, v16, v50
v_mfma_f32_16x16x32_bf16 v[56:59], a[224:227], v[136:139], v[56:59]
ds_read_b64_tr_b16 a[254:255], v4 offset:19456
v_add_f32 v16, v16, v51
v_mfma_f32_16x16x32_bf16 v[56:59], a[228:231], v[168:171], v[56:59]
v_exp_f32 v52, v52
v_mfma_f32_16x16x32_bf16 v[56:59], a[232:235], v[200:203], v[56:59]
v_cvt_pk_bf16_f32 v83, v50, v51
v_add_f32 v17, v17, v52
v_mfma_f32_16x16x32_bf16 v[56:59], a[236:239], v[232:235], v[56:59]
s_add_u32 m0, s47, 86912
v_exp_f32 v53, v53
v_mfma_f32_16x16x32_bf16 a[36:39], v[216:219], v[152:155], a[36:39]
v_exp_f32 v54, v54
v_mfma_f32_16x16x32_bf16 a[36:39], v[220:223], v[156:159], a[36:39]
v_exp_f32 v55, v55
v_mfma_f32_16x16x32_bf16 a[40:43], v[216:219], v[176:179], a[40:43]
v_add_f32 v17, v17, v53
v_cvt_pk_bf16_f32 v90, v52, v53
v_mfma_f32_16x16x32_bf16 a[40:43], v[220:223], v[180:183], a[40:43]
buffer_load_dwordx4 v9, s[20:23], s35 offen offset:128 nt lds
v_mfma_f32_16x16x32_bf16 a[44:47], v[216:219], v[184:187], a[44:47]
v_add_f32 v17, v17, v54
v_add_f32 v17, v17, v55
v_mfma_f32_16x16x32_bf16 a[44:47], v[220:223], v[188:191], a[44:47]
ds_read_b64_tr_b16 v[216:217], v5 offset:1024
v_cvt_pk_bf16_f32 v91, v54, v55
v_mfma_f32_16x16x32_bf16 v[60:63], a[216:219], v[76:79], v[44:47]
ds_read_b64_tr_b16 v[218:219], v5 offset:7168
v_mfma_f32_16x16x32_bf16 v[60:63], a[220:223], v[108:111], v[60:63]
ds_read_b64_tr_b16 v[220:221], v5 offset:13312
v_mfma_f32_16x16x32_bf16 v[60:63], a[224:227], v[140:143], v[60:63]
v_exp_f32 v56, v56
v_mfma_f32_16x16x32_bf16 v[60:63], a[228:231], v[172:175], v[60:63]
ds_read_b64_tr_b16 v[222:223], v5 offset:19456
v_add_f32 v18, v18, v56
v_mfma_f32_16x16x32_bf16 v[60:63], a[232:235], v[204:207], v[60:63]
v_exp_f32 v57, v57
v_mfma_f32_16x16x32_bf16 v[60:63], a[236:239], v[236:239], v[60:63]
s_waitcnt lgkmcnt(11)
v_exp_f32 v58, v58
v_mfma_f32_16x16x32_bf16 a[48:51], a[240:243], v[144:147], a[48:51]
ds_read_b128 a[216:219], v2 offset:18432
v_add_f32 v18, v18, v57
v_mfma_f32_16x16x32_bf16 a[48:51], a[244:247], v[148:151], a[48:51]
v_exp_f32 v59, v59
v_mfma_f32_16x16x32_bf16 a[52:55], a[240:243], v[152:155], a[52:55]
s_add_u32 m0, s47, 87808
v_cvt_pk_bf16_f32 v114, v56, v57
v_add_f32 v18, v18, v58
v_mfma_f32_16x16x32_bf16 a[52:55], a[244:247], v[156:159], a[52:55]
v_add_f32 v18, v18, v59
v_cvt_pk_bf16_f32 v115, v58, v59
v_mfma_f32_16x16x32_bf16 a[56:59], a[240:243], v[176:179], a[56:59]
v_exp_f32 v60, v60
v_mfma_f32_16x16x32_bf16 a[56:59], a[244:247], v[180:183], a[56:59]
ds_read_b128 a[220:223], v3 offset:18432
v_add_f32 v19, v19, v60
v_mfma_f32_16x16x32_bf16 v[48:51], a[192:195], v[64:67], v[32:35]
buffer_load_dwordx4 v9, s[20:23], s35 offen offset:256 nt lds
v_mfma_f32_16x16x32_bf16 v[48:51], a[196:199], v[96:99], v[48:51]
s_add_u32 s32, s32, 24576
v_exp_f32 v61, v61
v_mfma_f32_16x16x32_bf16 v[48:51], a[200:203], v[128:131], v[48:51]
s_waitcnt lgkmcnt(9)
v_exp_f32 v62, v62
v_mfma_f32_16x16x32_bf16 v[48:51], a[204:207], v[160:163], v[48:51]
s_add_u32 s33, s33, 24576
v_exp_f32 v63, v63
v_mfma_f32_16x16x32_bf16 v[48:51], a[208:211], v[192:195], v[48:51]
s_add_u32 s34, s34, 24576
v_add_f32 v19, v19, v61
v_cvt_pk_bf16_f32 v122, v60, v61
v_mfma_f32_16x16x32_bf16 v[48:51], a[212:215], v[224:227], v[48:51]
ds_read_b128 a[224:227], v2 offset:19456
v_add_f32 v19, v19, v62
v_mfma_f32_16x16x32_bf16 a[60:63], a[240:243], v[184:187], a[60:63]
s_add_u32 s35, s35, 24576
v_add_f32 v19, v19, v63
v_cvt_pk_bf16_f32 v123, v62, v63
v_mfma_f32_16x16x32_bf16 a[60:63], a[244:247], v[188:191], a[60:63]
s_waitcnt lgkmcnt(7)
ds_read_b64_tr_b16 a[240:241], v6 offset:1024
v_mfma_f32_16x16x32_bf16 a[64:67], a[248:251], v[144:147], a[64:67]
ds_read_b64_tr_b16 a[242:243], v6 offset:7168
s_mov_b32 s6, s40
v_mfma_f32_16x16x32_bf16 a[64:67], a[252:255], v[148:151], a[64:67]
ds_read_b64_tr_b16 a[244:245], v6 offset:13312
s_mov_b32 s40, s41
v_mfma_f32_16x16x32_bf16 a[68:71], a[248:251], v[152:155], a[68:71]
ds_read_b64_tr_b16 a[246:247], v6 offset:19456
s_mov_b32 s41, s47
v_mfma_f32_16x16x32_bf16 a[68:71], a[252:255], v[156:159], a[68:71]
s_mov_b32 s47, s6
ds_read_b128 a[228:231], v3 offset:19456
v_mfma_f32_16x16x32_bf16 v[52:55], a[192:195], v[68:71], v[36:39]
v_exp_f32 v48, v48
v_mfma_f32_16x16x32_bf16 v[52:55], a[196:199], v[100:103], v[52:55]
v_exp_f32 v49, v49
v_mfma_f32_16x16x32_bf16 v[52:55], a[200:203], v[132:135], v[52:55]
v_exp_f32 v50, v50
v_mfma_f32_16x16x32_bf16 v[52:55], a[204:207], v[164:167], v[52:55]
v_exp_f32 v51, v51
v_mfma_f32_16x16x32_bf16 v[52:55], a[208:211], v[196:199], v[52:55]
v_add_f32 v16, v16, v48
v_add_f32 v16, v16, v49
v_mfma_f32_16x16x32_bf16 v[52:55], a[212:215], v[228:231], v[52:55]
ds_read_b128 a[232:235], v2 offset:20480
v_cvt_pk_bf16_f32 v84, v48, v49
v_mfma_f32_16x16x32_bf16 a[72:75], a[248:251], v[176:179], a[72:75]
v_add_f32 v16, v16, v50
v_add_f32 v16, v16, v51
v_mfma_f32_16x16x32_bf16 a[72:75], a[252:255], v[180:183], a[72:75]
v_cvt_pk_bf16_f32 v85, v50, v51
v_mfma_f32_16x16x32_bf16 a[76:79], a[248:251], v[184:187], a[76:79]
v_exp_f32 v52, v52
v_mfma_f32_16x16x32_bf16 a[76:79], a[252:255], v[188:191], a[76:79]
s_waitcnt lgkmcnt(9)
ds_read_b64_tr_b16 a[248:249], v7 offset:1024
v_mfma_f32_16x16x32_bf16 a[80:83], v[216:219], v[144:147], a[80:83]
ds_read_b64_tr_b16 a[250:251], v7 offset:7168
v_add_f32 v17, v17, v52
v_mfma_f32_16x16x32_bf16 a[80:83], v[220:223], v[148:151], a[80:83]
ds_read_b128 a[236:239], v3 offset:20480
v_mfma_f32_16x16x32_bf16 v[56:59], a[192:195], v[72:75], v[40:43]
ds_read_b64_tr_b16 a[252:253], v7 offset:13312
v_mfma_f32_16x16x32_bf16 v[56:59], a[196:199], v[104:107], v[56:59]
ds_read_b64_tr_b16 a[254:255], v7 offset:19456
v_mfma_f32_16x16x32_bf16 v[56:59], a[200:203], v[136:139], v[56:59]
v_exp_f32 v53, v53
v_mfma_f32_16x16x32_bf16 v[56:59], a[204:207], v[168:171], v[56:59]
v_exp_f32 v54, v54
v_mfma_f32_16x16x32_bf16 v[56:59], a[208:211], v[200:203], v[56:59]
v_exp_f32 v55, v55
v_mfma_f32_16x16x32_bf16 v[56:59], a[212:215], v[232:235], v[56:59]
v_add_f32 v17, v17, v53
v_cvt_pk_bf16_f32 v92, v52, v53
v_mfma_f32_16x16x32_bf16 a[84:87], v[216:219], v[152:155], a[84:87]
v_add_f32 v17, v17, v54
v_add_f32 v17, v17, v55
v_mfma_f32_16x16x32_bf16 a[84:87], v[220:223], v[156:159], a[84:87]
v_cvt_pk_bf16_f32 v93, v54, v55
v_mfma_f32_16x16x32_bf16 a[88:91], v[216:219], v[176:179], a[88:91]
v_exp_f32 v56, v56
v_mfma_f32_16x16x32_bf16 a[88:91], v[220:223], v[180:183], a[88:91]
v_exp_f32 v57, v57
v_mfma_f32_16x16x32_bf16 a[92:95], v[216:219], v[184:187], a[92:95]
v_exp_f32 v58, v58
v_mfma_f32_16x16x32_bf16 a[92:95], v[220:223], v[188:191], a[92:95]
ds_read_b64_tr_b16 v[216:217], v4 offset:2048
v_add_f32 v18, v18, v56
v_mfma_f32_16x16x32_bf16 v[60:63], a[192:195], v[76:79], v[44:47]
ds_read_b64_tr_b16 v[218:219], v4 offset:8192
v_add_f32 v18, v18, v57
v_mfma_f32_16x16x32_bf16 v[60:63], a[196:199], v[108:111], v[60:63]
ds_read_b64_tr_b16 v[220:221], v4 offset:14336
v_cvt_pk_bf16_f32 v116, v56, v57
v_mfma_f32_16x16x32_bf16 v[60:63], a[200:203], v[140:143], v[60:63]
ds_read_b64_tr_b16 v[222:223], v4 offset:20480
v_add_f32 v18, v18, v58
v_mfma_f32_16x16x32_bf16 v[60:63], a[204:207], v[172:175], v[60:63]
v_exp_f32 v59, v59
v_mfma_f32_16x16x32_bf16 v[60:63], a[208:211], v[204:207], v[60:63]
v_add_f32 v18, v18, v59
v_cvt_pk_bf16_f32 v117, v58, v59
v_mfma_f32_16x16x32_bf16 v[60:63], a[212:215], v[236:239], v[60:63]
s_waitcnt lgkmcnt(11)
v_mfma_f32_16x16x32_bf16 a[96:99], a[240:243], v[144:147], a[96:99]
v_mfma_f32_16x16x32_bf16 a[96:99], a[244:247], v[148:151], a[96:99]
v_mfma_f32_16x16x32_bf16 a[100:103], a[240:243], v[152:155], a[100:103]
v_mfma_f32_16x16x32_bf16 a[100:103], a[244:247], v[156:159], a[100:103]
v_mfma_f32_16x16x32_bf16 a[104:107], a[240:243], v[176:179], a[104:107]
v_mfma_f32_16x16x32_bf16 a[104:107], a[244:247], v[180:183], a[104:107]
v_mfma_f32_16x16x32_bf16 v[48:51], a[216:219], v[64:67], v[32:35]
v_exp_f32 v60, v60
v_mfma_f32_16x16x32_bf16 v[48:51], a[220:223], v[96:99], v[48:51]
v_exp_f32 v61, v61
v_mfma_f32_16x16x32_bf16 v[48:51], a[224:227], v[128:131], v[48:51]
s_waitcnt lgkmcnt(6)
v_exp_f32 v62, v62
v_mfma_f32_16x16x32_bf16 v[48:51], a[228:231], v[160:163], v[48:51]
v_exp_f32 v63, v63
v_mfma_f32_16x16x32_bf16 v[48:51], a[232:235], v[192:195], v[48:51]
v_add_f32 v19, v19, v60
v_add_f32 v19, v19, v61
v_mfma_f32_16x16x32_bf16 v[48:51], a[236:239], v[224:227], v[48:51]
v_cvt_pk_bf16_f32 v124, v60, v61
v_add_f32 v19, v19, v62
v_mfma_f32_16x16x32_bf16 a[108:111], a[240:243], v[184:187], a[108:111]
v_add_f32 v19, v19, v63
v_cvt_pk_bf16_f32 v125, v62, v63
v_mfma_f32_16x16x32_bf16 a[108:111], a[244:247], v[188:191], a[108:111]
s_waitcnt lgkmcnt(4)
ds_read_b64_tr_b16 a[240:241], v5 offset:2048
v_mfma_f32_16x16x32_bf16 a[112:115], a[248:251], v[144:147], a[112:115]
ds_read_b64_tr_b16 a[242:243], v5 offset:8192
v_mfma_f32_16x16x32_bf16 a[112:115], a[252:255], v[148:151], a[112:115]
ds_read_b64_tr_b16 a[244:245], v5 offset:14336
v_mfma_f32_16x16x32_bf16 a[116:119], a[248:251], v[152:155], a[116:119]
ds_read_b64_tr_b16 a[246:247], v5 offset:20480
v_mfma_f32_16x16x32_bf16 a[116:119], a[252:255], v[156:159], a[116:119]
v_exp_f32 v48, v48
v_mfma_f32_16x16x32_bf16 v[52:55], a[216:219], v[68:71], v[36:39]
v_exp_f32 v49, v49
v_mfma_f32_16x16x32_bf16 v[52:55], a[220:223], v[100:103], v[52:55]
v_exp_f32 v50, v50
v_mfma_f32_16x16x32_bf16 v[52:55], a[224:227], v[132:135], v[52:55]
v_exp_f32 v51, v51
v_mfma_f32_16x16x32_bf16 v[52:55], a[228:231], v[164:167], v[52:55]
v_add_f32 v16, v16, v48
v_add_f32 v16, v16, v49
v_mfma_f32_16x16x32_bf16 v[52:55], a[232:235], v[196:199], v[52:55]
v_cvt_pk_bf16_f32 v86, v48, v49
v_add_f32 v16, v16, v50
v_mfma_f32_16x16x32_bf16 v[52:55], a[236:239], v[228:231], v[52:55]
v_add_f32 v16, v16, v51
v_cvt_pk_bf16_f32 v87, v50, v51
v_mfma_f32_16x16x32_bf16 a[120:123], a[248:251], v[176:179], a[120:123]
v_mfma_f32_16x16x32_bf16 a[120:123], a[252:255], v[180:183], a[120:123]
v_mfma_f32_16x16x32_bf16 a[124:127], a[248:251], v[184:187], a[124:127]
v_mfma_f32_16x16x32_bf16 a[124:127], a[252:255], v[188:191], a[124:127]
s_waitcnt lgkmcnt(4)
ds_read_b64_tr_b16 a[248:249], v6 offset:2048
v_mfma_f32_16x16x32_bf16 a[128:131], v[216:219], v[144:147], a[128:131]
ds_read_b64_tr_b16 a[250:251], v6 offset:8192
v_mfma_f32_16x16x32_bf16 a[128:131], v[220:223], v[148:151], a[128:131]
ds_read_b64_tr_b16 a[252:253], v6 offset:14336
v_mfma_f32_16x16x32_bf16 v[56:59], a[216:219], v[72:75], v[40:43]
ds_read_b64_tr_b16 a[254:255], v6 offset:20480
v_mfma_f32_16x16x32_bf16 v[56:59], a[220:223], v[104:107], v[56:59]
v_exp_f32 v52, v52
v_mfma_f32_16x16x32_bf16 v[56:59], a[224:227], v[136:139], v[56:59]
v_exp_f32 v53, v53
v_mfma_f32_16x16x32_bf16 v[56:59], a[228:231], v[168:171], v[56:59]
v_exp_f32 v54, v54
v_mfma_f32_16x16x32_bf16 v[56:59], a[232:235], v[200:203], v[56:59]
v_exp_f32 v55, v55
v_mfma_f32_16x16x32_bf16 v[56:59], a[236:239], v[232:235], v[56:59]
v_add_f32 v17, v17, v52
v_add_f32 v17, v17, v53
v_mfma_f32_16x16x32_bf16 a[132:135], v[216:219], v[152:155], a[132:135]
v_cvt_pk_bf16_f32 v94, v52, v53
v_add_f32 v17, v17, v54
v_mfma_f32_16x16x32_bf16 a[132:135], v[220:223], v[156:159], a[132:135]
v_add_f32 v17, v17, v55
v_cvt_pk_bf16_f32 v95, v54, v55
v_mfma_f32_16x16x32_bf16 a[136:139], v[216:219], v[176:179], a[136:139]
v_exp_f32 v56, v56
v_mfma_f32_16x16x32_bf16 a[136:139], v[220:223], v[180:183], a[136:139]
v_exp_f32 v57, v57
v_mfma_f32_16x16x32_bf16 a[140:143], v[216:219], v[184:187], a[140:143]
v_exp_f32 v58, v58
v_mfma_f32_16x16x32_bf16 a[140:143], v[220:223], v[188:191], a[140:143]
ds_read_b64_tr_b16 v[216:217], v7 offset:2048
v_add_f32 v18, v18, v56
v_mfma_f32_16x16x32_bf16 v[60:63], a[216:219], v[76:79], v[44:47]
ds_read_b64_tr_b16 v[218:219], v7 offset:8192
v_add_f32 v18, v18, v57
v_mfma_f32_16x16x32_bf16 v[60:63], a[220:223], v[108:111], v[60:63]
ds_read_b64_tr_b16 v[220:221], v7 offset:14336
v_cvt_pk_bf16_f32 v118, v56, v57
v_mfma_f32_16x16x32_bf16 v[60:63], a[224:227], v[140:143], v[60:63]
ds_read_b64_tr_b16 v[222:223], v7 offset:20480
v_add_f32 v18, v18, v58
v_mfma_f32_16x16x32_bf16 v[60:63], a[228:231], v[172:175], v[60:63]
v_exp_f32 v59, v59
v_mfma_f32_16x16x32_bf16 v[60:63], a[232:235], v[204:207], v[60:63]
v_add_f32 v18, v18, v59
v_cvt_pk_bf16_f32 v119, v58, v59
v_mfma_f32_16x16x32_bf16 v[60:63], a[236:239], v[236:239], v[60:63]
s_waitcnt lgkmcnt(8)
v_mfma_f32_16x16x32_bf16 a[144:147], a[240:243], v[144:147], a[144:147]
v_mfma_f32_16x16x32_bf16 a[144:147], a[244:247], v[148:151], a[144:147]
v_mfma_f32_16x16x32_bf16 a[148:151], a[240:243], v[152:155], a[148:151]
v_mfma_f32_16x16x32_bf16 a[148:151], a[244:247], v[156:159], a[148:151]
v_mfma_f32_16x16x32_bf16 a[152:155], a[240:243], v[176:179], a[152:155]
v_mfma_f32_16x16x32_bf16 a[152:155], a[244:247], v[180:183], a[152:155]
s_waitcnt vmcnt(10) lgkmcnt(0)
v_exp_f32 v60, v60
v_mfma_f32_16x16x32_bf16 a[156:159], a[240:243], v[184:187], a[156:159]
v_exp_f32 v61, v61
v_mfma_f32_16x16x32_bf16 a[156:159], a[244:247], v[188:191], a[156:159]
s_barrier
v_mfma_f32_16x16x32_bf16 a[160:163], a[248:251], v[144:147], a[160:163]
v_add_u32 v2, s38, v2
v_add_u32 v3, s38, v3
v_mfma_f32_16x16x32_bf16 a[160:163], a[252:255], v[148:151], a[160:163]
ds_read_b128 a[192:195], v2 offset:0
v_add_u32 v4, s39, v4
v_mfma_f32_16x16x32_bf16 a[164:167], a[248:251], v[152:155], a[164:167]
ds_read_b128 a[196:199], v3 offset:0
v_add_f32 v19, v19, v60
v_mfma_f32_16x16x32_bf16 a[164:167], a[252:255], v[156:159], a[164:167]
ds_read_b128 a[200:203], v2 offset:1024
v_add_f32 v19, v19, v61
v_mfma_f32_16x16x32_bf16 a[168:171], a[248:251], v[176:179], a[168:171]
ds_read_b128 a[204:207], v3 offset:1024
v_cvt_pk_bf16_f32 v126, v60, v61
v_mfma_f32_16x16x32_bf16 a[168:171], a[252:255], v[180:183], a[168:171]
ds_read_b128 a[208:211], v2 offset:2048
v_add_u32 v5, s39, v5
v_mfma_f32_16x16x32_bf16 a[172:175], a[248:251], v[184:187], a[172:175]
v_exp_f32 v62, v62
v_mfma_f32_16x16x32_bf16 a[172:175], a[252:255], v[188:191], a[172:175]
ds_read_b128 a[212:215], v3 offset:2048
v_add_f32 v19, v19, v62
v_mfma_f32_16x16x32_bf16 a[176:179], v[216:219], v[144:147], a[176:179]
v_exp_f32 v63, v63
v_mfma_f32_16x16x32_bf16 a[176:179], v[220:223], v[148:151], a[176:179]
ds_read_b64_tr_b16 a[240:241], v4 offset:0
v_add_f32 v19, v19, v63
v_mfma_f32_16x16x32_bf16 a[180:183], v[216:219], v[152:155], a[180:183]
ds_read_b64_tr_b16 a[242:243], v4 offset:6144
v_cvt_pk_bf16_f32 v127, v62, v63
v_mfma_f32_16x16x32_bf16 a[180:183], v[220:223], v[156:159], a[180:183]
ds_read_b64_tr_b16 a[244:245], v4 offset:12288
v_max3_f32 v240, v16, v17, v18
v_mfma_f32_16x16x32_bf16 a[184:187], v[216:219], v[176:179], a[184:187]
ds_read_b64_tr_b16 a[246:247], v4 offset:18432
v_add_u32 v6, s39, v6
v_mfma_f32_16x16x32_bf16 a[184:187], v[220:223], v[180:183], a[184:187]
v_max_f32 v240, v240, v19
v_cmp_lt_f32 vcc, s36, v240
v_mfma_f32_16x16x32_bf16 a[188:191], v[216:219], v[184:187], a[188:191]
v_add_u32 v7, s39, v7
v_mfma_f32_16x16x32_bf16 a[188:191], v[220:223], v[188:191], a[188:191]
s_cbranch_vccnz L_stub_s29
L_ret_s29:
s_mov_b32 s101, 0x200000
s_waitcnt vmcnt(6)
L_poll5:
v_cmp_gt_u32 vcc, 320, v253
s_cbranch_vccz L_go5
s_sub_u32 s101, s101, 1
s_cmp_eq_u32 s101, 0
s_cbranch_scc1 L_go5
buffer_load_dword v253, off, s[68:71], s95 sc1
s_waitcnt vmcnt(0)
s_branch L_poll5
L_go5:
v_readfirstlane_b32 s6, v251
s_cmp_eq_u32 s6, 32
s_cselect_b32 s46, 1, 0
s_waitcnt lgkmcnt(7)
v_mfma_f32_16x16x32_bf16 v[48:51], a[192:195], v[64:67], v[32:35]
s_sub_u32 s38, s47, s41
v_add_f32 v12, v12, v16
v_add_f32 v13, v13, v17
v_mfma_f32_16x16x32_bf16 v[48:51], a[196:199], v[96:99], v[48:51]
s_add_u32 s92, s96, 0
s_add_u32 m0, s94, 122880
v_add_f32 v14, v14, v18
v_mfma_f32_16x16x32_bf16 v[48:51], a[200:203], v[128:131], v[48:51]
s_waitcnt lgkmcnt(4)
s_sub_u32 s39, s41, s40
v_add_f32 v15, v15, v19
v_mfma_f32_16x16x32_bf16 v[48:51], a[204:207], v[160:163], v[48:51]
s_add_u32 s32, s32, 24576
ds_read_b128 a[216:219], v2 offset:6144
v_mfma_f32_16x16x32_bf16 v[48:51], a[208:211], v[192:195], v[48:51]
buffer_load_dwordx4 v21, s[48:51], s92 offen  lds
v_mfma_f32_16x16x32_bf16 v[48:51], a[212:215], v[224:227], v[48:51]
s_add_u32 s33, s33, 24576
ds_read_b128 a[220:223], v3 offset:6144
v_mfma_f32_16x16x32_bf16 v[52:55], a[192:195], v[68:71], v[36:39]
s_add_u32 s34, s34, 24576
ds_read_b128 a[224:227], v2 offset:7168
v_mfma_f32_16x16x32_bf16 v[52:55], a[196:199], v[100:103], v[52:55]
ds_read_b64_tr_b16 a[248:249], v5 offset:0
s_add_u32 s35, s35, 24576
v_mfma_f32_16x16x32_bf16 v[52:55], a[200:203], v[132:135], v[52:55]
v_exp_f32 v48, v48
v_mfma_f32_16x16x32_bf16 v[52:55], a[204:207], v[164:167], v[52:55]
ds_read_b128 a[228:231], v3 offset:7168
v_mfma_f32_16x16x32_bf16 v[52:55], a[208:211], v[196:199], v[52:55]
v_exp_f32 v49, v49
v_mfma_f32_16x16x32_bf16 v[52:55], a[212:215], v[228:231], v[52:55]
s_add_u32 m0, s94, 123904
v_exp_f32 v50, v50
v_mfma_f32_16x16x32_bf16 v[56:59], a[192:195], v[72:75], v[40:43]
ds_read_b128 a[232:235], v2 offset:8192
v_add_f32 v16, v48, v49
v_mfma_f32_16x16x32_bf16 v[56:59], a[196:199], v[104:107], v[56:59]
ds_read_b64_tr_b16 a[250:251], v5 offset:6144
v_cvt_pk_bf16_f32 v144, v48, v49
v_mfma_f32_16x16x32_bf16 v[56:59], a[200:203], v[136:139], v[56:59]
buffer_load_dwordx4 v22, s[48:51], s92 offen  lds
v_mfma_f32_16x16x32_bf16 v[56:59], a[204:207], v[168:171], v[56:59]
ds_read_b128 a[236:239], v3 offset:8192
v_add_f32 v16, v16, v50
v_mfma_f32_16x16x32_bf16 v[56:59], a[208:211], v[200:203], v[56:59]
v_exp_f32 v51, v51
v_mfma_f32_16x16x32_bf16 v[56:59], a[212:215], v[232:235], v[56:59]
ds_read_b64_tr_b16 a[252:253], v5 offset:12288
v_add_f32 v16, v16, v51
v_mfma_f32_16x16x32_bf16 v[60:63], a[192:195], v[76:79], v[44:47]
ds_read_b64_tr_b16 a[254:255], v5 offset:18432
v_cvt_pk_bf16_f32 v145, v50, v51
v_mfma_f32_16x16x32_bf16 v[60:63], a[196:199], v[108:111], v[60:63]
v_exp_f32 v52, v52
v_mfma_f32_16x16x32_bf16 v[60:63], a[200:203], v[140:143], v[60:63]
v_exp_f32 v53, v53
v_mfma_f32_16x16x32_bf16 v[60:63], a[204:207], v[172:175], v[60:63]
s_add_u32 m0, s94, 124928
v_exp_f32 v54, v54
v_mfma_f32_16x16x32_bf16 v[60:63], a[208:211], v[204:207], v[60:63]
ds_read_b64_tr_b16 v[216:217], v6 offset:0
v_add_f32 v17, v52, v53
v_mfma_f32_16x16x32_bf16 v[60:63], a[212:215], v[236:239], v[60:63]
s_waitcnt lgkmcnt(11)
v_exp_f32 v55, v55
v_mfma_f32_16x16x32_bf16 a[0:3], a[240:243], v[80:83], a[0:3]
buffer_load_dwordx4 v23, s[48:51], s92 offen  lds
v_mfma_f32_16x16x32_bf16 a[0:3], a[244:247], v[84:87], a[0:3]
ds_read_b64_tr_b16 v[218:219], v6 offset:6144
v_cvt_pk_bf16_f32 v152, v52, v53
v_mfma_f32_16x16x32_bf16 a[4:7], a[240:243], v[88:91], a[4:7]
ds_read_b64_tr_b16 v[220:221], v6 offset:12288
v_add_f32 v17, v17, v54
v_mfma_f32_16x16x32_bf16 a[4:7], a[244:247], v[92:95], a[4:7]
ds_read_b64_tr_b16 v[222:223], v6 offset:18432
v_add_f32 v17, v17, v55
v_mfma_f32_16x16x32_bf16 a[8:11], a[240:243], v[112:115], a[8:11]
ds_read_b128 a[192:195], v2 offset:12288
v_cvt_pk_bf16_f32 v153, v54, v55
v_mfma_f32_16x16x32_bf16 a[8:11], a[244:247], v[116:119], a[8:11]
s_waitcnt lgkmcnt(12)
v_exp_f32 v56, v56
v_mfma_f32_16x16x32_bf16 v[48:51], a[216:219], v[64:67], v[32:35]
s_mov_b32 s6, s40
v_exp_f32 v57, v57
v_mfma_f32_16x16x32_bf16 v[48:51], a[220:223], v[96:99], v[48:51]
s_add_u32 m0, s94, 125952
v_exp_f32 v58, v58
v_mfma_f32_16x16x32_bf16 v[48:51], a[224:227], v[128:131], v[48:51]
s_waitcnt lgkmcnt(7)
v_exp_f32 v59, v59
v_mfma_f32_16x16x32_bf16 v[48:51], a[228:231], v[160:163], v[48:51]
ds_read_b128 a[196:199], v3 offset:12288
v_add_f32 v18, v56, v57
v_mfma_f32_16x16x32_bf16 v[48:51], a[232:235], v[192:195], v[48:51]
buffer_load_dwordx4 v24, s[48:51], s92 offen  lds
v_mfma_f32_16x16x32_bf16 v[48:51], a[236:239], v[224:227], v[48:51]
s_mov_b32 s40, s41
v_cvt_pk_bf16_f32 v176, v56, v57
v_add_f32 v18, v18, v58
v_mfma_f32_16x16x32_bf16 a[12:15], a[240:243], v[120:123], a[12:15]
ds_read_b128 a[200:203], v2 offset:13312
v_add_f32 v18, v18, v59
v_mfma_f32_16x16x32_bf16 a[12:15], a[244:247], v[124:127], a[12:15]
s_waitcnt lgkmcnt(7)
v_exp_f32 v60, v60
v_mfma_f32_16x16x32_bf16 a[16:19], a[248:251], v[80:83], a[16:19]
ds_read_b64_tr_b16 a[240:241], v7 offset:0
v_cvt_pk_bf16_f32 v177, v58, v59
v_mfma_f32_16x16x32_bf16 a[16:19], a[252:255], v[84:87], a[16:19]
s_mov_b32 s41, s47
v_exp_f32 v61, v61
v_mfma_f32_16x16x32_bf16 a[20:23], a[248:251], v[88:91], a[20:23]
ds_read_b64_tr_b16 a[242:243], v7 offset:6144
v_add_f32 v19, v60, v61
v_mfma_f32_16x16x32_bf16 a[20:23], a[252:255], v[92:95], a[20:23]
s_add_u32 m0, s94, 126976
v_exp_f32 v62, v62
v_mfma_f32_16x16x32_bf16 v[52:55], a[216:219], v[68:71], v[36:39]
ds_read_b64_tr_b16 a[244:245], v7 offset:12288
v_cvt_pk_bf16_f32 v184, v60, v61
v_mfma_f32_16x16x32_bf16 v[52:55], a[220:223], v[100:103], v[52:55]
ds_read_b64_tr_b16 a[246:247], v7 offset:18432
v_add_f32 v19, v19, v62
v_mfma_f32_16x16x32_bf16 v[52:55], a[224:227], v[132:135], v[52:55]
buffer_load_dwordx4 v25, s[48:51], s92 offen  lds
v_mfma_f32_16x16x32_bf16 v[52:55], a[228:231], v[164:167], v[52:55]
s_mov_b32 s47, s6
v_exp_f32 v63, v63
v_mfma_f32_16x16x32_bf16 v[52:55], a[232:235], v[196:199], v[52:55]
ds_read_b128 a[204:207], v3 offset:13312
v_add_f32 v19, v19, v63
v_mfma_f32_16x16x32_bf16 v[52:55], a[236:239], v[228:231], v[52:55]
ds_read_b128 a[208:211], v2 offset:14336
v_cvt_pk_bf16_f32 v185, v62, v63
v_mfma_f32_16x16x32_bf16 a[24:27], a[248:251], v[112:115], a[24:27]
v_exp_f32 v48, v48
v_mfma_f32_16x16x32_bf16 a[24:27], a[252:255], v[116:119], a[24:27]
v_exp_f32 v49, v49
v_mfma_f32_16x16x32_bf16 a[28:31], a[248:251], v[120:123], a[28:31]
v_exp_f32 v50, v50
v_mfma_f32_16x16x32_bf16 a[28:31], a[252:255], v[124:127], a[28:31]
s_waitcnt lgkmcnt(9)
s_add_u32 s92, s96, 81920
s_add_u32 m0, s94, 143360
v_mfma_f32_16x16x32_bf16 a[32:35], v[216:219], v[80:83], a[32:35]
ds_read_b64_tr_b16 a[248:249], v4 offset:1024
v_add_f32 v16, v16, v48
v_mfma_f32_16x16x32_bf16 a[32:35], v[220:223], v[84:87], a[32:35]
ds_read_b128 a[212:215], v3 offset:14336
v_add_f32 v16, v16, v49
v_mfma_f32_16x16x32_bf16 v[56:59], a[216:219], v[72:75], v[40:43]
buffer_load_dwordx4 v21, s[48:51], s92 offen  lds
v_mfma_f32_16x16x32_bf16 v[56:59], a[220:223], v[104:107], v[56:59]
ds_read_b64_tr_b16 a[250:251], v4 offset:7168
v_cvt_pk_bf16_f32 v146, v48, v49
v_mfma_f32_16x16x32_bf16 v[56:59], a[224:227], v[136:139], v[56:59]
ds_read_b64_tr_b16 a[252:253], v4 offset:13312
v_add_f32 v16, v16, v50
v_mfma_f32_16x16x32_bf16 v[56:59], a[228:231], v[168:171], v[56:59]
v_exp_f32 v51, v51
v_mfma_f32_16x16x32_bf16 v[56:59], a[232:235], v[200:203], v[56:59]
ds_read_b64_tr_b16 a[254:255], v4 offset:19456
v_add_f32 v16, v16, v51
v_mfma_f32_16x16x32_bf16 v[56:59], a[236:239], v[232:235], v[56:59]
v_exp_f32 v52, v52
v_mfma_f32_16x16x32_bf16 a[36:39], v[216:219], v[88:91], a[36:39]
v_cvt_pk_bf16_f32 v147, v50, v51
v_add_f32 v17, v17, v52
v_mfma_f32_16x16x32_bf16 a[36:39], v[220:223], v[92:95], a[36:39]
s_add_u32 m0, s94, 144384
v_exp_f32 v53, v53
v_mfma_f32_16x16x32_bf16 a[40:43], v[216:219], v[112:115], a[40:43]
v_exp_f32 v54, v54
v_mfma_f32_16x16x32_bf16 a[40:43], v[220:223], v[116:119], a[40:43]
v_exp_f32 v55, v55
v_mfma_f32_16x16x32_bf16 a[44:47], v[216:219], v[120:123], a[44:47]
buffer_load_dwordx4 v22, s[48:51], s92 offen  lds
v_mfma_f32_16x16x32_bf16 a[44:47], v[220:223], v[124:127], a[44:47]
ds_read_b64_tr_b16 v[216:217], v5 offset:1024
v_add_f32 v17, v17, v53
v_mfma_f32_16x16x32_bf16 v[60:63], a[216:219], v[76:79], v[44:47]
ds_read_b64_tr_b16 v[218:219], v5 offset:7168
v_cvt_pk_bf16_f32 v154, v52, v53
v_mfma_f32_16x16x32_bf16 v[60:63], a[220:223], v[108:111], v[60:63]
ds_read_b64_tr_b16 v[220:221], v5 offset:13312
v_add_f32 v17, v17, v54
v_mfma_f32_16x16x32_bf16 v[60:63], a[224:227], v[140:143], v[60:63]
ds_read_b64_tr_b16 v[222:223], v5 offset:19456
v_add_f32 v17, v17, v55
v_mfma_f32_16x16x32_bf16 v[60:63], a[228:231], v[172:175], v[60:63]
v_exp_f32 v56, v56
v_mfma_f32_16x16x32_bf16 v[60:63], a[232:235], v[204:207], v[60:63]
v_cvt_pk_bf16_f32 v155, v54, v55
v_add_f32 v18, v18, v56
v_mfma_f32_16x16x32_bf16 v[60:63], a[236:239], v[236:239], v[60:63]
s_waitcnt lgkmcnt(11)
s_add_u32 m0, s94, 145408
v_mfma_f32_16x16x32_bf16 a[48:51], a[240:243], v[80:83], a[48:51]
v_exp_f32 v57, v57
v_mfma_f32_16x16x32_bf16 a[48:51], a[244:247], v[84:87], a[48:51]
ds_read_b128 a[216:219], v2 offset:18432
v_add_f32 v18, v18, v57
v_mfma_f32_16x16x32_bf16 a[52:55], a[240:243], v[88:91], a[52:55]
buffer_load_dwordx4 v23, s[48:51], s92 offen  lds
v_mfma_f32_16x16x32_bf16 a[52:55], a[244:247], v[92:95], a[52:55]
v_exp_f32 v58, v58
v_mfma_f32_16x16x32_bf16 a[56:59], a[240:243], v[112:115], a[56:59]
v_exp_f32 v59, v59
v_mfma_f32_16x16x32_bf16 a[56:59], a[244:247], v[116:119], a[56:59]
ds_read_b128 a[220:223], v3 offset:18432
v_cvt_pk_bf16_f32 v178, v56, v57
v_mfma_f32_16x16x32_bf16 v[48:51], a[192:195], v[64:67], v[32:35]
v_add_f32 v18, v18, v58
v_add_f32 v18, v18, v59
v_mfma_f32_16x16x32_bf16 v[48:51], a[196:199], v[96:99], v[48:51]
v_exp_f32 v60, v60
v_mfma_f32_16x16x32_bf16 v[48:51], a[200:203], v[128:131], v[48:51]
s_waitcnt lgkmcnt(9)
v_cvt_pk_bf16_f32 v179, v58, v59
v_add_f32 v19, v19, v60
v_mfma_f32_16x16x32_bf16 v[48:51], a[204:207], v[160:163], v[48:51]
s_add_u32 m0, s94, 146432
v_exp_f32 v61, v61
v_mfma_f32_16x16x32_bf16 v[48:51], a[208:211], v[192:195], v[48:51]
v_exp_f32 v62, v62
v_mfma_f32_16x16x32_bf16 v[48:51], a[212:215], v[224:227], v[48:51]
ds_read_b128 a[224:227], v2 offset:19456
v_add_f32 v19, v19, v61
v_mfma_f32_16x16x32_bf16 a[60:63], a[240:243], v[120:123], a[60:63]
buffer_load_dwordx4 v24, s[48:51], s92 offen  lds
v_mfma_f32_16x16x32_bf16 a[60:63], a[244:247], v[124:127], a[60:63]
s_waitcnt lgkmcnt(7)
v_exp_f32 v63, v63
v_mfma_f32_16x16x32_bf16 a[64:67], a[248:251], v[80:83], a[64:67]
ds_read_b64_tr_b16 a[240:241], v6 offset:1024
v_cvt_pk_bf16_f32 v186, v60, v61
v_mfma_f32_16x16x32_bf16 a[64:67], a[252:255], v[84:87], a[64:67]
ds_read_b64_tr_b16 a[242:243], v6 offset:7168
v_add_f32 v19, v19, v62
v_mfma_f32_16x16x32_bf16 a[68:71], a[248:251], v[88:91], a[68:71]
ds_read_b64_tr_b16 a[244:245], v6 offset:13312
v_add_f32 v19, v19, v63
v_mfma_f32_16x16x32_bf16 a[68:71], a[252:255], v[92:95], a[68:71]
ds_read_b64_tr_b16 a[246:247], v6 offset:19456
v_cvt_pk_bf16_f32 v187, v62, v63
v_mfma_f32_16x16x32_bf16 v[52:55], a[192:195], v[68:71], v[36:39]
ds_read_b128 a[228:231], v3 offset:19456
v_mfma_f32_16x16x32_bf16 v[52:55], a[196:199], v[100:103], v[52:55]
s_add_u32 m0, s94, 147456
v_exp_f32 v48, v48
v_mfma_f32_16x16x32_bf16 v[52:55], a[200:203], v[132:135], v[52:55]
v_exp_f32 v49, v49
v_mfma_f32_16x16x32_bf16 v[52:55], a[204:207], v[164:167], v[52:55]
v_exp_f32 v50, v50
v_mfma_f32_16x16x32_bf16 v[52:55], a[208:211], v[196:199], v[52:55]
buffer_load_dwordx4 v25, s[48:51], s92 offen  lds
v_mfma_f32_16x16x32_bf16 v[52:55], a[212:215], v[228:231], v[52:55]
ds_read_b128 a[232:235], v2 offset:20480
v_add_f32 v16, v16, v48
v_mfma_f32_16x16x32_bf16 a[72:75], a[248:251], v[112:115], a[72:75]
v_exp_f32 v51, v51
v_mfma_f32_16x16x32_bf16 a[72:75], a[252:255], v[116:119], a[72:75]
v_add_f32 v16, v16, v49
v_cvt_pk_bf16_f32 v148, v48, v49
v_mfma_f32_16x16x32_bf16 a[76:79], a[248:251], v[120:123], a[76:79]
v_add_f32 v16, v16, v50
v_add_f32 v16, v16, v51
v_mfma_f32_16x16x32_bf16 a[76:79], a[252:255], v[124:127], a[76:79]
s_waitcnt lgkmcnt(9)
ds_read_b64_tr_b16 a[248:249], v7 offset:1024
v_mfma_f32_16x16x32_bf16 a[80:83], v[216:219], v[80:83], a[80:83]
ds_read_b64_tr_b16 a[250:251], v7 offset:7168
v_cvt_pk_bf16_f32 v149, v50, v51
v_mfma_f32_16x16x32_bf16 a[80:83], v[220:223], v[84:87], a[80:83]
s_add_u32 s92, s96, 163840
s_add_u32 m0, s94, 0
v_mfma_f32_16x16x32_bf16 v[56:59], a[192:195], v[72:75], v[40:43]
ds_read_b128 a[236:239], v3 offset:20480
v_mfma_f32_16x16x32_bf16 v[56:59], a[196:199], v[104:107], v[56:59]
ds_read_b64_tr_b16 a[252:253], v7 offset:13312
v_mfma_f32_16x16x32_bf16 v[56:59], a[200:203], v[136:139], v[56:59]
buffer_load_dwordx4 v21, s[48:51], s92 offen  lds
v_mfma_f32_16x16x32_bf16 v[56:59], a[204:207], v[168:171], v[56:59]
ds_read_b64_tr_b16 a[254:255], v7 offset:19456
v_mfma_f32_16x16x32_bf16 v[56:59], a[208:211], v[200:203], v[56:59]
v_exp_f32 v52, v52
v_mfma_f32_16x16x32_bf16 v[56:59], a[212:215], v[232:235], v[56:59]
v_exp_f32 v53, v53
v_mfma_f32_16x16x32_bf16 a[84:87], v[216:219], v[88:91], a[84:87]
v_exp_f32 v54, v54
v_mfma_f32_16x16x32_bf16 a[84:87], v[220:223], v[92:95], a[84:87]
v_exp_f32 v55, v55
v_mfma_f32_16x16x32_bf16 a[88:91], v[216:219], v[112:115], a[88:91]
v_add_f32 v17, v17, v52
v_add_f32 v17, v17, v53
v_mfma_f32_16x16x32_bf16 a[88:91], v[220:223], v[116:119], a[88:91]
s_add_u32 m0, s94, 1024
v_cvt_pk_bf16_f32 v156, v52, v53
v_add_f32 v17, v17, v54
v_mfma_f32_16x16x32_bf16 a[92:95], v[216:219], v[120:123], a[92:95]
v_add_f32 v17, v17, v55
v_cvt_pk_bf16_f32 v157, v54, v55
v_mfma_f32_16x16x32_bf16 a[92:95], v[220:223], v[124:127], a[92:95]
ds_read_b64_tr_b16 v[216:217], v4 offset:2048
v_mfma_f32_16x16x32_bf16 v[60:63], a[192:195], v[76:79], v[44:47]
buffer_load_dwordx4 v22, s[48:51], s92 offen  lds
v_mfma_f32_16x16x32_bf16 v[60:63], a[196:199], v[108:111], v[60:63]
ds_read_b64_tr_b16 v[218:219], v4 offset:8192
v_mfma_f32_16x16x32_bf16 v[60:63], a[200:203], v[140:143], v[60:63]
ds_read_b64_tr_b16 v[220:221], v4 offset:14336
v_mfma_f32_16x16x32_bf16 v[60:63], a[204:207], v[172:175], v[60:63]
v_exp_f32 v56, v56
v_mfma_f32_16x16x32_bf16 v[60:63], a[208:211], v[204:207], v[60:63]
ds_read_b64_tr_b16 v[222:223], v4 offset:20480
v_add_f32 v18, v18, v56
v_mfma_f32_16x16x32_bf16 v[60:63], a[212:215], v[236:239], v[60:63]
s_waitcnt lgkmcnt(11)
v_exp_f32 v57, v57
v_mfma_f32_16x16x32_bf16 a[96:99], a[240:243], v[80:83], a[96:99]
v_exp_f32 v58, v58
v_mfma_f32_16x16x32_bf16 a[96:99], a[244:247], v[84:87], a[96:99]
s_add_u32 m0, s94, 2048
v_exp_f32 v59, v59
v_mfma_f32_16x16x32_bf16 a[100:103], a[240:243], v[88:91], a[100:103]
v_add_f32 v18, v18, v57
v_cvt_pk_bf16_f32 v180, v56, v57
v_mfma_f32_16x16x32_bf16 a[100:103], a[244:247], v[92:95], a[100:103]
v_add_f32 v18, v18, v58
v_add_f32 v18, v18, v59
v_mfma_f32_16x16x32_bf16 a[104:107], a[240:243], v[112:115], a[104:107]
buffer_load_dwordx4 v23, s[48:51], s92 offen  lds
v_mfma_f32_16x16x32_bf16 a[104:107], a[244:247], v[116:119], a[104:107]
v_exp_f32 v60, v60
v_mfma_f32_16x16x32_bf16 v[48:51], a[216:219], v[64:67], v[32:35]
v_cvt_pk_bf16_f32 v181, v58, v59
v_add_f32 v19, v19, v60
v_mfma_f32_16x16x32_bf16 v[48:51], a[220:223], v[96:99], v[48:51]
v_exp_f32 v61, v61
v_mfma_f32_16x16x32_bf16 v[48:51], a[224:227], v[128:131], v[48:51]
s_waitcnt lgkmcnt(6)
v_exp_f32 v62, v62
v_mfma_f32_16x16x32_bf16 v[48:51], a[228:231], v[160:163], v[48:51]
v_exp_f32 v63, v63
v_mfma_f32_16x16x32_bf16 v[48:51], a[232:235], v[192:195], v[48:51]
v_add_f32 v19, v19, v61
v_cvt_pk_bf16_f32 v188, v60, v61
v_mfma_f32_16x16x32_bf16 v[48:51], a[236:239], v[224:227], v[48:51]
s_add_u32 m0, s94, 3072
v_add_f32 v19, v19, v62
v_add_f32 v19, v19, v63
v_mfma_f32_16x16x32_bf16 a[108:111], a[240:243], v[120:123], a[108:111]
v_cvt_pk_bf16_f32 v189, v62, v63
v_mfma_f32_16x16x32_bf16 a[108:111], a[244:247], v[124:127], a[108:111]
s_waitcnt lgkmcnt(4)
ds_read_b64_tr_b16 a[240:241], v5 offset:2048
v_mfma_f32_16x16x32_bf16 a[112:115], a[248:251], v[80:83], a[112:115]
buffer_load_dwordx4 v24, s[48:51], s92 offen  lds
v_mfma_f32_16x16x32_bf16 a[112:115], a[252:255], v[84:87], a[112:115]
ds_read_b64_tr_b16 a[242:243], v5 offset:8192
v_mfma_f32_16x16x32_bf16 a[116:119], a[248:251], v[88:91], a[116:119]
ds_read_b64_tr_b16 a[244:245], v5 offset:14336
v_mfma_f32_16x16x32_bf16 a[116:119], a[252:255], v[92:95], a[116:119]
ds_read_b64_tr_b16 a[246:247], v5 offset:20480
v_mfma_f32_16x16x32_bf16 v[52:55], a[216:219], v[68:71], v[36:39]
v_exp_f32 v48, v48
v_mfma_f32_16x16x32_bf16 v[52:55], a[220:223], v[100:103], v[52:55]
v_exp_f32 v49, v49
v_mfma_f32_16x16x32_bf16 v[52:55], a[224:227], v[132:135], v[52:55]
v_exp_f32 v50, v50
v_mfma_f32_16x16x32_bf16 v[52:55], a[228:231], v[164:167], v[52:55]
s_add_u32 m0, s94, 4096
v_exp_f32 v51, v51
v_mfma_f32_16x16x32_bf16 v[52:55], a[232:235], v[196:199], v[52:55]
v_add_f32 v16, v16, v48
v_add_f32 v16, v16, v49
v_mfma_f32_16x16x32_bf16 v[52:55], a[236:239], v[228:231], v[52:55]
v_cvt_pk_bf16_f32 v150, v48, v49
v_add_f32 v16, v16, v50
v_mfma_f32_16x16x32_bf16 a[120:123], a[248:251], v[112:115], a[120:123]
buffer_load_dwordx4 v25, s[48:51], s92 offen  lds
v_mfma_f32_16x16x32_bf16 a[120:123], a[252:255], v[116:119], a[120:123]
v_add_f32 v16, v16, v51
v_cvt_pk_bf16_f32 v151, v50, v51
v_mfma_f32_16x16x32_bf16 a[124:127], a[248:251], v[120:123], a[124:127]
v_exp_f32 v52, v52
v_mfma_f32_16x16x32_bf16 a[124:127], a[252:255], v[124:127], a[124:127]
s_waitcnt lgkmcnt(4)
ds_read_b64_tr_b16 a[248:249], v6 offset:2048
v_mfma_f32_16x16x32_bf16 a[128:131], v[216:219], v[80:83], a[128:131]
ds_read_b64_tr_b16 a[250:251], v6 offset:8192
v_add_f32 v17, v17, v52
v_mfma_f32_16x16x32_bf16 a[128:131], v[220:223], v[84:87], a[128:131]
ds_read_b64_tr_b16 a[252:253], v6 offset:14336
v_mfma_f32_16x16x32_bf16 v[56:59], a[216:219], v[72:75], v[40:43]
ds_read_b64_tr_b16 a[254:255], v6 offset:20480
v_mfma_f32_16x16x32_bf16 v[56:59], a[220:223], v[104:107], v[56:59]
v_exp_f32 v53, v53
v_mfma_f32_16x16x32_bf16 v[56:59], a[224:227], v[136:139], v[56:59]
v_exp_f32 v54, v54
v_mfma_f32_16x16x32_bf16 v[56:59], a[228:231], v[168:171], v[56:59]
v_exp_f32 v55, v55
v_mfma_f32_16x16x32_bf16 v[56:59], a[232:235], v[200:203], v[56:59]
v_add_f32 v17, v17, v53
v_cvt_pk_bf16_f32 v158, v52, v53
v_mfma_f32_16x16x32_bf16 v[56:59], a[236:239], v[232:235], v[56:59]
v_add_f32 v17, v17, v54
v_add_f32 v17, v17, v55
v_mfma_f32_16x16x32_bf16 a[132:135], v[216:219], v[88:91], a[132:135]
v_cvt_pk_bf16_f32 v159, v54, v55
v_mfma_f32_16x16x32_bf16 a[132:135], v[220:223], v[92:95], a[132:135]
v_mfma_f32_16x16x32_bf16 a[136:139], v[216:219], v[112:115], a[136:139]
v_mfma_f32_16x16x32_bf16 a[136:139], v[220:223], v[116:119], a[136:139]
v_mfma_f32_16x16x32_bf16 a[140:143], v[216:219], v[120:123], a[140:143]
v_exp_f32 v56, v56
v_mfma_f32_16x16x32_bf16 a[140:143], v[220:223], v[124:127], a[140:143]
ds_read_b64_tr_b16 v[216:217], v7 offset:2048
v_add_f32 v18, v18, v56
v_mfma_f32_16x16x32_bf16 v[60:63], a[216:219], v[76:79], v[44:47]
ds_read_b64_tr_b16 v[218:219], v7 offset:8192
v_mfma_f32_16x16x32_bf16 v[60:63], a[220:223], v[108:111], v[60:63]
ds_read_b64_tr_b16 v[220:221], v7 offset:14336
v_mfma_f32_16x16x32_bf16 v[60:63], a[224:227], v[140:143], v[60:63]
ds_read_b64_tr_b16 v[222:223], v7 offset:20480
v_mfma_f32_16x16x32_bf16 v[60:63], a[228:231], v[172:175], v[60:63]
v_exp_f32 v57, v57
v_mfma_f32_16x16x32_bf16 v[60:63], a[232:235], v[204:207], v[60:63]
v_exp_f32 v58, v58
v_mfma_f32_16x16x32_bf16 v[60:63], a[236:239], v[236:239], v[60:63]
s_waitcnt lgkmcnt(8)
v_exp_f32 v59, v59
v_mfma_f32_16x16x32_bf16 a[144:147], a[240:243], v[80:83], a[144:147]
v_add_f32 v18, v18, v57
v_cvt_pk_bf16_f32 v182, v56, v57
v_mfma_f32_16x16x32_bf16 a[144:147], a[244:247], v[84:87], a[144:147]
v_add_f32 v18, v18, v58
v_add_f32 v18, v18, v59
v_mfma_f32_16x16x32_bf16 a[148:151], a[240:243], v[88:91], a[148:151]
v_exp_f32 v60, v60
v_mfma_f32_16x16x32_bf16 a[148:151], a[244:247], v[92:95], a[148:151]
v_exp_f32 v61, v61
v_mfma_f32_16x16x32_bf16 a[152:155], a[240:243], v[112:115], a[152:155]
v_exp_f32 v62, v62
v_mfma_f32_16x16x32_bf16 a[152:155], a[244:247], v[116:119], a[152:155]
s_waitcnt vmcnt(15) lgkmcnt(0)
v_exp_f32 v63, v63
v_mfma_f32_16x16x32_bf16 a[156:159], a[240:243], v[120:123], a[156:159]
v_cvt_pk_bf16_f32 v183, v58, v59
v_add_f32 v19, v19, v60
v_mfma_f32_16x16x32_bf16 a[156:159], a[244:247], v[124:127], a[156:159]
s_barrier
v_mfma_f32_16x16x32_bf16 a[160:163], a[248:251], v[80:83], a[160:163]
v_add_u32 v2, s38, v2
v_add_u32 v3, s38, v3
v_mfma_f32_16x16x32_bf16 a[160:163], a[252:255], v[84:87], a[160:163]
ds_read_b128 a[192:195], v2 offset:0
v_add_u32 v4, s39, v4
v_mfma_f32_16x16x32_bf16 a[164:167], a[248:251], v[88:91], a[164:167]
ds_read_b128 a[196:199], v3 offset:0
v_add_f32 v19, v19, v61
v_mfma_f32_16x16x32_bf16 a[164:167], a[252:255], v[92:95], a[164:167]
ds_read_b128 a[200:203], v2 offset:1024
v_cvt_pk_bf16_f32 v190, v60, v61
v_mfma_f32_16x16x32_bf16 a[168:171], a[248:251], v[112:115], a[168:171]
ds_read_b128 a[204:207], v3 offset:1024
v_add_f32 v19, v19, v62
v_mfma_f32_16x16x32_bf16 a[168:171], a[252:255], v[116:119], a[168:171]
ds_read_b128 a[208:211], v2 offset:2048
v_add_f32 v19, v19, v63
v_mfma_f32_16x16x32_bf16 a[172:175], a[248:251], v[120:123], a[172:175]
ds_read_b128 a[212:215], v3 offset:2048
v_cvt_pk_bf16_f32 v191, v62, v63
v_mfma_f32_16x16x32_bf16 a[172:175], a[252:255], v[124:127], a[172:175]
ds_read_b64_tr_b16 a[240:241], v4 offset:0
v_add_u32 v5, s39, v5
v_mfma_f32_16x16x32_bf16 a[176:179], v[216:219], v[80:83], a[176:179]
ds_read_b64_tr_b16 a[242:243], v4 offset:6144
v_max3_f32 v240, v16, v17, v18
v_mfma_f32_16x16x32_bf16 a[176:179], v[220:223], v[84:87], a[176:179]
ds_read_b64_tr_b16 a[244:245], v4 offset:12288
v_add_u32 v6, s39, v6
v_mfma_f32_16x16x32_bf16 a[180:183], v[216:219], v[88:91], a[180:183]
ds_read_b64_tr_b16 a[246:247], v4 offset:18432
v_max_f32 v240, v240, v19
v_mfma_f32_16x16x32_bf16 a[180:183], v[220:223], v[92:95], a[180:183]
v_add_u32 v7, s39, v7
v_cmp_lt_f32 vcc, s36, v240
v_mfma_f32_16x16x32_bf16 a[184:187], v[216:219], v[112:115], a[184:187]
v_mfma_f32_16x16x32_bf16 a[184:187], v[220:223], v[116:119], a[184:187]
v_mfma_f32_16x16x32_bf16 a[188:191], v[216:219], v[120:123], a[188:191]
v_mfma_f32_16x16x32_bf16 a[188:191], v[220:223], v[124:127], a[188:191]
s_cbranch_vccnz L_stub_s30
L_ret_s30:
L_al_on6:
s_waitcnt lgkmcnt(0)
v_mfma_f32_16x16x32_bf16 a[0:3], a[240:243], v[144:147], a[0:3]
ds_read_b64_tr_b16 a[248:249], v5 offset:0
ds_read_b64_tr_b16 a[250:251], v5 offset:6144
ds_read_b64_tr_b16 a[252:253], v5 offset:12288
v_add_f32 v12, v12, v16
v_mfma_f32_16x16x32_bf16 a[0:3], a[244:247], v[148:151], a[0:3]
s_add_u32 s92, s97, 0
s_add_u32 m0, s94, 20480
ds_read_b64_tr_b16 a[254:255], v5 offset:18432
ds_read_b64_tr_b16 v[216:217], v6 offset:0
v_add_f32 v13, v13, v17
v_mfma_f32_16x16x32_bf16 a[4:7], a[240:243], v[152:155], a[4:7]
ds_read_b64_tr_b16 v[218:219], v6 offset:6144
ds_read_b64_tr_b16 v[220:221], v6 offset:12288
ds_read_b64_tr_b16 v[222:223], v6 offset:18432
v_add_f32 v14, v14, v18
v_mfma_f32_16x16x32_bf16 a[4:7], a[244:247], v[156:159], a[4:7]
s_and_b32 s8, s2, 7
s_lshr_b32 s6, s2, 3
s_and_b32 s10, s6, 3
buffer_load_dwordx4 v21, s[48:51], s92 offen  lds
v_add_f32_e64 v15, v15, v19
v_mfma_f32_16x16x32_bf16 a[8:11], a[240:243], v[176:179], a[8:11]
s_lshr_b32 s9, s6, 2
s_lshl_b32 s11, s9, 2
s_add_u32 s11, s11, s28
s_lshl_b32 s16, s11, 7
s_add_u32 s16, s16, 65536
s_lshl_b32 s7, s8, 2
v_mfma_f32_16x16x32_bf16 a[8:11], a[244:247], v[180:183], a[8:11]
s_add_u32 s16, s16, s7
s_lshl_b32 s17, s8, 12
s_lshl_b32 s7, s11, 7
s_add_u32 s17, s17, s7
s_add_u32 s17, s17, 32768
s_lshl_b32 s11, s11, 2
v_mfma_f32_16x16x32_bf16 a[12:15], a[240:243], v[184:187], a[12:15]
s_add_u32 s7, s10, 0
s_and_b32 s7, s7, 3
s_mul_i32 s32, s7, 6144
s_add_u32 s7, s10, 1
s_and_b32 s7, s7, 3
s_add_u32 m0, s94, 21504
v_mfma_f32_16x16x32_bf16 a[12:15], a[244:247], v[188:191], a[12:15]
s_waitcnt lgkmcnt(4)
ds_read_b64_tr_b16 a[240:241], v7 offset:0
ds_read_b64_tr_b16 a[242:243], v7 offset:6144
ds_read_b64_tr_b16 a[244:245], v7 offset:12288
v_mfma_f32_16x16x32_bf16 a[16:19], a[248:251], v[144:147], a[16:19]
s_mul_i32 s33, s7, 6144
s_add_u32 s7, s10, 2
s_and_b32 s7, s7, 3
s_mul_i32 s34, s7, 6144
s_add_u32 s7, s10, 3
ds_read_b64_tr_b16 a[246:247], v7 offset:18432
v_mfma_f32_16x16x32_bf16 a[16:19], a[252:255], v[148:151], a[16:19]
s_and_b32 s7, s7, 3
s_mul_i32 s35, s7, 6144
s_mul_i32 s3, s11, 196608
s_mul_i32 s7, s8, 24576
buffer_load_dwordx4 v22, s[48:51], s92 offen  lds
v_mfma_f32_16x16x32_bf16 a[20:23], a[248:251], v[152:155], a[20:23]
s_add_u32 s3, s3, s7
s_add_u32 s3, s3, 67108864
s_add_u32 s72, s4, s3
s_addc_u32 s73, s5, 0
s_mov_b32 s74, 614400
s_mov_b32 s75, 0x20000
s_mul_i32 s3, s8, 2621440
v_mfma_f32_16x16x32_bf16 a[20:23], a[252:255], v[156:159], a[20:23]
s_add_u32 s3, s3, 33554432
s_add_u32 s76, s4, s3
s_addc_u32 s77, s5, 0
s_mov_b32 s78, 2621440
s_mov_b32 s79, 0x20000
s_mul_i32 s36, s11, 20480
s_mul_i32 s3, s10, 5120
v_mfma_f32_16x16x32_bf16 a[24:27], a[248:251], v[176:179], a[24:27]
s_add_u32 s36, s36, s3
s_add_u32 s37, s36, 20480
s_add_u32 s38, s36, 40960
s_add_u32 s39, s36, 61440
s_add_u32 s52, s4, 27262976
s_addc_u32 s53, s5, 0
s_add_u32 m0, s94, 22528
v_mfma_f32_16x16x32_bf16 a[24:27], a[252:255], v[180:183], a[24:27]
s_mov_b32 s54, 819200
s_mov_b32 s55, 0x20000
s_add_u32 s56, s4, 28082176
s_addc_u32 s57, s5, 0
s_mov_b32 s58, 819200
s_mov_b32 s59, 0x20000
v_add_u32 v16, 4096, v11
v_mfma_f32_16x16x32_bf16 a[28:31], a[248:251], v[184:187], a[28:31]
s_add_u32 s60, s4, 28901376
s_addc_u32 s61, s5, 0
s_mov_b32 s62, 1966080
s_mov_b32 s63, 0x20000
v_mov_b32 v32, v12
v_mov_b32 v33, v13
v_mov_b32 v34, v14
v_mfma_f32_16x16x32_bf16 a[28:31], a[252:255], v[188:191], a[28:31]
s_waitcnt lgkmcnt(4)
buffer_load_dwordx4 v23, s[48:51], s92 offen  lds
ds_read_b64_tr_b16 a[248:249], v4 offset:1024
v_mov_b32_e64 v35, v15
v_mfma_f32_16x16x32_bf16 a[32:35], v[216:219], v[144:147], a[32:35]
ds_read_b64_tr_b16 a[250:251], v4 offset:7168
ds_read_b64_tr_b16 a[252:253], v4 offset:13312
ds_read_b64_tr_b16 a[254:255], v4 offset:19456
v_permlane32_swap_b32 v12, v32
v_mfma_f32_16x16x32_bf16 a[32:35], v[220:223], v[148:151], a[32:35]
s_add_u32 s64, s4, 30867456
s_addc_u32 s65, s5, 0
s_mov_b32 s66, 1966080
s_mov_b32 s67, 0x20000
s_lshr_b32 s7, s2, 3
s_lshl_b32 s7, s7, 2
s_add_u32 s7, s7, s28
v_mfma_f32_16x16x32_bf16 a[36:39], v[216:219], v[152:155], a[36:39]
s_lshl_b32 s21, s7, 13
s_mov_b32 s82, 2621440
s_mov_b32 s83, 0x20000
s_add_u32 s84, s4, 0
s_addc_u32 s85, s5, 0
s_mov_b32 s86, 7680
s_add_u32 m0, s94, 23552
v_mfma_f32_16x16x32_bf16 a[36:39], v[220:223], v[156:159], a[36:39]
s_mov_b32 s87, 0x20000
s_add_u32 s18, s17, 229376
s_add_u32 s19, s17, 262144
s_add_u32 s20, s17, 294912
v_permlane32_swap_b32 v13, v33
v_permlane32_swap_b32 v14, v34
v_mfma_f32_16x16x32_bf16 a[40:43], v[216:219], v[176:179], a[40:43]
v_permlane32_swap_b32 v15, v35
v_add_f32 v12, v12, v32
v_add_f32 v13, v13, v33
v_add_f32 v14, v14, v34
v_add_f32 v15, v15, v35
v_mov_b32 v32, v12
v_mfma_f32_16x16x32_bf16 a[40:43], v[220:223], v[180:183], a[40:43]
buffer_load_dwordx4 v24, s[48:51], s92 offen  lds
v_mov_b32 v33, v13
v_mov_b32 v34, v14
v_mov_b32 v35, v15
v_permlane16_swap_b32 v12, v32
v_mfma_f32_16x16x32_bf16 a[44:47], v[216:219], v[184:187], a[44:47]
v_permlane16_swap_b32 v13, v33
v_permlane16_swap_b32 v14, v34
v_permlane16_swap_b32 v15, v35
v_add_f32 v12, v12, v32
v_add_f32_e64 v13, v13, v33
v_add_f32 v14, v14, v34
v_mfma_f32_16x16x32_bf16 a[44:47], v[220:223], v[188:191], a[44:47]
s_waitcnt lgkmcnt(4)
ds_read_b64_tr_b16 v[216:217], v5 offset:1024
ds_read_b64_tr_b16 v[218:219], v5 offset:7168
ds_read_b64_tr_b16 v[220:221], v5 offset:13312
v_mfma_f32_16x16x32_bf16 a[48:51], a[240:243], v[144:147], a[48:51]
s_add_u32 m0, s94, 24576
ds_read_b64_tr_b16 v[222:223], v5 offset:19456
v_add_f32 v15, v15, v35
v_rcp_f32 v56, v12
v_mfma_f32_16x16x32_bf16 a[48:51], a[244:247], v[148:151], a[48:51]
v_rcp_f32 v58, v13
v_rcp_f32 v60, v14
v_rcp_f32 v62, v15
v_mfma_f32_16x16x32_bf16 a[52:55], a[240:243], v[152:155], a[52:55]
v_mov_b32 v57, v56
v_mov_b32 v59, v58
v_mov_b32 v61, v60
v_mov_b32_e64 v63, v62
v_accvgpr_read_b32 v32, a0
v_accvgpr_read_b32 v33, a1
v_mfma_f32_16x16x32_bf16 a[52:55], a[244:247], v[156:159], a[52:55]
buffer_load_dwordx4 v25, s[48:51], s92 offen  lds
v_accvgpr_read_b32 v34, a2
v_accvgpr_read_b32 v35, a3
v_accvgpr_read_b32 v36, a16
v_accvgpr_read_b32 v37, a17
v_mfma_f32_16x16x32_bf16 a[56:59], a[240:243], v[176:179], a[56:59]
v_accvgpr_read_b32 v38, a18
v_accvgpr_read_b32 v39, a19
v_mul_f32 v32, v32, v56
v_mul_f32 v33, v33, v56
v_mul_f32 v34, v34, v56
v_mul_f32 v35, v35, v56
v_mfma_f32_16x16x32_bf16 a[56:59], a[244:247], v[180:183], a[56:59]
v_mul_f32 v36, v36, v56
v_mul_f32 v37, v37, v56
v_mul_f32 v38, v38, v56
v_mul_f32 v39, v39, v56
v_cvt_pk_bf16_f32 v32, v32, v33
v_cvt_pk_bf16_f32 v33, v34, v35
v_mfma_f32_16x16x32_bf16 a[60:63], a[240:243], v[184:187], a[60:63]
s_add_u32 s92, s98, 0
s_add_u32 m0, s94, 40960
v_cvt_pk_bf16_f32 v34, v36, v37
v_cvt_pk_bf16_f32 v35, v38, v39
v_accvgpr_write_b32 a0, v32
v_accvgpr_write_b32 a1, v33
v_accvgpr_write_b32 a2, v34
v_mfma_f32_16x16x32_bf16 a[60:63], a[244:247], v[188:191], a[60:63]
s_waitcnt lgkmcnt(4)
ds_read_b64_tr_b16 a[240:241], v6 offset:1024
ds_read_b64_tr_b16 a[242:243], v6 offset:7168
ds_read_b64_tr_b16 a[244:245], v6 offset:13312
v_mfma_f32_16x16x32_bf16 a[64:67], a[248:251], v[144:147], a[64:67]
ds_read_b64_tr_b16 a[246:247], v6 offset:19456
v_accvgpr_write_b32 a3, v35
buffer_store_dwordx4 a[0:3], v11, s[24:27], s42 offen offset:0 sc1
v_mfma_f32_16x16x32_bf16 a[64:67], a[252:255], v[148:151], a[64:67]
buffer_load_dwordx4 v21, s[48:51], s92 offen  lds
v_accvgpr_read_b32 v40, a4
v_accvgpr_read_b32 v41, a5
v_accvgpr_read_b32 v42, a6
v_accvgpr_read_b32 v43, a7
v_mfma_f32_16x16x32_bf16 a[68:71], a[248:251], v[152:155], a[68:71]
v_accvgpr_read_b32 v44, a20
v_accvgpr_read_b32 v45, a21
v_accvgpr_read_b32 v46, a22
v_accvgpr_read_b32 v47, a23
v_mul_f32 v40, v40, v58
v_mul_f32 v41, v41, v58
v_mfma_f32_16x16x32_bf16 a[68:71], a[252:255], v[156:159], a[68:71]
v_mul_f32 v42, v42, v58
v_mul_f32 v43, v43, v58
v_mul_f32 v44, v44, v58
v_mul_f32 v45, v45, v58
v_mul_f32 v46, v46, v58
v_mul_f32 v47, v47, v58
v_mfma_f32_16x16x32_bf16 a[72:75], a[248:251], v[176:179], a[72:75]
s_add_u32 m0, s94, 41984
v_cvt_pk_bf16_f32 v40, v40, v41
v_cvt_pk_bf16_f32 v41, v42, v43
v_cvt_pk_bf16_f32 v42, v44, v45
v_cvt_pk_bf16_f32 v43, v46, v47
v_accvgpr_write_b32 a4, v40
v_mfma_f32_16x16x32_bf16 a[72:75], a[252:255], v[180:183], a[72:75]
v_accvgpr_write_b32 a5, v41
v_accvgpr_write_b32 a6, v42
v_accvgpr_write_b32 a7, v43
v_mfma_f32_16x16x32_bf16 a[76:79], a[248:251], v[184:187], a[76:79]
buffer_store_dwordx4 a[4:7], v11, s[24:27], s43 offen offset:0 sc1
v_accvgpr_read_b32 v48, a8
v_accvgpr_read_b32 v49, a9
v_accvgpr_read_b32 v50, a10
v_accvgpr_read_b32 v51, a11
v_mfma_f32_16x16x32_bf16 a[76:79], a[252:255], v[188:191], a[76:79]
s_waitcnt lgkmcnt(4)
buffer_load_dwordx4 v22, s[48:51], s92 offen  lds
ds_read_b64_tr_b16 a[248:249], v7 offset:1024
v_accvgpr_read_b32 v52, a24
v_mfma_f32_16x16x32_bf16 a[80:83], v[216:219], v[144:147], a[80:83]
ds_read_b64_tr_b16 a[250:251], v7 offset:7168
ds_read_b64_tr_b16 a[252:253], v7 offset:13312
ds_read_b64_tr_b16 a[254:255], v7 offset:19456
v_accvgpr_read_b32 v53, a25
v_mfma_f32_16x16x32_bf16 a[80:83], v[220:223], v[148:151], a[80:83]
v_accvgpr_read_b32 v54, a26
v_accvgpr_read_b32 v55, a27
v_mul_f32 v48, v48, v60
v_mul_f32 v49, v49, v60
v_mul_f32 v50, v50, v60
v_mul_f32_e64 v51, v51, v60
v_mfma_f32_16x16x32_bf16 a[84:87], v[216:219], v[152:155], a[84:87]
s_add_u32 m0, s94, 43008
v_mul_f32 v52, v52, v60
v_mul_f32 v53, v53, v60
v_mul_f32 v54, v54, v60
v_mul_f32 v55, v55, v60
v_cvt_pk_bf16_f32 v48, v48, v49
v_mfma_f32_16x16x32_bf16 a[84:87], v[220:223], v[156:159], a[84:87]
v_cvt_pk_bf16_f32 v49, v50, v51
v_cvt_pk_bf16_f32 v50, v52, v53
v_cvt_pk_bf16_f32 v51, v54, v55
v_accvgpr_write_b32 a8, v48
v_accvgpr_write_b32 a9, v49
v_accvgpr_write_b32 a10, v50
v_mfma_f32_16x16x32_bf16 a[88:91], v[216:219], v[176:179], a[88:91]
v_accvgpr_write_b32 a11, v51
buffer_store_dwordx4 a[8:11], v11, s[24:27], s44 offen offset:0 sc1
v_accvgpr_read_b32 v32, a12
v_mfma_f32_16x16x32_bf16 a[88:91], v[220:223], v[180:183], a[88:91]
buffer_load_dwordx4 v23, s[48:51], s92 offen  lds
v_accvgpr_read_b32 v33, a13
v_accvgpr_read_b32 v34, a14
v_accvgpr_read_b32 v35, a15
v_accvgpr_read_b32 v36, a28
v_mfma_f32_16x16x32_bf16 a[92:95], v[216:219], v[184:187], a[92:95]
v_accvgpr_read_b32 v37, a29
v_accvgpr_read_b32 v38, a30
v_accvgpr_read_b32 v39, a31
v_mul_f32 v32, v32, v62
v_mul_f32 v33, v33, v62
v_mul_f32 v34, v34, v62
v_mfma_f32_16x16x32_bf16 a[92:95], v[220:223], v[188:191], a[92:95]
s_waitcnt lgkmcnt(4)
ds_read_b64_tr_b16 v[216:217], v4 offset:2048
ds_read_b64_tr_b16 v[218:219], v4 offset:8192
ds_read_b64_tr_b16 v[220:221], v4 offset:14336
v_mfma_f32_16x16x32_bf16 a[96:99], a[240:243], v[144:147], a[96:99]
s_add_u32 m0, s94, 44032
ds_read_b64_tr_b16 v[222:223], v4 offset:20480
v_mul_f32 v35, v35, v62
v_mul_f32 v36, v36, v62
v_mul_f32 v37, v37, v62
v_mul_f32 v38, v38, v62
v_mfma_f32_16x16x32_bf16 a[96:99], a[244:247], v[148:151], a[96:99]
v_mul_f32_e64 v39, v39, v62
v_cvt_pk_bf16_f32 v32, v32, v33
v_cvt_pk_bf16_f32 v33, v34, v35
v_cvt_pk_bf16_f32 v34, v36, v37
v_cvt_pk_bf16_f32 v35, v38, v39
v_accvgpr_write_b32 a12, v32
v_mfma_f32_16x16x32_bf16 a[100:103], a[240:243], v[152:155], a[100:103]
v_accvgpr_write_b32 a13, v33
v_accvgpr_write_b32 a14, v34
v_accvgpr_write_b32 a15, v35
v_mfma_f32_16x16x32_bf16 a[100:103], a[244:247], v[156:159], a[100:103]
buffer_load_dwordx4 v24, s[48:51], s92 offen  lds
buffer_store_dwordx4 a[12:15], v11, s[24:27], s45 offen offset:0 sc1
v_accvgpr_read_b32 v40, a32
v_mfma_f32_16x16x32_bf16 a[104:107], a[240:243], v[176:179], a[104:107]
v_accvgpr_read_b32 v41, a33
v_accvgpr_read_b32 v42, a34
v_accvgpr_read_b32 v43, a35
v_accvgpr_read_b32 v44, a48
v_accvgpr_read_b32 v45, a49
v_accvgpr_read_b32 v46, a50
v_mfma_f32_16x16x32_bf16 a[104:107], a[244:247], v[180:183], a[104:107]
v_accvgpr_read_b32 v47, a51
v_mul_f32 v40, v40, v56
v_mul_f32 v41, v41, v56
v_mul_f32 v42, v42, v56
v_mul_f32 v43, v43, v56
v_mul_f32_e64 v44, v44, v56
v_mfma_f32_16x16x32_bf16 a[108:111], a[240:243], v[184:187], a[108:111]
s_add_u32 m0, s94, 45056
v_mul_f32 v45, v45, v56
v_mul_f32 v46, v46, v56
v_mul_f32 v47, v47, v56
v_cvt_pk_bf16_f32 v40, v40, v41
v_cvt_pk_bf16_f32 v41, v42, v43
v_mfma_f32_16x16x32_bf16 a[108:111], a[244:247], v[188:191], a[108:111]
s_waitcnt lgkmcnt(4)
ds_read_b64_tr_b16 a[240:241], v5 offset:2048
ds_read_b64_tr_b16 a[242:243], v5 offset:8192
ds_read_b64_tr_b16 a[244:245], v5 offset:14336
v_mfma_f32_16x16x32_bf16 a[112:115], a[248:251], v[144:147], a[112:115]
ds_read_b64_tr_b16 a[246:247], v5 offset:20480
v_cvt_pk_bf16_f32 v42, v44, v45
v_cvt_pk_bf16_f32 v43, v46, v47
v_accvgpr_write_b32 a32, v40
v_accvgpr_write_b32 a33, v41
v_accvgpr_write_b32 a34, v42
v_mfma_f32_16x16x32_bf16 a[112:115], a[252:255], v[148:151], a[112:115]
buffer_load_dwordx4 v25, s[48:51], s92 offen  lds
v_accvgpr_write_b32 a35, v43
v_mfma_f32_16x16x32_bf16 a[116:119], a[248:251], v[152:155], a[116:119]
buffer_store_dwordx4 a[32:35], v11, s[24:27], s42 offen offset:1024 sc1
v_accvgpr_read_b32 v48, a36
v_accvgpr_read_b32 v49, a37
v_accvgpr_read_b32 v50, a38
v_accvgpr_read_b32 v51, a39
v_mfma_f32_16x16x32_bf16 a[116:119], a[252:255], v[156:159], a[116:119]
v_accvgpr_read_b32 v52, a52
v_accvgpr_read_b32 v53, a53
v_accvgpr_read_b32 v54, a54
v_accvgpr_read_b32 v55, a55
v_mul_f32 v48, v48, v58
v_mul_f32 v49, v49, v58
v_mfma_f32_16x16x32_bf16 a[120:123], a[248:251], v[176:179], a[120:123]
s_add_u32 s92, s99, 0
s_add_u32 m0, s94, 61440
v_mul_f32 v50, v50, v58
v_mul_f32 v51, v51, v58
v_mul_f32 v52, v52, v58
v_mul_f32 v53, v53, v58
v_mul_f32 v54, v54, v58
v_mfma_f32_16x16x32_bf16 a[120:123], a[252:255], v[180:183], a[120:123]
v_mul_f32 v55, v55, v58
v_cvt_pk_bf16_f32 v48, v48, v49
v_cvt_pk_bf16_f32 v49, v50, v51
v_cvt_pk_bf16_f32 v50, v52, v53
v_cvt_pk_bf16_f32 v51, v54, v55
v_accvgpr_write_b32 a36, v48
v_mfma_f32_16x16x32_bf16 a[124:127], a[248:251], v[184:187], a[124:127]
v_accvgpr_write_b32 a37, v49
v_accvgpr_write_b32 a38, v50
v_accvgpr_write_b32 a39, v51
v_mfma_f32_16x16x32_bf16 a[124:127], a[252:255], v[188:191], a[124:127]
s_waitcnt lgkmcnt(4)
buffer_load_dwordx4 v21, s[48:51], s92 offen  lds
ds_read_b64_tr_b16 a[248:249], v6 offset:2048
v_mfma_f32_16x16x32_bf16 a[128:131], v[216:219], v[144:147], a[128:131]
ds_read_b64_tr_b16 a[250:251], v6 offset:8192
ds_read_b64_tr_b16 a[252:253], v6 offset:14336
ds_read_b64_tr_b16 a[254:255], v6 offset:20480
v_mfma_f32_16x16x32_bf16 a[128:131], v[220:223], v[148:151], a[128:131]
buffer_store_dwordx4 a[36:39], v11, s[24:27], s43 offen offset:1024 sc1
v_accvgpr_read_b32 v32, a40
v_accvgpr_read_b32 v33, a41
v_accvgpr_read_b32 v34, a42
v_accvgpr_read_b32 v35, a43
v_mfma_f32_16x16x32_bf16 a[132:135], v[216:219], v[152:155], a[132:135]
s_add_u32 m0, s94, 62464
v_accvgpr_read_b32 v36, a56
v_accvgpr_read_b32 v37, a57
v_accvgpr_read_b32 v38, a58
v_accvgpr_read_b32 v39, a59
v_mul_f32_e64 v32, v32, v60
v_mfma_f32_16x16x32_bf16 a[132:135], v[220:223], v[156:159], a[132:135]
v_mul_f32 v33, v33, v60
v_mul_f32 v34, v34, v60
v_mul_f32 v35, v35, v60
v_mul_f32 v36, v36, v60
v_mul_f32 v37, v37, v60
v_mul_f32 v38, v38, v60
v_mfma_f32_16x16x32_bf16 a[136:139], v[216:219], v[176:179], a[136:139]
v_mul_f32_e64 v39, v39, v60
v_cvt_pk_bf16_f32 v32, v32, v33
v_cvt_pk_bf16_f32 v33, v34, v35
v_cvt_pk_bf16_f32 v34, v36, v37
v_cvt_pk_bf16_f32 v35, v38, v39
v_accvgpr_write_b32 a40, v32
v_mfma_f32_16x16x32_bf16 a[136:139], v[220:223], v[180:183], a[136:139]
buffer_load_dwordx4 v22, s[48:51], s92 offen  lds
v_accvgpr_write_b32 a41, v33
v_accvgpr_write_b32 a42, v34
v_accvgpr_write_b32 a43, v35
v_mfma_f32_16x16x32_bf16 a[140:143], v[216:219], v[184:187], a[140:143]
buffer_store_dwordx4 a[40:43], v11, s[24:27], s44 offen offset:1024 sc1
v_accvgpr_read_b32 v40, a44
v_accvgpr_read_b32 v41, a45
v_accvgpr_read_b32 v42, a46
v_accvgpr_read_b32 v43, a47
v_mfma_f32_16x16x32_bf16 a[140:143], v[220:223], v[188:191], a[140:143]
s_waitcnt lgkmcnt(4)
ds_read_b64_tr_b16 v[216:217], v7 offset:2048
ds_read_b64_tr_b16 v[218:219], v7 offset:8192
ds_read_b64_tr_b16 v[220:221], v7 offset:14336
v_mfma_f32_16x16x32_bf16 a[144:147], a[240:243], v[144:147], a[144:147]
s_add_u32 m0, s94, 63488
ds_read_b64_tr_b16 v[222:223], v7 offset:20480
v_accvgpr_read_b32 v44, a60
v_accvgpr_read_b32 v45, a61
v_accvgpr_read_b32 v46, a62
v_accvgpr_read_b32 v47, a63
v_mfma_f32_16x16x32_bf16 a[144:147], a[244:247], v[148:151], a[144:147]
v_mul_f32 v40, v40, v62
v_mul_f32 v41, v41, v62
v_mul_f32 v42, v42, v62
v_mul_f32 v43, v43, v62
v_mul_f32 v44, v44, v62
v_mul_f32_e64 v45, v45, v62
v_mfma_f32_16x16x32_bf16 a[148:151], a[240:243], v[152:155], a[148:151]
v_mul_f32 v46, v46, v62
v_mul_f32 v47, v47, v62
v_cvt_pk_bf16_f32 v40, v40, v41
v_cvt_pk_bf16_f32 v41, v42, v43
v_cvt_pk_bf16_f32 v42, v44, v45
v_cvt_pk_bf16_f32 v43, v46, v47
v_mfma_f32_16x16x32_bf16 a[148:151], a[244:247], v[156:159], a[148:151]
buffer_load_dwordx4 v23, s[48:51], s92 offen  lds
v_accvgpr_write_b32 a44, v40
v_accvgpr_write_b32 a45, v41
v_accvgpr_write_b32 a46, v42
v_accvgpr_write_b32 a47, v43
v_mfma_f32_16x16x32_bf16 a[152:155], a[240:243], v[176:179], a[152:155]
buffer_store_dwordx4 a[44:47], v11, s[24:27], s45 offen offset:1024 sc1
v_accvgpr_read_b32 v48, a64
v_accvgpr_read_b32 v49, a65
v_accvgpr_read_b32 v50, a66
v_accvgpr_read_b32 v51, a67
v_mfma_f32_16x16x32_bf16 a[152:155], a[244:247], v[180:183], a[152:155]
v_accvgpr_read_b32 v52, a80
v_accvgpr_read_b32 v53, a81
v_accvgpr_read_b32 v54, a82
v_accvgpr_read_b32 v55, a83
v_mul_f32 v48, v48, v56
v_mul_f32 v49, v49, v56
v_mfma_f32_16x16x32_bf16 a[156:159], a[240:243], v[184:187], a[156:159]
s_add_u32 m0, s94, 64512
v_mul_f32 v50, v50, v56
v_mul_f32 v51, v51, v56
v_mul_f32 v52, v52, v56
v_mul_f32 v53, v53, v56
v_mul_f32_e64 v54, v54, v56
v_mfma_f32_16x16x32_bf16 a[156:159], a[244:247], v[188:191], a[156:159]
s_waitcnt lgkmcnt(4)
v_mul_f32 v55, v55, v56
v_cvt_pk_bf16_f32 v48, v48, v49
v_cvt_pk_bf16_f32 v49, v50, v51
v_cvt_pk_bf16_f32 v50, v52, v53
v_cvt_pk_bf16_f32 v51, v54, v55
v_accvgpr_write_b32 a64, v48
v_mfma_f32_16x16x32_bf16 a[160:163], a[248:251], v[144:147], a[160:163]
v_accvgpr_write_b32 a65, v49
v_accvgpr_write_b32 a66, v50
v_accvgpr_write_b32 a67, v51
v_mfma_f32_16x16x32_bf16 a[160:163], a[252:255], v[148:151], a[160:163]
buffer_load_dwordx4 v24, s[48:51], s92 offen  lds
buffer_store_dwordx4 a[64:67], v11, s[24:27], s42 offen offset:2048 sc1
v_accvgpr_read_b32 v32, a68
v_mfma_f32_16x16x32_bf16 a[164:167], a[248:251], v[152:155], a[164:167]
v_accvgpr_read_b32 v33, a69
v_accvgpr_read_b32 v34, a70
v_accvgpr_read_b32 v35, a71
v_accvgpr_read_b32 v36, a84
v_accvgpr_read_b32 v37, a85
v_accvgpr_read_b32 v38, a86
v_mfma_f32_16x16x32_bf16 a[164:167], a[252:255], v[156:159], a[164:167]
v_accvgpr_read_b32 v39, a87
v_mul_f32 v32, v32, v58
v_mul_f32 v33, v33, v58
v_mul_f32 v34, v34, v58
v_mul_f32 v35, v35, v58
v_mul_f32_e64 v36, v36, v58
v_mfma_f32_16x16x32_bf16 a[168:171], a[248:251], v[176:179], a[168:171]
s_add_u32 m0, s94, 65536
v_mul_f32 v37, v37, v58
v_mul_f32 v38, v38, v58
v_mul_f32_e64 v39, v39, v58
v_cvt_pk_bf16_f32 v32, v32, v33
v_cvt_pk_bf16_f32 v33, v34, v35
v_mfma_f32_16x16x32_bf16 a[168:171], a[252:255], v[180:183], a[168:171]
v_cvt_pk_bf16_f32 v34, v36, v37
v_cvt_pk_bf16_f32 v35, v38, v39
v_accvgpr_write_b32 a68, v32
v_accvgpr_write_b32 a69, v33
v_accvgpr_write_b32 a70, v34
v_accvgpr_write_b32 a71, v35
v_mfma_f32_16x16x32_bf16 a[172:175], a[248:251], v[184:187], a[172:175]
buffer_store_dwordx4 a[68:71], v11, s[24:27], s43 offen offset:2048 sc1
v_accvgpr_read_b32 v40, a72
v_accvgpr_read_b32 v41, a73
v_accvgpr_read_b32 v42, a74
v_accvgpr_read_b32 v43, a75
v_mfma_f32_16x16x32_bf16 a[172:175], a[252:255], v[188:191], a[172:175]
s_waitcnt lgkmcnt(0)
buffer_load_dwordx4 v25, s[48:51], s92 offen  lds
v_accvgpr_read_b32 v44, a88
v_accvgpr_read_b32 v45, a89
v_accvgpr_read_b32 v46, a90
v_mfma_f32_16x16x32_bf16 a[176:179], v[216:219], v[144:147], a[176:179]
v_accvgpr_read_b32 v47, a91
v_mul_f32 v40, v40, v60
v_mul_f32 v41, v41, v60
v_mul_f32 v42, v42, v60
v_mul_f32 v43, v43, v60
v_mul_f32 v44, v44, v60
v_mfma_f32_16x16x32_bf16 a[176:179], v[220:223], v[148:151], a[176:179]
v_mul_f32 v45, v45, v60
v_mul_f32 v46, v46, v60
v_mul_f32_e64 v47, v47, v60
v_cvt_pk_bf16_f32 v40, v40, v41
v_cvt_pk_bf16_f32 v41, v42, v43
v_cvt_pk_bf16_f32 v42, v44, v45
v_mfma_f32_16x16x32_bf16 a[180:183], v[216:219], v[152:155], a[180:183]
v_cvt_pk_bf16_f32 v43, v46, v47
v_accvgpr_write_b32 a72, v40
v_accvgpr_write_b32 a73, v41
v_accvgpr_write_b32 a74, v42
v_accvgpr_write_b32 a75, v43
v_mfma_f32_16x16x32_bf16 a[180:183], v[220:223], v[156:159], a[180:183]
buffer_store_dwordx4 a[72:75], v11, s[24:27], s44 offen offset:2048 sc1
v_accvgpr_read_b32 v48, a76
v_accvgpr_read_b32 v49, a77
v_accvgpr_read_b32 v50, a78
v_accvgpr_read_b32 v51, a79
v_mfma_f32_16x16x32_bf16 a[184:187], v[216:219], v[176:179], a[184:187]
v_accvgpr_read_b32 v52, a92
v_accvgpr_read_b32 v53, a93
v_accvgpr_read_b32 v54, a94
v_accvgpr_read_b32 v55, a95
v_mul_f32 v48, v48, v62
v_mul_f32 v49, v49, v62
v_mfma_f32_16x16x32_bf16 a[184:187], v[220:223], v[180:183], a[184:187]
v_mul_f32 v50, v50, v62
v_mul_f32 v51, v51, v62
v_mul_f32 v52, v52, v62
v_mul_f32 v53, v53, v62
v_mul_f32 v54, v54, v62
v_mul_f32 v55, v55, v62
v_mfma_f32_16x16x32_bf16 a[188:191], v[216:219], v[184:187], a[188:191]
v_cvt_pk_bf16_f32 v48, v48, v49
v_cvt_pk_bf16_f32 v49, v50, v51
v_cvt_pk_bf16_f32 v50, v52, v53
v_cvt_pk_bf16_f32 v51, v54, v55
v_accvgpr_write_b32 a76, v48
v_accvgpr_write_b32 a77, v49
v_mfma_f32_16x16x32_bf16 a[188:191], v[220:223], v[188:191], a[188:191]
v_accvgpr_write_b32 a78, v50
v_accvgpr_write_b32 a79, v51
buffer_store_dwordx4 a[76:79], v11, s[24:27], s45 offen offset:2048 sc1
v_accvgpr_read_b32 v32, a96
v_accvgpr_read_b32 v33, a97
v_accvgpr_read_b32 v34, a98
v_accvgpr_read_b32 v35, a99
v_accvgpr_read_b32 v36, a112
v_accvgpr_read_b32 v37, a113
v_accvgpr_read_b32 v38, a114
v_accvgpr_read_b32 v39, a115
v_mul_f32 v32, v32, v56
v_mul_f32 v33, v33, v56
v_mul_f32 v34, v34, v56
v_mul_f32 v35, v35, v56
v_mul_f32 v36, v36, v56
v_mul_f32 v37, v37, v56
v_mul_f32 v38, v38, v56
v_mul_f32 v39, v39, v56
v_cvt_pk_bf16_f32 v32, v32, v33
v_cvt_pk_bf16_f32 v33, v34, v35
v_cvt_pk_bf16_f32 v34, v36, v37
v_cvt_pk_bf16_f32 v35, v38, v39
v_accvgpr_write_b32 a96, v32
v_accvgpr_write_b32 a97, v33
v_accvgpr_write_b32 a98, v34
v_accvgpr_write_b32 a99, v35
v_accvgpr_read_b32 v40, a100
v_accvgpr_read_b32 v41, a101
v_accvgpr_read_b32 v42, a102
v_accvgpr_read_b32 v43, a103
v_accvgpr_read_b32 v44, a116
v_accvgpr_read_b32 v45, a117
v_accvgpr_read_b32 v46, a118
v_accvgpr_read_b32 v47, a119
v_mul_f32 v40, v40, v58
v_mul_f32 v41, v41, v58
v_mul_f32 v42, v42, v58
v_mul_f32 v43, v43, v58
v_mul_f32 v44, v44, v58
v_mul_f32 v45, v45, v58
v_mul_f32 v46, v46, v58
v_mul_f32 v47, v47, v58
v_cvt_pk_bf16_f32 v40, v40, v41
v_cvt_pk_bf16_f32 v41, v42, v43
v_cvt_pk_bf16_f32 v42, v44, v45
v_cvt_pk_bf16_f32 v43, v46, v47
v_accvgpr_write_b32 a100, v40
v_accvgpr_write_b32 a101, v41
v_accvgpr_write_b32 a102, v42
v_accvgpr_write_b32 a103, v43
v_accvgpr_read_b32 v48, a104
v_accvgpr_read_b32 v49, a105
v_accvgpr_read_b32 v50, a106
v_accvgpr_read_b32 v51, a107
v_accvgpr_read_b32 v52, a120
v_accvgpr_read_b32 v53, a121
v_accvgpr_read_b32 v54, a122
v_accvgpr_read_b32 v55, a123
v_mul_f32 v48, v48, v60
v_mul_f32 v49, v49, v60
v_mul_f32 v50, v50, v60
v_mul_f32 v51, v51, v60
v_mul_f32 v52, v52, v60
v_mul_f32 v53, v53, v60
v_mul_f32 v54, v54, v60
v_mul_f32 v55, v55, v60
v_cvt_pk_bf16_f32 v48, v48, v49
v_cvt_pk_bf16_f32 v49, v50, v51
v_cvt_pk_bf16_f32 v50, v52, v53
v_cvt_pk_bf16_f32 v51, v54, v55
v_accvgpr_write_b32 a104, v48
v_accvgpr_write_b32 a105, v49
v_accvgpr_write_b32 a106, v50
v_accvgpr_write_b32 a107, v51
v_accvgpr_read_b32 v32, a108
v_accvgpr_read_b32 v33, a109
v_accvgpr_read_b32 v34, a110
v_accvgpr_read_b32 v35, a111
v_accvgpr_read_b32 v36, a124
v_accvgpr_read_b32 v37, a125
v_accvgpr_read_b32 v38, a126
v_accvgpr_read_b32 v39, a127
v_mul_f32 v32, v32, v62
v_mul_f32 v33, v33, v62
v_mul_f32 v34, v34, v62
v_mul_f32 v35, v35, v62
v_mul_f32 v36, v36, v62
v_mul_f32 v37, v37, v62
v_mul_f32 v38, v38, v62
v_mul_f32 v39, v39, v62
v_cvt_pk_bf16_f32 v32, v32, v33
v_cvt_pk_bf16_f32 v33, v34, v35
v_cvt_pk_bf16_f32 v34, v36, v37
v_cvt_pk_bf16_f32 v35, v38, v39
v_accvgpr_write_b32 a108, v32
v_accvgpr_write_b32 a109, v33
v_accvgpr_write_b32 a110, v34
v_accvgpr_write_b32 a111, v35
v_accvgpr_read_b32 v40, a128
v_accvgpr_read_b32 v41, a129
v_accvgpr_read_b32 v42, a130
v_accvgpr_read_b32 v43, a131
v_accvgpr_read_b32 v44, a144
v_accvgpr_read_b32 v45, a145
v_accvgpr_read_b32 v46, a146
v_accvgpr_read_b32 v47, a147
v_mul_f32 v40, v40, v56
v_mul_f32 v41, v41, v56
v_mul_f32 v42, v42, v56
v_mul_f32 v43, v43, v56
v_mul_f32 v44, v44, v56
v_mul_f32 v45, v45, v56
v_mul_f32 v46, v46, v56
v_mul_f32 v47, v47, v56
v_cvt_pk_bf16_f32 v40, v40, v41
v_cvt_pk_bf16_f32 v41, v42, v43
v_cvt_pk_bf16_f32 v42, v44, v45
v_cvt_pk_bf16_f32 v43, v46, v47
v_accvgpr_write_b32 a128, v40
v_accvgpr_write_b32 a129, v41
v_accvgpr_write_b32 a130, v42
v_accvgpr_write_b32 a131, v43
v_accvgpr_read_b32 v48, a132
v_accvgpr_read_b32 v49, a133
v_accvgpr_read_b32 v50, a134
v_accvgpr_read_b32 v51, a135
v_accvgpr_read_b32 v52, a148
v_accvgpr_read_b32 v53, a149
v_accvgpr_read_b32 v54, a150
v_accvgpr_read_b32 v55, a151
v_mul_f32 v48, v48, v58
v_mul_f32 v49, v49, v58
v_mul_f32 v50, v50, v58
v_mul_f32 v51, v51, v58
v_mul_f32 v52, v52, v58
v_mul_f32 v53, v53, v58
v_mul_f32 v54, v54, v58
v_mul_f32 v55, v55, v58
v_cvt_pk_bf16_f32 v48, v48, v49
v_cvt_pk_bf16_f32 v49, v50, v51
v_cvt_pk_bf16_f32 v50, v52, v53
v_cvt_pk_bf16_f32 v51, v54, v55
v_accvgpr_write_b32 a132, v48
v_accvgpr_write_b32 a133, v49
v_accvgpr_write_b32 a134, v50
v_accvgpr_write_b32 a135, v51
v_accvgpr_read_b32 v32, a136
v_accvgpr_read_b32 v33, a137
v_accvgpr_read_b32 v34, a138
v_accvgpr_read_b32 v35, a139
v_accvgpr_read_b32 v36, a152
v_accvgpr_read_b32 v37, a153
v_accvgpr_read_b32 v38, a154
v_accvgpr_read_b32 v39, a155
v_mul_f32 v32, v32, v60
v_mul_f32 v33, v33, v60
v_mul_f32 v34, v34, v60
v_mul_f32 v35, v35, v60
v_mul_f32 v36, v36, v60
v_mul_f32 v37, v37, v60
v_mul_f32 v38, v38, v60
v_mul_f32 v39, v39, v60
v_cvt_pk_bf16_f32 v32, v32, v33
v_cvt_pk_bf16_f32 v33, v34, v35
v_cvt_pk_bf16_f32 v34, v36, v37
v_cvt_pk_bf16_f32 v35, v38, v39
v_accvgpr_write_b32 a136, v32
v_accvgpr_write_b32 a137, v33
v_accvgpr_write_b32 a138, v34
v_accvgpr_write_b32 a139, v35
v_accvgpr_read_b32 v40, a140
v_accvgpr_read_b32 v41, a141
v_accvgpr_read_b32 v42, a142
v_accvgpr_read_b32 v43, a143
v_accvgpr_read_b32 v44, a156
v_accvgpr_read_b32 v45, a157
v_accvgpr_read_b32 v46, a158
v_accvgpr_read_b32 v47, a159
v_mul_f32 v40, v40, v62
v_mul_f32 v41, v41, v62
v_mul_f32 v42, v42, v62
v_mul_f32 v43, v43, v62
v_mul_f32 v44, v44, v62
v_mul_f32 v45, v45, v62
v_mul_f32 v46, v46, v62
v_mul_f32 v47, v47, v62
v_cvt_pk_bf16_f32 v40, v40, v41
v_cvt_pk_bf16_f32 v41, v42, v43
v_cvt_pk_bf16_f32 v42, v44, v45
v_cvt_pk_bf16_f32 v43, v46, v47
v_accvgpr_write_b32 a140, v40
v_accvgpr_write_b32 a141, v41
v_accvgpr_write_b32 a142, v42
v_accvgpr_write_b32 a143, v43
v_accvgpr_read_b32 v48, a160
v_accvgpr_read_b32 v49, a161
v_accvgpr_read_b32 v50, a162
v_accvgpr_read_b32 v51, a163
v_accvgpr_read_b32 v52, a176
v_accvgpr_read_b32 v53, a177
v_accvgpr_read_b32 v54, a178
v_accvgpr_read_b32 v55, a179
v_mul_f32 v48, v48, v56
v_mul_f32 v49, v49, v56
v_mul_f32 v50, v50, v56
v_mul_f32 v51, v51, v56
v_mul_f32 v52, v52, v56
v_mul_f32 v53, v53, v56
v_mul_f32 v54, v54, v56
v_mul_f32 v55, v55, v56
v_cvt_pk_bf16_f32 v48, v48, v49
v_cvt_pk_bf16_f32 v49, v50, v51
v_cvt_pk_bf16_f32 v50, v52, v53
v_cvt_pk_bf16_f32 v51, v54, v55
v_accvgpr_write_b32 a160, v48
v_accvgpr_write_b32 a161, v49
v_accvgpr_write_b32 a162, v50
v_accvgpr_write_b32 a163, v51
v_accvgpr_read_b32 v32, a164
v_accvgpr_read_b32 v33, a165
v_accvgpr_read_b32 v34, a166
v_accvgpr_read_b32 v35, a167
v_accvgpr_read_b32 v36, a180
v_accvgpr_read_b32 v37, a181
v_accvgpr_read_b32 v38, a182
v_accvgpr_read_b32 v39, a183
v_mul_f32 v32, v32, v58
v_mul_f32 v33, v33, v58
v_mul_f32 v34, v34, v58
v_mul_f32 v35, v35, v58
v_mul_f32 v36, v36, v58
v_mul_f32 v37, v37, v58
v_mul_f32 v38, v38, v58
v_mul_f32 v39, v39, v58
v_cvt_pk_bf16_f32 v32, v32, v33
v_cvt_pk_bf16_f32 v33, v34, v35
v_cvt_pk_bf16_f32 v34, v36, v37
v_cvt_pk_bf16_f32 v35, v38, v39
v_accvgpr_write_b32 a164, v32
v_accvgpr_write_b32 a165, v33
v_accvgpr_write_b32 a166, v34
v_accvgpr_write_b32 a167, v35
v_accvgpr_read_b32 v40, a168
v_accvgpr_read_b32 v41, a169
v_accvgpr_read_b32 v42, a170
v_accvgpr_read_b32 v43, a171
v_accvgpr_read_b32 v44, a184
v_accvgpr_read_b32 v45, a185
v_accvgpr_read_b32 v46, a186
v_accvgpr_read_b32 v47, a187
v_mul_f32 v40, v40, v60
v_mul_f32 v41, v41, v60
v_mul_f32 v42, v42, v60
v_mul_f32 v43, v43, v60
v_mul_f32 v44, v44, v60
v_mul_f32 v45, v45, v60
v_mul_f32 v46, v46, v60
v_mul_f32 v47, v47, v60
v_cvt_pk_bf16_f32 v40, v40, v41
v_cvt_pk_bf16_f32 v41, v42, v43
v_cvt_pk_bf16_f32 v42, v44, v45
v_cvt_pk_bf16_f32 v43, v46, v47
v_accvgpr_write_b32 a168, v40
v_accvgpr_write_b32 a169, v41
v_accvgpr_write_b32 a170, v42
v_accvgpr_write_b32 a171, v43
v_accvgpr_read_b32 v48, a172
v_accvgpr_read_b32 v49, a173
v_accvgpr_read_b32 v50, a174
v_accvgpr_read_b32 v51, a175
v_accvgpr_read_b32 v52, a188
v_accvgpr_read_b32 v53, a189
v_accvgpr_read_b32 v54, a190
v_accvgpr_read_b32 v55, a191
v_mul_f32 v48, v48, v62
v_mul_f32 v49, v49, v62
v_mul_f32 v50, v50, v62
v_mul_f32 v51, v51, v62
v_mul_f32 v52, v52, v62
v_mul_f32 v53, v53, v62
v_mul_f32 v54, v54, v62
v_mul_f32 v55, v55, v62
v_cvt_pk_bf16_f32 v48, v48, v49
v_cvt_pk_bf16_f32 v49, v50, v51
v_cvt_pk_bf16_f32 v50, v52, v53
v_cvt_pk_bf16_f32 v51, v54, v55
v_accvgpr_write_b32 a172, v48
v_accvgpr_write_b32 a173, v49
v_accvgpr_write_b32 a174, v50
v_accvgpr_write_b32 a175, v51
L_al_off7:
v_lshrrev_b32 v32, 2, v0
v_mul_u32_u24 v32, 320, v32
v_and_b32 v33, 3, v0
v_lshl_add_u32 v32, v33, 3, v32
v_bfe_u32 v33, v0, 4, 1
v_lshlrev_b32 v33, 5, v33
v_add_u32 v5, v32, v33
v_sub_u32 v6, v32, v33
v_add_u32 v7, 65536, v5
v_add_u32 v8, 65536, v6
v_add_u32 v9, 131072, v5
v_add_u32 v10, 131072, v6
v_add_u32 v12, 0, v11
v_add_u32 v13, 196608, v11
v_add_u32 v14, 393216, v11
v_add_u32 v15, 589824, v11
v_add_u32 v18, 4096, v11
v_lshl_add_u32 v17, v11, 3, s21
s_waitcnt vmcnt(27)
s_barrier
ds_read_b64_tr_b16 v[64:65], v7 offset:57344
ds_read_b64_tr_b16 v[66:67], v7 offset:62464
ds_read_b64_tr_b16 v[68:69], v9 offset:2048
ds_read_b64_tr_b16 v[70:71], v9 offset:7168
ds_read_b64_tr_b16 v[72:73], v8 offset:57376
ds_read_b64_tr_b16 v[74:75], v8 offset:62496
ds_read_b64_tr_b16 v[76:77], v10 offset:2080
ds_read_b64_tr_b16 v[78:79], v10 offset:7200
ds_read_b64_tr_b16 v[80:81], v7 offset:57408
ds_read_b64_tr_b16 v[82:83], v7 offset:62528
ds_read_b64_tr_b16 v[84:85], v9 offset:2112
ds_read_b64_tr_b16 v[86:87], v9 offset:7232
ds_read_b64_tr_b16 v[88:89], v8 offset:57440
ds_read_b64_tr_b16 v[90:91], v8 offset:62560
ds_read_b64_tr_b16 v[92:93], v10 offset:2144
ds_read_b64_tr_b16 v[94:95], v10 offset:7264
s_waitcnt lgkmcnt(12)
v_mfma_f32_16x16x32_bf16 v[96:99], v[64:67], a[0:3], 0
v_mfma_f32_16x16x32_bf16 v[96:99], v[68:71], a[32:35], v[96:99]
v_mfma_f32_16x16x32_bf16 v[136:139], v[64:67], a[4:7], 0
buffer_store_dwordx4 a[96:99], v11, s[24:27], s42 offen offset:3072 sc1
v_mfma_f32_16x16x32_bf16 v[136:139], v[68:71], a[36:39], v[136:139]
v_mfma_f32_16x16x32_bf16 v[176:179], v[64:67], a[8:11], 0
v_mfma_f32_16x16x32_bf16 v[176:179], v[68:71], a[40:43], v[176:179]
v_mfma_f32_16x16x32_bf16 v[216:219], v[64:67], a[12:15], 0
s_waitcnt vmcnt(7)
s_mov_b64 exec, 1
buffer_atomic_add v31, off, s[68:71], s17 sc1
s_mov_b64 exec, -1
v_mfma_f32_16x16x32_bf16 v[216:219], v[68:71], a[44:47], v[216:219]
s_waitcnt lgkmcnt(8)
ds_read_b64_tr_b16 v[64:65], v7 offset:57472
v_mfma_f32_16x16x32_bf16 v[100:103], v[72:75], a[0:3], 0
ds_read_b64_tr_b16 v[66:67], v7 offset:62592
v_mfma_f32_16x16x32_bf16 v[100:103], v[76:79], a[32:35], v[100:103]
ds_read_b64_tr_b16 v[68:69], v9 offset:2176
v_mfma_f32_16x16x32_bf16 v[140:143], v[72:75], a[4:7], 0
ds_read_b64_tr_b16 v[70:71], v9 offset:7296
v_mfma_f32_16x16x32_bf16 v[140:143], v[76:79], a[36:39], v[140:143]
v_mfma_f32_16x16x32_bf16 v[180:183], v[72:75], a[8:11], 0
v_mfma_f32_16x16x32_bf16 v[180:183], v[76:79], a[40:43], v[180:183]
v_mfma_f32_16x16x32_bf16 v[220:223], v[72:75], a[12:15], 0
v_mfma_f32_16x16x32_bf16 v[220:223], v[76:79], a[44:47], v[220:223]
s_waitcnt lgkmcnt(8)
ds_read_b64_tr_b16 v[72:73], v8 offset:57504
v_mfma_f32_16x16x32_bf16 v[104:107], v[80:83], a[0:3], 0
ds_read_b64_tr_b16 v[74:75], v8 offset:62624
v_mfma_f32_16x16x32_bf16 v[104:107], v[84:87], a[32:35], v[104:107]
ds_read_b64_tr_b16 v[76:77], v10 offset:2208
v_mfma_f32_16x16x32_bf16 v[144:147], v[80:83], a[4:7], 0
ds_read_b64_tr_b16 v[78:79], v10 offset:7328
v_mfma_f32_16x16x32_bf16 v[144:147], v[84:87], a[36:39], v[144:147]
v_mfma_f32_16x16x32_bf16 v[184:187], v[80:83], a[8:11], 0
v_mfma_f32_16x16x32_bf16 v[184:187], v[84:87], a[40:43], v[184:187]
v_mfma_f32_16x16x32_bf16 v[224:227], v[80:83], a[12:15], 0
v_mfma_f32_16x16x32_bf16 v[224:227], v[84:87], a[44:47], v[224:227]
s_waitcnt lgkmcnt(8)
ds_read_b64_tr_b16 v[80:81], v7 offset:57536
v_mfma_f32_16x16x32_bf16 v[108:111], v[88:91], a[0:3], 0
ds_read_b64_tr_b16 v[82:83], v7 offset:62656
buffer_store_dwordx4 a[100:103], v11, s[24:27], s43 offen offset:3072 sc1
v_mfma_f32_16x16x32_bf16 v[108:111], v[92:95], a[32:35], v[108:111]
ds_read_b64_tr_b16 v[84:85], v9 offset:2240
v_mfma_f32_16x16x32_bf16 v[148:151], v[88:91], a[4:7], 0
ds_read_b64_tr_b16 v[86:87], v9 offset:7360
v_mfma_f32_16x16x32_bf16 v[148:151], v[92:95], a[36:39], v[148:151]
v_mfma_f32_16x16x32_bf16 v[188:191], v[88:91], a[8:11], 0
v_mfma_f32_16x16x32_bf16 v[188:191], v[92:95], a[40:43], v[188:191]
v_mfma_f32_16x16x32_bf16 v[228:231], v[88:91], a[12:15], 0
v_mfma_f32_16x16x32_bf16 v[228:231], v[92:95], a[44:47], v[228:231]
s_waitcnt lgkmcnt(8)
ds_read_b64_tr_b16 v[88:89], v8 offset:57568
v_mfma_f32_16x16x32_bf16 v[112:115], v[64:67], a[0:3], 0
ds_read_b64_tr_b16 v[90:91], v8 offset:62688
v_mfma_f32_16x16x32_bf16 v[112:115], v[68:71], a[32:35], v[112:115]
ds_read_b64_tr_b16 v[92:93], v10 offset:2272
v_mfma_f32_16x16x32_bf16 v[152:155], v[64:67], a[4:7], 0
ds_read_b64_tr_b16 v[94:95], v10 offset:7392
v_mfma_f32_16x16x32_bf16 v[152:155], v[68:71], a[36:39], v[152:155]
v_mfma_f32_16x16x32_bf16 v[192:195], v[64:67], a[8:11], 0
v_mfma_f32_16x16x32_bf16 v[192:195], v[68:71], a[40:43], v[192:195]
v_mfma_f32_16x16x32_bf16 v[232:235], v[64:67], a[12:15], 0
v_mfma_f32_16x16x32_bf16 v[232:235], v[68:71], a[44:47], v[232:235]
s_waitcnt lgkmcnt(8)
ds_read_b64_tr_b16 v[64:65], v7 offset:57600
v_mfma_f32_16x16x32_bf16 v[116:119], v[72:75], a[0:3], 0
ds_read_b64_tr_b16 v[66:67], v7 offset:62720
v_mfma_f32_16x16x32_bf16 v[116:119], v[76:79], a[32:35], v[116:119]
ds_read_b64_tr_b16 v[68:69], v9 offset:2304
v_mfma_f32_16x16x32_bf16 v[156:159], v[72:75], a[4:7], 0
ds_read_b64_tr_b16 v[70:71], v9 offset:7424
v_mfma_f32_16x16x32_bf16 v[156:159], v[76:79], a[36:39], v[156:159]
v_mfma_f32_16x16x32_bf16 v[196:199], v[72:75], a[8:11], 0
v_mfma_f32_16x16x32_bf16 v[196:199], v[76:79], a[40:43], v[196:199]
v_mfma_f32_16x16x32_bf16 v[236:239], v[72:75], a[12:15], 0
buffer_store_dwordx4 a[104:107], v11, s[24:27], s44 offen offset:3072 sc1
v_mfma_f32_16x16x32_bf16 v[236:239], v[76:79], a[44:47], v[236:239]
s_waitcnt lgkmcnt(8)
ds_read_b64_tr_b16 v[72:73], v8 offset:57632
v_mfma_f32_16x16x32_bf16 v[120:123], v[80:83], a[0:3], 0
ds_read_b64_tr_b16 v[74:75], v8 offset:62752
v_mfma_f32_16x16x32_bf16 v[120:123], v[84:87], a[32:35], v[120:123]
ds_read_b64_tr_b16 v[76:77], v10 offset:2336
v_mfma_f32_16x16x32_bf16 v[160:163], v[80:83], a[4:7], 0
ds_read_b64_tr_b16 v[78:79], v10 offset:7456
v_mfma_f32_16x16x32_bf16 v[160:163], v[84:87], a[36:39], v[160:163]
v_mfma_f32_16x16x32_bf16 v[200:203], v[80:83], a[8:11], 0
v_mfma_f32_16x16x32_bf16 v[200:203], v[84:87], a[40:43], v[200:203]
v_mfma_f32_16x16x32_bf16 v[240:243], v[80:83], a[12:15], 0
v_mfma_f32_16x16x32_bf16 v[240:243], v[84:87], a[44:47], v[240:243]
s_waitcnt lgkmcnt(8)
ds_read_b64_tr_b16 v[80:81], v9 offset:12288
v_mfma_f32_16x16x32_bf16 v[124:127], v[88:91], a[0:3], 0
ds_read_b64_tr_b16 v[82:83], v9 offset:17408
v_mfma_f32_16x16x32_bf16 v[124:127], v[92:95], a[32:35], v[124:127]
ds_read_b64_tr_b16 v[84:85], v9 offset:22528
v_mfma_f32_16x16x32_bf16 v[164:167], v[88:91], a[4:7], 0
ds_read_b64_tr_b16 v[86:87], v9 offset:27648
v_mfma_f32_16x16x32_bf16 v[164:167], v[92:95], a[36:39], v[164:167]
v_mfma_f32_16x16x32_bf16 v[204:207], v[88:91], a[8:11], 0
v_mfma_f32_16x16x32_bf16 v[204:207], v[92:95], a[40:43], v[204:207]
v_mfma_f32_16x16x32_bf16 v[244:247], v[88:91], a[12:15], 0
v_mfma_f32_16x16x32_bf16 v[244:247], v[92:95], a[44:47], v[244:247]
s_waitcnt lgkmcnt(8)
ds_read_b64_tr_b16 v[88:89], v10 offset:12320
v_mfma_f32_16x16x32_bf16 v[128:131], v[64:67], a[0:3], 0
ds_read_b64_tr_b16 v[90:91], v10 offset:17440
v_mfma_f32_16x16x32_bf16 v[128:131], v[68:71], a[32:35], v[128:131]
ds_read_b64_tr_b16 v[92:93], v10 offset:22560
v_mfma_f32_16x16x32_bf16 v[168:171], v[64:67], a[4:7], 0
ds_read_b64_tr_b16 v[94:95], v10 offset:27680
v_mfma_f32_16x16x32_bf16 v[168:171], v[68:71], a[36:39], v[168:171]
v_mfma_f32_16x16x32_bf16 v[208:211], v[64:67], a[8:11], 0
buffer_store_dwordx4 a[108:111], v11, s[24:27], s45 offen offset:3072 sc1
v_mfma_f32_16x16x32_bf16 v[208:211], v[68:71], a[40:43], v[208:211]
v_mfma_f32_16x16x32_bf16 v[248:251], v[64:67], a[12:15], 0
v_mfma_f32_16x16x32_bf16 v[248:251], v[68:71], a[44:47], v[248:251]
s_waitcnt lgkmcnt(8)
ds_read_b64_tr_b16 v[64:65], v9 offset:12352
v_mfma_f32_16x16x32_bf16 v[132:135], v[72:75], a[0:3], 0
ds_read_b64_tr_b16 v[66:67], v9 offset:17472
v_mfma_f32_16x16x32_bf16 v[132:135], v[76:79], a[32:35], v[132:135]
ds_read_b64_tr_b16 v[68:69], v9 offset:22592
v_mfma_f32_16x16x32_bf16 v[172:175], v[72:75], a[4:7], 0
ds_read_b64_tr_b16 v[70:71], v9 offset:27712
v_mfma_f32_16x16x32_bf16 v[172:175], v[76:79], a[36:39], v[172:175]
v_mfma_f32_16x16x32_bf16 v[212:215], v[72:75], a[8:11], 0
v_mfma_f32_16x16x32_bf16 v[212:215], v[76:79], a[40:43], v[212:215]
v_mfma_f32_16x16x32_bf16 v[252:255], v[72:75], a[12:15], 0
v_mfma_f32_16x16x32_bf16 v[252:255], v[76:79], a[44:47], v[252:255]
s_waitcnt lgkmcnt(8)
ds_read_b64_tr_b16 v[72:73], v10 offset:12384
v_mfma_f32_16x16x32_bf16 v[96:99], v[80:83], a[64:67], v[96:99]
ds_read_b64_tr_b16 v[74:75], v10 offset:17504
v_mfma_f32_16x16x32_bf16 v[96:99], v[84:87], a[96:99], v[96:99]
ds_read_b64_tr_b16 v[76:77], v10 offset:22624
v_mfma_f32_16x16x32_bf16 v[136:139], v[80:83], a[68:71], v[136:139]
ds_read_b64_tr_b16 v[78:79], v10 offset:27744
v_mfma_f32_16x16x32_bf16 v[136:139], v[84:87], a[100:103], v[136:139]
v_mfma_f32_16x16x32_bf16 v[176:179], v[80:83], a[72:75], v[176:179]
v_mfma_f32_16x16x32_bf16 v[176:179], v[84:87], a[104:107], v[176:179]
v_mfma_f32_16x16x32_bf16 v[216:219], v[80:83], a[76:79], v[216:219]
v_mfma_f32_16x16x32_bf16 v[216:219], v[84:87], a[108:111], v[216:219]
s_waitcnt lgkmcnt(8)
ds_read_b64_tr_b16 v[80:81], v9 offset:12416
v_mfma_f32_16x16x32_bf16 v[100:103], v[88:91], a[64:67], v[100:103]
ds_read_b64_tr_b16 v[82:83], v9 offset:17536
v_mfma_f32_16x16x32_bf16 v[100:103], v[92:95], a[96:99], v[100:103]
ds_read_b64_tr_b16 v[84:85], v9 offset:22656
v_mfma_f32_16x16x32_bf16 v[140:143], v[88:91], a[68:71], v[140:143]
ds_read_b64_tr_b16 v[86:87], v9 offset:27776
buffer_store_dwordx4 a[128:131], v16, s[24:27], s42 offen offset:0 sc1
v_mfma_f32_16x16x32_bf16 v[140:143], v[92:95], a[100:103], v[140:143]
v_mfma_f32_16x16x32_bf16 v[180:183], v[88:91], a[72:75], v[180:183]
v_mfma_f32_16x16x32_bf16 v[180:183], v[92:95], a[104:107], v[180:183]
v_mfma_f32_16x16x32_bf16 v[220:223], v[88:91], a[76:79], v[220:223]
v_mfma_f32_16x16x32_bf16 v[220:223], v[92:95], a[108:111], v[220:223]
s_waitcnt lgkmcnt(8)
ds_read_b64_tr_b16 v[88:89], v10 offset:12448
v_mfma_f32_16x16x32_bf16 v[104:107], v[64:67], a[64:67], v[104:107]
ds_read_b64_tr_b16 v[90:91], v10 offset:17568
v_mfma_f32_16x16x32_bf16 v[104:107], v[68:71], a[96:99], v[104:107]
ds_read_b64_tr_b16 v[92:93], v10 offset:22688
v_mfma_f32_16x16x32_bf16 v[144:147], v[64:67], a[68:71], v[144:147]
ds_read_b64_tr_b16 v[94:95], v10 offset:27808
v_mfma_f32_16x16x32_bf16 v[144:147], v[68:71], a[100:103], v[144:147]
v_mfma_f32_16x16x32_bf16 v[184:187], v[64:67], a[72:75], v[184:187]
buffer_load_dword v19, off, s[68:71], s17 sc1
v_mfma_f32_16x16x32_bf16 v[184:187], v[68:71], a[104:107], v[184:187]
v_mfma_f32_16x16x32_bf16 v[224:227], v[64:67], a[76:79], v[224:227]
v_mfma_f32_16x16x32_bf16 v[224:227], v[68:71], a[108:111], v[224:227]
s_waitcnt lgkmcnt(8)
ds_read_b64_tr_b16 v[64:65], v9 offset:12480
v_mfma_f32_16x16x32_bf16 v[108:111], v[72:75], a[64:67], v[108:111]
ds_read_b64_tr_b16 v[66:67], v9 offset:17600
v_mfma_f32_16x16x32_bf16 v[108:111], v[76:79], a[96:99], v[108:111]
ds_read_b64_tr_b16 v[68:69], v9 offset:22720
v_mfma_f32_16x16x32_bf16 v[148:151], v[72:75], a[68:71], v[148:151]
ds_read_b64_tr_b16 v[70:71], v9 offset:27840
v_mfma_f32_16x16x32_bf16 v[148:151], v[76:79], a[100:103], v[148:151]
v_mfma_f32_16x16x32_bf16 v[188:191], v[72:75], a[72:75], v[188:191]
v_mfma_f32_16x16x32_bf16 v[188:191], v[76:79], a[104:107], v[188:191]
v_mfma_f32_16x16x32_bf16 v[228:231], v[72:75], a[76:79], v[228:231]
v_mfma_f32_16x16x32_bf16 v[228:231], v[76:79], a[108:111], v[228:231]
s_waitcnt lgkmcnt(8)
ds_read_b64_tr_b16 v[72:73], v10 offset:12512
v_mfma_f32_16x16x32_bf16 v[112:115], v[80:83], a[64:67], v[112:115]
ds_read_b64_tr_b16 v[74:75], v10 offset:17632
buffer_store_dwordx4 a[132:135], v16, s[24:27], s43 offen offset:0 sc1
v_mfma_f32_16x16x32_bf16 v[112:115], v[84:87], a[96:99], v[112:115]
ds_read_b64_tr_b16 v[76:77], v10 offset:22752
v_mfma_f32_16x16x32_bf16 v[152:155], v[80:83], a[68:71], v[152:155]
ds_read_b64_tr_b16 v[78:79], v10 offset:27872
v_mfma_f32_16x16x32_bf16 v[152:155], v[84:87], a[100:103], v[152:155]
v_mfma_f32_16x16x32_bf16 v[192:195], v[80:83], a[72:75], v[192:195]
v_mfma_f32_16x16x32_bf16 v[192:195], v[84:87], a[104:107], v[192:195]
v_mfma_f32_16x16x32_bf16 v[232:235], v[80:83], a[76:79], v[232:235]
v_mfma_f32_16x16x32_bf16 v[232:235], v[84:87], a[108:111], v[232:235]
s_waitcnt lgkmcnt(8)
ds_read_b64_tr_b16 v[80:81], v9 offset:12544
v_mfma_f32_16x16x32_bf16 v[116:119], v[88:91], a[64:67], v[116:119]
ds_read_b64_tr_b16 v[82:83], v9 offset:17664
v_mfma_f32_16x16x32_bf16 v[116:119], v[92:95], a[96:99], v[116:119]
ds_read_b64_tr_b16 v[84:85], v9 offset:22784
v_mfma_f32_16x16x32_bf16 v[156:159], v[88:91], a[68:71], v[156:159]
ds_read_b64_tr_b16 v[86:87], v9 offset:27904
v_mfma_f32_16x16x32_bf16 v[156:159], v[92:95], a[100:103], v[156:159]
v_mfma_f32_16x16x32_bf16 v[196:199], v[88:91], a[72:75], v[196:199]
v_mfma_f32_16x16x32_bf16 v[196:199], v[92:95], a[104:107], v[196:199]
v_mfma_f32_16x16x32_bf16 v[236:239], v[88:91], a[76:79], v[236:239]
v_mfma_f32_16x16x32_bf16 v[236:239], v[92:95], a[108:111], v[236:239]
s_waitcnt lgkmcnt(8)
ds_read_b64_tr_b16 v[88:89], v10 offset:12576
v_mfma_f32_16x16x32_bf16 v[120:123], v[64:67], a[64:67], v[120:123]
ds_read_b64_tr_b16 v[90:91], v10 offset:17696
v_mfma_f32_16x16x32_bf16 v[120:123], v[68:71], a[96:99], v[120:123]
ds_read_b64_tr_b16 v[92:93], v10 offset:22816
v_mfma_f32_16x16x32_bf16 v[160:163], v[64:67], a[68:71], v[160:163]
ds_read_b64_tr_b16 v[94:95], v10 offset:27936
v_mfma_f32_16x16x32_bf16 v[160:163], v[68:71], a[100:103], v[160:163]
v_mfma_f32_16x16x32_bf16 v[200:203], v[64:67], a[72:75], v[200:203]
v_mfma_f32_16x16x32_bf16 v[200:203], v[68:71], a[104:107], v[200:203]
v_mfma_f32_16x16x32_bf16 v[240:243], v[64:67], a[76:79], v[240:243]
buffer_store_dwordx4 a[136:139], v16, s[24:27], s44 offen offset:0 sc1
v_mfma_f32_16x16x32_bf16 v[240:243], v[68:71], a[108:111], v[240:243]
s_waitcnt lgkmcnt(8)
ds_read_b64_tr_b16 v[64:65], v5 offset:0
v_mfma_f32_16x16x32_bf16 v[124:127], v[72:75], a[64:67], v[124:127]
ds_read_b64_tr_b16 v[66:67], v5 offset:5120
v_mfma_f32_16x16x32_bf16 v[124:127], v[76:79], a[96:99], v[124:127]
ds_read_b64_tr_b16 v[68:69], v5 offset:10240
v_mfma_f32_16x16x32_bf16 v[164:167], v[72:75], a[68:71], v[164:167]
ds_read_b64_tr_b16 v[70:71], v5 offset:15360
v_mfma_f32_16x16x32_bf16 v[164:167], v[76:79], a[100:103], v[164:167]
v_mfma_f32_16x16x32_bf16 v[204:207], v[72:75], a[72:75], v[204:207]
s_mov_b32 s101, 0x200000
s_waitcnt vmcnt(2)
L_poll8:
v_cmp_gt_u32 vcc, 4, v19
s_cbranch_vccz L_go8
s_sub_u32 s101, s101, 1
s_cmp_eq_u32 s101, 0
s_cbranch_scc1 L_go8
buffer_load_dword v19, off, s[68:71], s17 sc1
s_waitcnt vmcnt(0)
s_branch L_poll8
L_go8:
v_mfma_f32_16x16x32_bf16 v[204:207], v[76:79], a[104:107], v[204:207]
v_mfma_f32_16x16x32_bf16 v[244:247], v[72:75], a[76:79], v[244:247]
v_mfma_f32_16x16x32_bf16 v[244:247], v[76:79], a[108:111], v[244:247]
s_waitcnt lgkmcnt(8)
ds_read_b64_tr_b16 v[72:73], v6 offset:32
v_mfma_f32_16x16x32_bf16 v[128:131], v[80:83], a[64:67], v[128:131]
ds_read_b64_tr_b16 v[74:75], v6 offset:5152
v_mfma_f32_16x16x32_bf16 v[128:131], v[84:87], a[96:99], v[128:131]
ds_read_b64_tr_b16 v[76:77], v6 offset:10272
v_mfma_f32_16x16x32_bf16 v[168:171], v[80:83], a[68:71], v[168:171]
s_add_u32 s93, s33, 0
buffer_load_dwordx4 a[16:19], v12, s[72:75], s93 offen offset:0 sc1
v_mfma_f32_16x16x32_bf16 v[168:171], v[84:87], a[100:103], v[168:171]
ds_read_b64_tr_b16 v[78:79], v6 offset:15392
v_mfma_f32_16x16x32_bf16 v[208:211], v[80:83], a[72:75], v[208:211]
v_mfma_f32_16x16x32_bf16 v[208:211], v[84:87], a[104:107], v[208:211]
v_mfma_f32_16x16x32_bf16 v[248:251], v[80:83], a[76:79], v[248:251]
s_mov_b64 exec, 1
buffer_atomic_add v31, off, s[68:71], s18 sc1
s_mov_b64 exec, -1
v_mfma_f32_16x16x32_bf16 v[248:251], v[84:87], a[108:111], v[248:251]
s_waitcnt lgkmcnt(8)
ds_read_b64_tr_b16 v[80:81], v5 offset:64
v_mfma_f32_16x16x32_bf16 v[132:135], v[88:91], a[64:67], v[132:135]
buffer_load_dwordx4 a[24:27], v13, s[72:75], s93 offen offset:0 sc1
v_mfma_f32_16x16x32_bf16 v[132:135], v[92:95], a[96:99], v[132:135]
ds_read_b64_tr_b16 v[82:83], v5 offset:5184
v_mfma_f32_16x16x32_bf16 v[172:175], v[88:91], a[68:71], v[172:175]
ds_read_b64_tr_b16 v[84:85], v5 offset:10304
v_mfma_f32_16x16x32_bf16 v[172:175], v[92:95], a[100:103], v[172:175]
ds_read_b64_tr_b16 v[86:87], v5 offset:15424
v_mfma_f32_16x16x32_bf16 v[212:215], v[88:91], a[72:75], v[212:215]
buffer_store_dwordx4 a[140:143], v16, s[24:27], s45 offen offset:0 sc1
v_mfma_f32_16x16x32_bf16 v[212:215], v[92:95], a[104:107], v[212:215]
buffer_load_dwordx4 a[48:51], v14, s[72:75], s93 offen offset:0 sc1
v_mfma_f32_16x16x32_bf16 v[252:255], v[88:91], a[76:79], v[252:255]
v_mfma_f32_16x16x32_bf16 v[252:255], v[92:95], a[108:111], v[252:255]
s_waitcnt lgkmcnt(8)
ds_read_b64_tr_b16 v[88:89], v6 offset:96
v_mfma_f32_16x16x32_bf16 v[96:99], v[64:67], a[128:131], v[96:99]
ds_read_b64_tr_b16 v[90:91], v6 offset:5216
v_mfma_f32_16x16x32_bf16 v[96:99], v[68:71], a[160:163], v[96:99]
ds_read_b64_tr_b16 v[92:93], v6 offset:10336
v_mfma_f32_16x16x32_bf16 v[136:139], v[64:67], a[132:135], v[136:139]
ds_read_b64_tr_b16 v[94:95], v6 offset:15456
v_mfma_f32_16x16x32_bf16 v[136:139], v[68:71], a[164:167], v[136:139]
buffer_load_dwordx4 a[56:59], v15, s[72:75], s93 offen offset:0 sc1
v_mfma_f32_16x16x32_bf16 v[176:179], v[64:67], a[136:139], v[176:179]
v_mfma_f32_16x16x32_bf16 v[176:179], v[68:71], a[168:171], v[176:179]
v_mfma_f32_16x16x32_bf16 v[216:219], v[64:67], a[140:143], v[216:219]
v_mfma_f32_16x16x32_bf16 v[216:219], v[68:71], a[172:175], v[216:219]
s_waitcnt lgkmcnt(8)
ds_read_b64_tr_b16 v[64:65], v5 offset:128
v_mfma_f32_16x16x32_bf16 v[100:103], v[72:75], a[128:131], v[100:103]
ds_read_b64_tr_b16 v[66:67], v5 offset:5248
v_mfma_f32_16x16x32_bf16 v[100:103], v[76:79], a[160:163], v[100:103]
buffer_load_dwordx4 a[20:23], v12, s[72:75], s93 offen offset:1024 sc1
v_mfma_f32_16x16x32_bf16 v[140:143], v[72:75], a[132:135], v[140:143]
ds_read_b64_tr_b16 v[68:69], v5 offset:10368
v_mfma_f32_16x16x32_bf16 v[140:143], v[76:79], a[164:167], v[140:143]
ds_read_b64_tr_b16 v[70:71], v5 offset:15488
v_mfma_f32_16x16x32_bf16 v[180:183], v[72:75], a[136:139], v[180:183]
v_mfma_f32_16x16x32_bf16 v[180:183], v[76:79], a[168:171], v[180:183]
v_mfma_f32_16x16x32_bf16 v[220:223], v[72:75], a[140:143], v[220:223]
v_mfma_f32_16x16x32_bf16 v[220:223], v[76:79], a[172:175], v[220:223]
s_waitcnt lgkmcnt(8)
ds_read_b64_tr_b16 v[72:73], v6 offset:160
v_mfma_f32_16x16x32_bf16 v[104:107], v[80:83], a[128:131], v[104:107]
buffer_load_dwordx4 a[28:31], v13, s[72:75], s93 offen offset:1024 sc1
v_mfma_f32_16x16x32_bf16 v[104:107], v[84:87], a[160:163], v[104:107]
ds_read_b64_tr_b16 v[74:75], v6 offset:5280
v_mfma_f32_16x16x32_bf16 v[144:147], v[80:83], a[132:135], v[144:147]
ds_read_b64_tr_b16 v[76:77], v6 offset:10400
buffer_store_dwordx4 a[160:163], v16, s[24:27], s42 offen offset:1024 sc1
v_mfma_f32_16x16x32_bf16 v[144:147], v[84:87], a[164:167], v[144:147]
ds_read_b64_tr_b16 v[78:79], v6 offset:15520
v_mfma_f32_16x16x32_bf16 v[184:187], v[80:83], a[136:139], v[184:187]
buffer_load_dwordx4 a[52:55], v14, s[72:75], s93 offen offset:1024 sc1
v_mfma_f32_16x16x32_bf16 v[184:187], v[84:87], a[168:171], v[184:187]
v_mfma_f32_16x16x32_bf16 v[224:227], v[80:83], a[140:143], v[224:227]
v_mfma_f32_16x16x32_bf16 v[224:227], v[84:87], a[172:175], v[224:227]
s_waitcnt lgkmcnt(8)
ds_read_b64_tr_b16 v[80:81], v5 offset:192
v_mfma_f32_16x16x32_bf16 v[108:111], v[88:91], a[128:131], v[108:111]
ds_read_b64_tr_b16 v[82:83], v5 offset:5312
v_mfma_f32_16x16x32_bf16 v[108:111], v[92:95], a[160:163], v[108:111]
ds_read_b64_tr_b16 v[84:85], v5 offset:10432
v_mfma_f32_16x16x32_bf16 v[148:151], v[88:91], a[132:135], v[148:151]
buffer_load_dwordx4 a[60:63], v15, s[72:75], s93 offen offset:1024 sc1
v_mfma_f32_16x16x32_bf16 v[148:151], v[92:95], a[164:167], v[148:151]
ds_read_b64_tr_b16 v[86:87], v5 offset:15552
v_mfma_f32_16x16x32_bf16 v[188:191], v[88:91], a[136:139], v[188:191]
v_mfma_f32_16x16x32_bf16 v[188:191], v[92:95], a[168:171], v[188:191]
v_mfma_f32_16x16x32_bf16 v[228:231], v[88:91], a[140:143], v[228:231]
v_mfma_f32_16x16x32_bf16 v[228:231], v[92:95], a[172:175], v[228:231]
s_waitcnt lgkmcnt(8)
ds_read_b64_tr_b16 v[88:89], v6 offset:224
v_mfma_f32_16x16x32_bf16 v[112:115], v[64:67], a[128:131], v[112:115]
s_add_u32 s93, s34, 0
buffer_load_dwordx4 a[80:83], v12, s[72:75], s93 offen offset:0 sc1
v_mfma_f32_16x16x32_bf16 v[112:115], v[68:71], a[160:163], v[112:115]
ds_read_b64_tr_b16 v[90:91], v6 offset:5344
v_mfma_f32_16x16x32_bf16 v[152:155], v[64:67], a[132:135], v[152:155]
ds_read_b64_tr_b16 v[92:93], v6 offset:10464
v_mfma_f32_16x16x32_bf16 v[152:155], v[68:71], a[164:167], v[152:155]
ds_read_b64_tr_b16 v[94:95], v6 offset:15584
v_mfma_f32_16x16x32_bf16 v[192:195], v[64:67], a[136:139], v[192:195]
v_mfma_f32_16x16x32_bf16 v[192:195], v[68:71], a[168:171], v[192:195]
v_mfma_f32_16x16x32_bf16 v[232:235], v[64:67], a[140:143], v[232:235]
buffer_load_dwordx4 a[88:91], v13, s[72:75], s93 offen offset:0 sc1
v_mfma_f32_16x16x32_bf16 v[232:235], v[68:71], a[172:175], v[232:235]
s_waitcnt lgkmcnt(8)
ds_read_b64_tr_b16 v[64:65], v5 offset:256
v_mfma_f32_16x16x32_bf16 v[116:119], v[72:75], a[128:131], v[116:119]
ds_read_b64_tr_b16 v[66:67], v5 offset:5376
buffer_store_dwordx4 a[164:167], v16, s[24:27], s43 offen offset:1024 sc1
v_mfma_f32_16x16x32_bf16 v[116:119], v[76:79], a[160:163], v[116:119]
ds_read_b64_tr_b16 v[68:69], v5 offset:10496
v_mfma_f32_16x16x32_bf16 v[156:159], v[72:75], a[132:135], v[156:159]
ds_read_b64_tr_b16 v[70:71], v5 offset:15616
v_mfma_f32_16x16x32_bf16 v[156:159], v[76:79], a[164:167], v[156:159]
v_mfma_f32_16x16x32_bf16 v[196:199], v[72:75], a[136:139], v[196:199]
buffer_load_dwordx4 a[112:115], v14, s[72:75], s93 offen offset:0 sc1
v_mfma_f32_16x16x32_bf16 v[196:199], v[76:79], a[168:171], v[196:199]
v_mfma_f32_16x16x32_bf16 v[236:239], v[72:75], a[140:143], v[236:239]
v_mfma_f32_16x16x32_bf16 v[236:239], v[76:79], a[172:175], v[236:239]
s_waitcnt lgkmcnt(8)
ds_read_b64_tr_b16 v[72:73], v6 offset:288
v_mfma_f32_16x16x32_bf16 v[120:123], v[80:83], a[128:131], v[120:123]
ds_read_b64_tr_b16 v[74:75], v6 offset:5408
v_mfma_f32_16x16x32_bf16 v[120:123], v[84:87], a[160:163], v[120:123]
buffer_load_dwordx4 a[120:123], v15, s[72:75], s93 offen offset:0 sc1
v_mfma_f32_16x16x32_bf16 v[160:163], v[80:83], a[132:135], v[160:163]
ds_read_b64_tr_b16 v[76:77], v6 offset:10528
v_mfma_f32_16x16x32_bf16 v[160:163], v[84:87], a[164:167], v[160:163]
ds_read_b64_tr_b16 v[78:79], v6 offset:15648
v_mfma_f32_16x16x32_bf16 v[200:203], v[80:83], a[136:139], v[200:203]
v_mfma_f32_16x16x32_bf16 v[200:203], v[84:87], a[168:171], v[200:203]
v_mfma_f32_16x16x32_bf16 v[240:243], v[80:83], a[140:143], v[240:243]
v_mfma_f32_16x16x32_bf16 v[240:243], v[84:87], a[172:175], v[240:243]
s_waitcnt lgkmcnt(8)
s_barrier
v_mfma_f32_16x16x32_bf16 v[124:127], v[88:91], a[128:131], v[124:127]
buffer_load_dwordx4 a[84:87], v12, s[72:75], s93 offen offset:1024 sc1
v_mfma_f32_16x16x32_bf16 v[124:127], v[92:95], a[160:163], v[124:127]
ds_read_b64_tr_b16 v[80:81], v5 offset:20480
v_mfma_f32_16x16x32_bf16 v[164:167], v[88:91], a[132:135], v[164:167]
ds_read_b64_tr_b16 v[82:83], v5 offset:25600
v_mfma_f32_16x16x32_bf16 v[164:167], v[92:95], a[164:167], v[164:167]
ds_read_b64_tr_b16 v[84:85], v5 offset:30720
v_mfma_f32_16x16x32_bf16 v[204:207], v[88:91], a[136:139], v[204:207]
ds_read_b64_tr_b16 v[86:87], v5 offset:35840
v_mfma_f32_16x16x32_bf16 v[204:207], v[92:95], a[168:171], v[204:207]
buffer_load_dwordx4 a[92:95], v13, s[72:75], s93 offen offset:1024 sc1
v_mfma_f32_16x16x32_bf16 v[244:247], v[88:91], a[140:143], v[244:247]
buffer_store_dwordx4 a[168:171], v16, s[24:27], s44 offen offset:1024 sc1
v_mfma_f32_16x16x32_bf16 v[244:247], v[92:95], a[172:175], v[244:247]
s_waitcnt lgkmcnt(8)
ds_read_b64_tr_b16 v[88:89], v6 offset:20512
v_mfma_f32_16x16x32_bf16 v[128:131], v[64:67], a[128:131], v[128:131]
ds_read_b64_tr_b16 v[90:91], v6 offset:25632
v_mfma_f32_16x16x32_bf16 v[128:131], v[68:71], a[160:163], v[128:131]
ds_read_b64_tr_b16 v[92:93], v6 offset:30752
v_mfma_f32_16x16x32_bf16 v[168:171], v[64:67], a[132:135], v[168:171]
ds_read_b64_tr_b16 v[94:95], v6 offset:35872
v_mfma_f32_16x16x32_bf16 v[168:171], v[68:71], a[164:167], v[168:171]
buffer_load_dwordx4 a[116:119], v14, s[72:75], s93 offen offset:1024 sc1
v_mfma_f32_16x16x32_bf16 v[208:211], v[64:67], a[136:139], v[208:211]
v_mfma_f32_16x16x32_bf16 v[208:211], v[68:71], a[168:171], v[208:211]
v_mfma_f32_16x16x32_bf16 v[248:251], v[64:67], a[140:143], v[248:251]
v_mfma_f32_16x16x32_bf16 v[248:251], v[68:71], a[172:175], v[248:251]
s_waitcnt lgkmcnt(8)
ds_read_b64_tr_b16 v[64:65], v5 offset:20544
v_mfma_f32_16x16x32_bf16 v[132:135], v[72:75], a[128:131], v[132:135]
ds_read_b64_tr_b16 v[66:67], v5 offset:25664
v_mfma_f32_16x16x32_bf16 v[132:135], v[76:79], a[160:163], v[132:135]
buffer_load_dwordx4 a[124:127], v15, s[72:75], s93 offen offset:1024 sc1
v_mfma_f32_16x16x32_bf16 v[172:175], v[72:75], a[132:135], v[172:175]
ds_read_b64_tr_b16 v[68:69], v5 offset:30784
v_mfma_f32_16x16x32_bf16 v[172:175], v[76:79], a[164:167], v[172:175]
ds_read_b64_tr_b16 v[70:71], v5 offset:35904
v_mfma_f32_16x16x32_bf16 v[212:215], v[72:75], a[136:139], v[212:215]
v_mfma_f32_16x16x32_bf16 v[212:215], v[76:79], a[168:171], v[212:215]
v_mfma_f32_16x16x32_bf16 v[252:255], v[72:75], a[140:143], v[252:255]
s_add_u32 s93, s35, 0
buffer_load_dwordx4 a[144:147], v12, s[72:75], s93 offen offset:0 sc1
v_mfma_f32_16x16x32_bf16 v[252:255], v[76:79], a[172:175], v[252:255]
s_waitcnt vmcnt(11) lgkmcnt(8)
ds_read_b64_tr_b16 v[72:73], v6 offset:20576
v_mfma_f32_16x16x32_bf16 v[96:99], v[80:83], a[16:19], v[96:99]
ds_read_b64_tr_b16 v[74:75], v6 offset:25696
v_mfma_f32_16x16x32_bf16 v[96:99], v[84:87], a[20:23], v[96:99]
ds_read_b64_tr_b16 v[76:77], v6 offset:30816
v_mfma_f32_16x16x32_bf16 v[136:139], v[80:83], a[24:27], v[136:139]
ds_read_b64_tr_b16 v[78:79], v6 offset:35936
v_mfma_f32_16x16x32_bf16 v[136:139], v[84:87], a[28:31], v[136:139]
v_mfma_f32_16x16x32_bf16 v[176:179], v[80:83], a[48:51], v[176:179]
buffer_load_dwordx4 a[152:155], v13, s[72:75], s93 offen offset:0 sc1
buffer_store_dwordx4 a[172:175], v16, s[24:27], s45 offen offset:1024 sc1
v_mfma_f32_16x16x32_bf16 v[176:179], v[84:87], a[52:55], v[176:179]
v_mfma_f32_16x16x32_bf16 v[216:219], v[80:83], a[56:59], v[216:219]
v_mfma_f32_16x16x32_bf16 v[216:219], v[84:87], a[60:63], v[216:219]
s_waitcnt lgkmcnt(8)
ds_read_b64_tr_b16 v[80:81], v5 offset:20608
v_mfma_f32_16x16x32_bf16 v[100:103], v[88:91], a[16:19], v[100:103]
ds_read_b64_tr_b16 v[82:83], v5 offset:25728
v_mfma_f32_16x16x32_bf16 v[100:103], v[92:95], a[20:23], v[100:103]
ds_read_b64_tr_b16 v[84:85], v5 offset:30848
v_mfma_f32_16x16x32_bf16 v[140:143], v[88:91], a[24:27], v[140:143]
buffer_load_dwordx4 a[176:179], v14, s[72:75], s93 offen offset:0 sc1
v_mfma_f32_16x16x32_bf16 v[140:143], v[92:95], a[28:31], v[140:143]
ds_read_b64_tr_b16 v[86:87], v5 offset:35968
v_mfma_f32_16x16x32_bf16 v[180:183], v[88:91], a[48:51], v[180:183]
v_mfma_f32_16x16x32_bf16 v[180:183], v[92:95], a[52:55], v[180:183]
v_mfma_f32_16x16x32_bf16 v[220:223], v[88:91], a[56:59], v[220:223]
v_mfma_f32_16x16x32_bf16 v[220:223], v[92:95], a[60:63], v[220:223]
s_waitcnt lgkmcnt(8)
ds_read_b64_tr_b16 v[88:89], v6 offset:20640
v_mfma_f32_16x16x32_bf16 v[104:107], v[64:67], a[16:19], v[104:107]
buffer_load_dwordx4 a[184:187], v15, s[72:75], s93 offen offset:0 sc1
v_mfma_f32_16x16x32_bf16 v[104:107], v[68:71], a[20:23], v[104:107]
ds_read_b64_tr_b16 v[90:91], v6 offset:25760
v_mfma_f32_16x16x32_bf16 v[144:147], v[64:67], a[24:27], v[144:147]
ds_read_b64_tr_b16 v[92:93], v6 offset:30880
v_mfma_f32_16x16x32_bf16 v[144:147], v[68:71], a[28:31], v[144:147]
ds_read_b64_tr_b16 v[94:95], v6 offset:36000
v_mfma_f32_16x16x32_bf16 v[184:187], v[64:67], a[48:51], v[184:187]
v_mfma_f32_16x16x32_bf16 v[184:187], v[68:71], a[52:55], v[184:187]
v_mfma_f32_16x16x32_bf16 v[224:227], v[64:67], a[56:59], v[224:227]
buffer_load_dwordx4 a[148:151], v12, s[72:75], s93 offen offset:1024 sc1
v_mfma_f32_16x16x32_bf16 v[224:227], v[68:71], a[60:63], v[224:227]
s_waitcnt lgkmcnt(8)
ds_read_b64_tr_b16 v[64:65], v5 offset:20672
v_mfma_f32_16x16x32_bf16 v[108:111], v[72:75], a[16:19], v[108:111]
ds_read_b64_tr_b16 v[66:67], v5 offset:25792
v_mfma_f32_16x16x32_bf16 v[108:111], v[76:79], a[20:23], v[108:111]
ds_read_b64_tr_b16 v[68:69], v5 offset:30912
v_mfma_f32_16x16x32_bf16 v[148:151], v[72:75], a[24:27], v[148:151]
ds_read_b64_tr_b16 v[70:71], v5 offset:36032
v_mfma_f32_16x16x32_bf16 v[148:151], v[76:79], a[28:31], v[148:151]
buffer_load_dwordx4 a[156:159], v13, s[72:75], s93 offen offset:1024 sc1
v_mfma_f32_16x16x32_bf16 v[188:191], v[72:75], a[48:51], v[188:191]
v_mfma_f32_16x16x32_bf16 v[188:191], v[76:79], a[52:55], v[188:191]
v_mfma_f32_16x16x32_bf16 v[228:231], v[72:75], a[56:59], v[228:231]
v_mfma_f32_16x16x32_bf16 v[228:231], v[76:79], a[60:63], v[228:231]
s_waitcnt lgkmcnt(8)
ds_read_b64_tr_b16 v[72:73], v6 offset:20704
v_mfma_f32_16x16x32_bf16 v[112:115], v[80:83], a[16:19], v[112:115]
ds_read_b64_tr_b16 v[74:75], v6 offset:25824
v_mfma_f32_16x16x32_bf16 v[112:115], v[84:87], a[20:23], v[112:115]
buffer_load_dwordx4 a[180:183], v14, s[72:75], s93 offen offset:1024 sc1
v_mfma_f32_16x16x32_bf16 v[152:155], v[80:83], a[24:27], v[152:155]
ds_read_b64_tr_b16 v[76:77], v6 offset:30944
v_mfma_f32_16x16x32_bf16 v[152:155], v[84:87], a[28:31], v[152:155]
ds_read_b64_tr_b16 v[78:79], v6 offset:36064
v_mfma_f32_16x16x32_bf16 v[192:195], v[80:83], a[48:51], v[192:195]
v_mfma_f32_16x16x32_bf16 v[192:195], v[84:87], a[52:55], v[192:195]
v_mfma_f32_16x16x32_bf16 v[232:235], v[80:83], a[56:59], v[232:235]
v_mfma_f32_16x16x32_bf16 v[232:235], v[84:87], a[60:63], v[232:235]
s_waitcnt lgkmcnt(8)
ds_read_b64_tr_b16 v[80:81], v5 offset:20736
v_mfma_f32_16x16x32_bf16 v[116:119], v[88:91], a[16:19], v[116:119]
buffer_load_dwordx4 a[188:191], v15, s[72:75], s93 offen offset:1024 sc1
buffer_load_dword v19, off, s[68:71], s18 sc1
v_mfma_f32_16x16x32_bf16 v[116:119], v[92:95], a[20:23], v[116:119]
ds_read_b64_tr_b16 v[82:83], v5 offset:25856
v_mfma_f32_16x16x32_bf16 v[156:159], v[88:91], a[24:27], v[156:159]
ds_read_b64_tr_b16 v[84:85], v5 offset:30976
v_mfma_f32_16x16x32_bf16 v[156:159], v[92:95], a[28:31], v[156:159]
ds_read_b64_tr_b16 v[86:87], v5 offset:36096
v_mfma_f32_16x16x32_bf16 v[196:199], v[88:91], a[48:51], v[196:199]
s_add_u32 s92, s97, 81920
s_add_u32 m0, s94, 81920
v_mfma_f32_16x16x32_bf16 v[196:199], v[92:95], a[52:55], v[196:199]
buffer_load_dwordx4 v21, s[48:51], s92 offen  lds
v_mfma_f32_16x16x32_bf16 v[236:239], v[88:91], a[56:59], v[236:239]
v_mfma_f32_16x16x32_bf16 v[236:239], v[92:95], a[60:63], v[236:239]
s_waitcnt lgkmcnt(8)
ds_read_b64_tr_b16 v[88:89], v6 offset:20768
v_mfma_f32_16x16x32_bf16 v[120:123], v[64:67], a[16:19], v[120:123]
ds_read_b64_tr_b16 v[90:91], v6 offset:25888
v_mfma_f32_16x16x32_bf16 v[120:123], v[68:71], a[20:23], v[120:123]
ds_read_b64_tr_b16 v[92:93], v6 offset:31008
v_mfma_f32_16x16x32_bf16 v[160:163], v[64:67], a[24:27], v[160:163]
s_add_u32 m0, s94, 82944
ds_read_b64_tr_b16 v[94:95], v6 offset:36128
v_mfma_f32_16x16x32_bf16 v[160:163], v[68:71], a[28:31], v[160:163]
buffer_load_dwordx4 v22, s[48:51], s92 offen  lds
v_mfma_f32_16x16x32_bf16 v[200:203], v[64:67], a[48:51], v[200:203]
v_mfma_f32_16x16x32_bf16 v[200:203], v[68:71], a[52:55], v[200:203]
v_mfma_f32_16x16x32_bf16 v[240:243], v[64:67], a[56:59], v[240:243]
v_mfma_f32_16x16x32_bf16 v[240:243], v[68:71], a[60:63], v[240:243]
s_waitcnt lgkmcnt(8)
s_add_u32 m0, s94, 83968
v_mfma_f32_16x16x32_bf16 v[124:127], v[72:75], a[16:19], v[124:127]
buffer_load_dwordx4 v23, s[48:51], s92 offen  lds
v_mfma_f32_16x16x32_bf16 v[124:127], v[76:79], a[20:23], v[124:127]
ds_read_b64_tr_b16 v[64:65], v5 offset:40960
v_mfma_f32_16x16x32_bf16 v[164:167], v[72:75], a[24:27], v[164:167]
ds_read_b64_tr_b16 v[66:67], v5 offset:46080
v_mfma_f32_16x16x32_bf16 v[164:167], v[76:79], a[28:31], v[164:167]
ds_read_b64_tr_b16 v[68:69], v5 offset:51200
v_mfma_f32_16x16x32_bf16 v[204:207], v[72:75], a[48:51], v[204:207]
ds_read_b64_tr_b16 v[70:71], v5 offset:56320
v_mfma_f32_16x16x32_bf16 v[204:207], v[76:79], a[52:55], v[204:207]
s_add_u32 m0, s94, 84992
v_mfma_f32_16x16x32_bf16 v[244:247], v[72:75], a[56:59], v[244:247]
buffer_load_dwordx4 v24, s[48:51], s92 offen  lds
v_mfma_f32_16x16x32_bf16 v[244:247], v[76:79], a[60:63], v[244:247]
s_waitcnt lgkmcnt(8)
ds_read_b64_tr_b16 v[72:73], v6 offset:40992
v_mfma_f32_16x16x32_bf16 v[128:131], v[80:83], a[16:19], v[128:131]
ds_read_b64_tr_b16 v[74:75], v6 offset:46112
v_mfma_f32_16x16x32_bf16 v[128:131], v[84:87], a[20:23], v[128:131]
ds_read_b64_tr_b16 v[76:77], v6 offset:51232
v_mfma_f32_16x16x32_bf16 v[168:171], v[80:83], a[24:27], v[168:171]
ds_read_b64_tr_b16 v[78:79], v6 offset:56352
v_mfma_f32_16x16x32_bf16 v[168:171], v[84:87], a[28:31], v[168:171]
s_add_u32 m0, s94, 86016
v_mfma_f32_16x16x32_bf16 v[208:211], v[80:83], a[48:51], v[208:211]
buffer_load_dwordx4 v25, s[48:51], s92 offen  lds
v_mfma_f32_16x16x32_bf16 v[208:211], v[84:87], a[52:55], v[208:211]
v_mfma_f32_16x16x32_bf16 v[248:251], v[80:83], a[56:59], v[248:251]
v_mfma_f32_16x16x32_bf16 v[248:251], v[84:87], a[60:63], v[248:251]
s_waitcnt lgkmcnt(8)
ds_read_b64_tr_b16 v[80:81], v5 offset:41024
v_mfma_f32_16x16x32_bf16 v[132:135], v[88:91], a[16:19], v[132:135]
ds_read_b64_tr_b16 v[82:83], v5 offset:46144
v_mfma_f32_16x16x32_bf16 v[132:135], v[92:95], a[20:23], v[132:135]
s_add_u32 s92, s98, 81920
s_add_u32 m0, s94, 102400
v_mfma_f32_16x16x32_bf16 v[172:175], v[88:91], a[24:27], v[172:175]
buffer_load_dwordx4 v21, s[48:51], s92 offen  lds
v_mfma_f32_16x16x32_bf16 v[172:175], v[92:95], a[28:31], v[172:175]
ds_read_b64_tr_b16 v[84:85], v5 offset:51264
v_mfma_f32_16x16x32_bf16 v[212:215], v[88:91], a[48:51], v[212:215]
ds_read_b64_tr_b16 v[86:87], v5 offset:56384
v_mfma_f32_16x16x32_bf16 v[212:215], v[92:95], a[52:55], v[212:215]
v_mfma_f32_16x16x32_bf16 v[252:255], v[88:91], a[56:59], v[252:255]
v_mfma_f32_16x16x32_bf16 v[252:255], v[92:95], a[60:63], v[252:255]
s_waitcnt vmcnt(16) lgkmcnt(8)
s_add_u32 m0, s94, 103424
v_mfma_f32_16x16x32_bf16 v[96:99], v[64:67], a[80:83], v[96:99]
buffer_load_dwordx4 v22, s[48:51], s92 offen  lds
s_mov_b32 s101, 0x200000
s_waitcnt vmcnt(7)
L_poll9:
v_cmp_gt_u32 vcc, 4, v19
s_cbranch_vccz L_go9
s_sub_u32 s101, s101, 1
s_cmp_eq_u32 s101, 0
s_cbranch_scc1 L_go9
buffer_load_dword v19, off, s[68:71], s18 sc1
s_waitcnt vmcnt(0)
s_branch L_poll9
L_go9:
v_mfma_f32_16x16x32_bf16 v[96:99], v[68:71], a[84:87], v[96:99]
s_lshl_b32 s20, s8, 5
ds_read_b64_tr_b16 v[88:89], v6 offset:41056
v_mfma_f32_16x16x32_bf16 v[136:139], v[64:67], a[88:91], v[136:139]
s_lshr_b32 s21, s2, 3
ds_read_b64_tr_b16 v[90:91], v6 offset:46176
v_mfma_f32_16x16x32_bf16 v[136:139], v[68:71], a[92:95], v[136:139]
s_add_u32 s20, s20, s21
ds_read_b64_tr_b16 v[92:93], v6 offset:51296
v_mfma_f32_16x16x32_bf16 v[176:179], v[64:67], a[112:115], v[176:179]
s_add_u32 m0, s94, 104448
ds_read_b64_tr_b16 v[94:95], v6 offset:56416
v_mfma_f32_16x16x32_bf16 v[176:179], v[68:71], a[116:119], v[176:179]
buffer_load_dwordx4 v23, s[48:51], s92 offen  lds
v_mfma_f32_16x16x32_bf16 v[216:219], v[64:67], a[120:123], v[216:219]
v_and_b32 v40, 7, v0
v_bfe_u32 v41, v0, 3, 2
v_mfma_f32_16x16x32_bf16 v[216:219], v[68:71], a[124:127], v[216:219]
s_waitcnt lgkmcnt(8)
ds_read_b64_tr_b16 v[64:65], v5 offset:41088
v_mfma_f32_16x16x32_bf16 v[100:103], v[72:75], a[80:83], v[100:103]
ds_read_b64_tr_b16 v[66:67], v5 offset:46208
v_lshrrev_b32 v42, 5, v0
v_mfma_f32_16x16x32_bf16 v[100:103], v[76:79], a[84:87], v[100:103]
s_lshl_b32 s21, s28, 1
ds_read_b64_tr_b16 v[68:69], v5 offset:51328
v_mfma_f32_16x16x32_bf16 v[140:143], v[72:75], a[88:91], v[140:143]
s_add_u32 m0, s94, 105472
ds_read_b64_tr_b16 v[70:71], v5 offset:56448
s_mov_b64 exec, 1
buffer_atomic_add v31, off, s[68:71], s19 sc1
s_mov_b64 exec, -1
v_mfma_f32_16x16x32_bf16 v[140:143], v[76:79], a[92:95], v[140:143]
buffer_load_dwordx4 v24, s[48:51], s92 offen  lds
v_mfma_f32_16x16x32_bf16 v[180:183], v[72:75], a[112:115], v[180:183]
v_add_u32 v42, s21, v42
s_and_b32 s21, s20, 1
v_mfma_f32_16x16x32_bf16 v[180:183], v[76:79], a[116:119], v[180:183]
s_lshl_b32 s21, s21, 3
v_add_u32 v43, s21, v40
v_lshl_add_u32 v44, v41, 4, v43
v_mfma_f32_16x16x32_bf16 v[220:223], v[72:75], a[120:123], v[220:223]
v_lshlrev_b32 v44, 4, v44
v_lshl_add_u32 v32, v42, 10, v44
v_mfma_f32_16x16x32_bf16 v[220:223], v[76:79], a[124:127], v[220:223]
s_waitcnt lgkmcnt(8)
ds_read_b64_tr_b16 v[72:73], v6 offset:41120
v_mfma_f32_16x16x32_bf16 v[104:107], v[80:83], a[80:83], v[104:107]
s_add_u32 m0, s94, 106496
ds_read_b64_tr_b16 v[74:75], v6 offset:46240
v_mfma_f32_16x16x32_bf16 v[104:107], v[84:87], a[84:87], v[104:107]
buffer_load_dwordx4 v25, s[48:51], s92 offen  lds
v_mfma_f32_16x16x32_bf16 v[144:147], v[80:83], a[88:91], v[144:147]
ds_read_b64_tr_b16 v[76:77], v6 offset:51360
v_mul_u32_u24 v44, 1280, v43
v_mfma_f32_16x16x32_bf16 v[144:147], v[84:87], a[92:95], v[144:147]
ds_read_b64_tr_b16 v[78:79], v6 offset:56480
v_lshl_add_u32 v44, v42, 6, v44
v_mfma_f32_16x16x32_bf16 v[184:187], v[80:83], a[112:115], v[184:187]
v_lshl_add_u32 v34, v41, 3, v44
v_lshlrev_b32 v44, 6, v42
v_mfma_f32_16x16x32_bf16 v[184:187], v[84:87], a[116:119], v[184:187]
v_lshl_add_u32 v36, v41, 4, v44
v_lshlrev_b32 v39, 5, v40
v_mfma_f32_16x16x32_bf16 v[224:227], v[80:83], a[120:123], v[224:227]
s_lshl_b32 s21, s28, 3
v_add_u32 v38, s21, v39
v_add_u32 v38, 162816, v38
v_mfma_f32_16x16x32_bf16 v[224:227], v[84:87], a[124:127], v[224:227]
s_waitcnt lgkmcnt(8)
ds_read_b64_tr_b16 v[80:81], v5 offset:41152
v_mfma_f32_16x16x32_bf16 v[108:111], v[88:91], a[80:83], v[108:111]
s_add_u32 s93, s33, 2048
buffer_load_dwordx4 a[192:195], v12, s[72:75], s93 offen offset:0 sc1
v_mfma_f32_16x16x32_bf16 v[108:111], v[92:95], a[84:87], v[108:111]
ds_read_b64_tr_b16 v[82:83], v5 offset:46272
v_add_u32 v39, 162816, v39
v_mfma_f32_16x16x32_bf16 v[148:151], v[88:91], a[88:91], v[148:151]
ds_read_b64_tr_b16 v[84:85], v5 offset:51392
v_mfma_f32_16x16x32_bf16 v[148:151], v[92:95], a[92:95], v[148:151]
ds_read_b64_tr_b16 v[86:87], v5 offset:56512
v_mfma_f32_16x16x32_bf16 v[188:191], v[88:91], a[112:115], v[188:191]
s_cmp_lt_u32 s28, 2
s_cselect_b32 s21, 0, 0x40000000
v_add_u32 v33, s21, v32
v_mfma_f32_16x16x32_bf16 v[188:191], v[92:95], a[116:119], v[188:191]
buffer_load_dwordx4 a[200:203], v13, s[72:75], s93 offen offset:0 sc1
v_mfma_f32_16x16x32_bf16 v[228:231], v[88:91], a[120:123], v[228:231]
v_add_u32 v33, 16384, v33
v_add_u32 v35, s21, v34
v_mfma_f32_16x16x32_bf16 v[228:231], v[92:95], a[124:127], v[228:231]
s_waitcnt lgkmcnt(8)
ds_read_b64_tr_b16 v[88:89], v6 offset:41184
v_mfma_f32_16x16x32_bf16 v[112:115], v[64:67], a[80:83], v[112:115]
ds_read_b64_tr_b16 v[90:91], v6 offset:46304
v_add_u32 v37, s21, v36
v_mfma_f32_16x16x32_bf16 v[112:115], v[68:71], a[84:87], v[112:115]
s_lshr_b32 s21, s20, 1
ds_read_b64_tr_b16 v[92:93], v6 offset:51424
v_mfma_f32_16x16x32_bf16 v[152:155], v[64:67], a[88:91], v[152:155]
buffer_load_dwordx4 a[208:211], v14, s[72:75], s93 offen offset:0 sc1
v_mfma_f32_16x16x32_bf16 v[152:155], v[68:71], a[92:95], v[152:155]
s_mul_i32 s12, s21, 20480
ds_read_b64_tr_b16 v[94:95], v6 offset:56544
v_mfma_f32_16x16x32_bf16 v[192:195], v[64:67], a[112:115], v[192:195]
s_add_u32 s14, s12, 8192
s_lshr_b32 s13, s20, 3
s_lshl_b32 s13, s13, 7
v_mfma_f32_16x16x32_bf16 v[192:195], v[68:71], a[116:119], v[192:195]
s_add_u32 s13, s13, 65536
v_mfma_f32_16x16x32_bf16 v[232:235], v[64:67], a[120:123], v[232:235]
v_mfma_f32_16x16x32_bf16 v[232:235], v[68:71], a[124:127], v[232:235]
s_waitcnt lgkmcnt(8)
ds_read_b64_tr_b16 v[64:65], v5 offset:41216
v_mfma_f32_16x16x32_bf16 v[116:119], v[72:75], a[80:83], v[116:119]
buffer_load_dwordx4 a[216:219], v15, s[72:75], s93 offen offset:0 sc1
v_mfma_f32_16x16x32_bf16 v[116:119], v[76:79], a[84:87], v[116:119]
ds_read_b64_tr_b16 v[66:67], v5 offset:46336
v_mfma_f32_16x16x32_bf16 v[156:159], v[72:75], a[88:91], v[156:159]
ds_read_b64_tr_b16 v[68:69], v5 offset:51456
v_mfma_f32_16x16x32_bf16 v[156:159], v[76:79], a[92:95], v[156:159]
ds_read_b64_tr_b16 v[70:71], v5 offset:56576
v_mfma_f32_16x16x32_bf16 v[196:199], v[72:75], a[112:115], v[196:199]
v_mfma_f32_16x16x32_bf16 v[196:199], v[76:79], a[116:119], v[196:199]
v_mfma_f32_16x16x32_bf16 v[236:239], v[72:75], a[120:123], v[236:239]
buffer_load_dwordx4 a[196:199], v12, s[72:75], s93 offen offset:1024 sc1
v_mfma_f32_16x16x32_bf16 v[236:239], v[76:79], a[124:127], v[236:239]
s_waitcnt lgkmcnt(8)
ds_read_b64_tr_b16 v[72:73], v6 offset:41248
v_mfma_f32_16x16x32_bf16 v[120:123], v[80:83], a[80:83], v[120:123]
ds_read_b64_tr_b16 v[74:75], v6 offset:46368
v_mfma_f32_16x16x32_bf16 v[120:123], v[84:87], a[84:87], v[120:123]
ds_read_b64_tr_b16 v[76:77], v6 offset:51488
v_mfma_f32_16x16x32_bf16 v[160:163], v[80:83], a[88:91], v[160:163]
ds_read_b64_tr_b16 v[78:79], v6 offset:56608
v_mfma_f32_16x16x32_bf16 v[160:163], v[84:87], a[92:95], v[160:163]
v_mfma_f32_16x16x32_bf16 v[200:203], v[80:83], a[112:115], v[200:203]
buffer_load_dwordx4 a[204:207], v13, s[72:75], s93 offen offset:1024 sc1
v_mfma_f32_16x16x32_bf16 v[200:203], v[84:87], a[116:119], v[200:203]
v_mfma_f32_16x16x32_bf16 v[240:243], v[80:83], a[120:123], v[240:243]
v_mfma_f32_16x16x32_bf16 v[240:243], v[84:87], a[124:127], v[240:243]
s_waitcnt lgkmcnt(8)
ds_read_b64_tr_b16 v[80:81], v5 offset:61440
v_mfma_f32_16x16x32_bf16 v[124:127], v[88:91], a[80:83], v[124:127]
ds_read_b64_tr_b16 v[82:83], v7 offset:1024
v_mfma_f32_16x16x32_bf16 v[124:127], v[92:95], a[84:87], v[124:127]
ds_read_b64_tr_b16 v[84:85], v7 offset:6144
v_mfma_f32_16x16x32_bf16 v[164:167], v[88:91], a[88:91], v[164:167]
buffer_load_dwordx4 a[212:215], v14, s[72:75], s93 offen offset:1024 sc1
v_mfma_f32_16x16x32_bf16 v[164:167], v[92:95], a[92:95], v[164:167]
ds_read_b64_tr_b16 v[86:87], v7 offset:11264
v_mfma_f32_16x16x32_bf16 v[204:207], v[88:91], a[112:115], v[204:207]
v_mfma_f32_16x16x32_bf16 v[204:207], v[92:95], a[116:119], v[204:207]
v_mfma_f32_16x16x32_bf16 v[244:247], v[88:91], a[120:123], v[244:247]
v_mfma_f32_16x16x32_bf16 v[244:247], v[92:95], a[124:127], v[244:247]
s_waitcnt lgkmcnt(8)
ds_read_b64_tr_b16 v[88:89], v6 offset:61472
v_mfma_f32_16x16x32_bf16 v[128:131], v[64:67], a[80:83], v[128:131]
buffer_load_dwordx4 a[220:223], v15, s[72:75], s93 offen offset:1024 sc1
v_mfma_f32_16x16x32_bf16 v[128:131], v[68:71], a[84:87], v[128:131]
ds_read_b64_tr_b16 v[90:91], v8 offset:1056
v_mfma_f32_16x16x32_bf16 v[168:171], v[64:67], a[88:91], v[168:171]
ds_read_b64_tr_b16 v[92:93], v8 offset:6176
v_mfma_f32_16x16x32_bf16 v[168:171], v[68:71], a[92:95], v[168:171]
ds_read_b64_tr_b16 v[94:95], v8 offset:11296
v_mfma_f32_16x16x32_bf16 v[208:211], v[64:67], a[112:115], v[208:211]
v_mfma_f32_16x16x32_bf16 v[208:211], v[68:71], a[116:119], v[208:211]
s_add_u32 s93, s34, 2048
buffer_load_dwordx4 a[224:227], v12, s[72:75], s93 offen offset:0 sc1
v_mfma_f32_16x16x32_bf16 v[248:251], v[64:67], a[120:123], v[248:251]
v_mfma_f32_16x16x32_bf16 v[248:251], v[68:71], a[124:127], v[248:251]
s_waitcnt lgkmcnt(8)
ds_read_b64_tr_b16 v[64:65], v5 offset:61504
v_mfma_f32_16x16x32_bf16 v[132:135], v[72:75], a[80:83], v[132:135]
ds_read_b64_tr_b16 v[66:67], v7 offset:1088
v_mfma_f32_16x16x32_bf16 v[132:135], v[76:79], a[84:87], v[132:135]
ds_read_b64_tr_b16 v[68:69], v7 offset:6208
v_mfma_f32_16x16x32_bf16 v[172:175], v[72:75], a[88:91], v[172:175]
ds_read_b64_tr_b16 v[70:71], v7 offset:11328
v_mfma_f32_16x16x32_bf16 v[172:175], v[76:79], a[92:95], v[172:175]
buffer_load_dwordx4 a[232:235], v13, s[72:75], s93 offen offset:0 sc1
v_mfma_f32_16x16x32_bf16 v[212:215], v[72:75], a[112:115], v[212:215]
v_mfma_f32_16x16x32_bf16 v[212:215], v[76:79], a[116:119], v[212:215]
v_mfma_f32_16x16x32_bf16 v[252:255], v[72:75], a[120:123], v[252:255]
v_mfma_f32_16x16x32_bf16 v[252:255], v[76:79], a[124:127], v[252:255]
s_waitcnt lgkmcnt(8)
ds_read_b64_tr_b16 v[72:73], v6 offset:61536
v_mfma_f32_16x16x32_bf16 v[96:99], v[80:83], a[144:147], v[96:99]
ds_read_b64_tr_b16 v[74:75], v8 offset:1120
v_mfma_f32_16x16x32_bf16 v[96:99], v[84:87], a[148:151], v[96:99]
buffer_load_dwordx4 a[240:243], v14, s[72:75], s93 offen offset:0 sc1
v_mfma_f32_16x16x32_bf16 v[136:139], v[80:83], a[152:155], v[136:139]
ds_read_b64_tr_b16 v[76:77], v8 offset:6240
v_mfma_f32_16x16x32_bf16 v[136:139], v[84:87], a[156:159], v[136:139]
ds_read_b64_tr_b16 v[78:79], v8 offset:11360
v_mfma_f32_16x16x32_bf16 v[176:179], v[80:83], a[176:179], v[176:179]
v_mfma_f32_16x16x32_bf16 v[176:179], v[84:87], a[180:183], v[176:179]
v_mfma_f32_16x16x32_bf16 v[216:219], v[80:83], a[184:187], v[216:219]
v_mfma_f32_16x16x32_bf16 v[216:219], v[84:87], a[188:191], v[216:219]
s_waitcnt lgkmcnt(8)
ds_read_b64_tr_b16 v[80:81], v5 offset:61568
v_mfma_f32_16x16x32_bf16 v[100:103], v[88:91], a[144:147], v[100:103]
buffer_load_dwordx4 a[248:251], v15, s[72:75], s93 offen offset:0 sc1
v_mfma_f32_16x16x32_bf16 v[100:103], v[92:95], a[148:151], v[100:103]
ds_read_b64_tr_b16 v[82:83], v7 offset:1152
v_mfma_f32_16x16x32_bf16 v[140:143], v[88:91], a[152:155], v[140:143]
ds_read_b64_tr_b16 v[84:85], v7 offset:6272
v_mfma_f32_16x16x32_bf16 v[140:143], v[92:95], a[156:159], v[140:143]
ds_read_b64_tr_b16 v[86:87], v7 offset:11392
v_mfma_f32_16x16x32_bf16 v[180:183], v[88:91], a[176:179], v[180:183]
buffer_load_dwordx4 a[228:231], v12, s[72:75], s93 offen offset:1024 sc1
v_mfma_f32_16x16x32_bf16 v[180:183], v[92:95], a[180:183], v[180:183]
v_mfma_f32_16x16x32_bf16 v[220:223], v[88:91], a[184:187], v[220:223]
v_mfma_f32_16x16x32_bf16 v[220:223], v[92:95], a[188:191], v[220:223]
s_waitcnt lgkmcnt(8)
ds_read_b64_tr_b16 v[88:89], v6 offset:61600
v_mfma_f32_16x16x32_bf16 v[104:107], v[64:67], a[144:147], v[104:107]
ds_read_b64_tr_b16 v[90:91], v8 offset:1184
v_mfma_f32_16x16x32_bf16 v[104:107], v[68:71], a[148:151], v[104:107]
ds_read_b64_tr_b16 v[92:93], v8 offset:6304
v_mfma_f32_16x16x32_bf16 v[144:147], v[64:67], a[152:155], v[144:147]
buffer_load_dwordx4 a[236:239], v13, s[72:75], s93 offen offset:1024 sc1
v_mfma_f32_16x16x32_bf16 v[144:147], v[68:71], a[156:159], v[144:147]
ds_read_b64_tr_b16 v[94:95], v8 offset:11424
v_mfma_f32_16x16x32_bf16 v[184:187], v[64:67], a[176:179], v[184:187]
v_mfma_f32_16x16x32_bf16 v[184:187], v[68:71], a[180:183], v[184:187]
v_mfma_f32_16x16x32_bf16 v[224:227], v[64:67], a[184:187], v[224:227]
v_mfma_f32_16x16x32_bf16 v[224:227], v[68:71], a[188:191], v[224:227]
s_waitcnt lgkmcnt(8)
ds_read_b64_tr_b16 v[64:65], v5 offset:61632
v_mfma_f32_16x16x32_bf16 v[108:111], v[72:75], a[144:147], v[108:111]
buffer_load_dwordx4 a[244:247], v14, s[72:75], s93 offen offset:1024 sc1
v_mfma_f32_16x16x32_bf16 v[108:111], v[76:79], a[148:151], v[108:111]
ds_read_b64_tr_b16 v[66:67], v7 offset:1216
v_mfma_f32_16x16x32_bf16 v[148:151], v[72:75], a[152:155], v[148:151]
ds_read_b64_tr_b16 v[68:69], v7 offset:6336
v_mfma_f32_16x16x32_bf16 v[148:151], v[76:79], a[156:159], v[148:151]
ds_read_b64_tr_b16 v[70:71], v7 offset:11456
v_mfma_f32_16x16x32_bf16 v[188:191], v[72:75], a[176:179], v[188:191]
v_mfma_f32_16x16x32_bf16 v[188:191], v[76:79], a[180:183], v[188:191]
v_mfma_f32_16x16x32_bf16 v[228:231], v[72:75], a[184:187], v[228:231]
buffer_load_dwordx4 a[252:255], v15, s[72:75], s93 offen offset:1024 sc1
v_mfma_f32_16x16x32_bf16 v[228:231], v[76:79], a[188:191], v[228:231]
s_waitcnt lgkmcnt(8)
ds_read_b64_tr_b16 v[72:73], v6 offset:61664
v_mfma_f32_16x16x32_bf16 v[112:115], v[80:83], a[144:147], v[112:115]
ds_read_b64_tr_b16 v[74:75], v8 offset:1248
v_mfma_f32_16x16x32_bf16 v[112:115], v[84:87], a[148:151], v[112:115]
ds_read_b64_tr_b16 v[76:77], v8 offset:6368
v_mfma_f32_16x16x32_bf16 v[152:155], v[80:83], a[152:155], v[152:155]
ds_read_b64_tr_b16 v[78:79], v8 offset:11488
v_mfma_f32_16x16x32_bf16 v[152:155], v[84:87], a[156:159], v[152:155]
s_add_u32 s92, s99, 81920
s_add_u32 m0, s94, 122880
v_mfma_f32_16x16x32_bf16 v[192:195], v[80:83], a[176:179], v[192:195]
buffer_load_dwordx4 v21, s[48:51], s92 offen  lds
v_mfma_f32_16x16x32_bf16 v[192:195], v[84:87], a[180:183], v[192:195]
v_mfma_f32_16x16x32_bf16 v[232:235], v[80:83], a[184:187], v[232:235]
v_mfma_f32_16x16x32_bf16 v[232:235], v[84:87], a[188:191], v[232:235]
s_waitcnt lgkmcnt(8)
ds_read_b64_tr_b16 v[80:81], v5 offset:61696
v_mfma_f32_16x16x32_bf16 v[116:119], v[88:91], a[144:147], v[116:119]
s_add_u32 m0, s94, 123904
ds_read_b64_tr_b16 v[82:83], v7 offset:1280
v_mfma_f32_16x16x32_bf16 v[116:119], v[92:95], a[148:151], v[116:119]
buffer_load_dwordx4 v22, s[48:51], s92 offen  lds
v_mfma_f32_16x16x32_bf16 v[156:159], v[88:91], a[152:155], v[156:159]
ds_read_b64_tr_b16 v[84:85], v7 offset:6400
v_mfma_f32_16x16x32_bf16 v[156:159], v[92:95], a[156:159], v[156:159]
ds_read_b64_tr_b16 v[86:87], v7 offset:11520
v_mfma_f32_16x16x32_bf16 v[196:199], v[88:91], a[176:179], v[196:199]
v_mfma_f32_16x16x32_bf16 v[196:199], v[92:95], a[180:183], v[196:199]
v_mfma_f32_16x16x32_bf16 v[236:239], v[88:91], a[184:187], v[236:239]
s_add_u32 m0, s94, 124928
v_mfma_f32_16x16x32_bf16 v[236:239], v[92:95], a[188:191], v[236:239]
s_waitcnt lgkmcnt(8)
ds_read_b64_tr_b16 v[88:89], v6 offset:61728
v_mfma_f32_16x16x32_bf16 v[120:123], v[64:67], a[144:147], v[120:123]
buffer_load_dwordx4 v23, s[48:51], s92 offen  lds
v_mfma_f32_16x16x32_bf16 v[120:123], v[68:71], a[148:151], v[120:123]
ds_read_b64_tr_b16 v[90:91], v8 offset:1312
v_mfma_f32_16x16x32_bf16 v[160:163], v[64:67], a[152:155], v[160:163]
ds_read_b64_tr_b16 v[92:93], v8 offset:6432
v_mfma_f32_16x16x32_bf16 v[160:163], v[68:71], a[156:159], v[160:163]
ds_read_b64_tr_b16 v[94:95], v8 offset:11552
v_mfma_f32_16x16x32_bf16 v[200:203], v[64:67], a[176:179], v[200:203]
s_add_u32 m0, s94, 125952
v_mfma_f32_16x16x32_bf16 v[200:203], v[68:71], a[180:183], v[200:203]
buffer_load_dwordx4 v24, s[48:51], s92 offen  lds
v_mfma_f32_16x16x32_bf16 v[240:243], v[64:67], a[184:187], v[240:243]
v_mfma_f32_16x16x32_bf16 v[240:243], v[68:71], a[188:191], v[240:243]
s_waitcnt lgkmcnt(8)
s_waitcnt vmcnt(20)
s_barrier
v_mfma_f32_16x16x32_bf16 v[124:127], v[72:75], a[144:147], v[124:127]
ds_read_b64_tr_b16 v[64:65], v7 offset:16384
v_mfma_f32_16x16x32_bf16 v[124:127], v[76:79], a[148:151], v[124:127]
ds_read_b64_tr_b16 v[66:67], v7 offset:21504
v_mfma_f32_16x16x32_bf16 v[164:167], v[72:75], a[152:155], v[164:167]
s_add_u32 m0, s94, 126976
ds_read_b64_tr_b16 v[68:69], v7 offset:26624
v_mfma_f32_16x16x32_bf16 v[164:167], v[76:79], a[156:159], v[164:167]
buffer_load_dwordx4 v25, s[48:51], s92 offen  lds
v_mfma_f32_16x16x32_bf16 v[204:207], v[72:75], a[176:179], v[204:207]
ds_read_b64_tr_b16 v[70:71], v7 offset:31744
buffer_load_dword v19, off, s[68:71], s19 sc1
v_mfma_f32_16x16x32_bf16 v[204:207], v[76:79], a[180:183], v[204:207]
v_mfma_f32_16x16x32_bf16 v[244:247], v[72:75], a[184:187], v[244:247]
v_mfma_f32_16x16x32_bf16 v[244:247], v[76:79], a[188:191], v[244:247]
s_waitcnt lgkmcnt(8)
ds_read_b64_tr_b16 v[72:73], v8 offset:16416
v_mfma_f32_16x16x32_bf16 v[128:131], v[80:83], a[144:147], v[128:131]
s_add_u32 s92, s97, 163840
s_add_u32 m0, s94, 143360
v_mfma_f32_16x16x32_bf16 v[128:131], v[84:87], a[148:151], v[128:131]
buffer_load_dwordx4 v21, s[48:51], s92 offen  lds
v_mfma_f32_16x16x32_bf16 v[168:171], v[80:83], a[152:155], v[168:171]
ds_read_b64_tr_b16 v[74:75], v8 offset:21536
v_mfma_f32_16x16x32_bf16 v[168:171], v[84:87], a[156:159], v[168:171]
ds_read_b64_tr_b16 v[76:77], v8 offset:26656
v_mfma_f32_16x16x32_bf16 v[208:211], v[80:83], a[176:179], v[208:211]
ds_read_b64_tr_b16 v[78:79], v8 offset:31776
v_mfma_f32_16x16x32_bf16 v[208:211], v[84:87], a[180:183], v[208:211]
s_add_u32 m0, s94, 144384
v_mfma_f32_16x16x32_bf16 v[248:251], v[80:83], a[184:187], v[248:251]
buffer_load_dwordx4 v22, s[48:51], s92 offen  lds
v_mfma_f32_16x16x32_bf16 v[248:251], v[84:87], a[188:191], v[248:251]
s_waitcnt lgkmcnt(8)
ds_read_b64_tr_b16 v[80:81], v7 offset:16448
v_mfma_f32_16x16x32_bf16 v[132:135], v[88:91], a[144:147], v[132:135]
ds_read_b64_tr_b16 v[82:83], v7 offset:21568
v_mfma_f32_16x16x32_bf16 v[132:135], v[92:95], a[148:151], v[132:135]
ds_read_b64_tr_b16 v[84:85], v7 offset:26688
v_mfma_f32_16x16x32_bf16 v[172:175], v[88:91], a[152:155], v[172:175]
ds_read_b64_tr_b16 v[86:87], v7 offset:31808
v_mfma_f32_16x16x32_bf16 v[172:175], v[92:95], a[156:159], v[172:175]
s_add_u32 m0, s94, 145408
v_mfma_f32_16x16x32_bf16 v[212:215], v[88:91], a[176:179], v[212:215]
buffer_load_dwordx4 v23, s[48:51], s92 offen  lds
v_mfma_f32_16x16x32_bf16 v[212:215], v[92:95], a[180:183], v[212:215]
v_mfma_f32_16x16x32_bf16 v[252:255], v[88:91], a[184:187], v[252:255]
v_mfma_f32_16x16x32_bf16 v[252:255], v[92:95], a[188:191], v[252:255]
s_waitcnt vmcnt(17) lgkmcnt(8)
ds_read_b64_tr_b16 v[88:89], v8 offset:16480
v_mfma_f32_16x16x32_bf16 v[96:99], v[64:67], a[192:195], v[96:99]
ds_read_b64_tr_b16 v[90:91], v8 offset:21600
v_mfma_f32_16x16x32_bf16 v[96:99], v[68:71], a[196:199], v[96:99]
s_add_u32 m0, s94, 146432
ds_read_b64_tr_b16 v[92:93], v8 offset:26720
v_mfma_f32_16x16x32_bf16 v[136:139], v[64:67], a[200:203], v[136:139]
buffer_load_dwordx4 v24, s[48:51], s92 offen  lds
v_mfma_f32_16x16x32_bf16 v[136:139], v[68:71], a[204:207], v[136:139]
ds_read_b64_tr_b16 v[94:95], v8 offset:31840
v_mfma_f32_16x16x32_bf16 v[176:179], v[64:67], a[208:211], v[176:179]
v_mfma_f32_16x16x32_bf16 v[176:179], v[68:71], a[212:215], v[176:179]
v_mfma_f32_16x16x32_bf16 v[216:219], v[64:67], a[216:219], v[216:219]
v_mfma_f32_16x16x32_bf16 v[216:219], v[68:71], a[220:223], v[216:219]
s_waitcnt lgkmcnt(8)
s_add_u32 m0, s94, 147456
v_mfma_f32_16x16x32_bf16 v[100:103], v[72:75], a[192:195], v[100:103]
buffer_load_dwordx4 v25, s[48:51], s92 offen  lds
v_mfma_f32_16x16x32_bf16 v[100:103], v[76:79], a[196:199], v[100:103]
ds_read_b64_tr_b16 v[64:65], v7 offset:16512
v_mfma_f32_16x16x32_bf16 v[140:143], v[72:75], a[200:203], v[140:143]
ds_read_b64_tr_b16 v[66:67], v7 offset:21632
v_mfma_f32_16x16x32_bf16 v[140:143], v[76:79], a[204:207], v[140:143]
ds_read_b64_tr_b16 v[68:69], v7 offset:26752
v_mfma_f32_16x16x32_bf16 v[180:183], v[72:75], a[208:211], v[180:183]
ds_read_b64_tr_b16 v[70:71], v7 offset:31872
v_mfma_f32_16x16x32_bf16 v[180:183], v[76:79], a[212:215], v[180:183]
v_mfma_f32_16x16x32_bf16 v[220:223], v[72:75], a[216:219], v[220:223]
s_add_u32 s93, s35, 2048
buffer_load_dwordx4 a[16:19], v12, s[72:75], s93 offen offset:0 sc1
v_mfma_f32_16x16x32_bf16 v[220:223], v[76:79], a[220:223], v[220:223]
s_waitcnt lgkmcnt(8)
ds_read_b64_tr_b16 v[72:73], v8 offset:16544
v_mfma_f32_16x16x32_bf16 v[104:107], v[80:83], a[192:195], v[104:107]
ds_read_b64_tr_b16 v[74:75], v8 offset:21664
v_mfma_f32_16x16x32_bf16 v[104:107], v[84:87], a[196:199], v[104:107]
ds_read_b64_tr_b16 v[76:77], v8 offset:26784
v_mfma_f32_16x16x32_bf16 v[144:147], v[80:83], a[200:203], v[144:147]
ds_read_b64_tr_b16 v[78:79], v8 offset:31904
v_mfma_f32_16x16x32_bf16 v[144:147], v[84:87], a[204:207], v[144:147]
buffer_load_dwordx4 a[24:27], v13, s[72:75], s93 offen offset:0 sc1
v_mfma_f32_16x16x32_bf16 v[184:187], v[80:83], a[208:211], v[184:187]
s_mov_b32 s101, 0x200000
s_waitcnt vmcnt(7)
L_poll10:
v_cmp_gt_u32 vcc, 4, v19
s_cbranch_vccz L_go10
s_sub_u32 s101, s101, 1
s_cmp_eq_u32 s101, 0
s_cbranch_scc1 L_go10
buffer_load_dword v19, off, s[68:71], s19 sc1
s_waitcnt vmcnt(0)
s_branch L_poll10
L_go10:
v_mfma_f32_16x16x32_bf16 v[184:187], v[84:87], a[212:215], v[184:187]
v_mfma_f32_16x16x32_bf16 v[224:227], v[80:83], a[216:219], v[224:227]
v_mfma_f32_16x16x32_bf16 v[224:227], v[84:87], a[220:223], v[224:227]
s_waitcnt lgkmcnt(8)
ds_read_b64_tr_b16 v[80:81], v7 offset:16576
v_mfma_f32_16x16x32_bf16 v[108:111], v[88:91], a[192:195], v[108:111]
ds_read_b64_tr_b16 v[82:83], v7 offset:21696
v_mfma_f32_16x16x32_bf16 v[108:111], v[92:95], a[196:199], v[108:111]
buffer_load_dwordx4 a[48:51], v14, s[72:75], s93 offen offset:0 sc1
v_mfma_f32_16x16x32_bf16 v[148:151], v[88:91], a[200:203], v[148:151]
ds_read_b64_tr_b16 v[84:85], v7 offset:26816
v_mfma_f32_16x16x32_bf16 v[148:151], v[92:95], a[204:207], v[148:151]
ds_read_b64_tr_b16 v[86:87], v7 offset:31936
v_mfma_f32_16x16x32_bf16 v[188:191], v[88:91], a[208:211], v[188:191]
v_mfma_f32_16x16x32_bf16 v[188:191], v[92:95], a[212:215], v[188:191]
v_mfma_f32_16x16x32_bf16 v[228:231], v[88:91], a[216:219], v[228:231]
v_mfma_f32_16x16x32_bf16 v[228:231], v[92:95], a[220:223], v[228:231]
s_waitcnt lgkmcnt(8)
ds_read_b64_tr_b16 v[88:89], v8 offset:16608
v_mfma_f32_16x16x32_bf16 v[112:115], v[64:67], a[192:195], v[112:115]
buffer_load_dwordx4 a[56:59], v15, s[72:75], s93 offen offset:0 sc1
v_mfma_f32_16x16x32_bf16 v[112:115], v[68:71], a[196:199], v[112:115]
ds_read_b64_tr_b16 v[90:91], v8 offset:21728
v_mfma_f32_16x16x32_bf16 v[152:155], v[64:67], a[200:203], v[152:155]
ds_read_b64_tr_b16 v[92:93], v8 offset:26848
v_mfma_f32_16x16x32_bf16 v[152:155], v[68:71], a[204:207], v[152:155]
ds_read_b64_tr_b16 v[94:95], v8 offset:31968
v_mfma_f32_16x16x32_bf16 v[192:195], v[64:67], a[208:211], v[192:195]
v_mfma_f32_16x16x32_bf16 v[192:195], v[68:71], a[212:215], v[192:195]
buffer_load_dwordx4 a[20:23], v12, s[72:75], s93 offen offset:1024 sc1
v_mfma_f32_16x16x32_bf16 v[232:235], v[64:67], a[216:219], v[232:235]
v_mfma_f32_16x16x32_bf16 v[232:235], v[68:71], a[220:223], v[232:235]
s_waitcnt lgkmcnt(8)
ds_read_b64_tr_b16 v[64:65], v7 offset:16640
v_mfma_f32_16x16x32_bf16 v[116:119], v[72:75], a[192:195], v[116:119]
ds_read_b64_tr_b16 v[66:67], v7 offset:21760
v_mfma_f32_16x16x32_bf16 v[116:119], v[76:79], a[196:199], v[116:119]
ds_read_b64_tr_b16 v[68:69], v7 offset:26880
v_mfma_f32_16x16x32_bf16 v[156:159], v[72:75], a[200:203], v[156:159]
ds_read_b64_tr_b16 v[70:71], v7 offset:32000
v_mfma_f32_16x16x32_bf16 v[156:159], v[76:79], a[204:207], v[156:159]
buffer_load_dwordx4 a[28:31], v13, s[72:75], s93 offen offset:1024 sc1
v_mfma_f32_16x16x32_bf16 v[196:199], v[72:75], a[208:211], v[196:199]
v_mfma_f32_16x16x32_bf16 v[196:199], v[76:79], a[212:215], v[196:199]
v_mfma_f32_16x16x32_bf16 v[236:239], v[72:75], a[216:219], v[236:239]
v_mfma_f32_16x16x32_bf16 v[236:239], v[76:79], a[220:223], v[236:239]
s_waitcnt lgkmcnt(8)
ds_read_b64_tr_b16 v[72:73], v8 offset:16672
v_mfma_f32_16x16x32_bf16 v[120:123], v[80:83], a[192:195], v[120:123]
buffer_load_dwordx4 a[52:55], v14, s[72:75], s93 offen offset:1024 sc1
v_mfma_f32_16x16x32_bf16 v[120:123], v[84:87], a[196:199], v[120:123]
ds_read_b64_tr_b16 v[74:75], v8 offset:21792
v_mfma_f32_16x16x32_bf16 v[160:163], v[80:83], a[200:203], v[160:163]
ds_read_b64_tr_b16 v[76:77], v8 offset:26912
v_mfma_f32_16x16x32_bf16 v[160:163], v[84:87], a[204:207], v[160:163]
ds_read_b64_tr_b16 v[78:79], v8 offset:32032
v_mfma_f32_16x16x32_bf16 v[200:203], v[80:83], a[208:211], v[200:203]
v_mfma_f32_16x16x32_bf16 v[200:203], v[84:87], a[212:215], v[200:203]
v_mfma_f32_16x16x32_bf16 v[240:243], v[80:83], a[216:219], v[240:243]
buffer_load_dwordx4 a[60:63], v15, s[72:75], s93 offen offset:1024 sc1
v_mfma_f32_16x16x32_bf16 v[240:243], v[84:87], a[220:223], v[240:243]
s_waitcnt lgkmcnt(8)
ds_read_b64_tr_b16 v[80:81], v7 offset:36864
v_mfma_f32_16x16x32_bf16 v[124:127], v[88:91], a[192:195], v[124:127]
ds_read_b64_tr_b16 v[82:83], v7 offset:41984
v_mfma_f32_16x16x32_bf16 v[124:127], v[92:95], a[196:199], v[124:127]
ds_read_b64_tr_b16 v[84:85], v7 offset:47104
v_mfma_f32_16x16x32_bf16 v[164:167], v[88:91], a[200:203], v[164:167]
ds_read_b64_tr_b16 v[86:87], v7 offset:52224
v_mfma_f32_16x16x32_bf16 v[164:167], v[92:95], a[204:207], v[164:167]
v_mfma_f32_16x16x32_bf16 v[204:207], v[88:91], a[208:211], v[204:207]
s_add_u32 s93, s33, 4096
buffer_load_dwordx4 a[80:83], v12, s[72:75], s93 offen offset:0 sc1
v_mfma_f32_16x16x32_bf16 v[204:207], v[92:95], a[212:215], v[204:207]
v_mfma_f32_16x16x32_bf16 v[244:247], v[88:91], a[216:219], v[244:247]
v_mfma_f32_16x16x32_bf16 v[244:247], v[92:95], a[220:223], v[244:247]
s_waitcnt lgkmcnt(8)
ds_read_b64_tr_b16 v[88:89], v8 offset:36896
v_mfma_f32_16x16x32_bf16 v[128:131], v[64:67], a[192:195], v[128:131]
ds_read_b64_tr_b16 v[90:91], v8 offset:42016
v_mfma_f32_16x16x32_bf16 v[128:131], v[68:71], a[196:199], v[128:131]
ds_read_b64_tr_b16 v[92:93], v8 offset:47136
v_mfma_f32_16x16x32_bf16 v[168:171], v[64:67], a[200:203], v[168:171]
buffer_load_dwordx4 a[88:91], v13, s[72:75], s93 offen offset:0 sc1
v_mfma_f32_16x16x32_bf16 v[168:171], v[68:71], a[204:207], v[168:171]
ds_read_b64_tr_b16 v[94:95], v8 offset:52256
v_mfma_f32_16x16x32_bf16 v[208:211], v[64:67], a[208:211], v[208:211]
v_mfma_f32_16x16x32_bf16 v[208:211], v[68:71], a[212:215], v[208:211]
v_mfma_f32_16x16x32_bf16 v[248:251], v[64:67], a[216:219], v[248:251]
v_mfma_f32_16x16x32_bf16 v[248:251], v[68:71], a[220:223], v[248:251]
s_waitcnt lgkmcnt(8)
ds_read_b64_tr_b16 v[64:65], v7 offset:36928
v_mfma_f32_16x16x32_bf16 v[132:135], v[72:75], a[192:195], v[132:135]
buffer_load_dwordx4 a[112:115], v14, s[72:75], s93 offen offset:0 sc1
v_mfma_f32_16x16x32_bf16 v[132:135], v[76:79], a[196:199], v[132:135]
ds_read_b64_tr_b16 v[66:67], v7 offset:42048
v_mfma_f32_16x16x32_bf16 v[172:175], v[72:75], a[200:203], v[172:175]
ds_read_b64_tr_b16 v[68:69], v7 offset:47168
v_mfma_f32_16x16x32_bf16 v[172:175], v[76:79], a[204:207], v[172:175]
ds_read_b64_tr_b16 v[70:71], v7 offset:52288
v_mfma_f32_16x16x32_bf16 v[212:215], v[72:75], a[208:211], v[212:215]
v_mfma_f32_16x16x32_bf16 v[212:215], v[76:79], a[212:215], v[212:215]
buffer_load_dwordx4 a[120:123], v15, s[72:75], s93 offen offset:0 sc1
v_mfma_f32_16x16x32_bf16 v[252:255], v[72:75], a[216:219], v[252:255]
v_mfma_f32_16x16x32_bf16 v[252:255], v[76:79], a[220:223], v[252:255]
s_waitcnt lgkmcnt(8)
ds_read_b64_tr_b16 v[72:73], v8 offset:36960
v_mfma_f32_16x16x32_bf16 v[96:99], v[80:83], a[224:227], v[96:99]
ds_read_b64_tr_b16 v[74:75], v8 offset:42080
v_mfma_f32_16x16x32_bf16 v[96:99], v[84:87], a[228:231], v[96:99]
ds_read_b64_tr_b16 v[76:77], v8 offset:47200
v_mfma_f32_16x16x32_bf16 v[136:139], v[80:83], a[232:235], v[136:139]
ds_read_b64_tr_b16 v[78:79], v8 offset:52320
v_mfma_f32_16x16x32_bf16 v[136:139], v[84:87], a[236:239], v[136:139]
buffer_load_dwordx4 a[84:87], v12, s[72:75], s93 offen offset:1024 sc1
v_mfma_f32_16x16x32_bf16 v[176:179], v[80:83], a[240:243], v[176:179]
v_mfma_f32_16x16x32_bf16 v[176:179], v[84:87], a[244:247], v[176:179]
v_mfma_f32_16x16x32_bf16 v[216:219], v[80:83], a[248:251], v[216:219]
v_mfma_f32_16x16x32_bf16 v[216:219], v[84:87], a[252:255], v[216:219]
s_waitcnt lgkmcnt(8)
ds_read_b64_tr_b16 v[80:81], v7 offset:36992
v_mfma_f32_16x16x32_bf16 v[100:103], v[88:91], a[224:227], v[100:103]
ds_read_b64_tr_b16 v[82:83], v7 offset:42112
v_mfma_f32_16x16x32_bf16 v[100:103], v[92:95], a[228:231], v[100:103]
buffer_load_dwordx4 a[92:95], v13, s[72:75], s93 offen offset:1024 sc1
v_mfma_f32_16x16x32_bf16 v[140:143], v[88:91], a[232:235], v[140:143]
ds_read_b64_tr_b16 v[84:85], v7 offset:47232
v_mfma_f32_16x16x32_bf16 v[140:143], v[92:95], a[236:239], v[140:143]
ds_read_b64_tr_b16 v[86:87], v7 offset:52352
v_mfma_f32_16x16x32_bf16 v[180:183], v[88:91], a[240:243], v[180:183]
v_mfma_f32_16x16x32_bf16 v[180:183], v[92:95], a[244:247], v[180:183]
v_mfma_f32_16x16x32_bf16 v[220:223], v[88:91], a[248:251], v[220:223]
v_mfma_f32_16x16x32_bf16 v[220:223], v[92:95], a[252:255], v[220:223]
s_waitcnt lgkmcnt(8)
ds_read_b64_tr_b16 v[88:89], v8 offset:37024
v_mfma_f32_16x16x32_bf16 v[104:107], v[64:67], a[224:227], v[104:107]
buffer_load_dwordx4 a[116:119], v14, s[72:75], s93 offen offset:1024 sc1
v_mfma_f32_16x16x32_bf16 v[104:107], v[68:71], a[228:231], v[104:107]
ds_read_b64_tr_b16 v[90:91], v8 offset:42144
v_mfma_f32_16x16x32_bf16 v[144:147], v[64:67], a[232:235], v[144:147]
ds_read_b64_tr_b16 v[92:93], v8 offset:47264
v_mfma_f32_16x16x32_bf16 v[144:147], v[68:71], a[236:239], v[144:147]
ds_read_b64_tr_b16 v[94:95], v8 offset:52384
v_mfma_f32_16x16x32_bf16 v[184:187], v[64:67], a[240:243], v[184:187]
v_mfma_f32_16x16x32_bf16 v[184:187], v[68:71], a[244:247], v[184:187]
buffer_load_dwordx4 a[124:127], v15, s[72:75], s93 offen offset:1024 sc1
v_mfma_f32_16x16x32_bf16 v[224:227], v[64:67], a[248:251], v[224:227]
v_mfma_f32_16x16x32_bf16 v[224:227], v[68:71], a[252:255], v[224:227]
s_waitcnt lgkmcnt(8)
ds_read_b64_tr_b16 v[64:65], v7 offset:37056
v_mfma_f32_16x16x32_bf16 v[108:111], v[72:75], a[224:227], v[108:111]
ds_read_b64_tr_b16 v[66:67], v7 offset:42176
v_mfma_f32_16x16x32_bf16 v[108:111], v[76:79], a[228:231], v[108:111]
s_add_u32 s92, s98, 163840
s_add_u32 m0, s94, 0
v_mfma_f32_16x16x32_bf16 v[148:151], v[72:75], a[232:235], v[148:151]
buffer_load_dwordx4 v21, s[48:51], s92 offen  lds
v_mfma_f32_16x16x32_bf16 v[148:151], v[76:79], a[236:239], v[148:151]
ds_read_b64_tr_b16 v[68:69], v7 offset:47296
v_mfma_f32_16x16x32_bf16 v[188:191], v[72:75], a[240:243], v[188:191]
ds_read_b64_tr_b16 v[70:71], v7 offset:52416
v_mfma_f32_16x16x32_bf16 v[188:191], v[76:79], a[244:247], v[188:191]
v_mfma_f32_16x16x32_bf16 v[228:231], v[72:75], a[248:251], v[228:231]
v_mfma_f32_16x16x32_bf16 v[228:231], v[76:79], a[252:255], v[228:231]
s_waitcnt lgkmcnt(8)
s_add_u32 m0, s94, 1024
v_mfma_f32_16x16x32_bf16 v[112:115], v[80:83], a[224:227], v[112:115]
buffer_load_dwordx4 v22, s[48:51], s92 offen  lds
v_mfma_f32_16x16x32_bf16 v[112:115], v[84:87], a[228:231], v[112:115]
ds_read_b64_tr_b16 v[72:73], v8 offset:37088
v_mfma_f32_16x16x32_bf16 v[152:155], v[80:83], a[232:235], v[152:155]
ds_read_b64_tr_b16 v[74:75], v8 offset:42208
v_mfma_f32_16x16x32_bf16 v[152:155], v[84:87], a[236:239], v[152:155]
ds_read_b64_tr_b16 v[76:77], v8 offset:47328
v_mfma_f32_16x16x32_bf16 v[192:195], v[80:83], a[240:243], v[192:195]
ds_read_b64_tr_b16 v[78:79], v8 offset:52448
v_mfma_f32_16x16x32_bf16 v[192:195], v[84:87], a[244:247], v[192:195]
s_add_u32 m0, s94, 2048
v_mfma_f32_16x16x32_bf16 v[232:235], v[80:83], a[248:251], v[232:235]
buffer_load_dwordx4 v23, s[48:51], s92 offen  lds
v_mfma_f32_16x16x32_bf16 v[232:235], v[84:87], a[252:255], v[232:235]
s_waitcnt lgkmcnt(8)
ds_read_b64_tr_b16 v[80:81], v7 offset:37120
v_mfma_f32_16x16x32_bf16 v[116:119], v[88:91], a[224:227], v[116:119]
ds_read_b64_tr_b16 v[82:83], v7 offset:42240
v_mfma_f32_16x16x32_bf16 v[116:119], v[92:95], a[228:231], v[116:119]
ds_read_b64_tr_b16 v[84:85], v7 offset:47360
v_mfma_f32_16x16x32_bf16 v[156:159], v[88:91], a[232:235], v[156:159]
ds_read_b64_tr_b16 v[86:87], v7 offset:52480
v_mfma_f32_16x16x32_bf16 v[156:159], v[92:95], a[236:239], v[156:159]
s_add_u32 m0, s94, 3072
v_mfma_f32_16x16x32_bf16 v[196:199], v[88:91], a[240:243], v[196:199]
buffer_load_dwordx4 v24, s[48:51], s92 offen  lds
v_mfma_f32_16x16x32_bf16 v[196:199], v[92:95], a[244:247], v[196:199]
v_mfma_f32_16x16x32_bf16 v[236:239], v[88:91], a[248:251], v[236:239]
v_mfma_f32_16x16x32_bf16 v[236:239], v[92:95], a[252:255], v[236:239]
s_waitcnt lgkmcnt(8)
ds_read_b64_tr_b16 v[88:89], v8 offset:37152
v_mfma_f32_16x16x32_bf16 v[120:123], v[64:67], a[224:227], v[120:123]
ds_read_b64_tr_b16 v[90:91], v8 offset:42272
v_mfma_f32_16x16x32_bf16 v[120:123], v[68:71], a[228:231], v[120:123]
s_add_u32 m0, s94, 4096
ds_read_b64_tr_b16 v[92:93], v8 offset:47392
v_mfma_f32_16x16x32_bf16 v[160:163], v[64:67], a[232:235], v[160:163]
buffer_load_dwordx4 v25, s[48:51], s92 offen  lds
v_mfma_f32_16x16x32_bf16 v[160:163], v[68:71], a[236:239], v[160:163]
ds_read_b64_tr_b16 v[94:95], v8 offset:52512
v_mfma_f32_16x16x32_bf16 v[200:203], v[64:67], a[240:243], v[200:203]
v_mfma_f32_16x16x32_bf16 v[200:203], v[68:71], a[244:247], v[200:203]
v_mfma_f32_16x16x32_bf16 v[240:243], v[64:67], a[248:251], v[240:243]
s_add_u32 s92, s99, 163840
s_add_u32 m0, s94, 20480
v_mfma_f32_16x16x32_bf16 v[240:243], v[68:71], a[252:255], v[240:243]
s_waitcnt lgkmcnt(8)
s_waitcnt vmcnt(21)
s_barrier
v_mfma_f32_16x16x32_bf16 v[124:127], v[72:75], a[224:227], v[124:127]
buffer_load_dwordx4 v21, s[48:51], s92 offen  lds
v_mfma_f32_16x16x32_bf16 v[124:127], v[76:79], a[228:231], v[124:127]
ds_read_b64_tr_b16 v[64:65], v7 offset:57344
v_mfma_f32_16x16x32_bf16 v[164:167], v[72:75], a[232:235], v[164:167]
ds_read_b64_tr_b16 v[66:67], v7 offset:62464
v_mfma_f32_16x16x32_bf16 v[164:167], v[76:79], a[236:239], v[164:167]
ds_read_b64_tr_b16 v[68:69], v9 offset:2048
v_mfma_f32_16x16x32_bf16 v[204:207], v[72:75], a[240:243], v[204:207]
s_add_u32 m0, s94, 21504
ds_read_b64_tr_b16 v[70:71], v9 offset:7168
v_mfma_f32_16x16x32_bf16 v[204:207], v[76:79], a[244:247], v[204:207]
buffer_load_dwordx4 v22, s[48:51], s92 offen  lds
v_mfma_f32_16x16x32_bf16 v[244:247], v[72:75], a[248:251], v[244:247]
v_mfma_f32_16x16x32_bf16 v[244:247], v[76:79], a[252:255], v[244:247]
s_waitcnt lgkmcnt(8)
ds_read_b64_tr_b16 v[72:73], v8 offset:57376
v_mfma_f32_16x16x32_bf16 v[128:131], v[80:83], a[224:227], v[128:131]
ds_read_b64_tr_b16 v[74:75], v8 offset:62496
v_mfma_f32_16x16x32_bf16 v[128:131], v[84:87], a[228:231], v[128:131]
ds_read_b64_tr_b16 v[76:77], v10 offset:2080
v_mfma_f32_16x16x32_bf16 v[168:171], v[80:83], a[232:235], v[168:171]
s_add_u32 m0, s94, 22528
ds_read_b64_tr_b16 v[78:79], v10 offset:7200
v_mfma_f32_16x16x32_bf16 v[168:171], v[84:87], a[236:239], v[168:171]
buffer_load_dwordx4 v23, s[48:51], s92 offen  lds
v_mfma_f32_16x16x32_bf16 v[208:211], v[80:83], a[240:243], v[208:211]
v_mfma_f32_16x16x32_bf16 v[208:211], v[84:87], a[244:247], v[208:211]
v_mfma_f32_16x16x32_bf16 v[248:251], v[80:83], a[248:251], v[248:251]
v_mfma_f32_16x16x32_bf16 v[248:251], v[84:87], a[252:255], v[248:251]
s_waitcnt lgkmcnt(8)
ds_read_b64_tr_b16 v[80:81], v7 offset:57408
v_mfma_f32_16x16x32_bf16 v[132:135], v[88:91], a[224:227], v[132:135]
s_add_u32 m0, s94, 23552
ds_read_b64_tr_b16 v[82:83], v7 offset:62528
v_mfma_f32_16x16x32_bf16 v[132:135], v[92:95], a[228:231], v[132:135]
buffer_load_dwordx4 v24, s[48:51], s92 offen  lds
v_mfma_f32_16x16x32_bf16 v[172:175], v[88:91], a[232:235], v[172:175]
ds_read_b64_tr_b16 v[84:85], v9 offset:2112
v_mfma_f32_16x16x32_bf16 v[172:175], v[92:95], a[236:239], v[172:175]
ds_read_b64_tr_b16 v[86:87], v9 offset:7232
v_mfma_f32_16x16x32_bf16 v[212:215], v[88:91], a[240:243], v[212:215]
v_mfma_f32_16x16x32_bf16 v[212:215], v[92:95], a[244:247], v[212:215]
s_add_u32 m0, s94, 24576
v_mfma_f32_16x16x32_bf16 v[252:255], v[88:91], a[248:251], v[252:255]
buffer_load_dwordx4 v25, s[48:51], s92 offen  lds
v_mfma_f32_16x16x32_bf16 v[252:255], v[92:95], a[252:255], v[252:255]
s_waitcnt vmcnt(18) lgkmcnt(8)
ds_read_b64_tr_b16 v[88:89], v8 offset:57440
v_mfma_f32_16x16x32_bf16 v[96:99], v[64:67], a[16:19], v[96:99]
ds_read_b64_tr_b16 v[90:91], v8 offset:62560
v_mfma_f32_16x16x32_bf16 v[96:99], v[68:71], a[20:23], v[96:99]
ds_read_b64_tr_b16 v[92:93], v10 offset:2144
v_mfma_f32_16x16x32_bf16 v[136:139], v[64:67], a[24:27], v[136:139]
ds_read_b64_tr_b16 v[94:95], v10 offset:7264
v_mfma_f32_16x16x32_bf16 v[136:139], v[68:71], a[28:31], v[136:139]
s_waitcnt lgkmcnt(8)
ds_read_b64_tr_b16 v[64:65], v7 offset:57472
v_mfma_f32_16x16x32_bf16 v[100:103], v[72:75], a[16:19], v[100:103]
s_add_u32 s93, s34, 4096
buffer_load_dwordx4 a[144:147], v12, s[72:75], s93 offen offset:0 sc1
v_mfma_f32_16x16x32_bf16 v[100:103], v[76:79], a[20:23], v[100:103]
ds_read_b64_tr_b16 v[66:67], v7 offset:62592
v_mfma_f32_16x16x32_bf16 v[140:143], v[72:75], a[24:27], v[140:143]
ds_read_b64_tr_b16 v[68:69], v9 offset:2176
v_mfma_f32_16x16x32_bf16 v[140:143], v[76:79], a[28:31], v[140:143]
s_waitcnt lgkmcnt(7)
ds_read_b64_tr_b16 v[70:71], v9 offset:7296
v_mfma_f32_16x16x32_bf16 v[104:107], v[80:83], a[16:19], v[104:107]
ds_read_b64_tr_b16 v[72:73], v8 offset:57504
v_mfma_f32_16x16x32_bf16 v[104:107], v[84:87], a[20:23], v[104:107]
ds_read_b64_tr_b16 v[74:75], v8 offset:62624
v_mfma_f32_16x16x32_bf16 v[144:147], v[80:83], a[24:27], v[144:147]
buffer_load_dwordx4 a[152:155], v13, s[72:75], s93 offen offset:0 sc1
v_mfma_f32_16x16x32_bf16 v[144:147], v[84:87], a[28:31], v[144:147]
s_waitcnt lgkmcnt(6)
ds_read_b64_tr_b16 v[76:77], v10 offset:2208
v_mfma_f32_16x16x32_bf16 v[108:111], v[88:91], a[16:19], v[108:111]
ds_read_b64_tr_b16 v[78:79], v10 offset:7328
v_mfma_f32_16x16x32_bf16 v[108:111], v[92:95], a[20:23], v[108:111]
ds_read_b64_tr_b16 v[80:81], v7 offset:57536
v_mfma_f32_16x16x32_bf16 v[148:151], v[88:91], a[24:27], v[148:151]
ds_read_b64_tr_b16 v[82:83], v7 offset:62656
v_mfma_f32_16x16x32_bf16 v[148:151], v[92:95], a[28:31], v[148:151]
s_waitcnt lgkmcnt(6)
ds_read_b64_tr_b16 v[84:85], v9 offset:2240
v_mfma_f32_16x16x32_bf16 v[112:115], v[64:67], a[16:19], v[112:115]
buffer_load_dwordx4 a[176:179], v14, s[72:75], s93 offen offset:0 sc1
v_mfma_f32_16x16x32_bf16 v[112:115], v[68:71], a[20:23], v[112:115]
ds_read_b64_tr_b16 v[86:87], v9 offset:7360
v_mfma_f32_16x16x32_bf16 v[152:155], v[64:67], a[24:27], v[152:155]
ds_read_b64_tr_b16 v[88:89], v8 offset:57568
v_mfma_f32_16x16x32_bf16 v[152:155], v[68:71], a[28:31], v[152:155]
s_waitcnt lgkmcnt(5)
ds_read_b64_tr_b16 v[90:91], v8 offset:62688
v_mfma_f32_16x16x32_bf16 v[116:119], v[72:75], a[16:19], v[116:119]
ds_read_b64_tr_b16 v[92:93], v10 offset:2272
v_mfma_f32_16x16x32_bf16 v[116:119], v[76:79], a[20:23], v[116:119]
ds_read_b64_tr_b16 v[94:95], v10 offset:7392
v_mfma_f32_16x16x32_bf16 v[156:159], v[72:75], a[24:27], v[156:159]
ds_read_b64_tr_b16 v[64:65], v7 offset:57600
v_mfma_f32_16x16x32_bf16 v[156:159], v[76:79], a[28:31], v[156:159]
s_waitcnt lgkmcnt(5)
ds_read_b64_tr_b16 v[66:67], v7 offset:62720
buffer_load_dwordx4 a[184:187], v15, s[72:75], s93 offen offset:0 sc1
v_mfma_f32_16x16x32_bf16 v[120:123], v[80:83], a[16:19], v[120:123]
ds_read_b64_tr_b16 v[68:69], v9 offset:2304
v_mfma_f32_16x16x32_bf16 v[120:123], v[84:87], a[20:23], v[120:123]
ds_read_b64_tr_b16 v[70:71], v9 offset:7424
v_mfma_f32_16x16x32_bf16 v[160:163], v[80:83], a[24:27], v[160:163]
ds_read_b64_tr_b16 v[72:73], v8 offset:57632
v_mfma_f32_16x16x32_bf16 v[160:163], v[84:87], a[28:31], v[160:163]
s_waitcnt lgkmcnt(5)
ds_read_b64_tr_b16 v[74:75], v8 offset:62752
v_mfma_f32_16x16x32_bf16 v[124:127], v[88:91], a[16:19], v[124:127]
buffer_load_dwordx4 a[148:151], v12, s[72:75], s93 offen offset:1024 sc1
v_mfma_f32_16x16x32_bf16 v[124:127], v[92:95], a[20:23], v[124:127]
ds_read_b64_tr_b16 v[76:77], v10 offset:2336
ds_read_b64_tr_b16 v[78:79], v10 offset:7456
v_mfma_f32_16x16x32_bf16 v[164:167], v[88:91], a[24:27], v[164:167]
ds_read_b64_tr_b16 v[80:81], v9 offset:12288
v_mfma_f32_16x16x32_bf16 v[164:167], v[92:95], a[28:31], v[164:167]
s_waitcnt lgkmcnt(5)
ds_read_b64_tr_b16 v[82:83], v9 offset:17408
v_mfma_f32_16x16x32_bf16 v[128:131], v[64:67], a[16:19], v[128:131]
ds_read_b64_tr_b16 v[84:85], v9 offset:22528
v_mfma_f32_16x16x32_bf16 v[128:131], v[68:71], a[20:23], v[128:131]
ds_read_b64_tr_b16 v[86:87], v9 offset:27648
v_mfma_f32_16x16x32_bf16 v[168:171], v[64:67], a[24:27], v[168:171]
buffer_load_dwordx4 a[156:159], v13, s[72:75], s93 offen offset:1024 sc1
v_mfma_f32_16x16x32_bf16 v[168:171], v[68:71], a[28:31], v[168:171]
s_waitcnt lgkmcnt(4)
ds_read_b64_tr_b16 v[88:89], v10 offset:12320
v_mfma_f32_16x16x32_bf16 v[132:135], v[72:75], a[16:19], v[132:135]
ds_read_b64_tr_b16 v[90:91], v10 offset:17440
v_mfma_f32_16x16x32_bf16 v[132:135], v[76:79], a[20:23], v[132:135]
ds_read_b64_tr_b16 v[92:93], v10 offset:22560
ds_read_b64_tr_b16 v[94:95], v10 offset:27680
v_mfma_f32_16x16x32_bf16 v[172:175], v[72:75], a[24:27], v[172:175]
ds_read_b64_tr_b16 v[64:65], v9 offset:12352
v_mfma_f32_16x16x32_bf16 v[172:175], v[76:79], a[28:31], v[172:175]
s_waitcnt vmcnt(16) lgkmcnt(5)
ds_read_b64_tr_b16 v[66:67], v9 offset:17472
v_mfma_f32_16x16x32_bf16 v[96:99], v[80:83], a[80:83], v[96:99]
buffer_load_dwordx4 a[180:183], v14, s[72:75], s93 offen offset:1024 sc1
v_mfma_f32_16x16x32_bf16 v[96:99], v[84:87], a[84:87], v[96:99]
ds_read_b64_tr_b16 v[68:69], v9 offset:22592
ds_read_b64_tr_b16 v[70:71], v9 offset:27712
v_mfma_f32_16x16x32_bf16 v[136:139], v[80:83], a[88:91], v[136:139]
ds_read_b64_tr_b16 v[72:73], v10 offset:12384
v_mfma_f32_16x16x32_bf16 v[136:139], v[84:87], a[92:95], v[136:139]
s_waitcnt lgkmcnt(5)
ds_read_b64_tr_b16 v[74:75], v10 offset:17504
v_mfma_f32_16x16x32_bf16 v[100:103], v[88:91], a[80:83], v[100:103]
ds_read_b64_tr_b16 v[76:77], v10 offset:22624
v_mfma_f32_16x16x32_bf16 v[100:103], v[92:95], a[84:87], v[100:103]
ds_read_b64_tr_b16 v[78:79], v10 offset:27744
v_mfma_f32_16x16x32_bf16 v[140:143], v[88:91], a[88:91], v[140:143]
buffer_load_dwordx4 a[188:191], v15, s[72:75], s93 offen offset:1024 sc1
v_mfma_f32_16x16x32_bf16 v[140:143], v[92:95], a[92:95], v[140:143]
s_waitcnt lgkmcnt(4)
ds_read_b64_tr_b16 v[80:81], v9 offset:12416
v_mfma_f32_16x16x32_bf16 v[104:107], v[64:67], a[80:83], v[104:107]
ds_read_b64_tr_b16 v[82:83], v9 offset:17536
v_mfma_f32_16x16x32_bf16 v[104:107], v[68:71], a[84:87], v[104:107]
ds_read_b64_tr_b16 v[84:85], v9 offset:22656
ds_read_b64_tr_b16 v[86:87], v9 offset:27776
v_mfma_f32_16x16x32_bf16 v[144:147], v[64:67], a[88:91], v[144:147]
ds_read_b64_tr_b16 v[88:89], v10 offset:12448
v_mfma_f32_16x16x32_bf16 v[144:147], v[68:71], a[92:95], v[144:147]
s_waitcnt lgkmcnt(5)
ds_read_b64_tr_b16 v[90:91], v10 offset:17568
v_mfma_f32_16x16x32_bf16 v[108:111], v[72:75], a[80:83], v[108:111]
s_add_u32 s93, s35, 4096
buffer_load_dwordx4 a[192:195], v12, s[72:75], s93 offen offset:0 sc1
v_mfma_f32_16x16x32_bf16 v[108:111], v[76:79], a[84:87], v[108:111]
ds_read_b64_tr_b16 v[92:93], v10 offset:22688
ds_read_b64_tr_b16 v[94:95], v10 offset:27808
v_mfma_f32_16x16x32_bf16 v[148:151], v[72:75], a[88:91], v[148:151]
ds_read_b64_tr_b16 v[64:65], v9 offset:12480
v_mfma_f32_16x16x32_bf16 v[148:151], v[76:79], a[92:95], v[148:151]
s_waitcnt lgkmcnt(5)
ds_read_b64_tr_b16 v[66:67], v9 offset:17600
v_mfma_f32_16x16x32_bf16 v[112:115], v[80:83], a[80:83], v[112:115]
ds_read_b64_tr_b16 v[68:69], v9 offset:22720
v_mfma_f32_16x16x32_bf16 v[112:115], v[84:87], a[84:87], v[112:115]
buffer_load_dwordx4 a[200:203], v13, s[72:75], s93 offen offset:0 sc1
ds_read_b64_tr_b16 v[70:71], v9 offset:27840
v_mfma_f32_16x16x32_bf16 v[152:155], v[80:83], a[88:91], v[152:155]
ds_read_b64_tr_b16 v[72:73], v10 offset:12512
v_mfma_f32_16x16x32_bf16 v[152:155], v[84:87], a[92:95], v[152:155]
s_waitcnt lgkmcnt(5)
ds_read_b64_tr_b16 v[74:75], v10 offset:17632
v_mfma_f32_16x16x32_bf16 v[116:119], v[88:91], a[80:83], v[116:119]
ds_read_b64_tr_b16 v[76:77], v10 offset:22752
v_mfma_f32_16x16x32_bf16 v[116:119], v[92:95], a[84:87], v[116:119]
ds_read_b64_tr_b16 v[78:79], v10 offset:27872
v_mfma_f32_16x16x32_bf16 v[156:159], v[88:91], a[88:91], v[156:159]
ds_read_b64_tr_b16 v[80:81], v9 offset:12544
v_mfma_f32_16x16x32_bf16 v[156:159], v[92:95], a[92:95], v[156:159]
s_waitcnt lgkmcnt(5)
ds_read_b64_tr_b16 v[82:83], v9 offset:17664
buffer_load_dwordx4 a[208:211], v14, s[72:75], s93 offen offset:0 sc1
v_mfma_f32_16x16x32_bf16 v[120:123], v[64:67], a[80:83], v[120:123]
ds_read_b64_tr_b16 v[84:85], v9 offset:22784
v_mfma_f32_16x16x32_bf16 v[120:123], v[68:71], a[84:87], v[120:123]
ds_read_b64_tr_b16 v[86:87], v9 offset:27904
v_mfma_f32_16x16x32_bf16 v[160:163], v[64:67], a[88:91], v[160:163]
ds_read_b64_tr_b16 v[88:89], v10 offset:12576
v_mfma_f32_16x16x32_bf16 v[160:163], v[68:71], a[92:95], v[160:163]
s_waitcnt lgkmcnt(5)
ds_read_b64_tr_b16 v[90:91], v10 offset:17696
ds_read_b64_tr_b16 v[92:93], v10 offset:22816
ds_read_b64_tr_b16 v[94:95], v10 offset:27936
s_waitcnt vmcnt(11)
s_barrier
v_mfma_f32_16x16x32_bf16 v[124:127], v[72:75], a[80:83], v[124:127]
buffer_load_dwordx4 a[216:219], v15, s[72:75], s93 offen offset:0 sc1
v_mfma_f32_16x16x32_bf16 v[124:127], v[76:79], a[84:87], v[124:127]
ds_read_b64_tr_b16 v[64:65], v5 offset:0
v_mfma_f32_16x16x32_bf16 v[164:167], v[72:75], a[88:91], v[164:167]
ds_read_b64_tr_b16 v[66:67], v5 offset:5120
v_mfma_f32_16x16x32_bf16 v[164:167], v[76:79], a[92:95], v[164:167]
s_waitcnt lgkmcnt(6)
ds_read_b64_tr_b16 v[68:69], v5 offset:10240
v_mfma_f32_16x16x32_bf16 v[128:131], v[80:83], a[80:83], v[128:131]
ds_read_b64_tr_b16 v[70:71], v5 offset:15360
v_mfma_f32_16x16x32_bf16 v[128:131], v[84:87], a[84:87], v[128:131]
ds_read_b64_tr_b16 v[72:73], v6 offset:32
v_mfma_f32_16x16x32_bf16 v[168:171], v[80:83], a[88:91], v[168:171]
buffer_load_dwordx4 a[196:199], v12, s[72:75], s93 offen offset:1024 sc1
v_mfma_f32_16x16x32_bf16 v[168:171], v[84:87], a[92:95], v[168:171]
s_waitcnt lgkmcnt(5)
ds_read_b64_tr_b16 v[74:75], v6 offset:5152
v_mfma_f32_16x16x32_bf16 v[132:135], v[88:91], a[80:83], v[132:135]
ds_read_b64_tr_b16 v[76:77], v6 offset:10272
v_mfma_f32_16x16x32_bf16 v[132:135], v[92:95], a[84:87], v[132:135]
ds_read_b64_tr_b16 v[78:79], v6 offset:15392
v_mfma_f32_16x16x32_bf16 v[172:175], v[88:91], a[88:91], v[172:175]
ds_read_b64_tr_b16 v[80:81], v5 offset:64
v_mfma_f32_16x16x32_bf16 v[172:175], v[92:95], a[92:95], v[172:175]
s_waitcnt vmcnt(5) lgkmcnt(5)
ds_read_b64_tr_b16 v[82:83], v5 offset:5184
v_mfma_f32_16x16x32_bf16 v[96:99], v[64:67], a[144:147], v[96:99]
ds_read_b64_tr_b16 v[84:85], v5 offset:10304
v_mfma_f32_16x16x32_bf16 v[96:99], v[68:71], a[148:151], v[96:99]
buffer_load_dwordx4 a[204:207], v13, s[72:75], s93 offen offset:1024 sc1
ds_read_b64_tr_b16 v[86:87], v5 offset:15424
v_mfma_f32_16x16x32_bf16 v[136:139], v[64:67], a[152:155], v[136:139]
ds_read_b64_tr_b16 v[88:89], v6 offset:96
v_mfma_f32_16x16x32_bf16 v[136:139], v[68:71], a[156:159], v[136:139]
s_waitcnt lgkmcnt(5)
ds_read_b64_tr_b16 v[90:91], v6 offset:5216
v_mfma_f32_16x16x32_bf16 v[100:103], v[72:75], a[144:147], v[100:103]
ds_read_b64_tr_b16 v[92:93], v6 offset:10336
v_mfma_f32_16x16x32_bf16 v[100:103], v[76:79], a[148:151], v[100:103]
ds_read_b64_tr_b16 v[94:95], v6 offset:15456
v_mfma_f32_16x16x32_bf16 v[140:143], v[72:75], a[152:155], v[140:143]
buffer_load_dwordx4 a[212:215], v14, s[72:75], s93 offen offset:1024 sc1
v_mfma_f32_16x16x32_bf16 v[140:143], v[76:79], a[156:159], v[140:143]
s_waitcnt lgkmcnt(4)
ds_read_b64_tr_b16 v[64:65], v5 offset:128
v_mfma_f32_16x16x32_bf16 v[104:107], v[80:83], a[144:147], v[104:107]
ds_read_b64_tr_b16 v[66:67], v5 offset:5248
v_mfma_f32_16x16x32_bf16 v[104:107], v[84:87], a[148:151], v[104:107]
ds_read_b64_tr_b16 v[68:69], v5 offset:10368
ds_read_b64_tr_b16 v[70:71], v5 offset:15488
v_mfma_f32_16x16x32_bf16 v[144:147], v[80:83], a[152:155], v[144:147]
ds_read_b64_tr_b16 v[72:73], v6 offset:160
v_mfma_f32_16x16x32_bf16 v[144:147], v[84:87], a[156:159], v[144:147]
s_waitcnt lgkmcnt(5)
ds_read_b64_tr_b16 v[74:75], v6 offset:5280
v_mfma_f32_16x16x32_bf16 v[108:111], v[88:91], a[144:147], v[108:111]
buffer_load_dwordx4 a[220:223], v15, s[72:75], s93 offen offset:1024 sc1
v_mfma_f32_16x16x32_bf16 v[108:111], v[92:95], a[148:151], v[108:111]
ds_read_b64_tr_b16 v[76:77], v6 offset:10400
ds_read_b64_tr_b16 v[78:79], v6 offset:15520
v_mfma_f32_16x16x32_bf16 v[148:151], v[88:91], a[152:155], v[148:151]
ds_read_b64_tr_b16 v[80:81], v5 offset:192
v_mfma_f32_16x16x32_bf16 v[148:151], v[92:95], a[156:159], v[148:151]
s_waitcnt lgkmcnt(5)
ds_read_b64_tr_b16 v[82:83], v5 offset:5312
v_mfma_f32_16x16x32_bf16 v[112:115], v[64:67], a[144:147], v[112:115]
ds_read_b64_tr_b16 v[84:85], v5 offset:10432
v_mfma_f32_16x16x32_bf16 v[112:115], v[68:71], a[148:151], v[112:115]
ds_read_b64_tr_b16 v[86:87], v5 offset:15552
v_mfma_f32_16x16x32_bf16 v[152:155], v[64:67], a[152:155], v[152:155]
ds_read_b64_tr_b16 v[88:89], v6 offset:224
s_mov_b32 s95, 0
buffer_load_dword v20, v17, s[52:55], s95 offen
v_mfma_f32_16x16x32_bf16 v[152:155], v[68:71], a[156:159], v[152:155]
s_waitcnt lgkmcnt(5)
ds_read_b64_tr_b16 v[90:91], v6 offset:5344
v_mfma_f32_16x16x32_bf16 v[116:119], v[72:75], a[144:147], v[116:119]
ds_read_b64_tr_b16 v[92:93], v6 offset:10464
v_mfma_f32_16x16x32_bf16 v[116:119], v[76:79], a[148:151], v[116:119]
ds_read_b64_tr_b16 v[94:95], v6 offset:15584
v_mfma_f32_16x16x32_bf16 v[156:159], v[72:75], a[152:155], v[156:159]
ds_read_b64_tr_b16 v[64:65], v5 offset:256
v_mfma_f32_16x16x32_bf16 v[156:159], v[76:79], a[156:159], v[156:159]
s_waitcnt lgkmcnt(5)
ds_read_b64_tr_b16 v[66:67], v5 offset:5376
v_mfma_f32_16x16x32_bf16 v[120:123], v[80:83], a[144:147], v[120:123]
ds_read_b64_tr_b16 v[68:69], v5 offset:10496
buffer_load_dwordx2 v[40:41], v34, s[80:83], s12 offen offset:0
v_mfma_f32_16x16x32_bf16 v[120:123], v[84:87], a[148:151], v[120:123]
ds_read_b64_tr_b16 v[70:71], v5 offset:15616
v_mfma_f32_16x16x32_bf16 v[160:163], v[80:83], a[152:155], v[160:163]
ds_read_b64_tr_b16 v[72:73], v6 offset:288
v_mfma_f32_16x16x32_bf16 v[160:163], v[84:87], a[156:159], v[160:163]
s_waitcnt lgkmcnt(5)
ds_read_b64_tr_b16 v[74:75], v6 offset:5408
v_mfma_f32_16x16x32_bf16 v[124:127], v[88:91], a[144:147], v[124:127]
ds_read_b64_tr_b16 v[76:77], v6 offset:10528
v_mfma_f32_16x16x32_bf16 v[124:127], v[92:95], a[148:151], v[124:127]
ds_read_b64_tr_b16 v[78:79], v6 offset:15648
v_mfma_f32_16x16x32_bf16 v[164:167], v[88:91], a[152:155], v[164:167]
ds_read_b64_tr_b16 v[80:81], v5 offset:20480
buffer_load_dwordx2 v[42:43], v34, s[80:83], s12 offen offset:32
v_mfma_f32_16x16x32_bf16 v[164:167], v[92:95], a[156:159], v[164:167]
s_waitcnt lgkmcnt(5)
ds_read_b64_tr_b16 v[82:83], v5 offset:25600
v_mfma_f32_16x16x32_bf16 v[128:131], v[64:67], a[144:147], v[128:131]
ds_read_b64_tr_b16 v[84:85], v5 offset:30720
v_mfma_f32_16x16x32_bf16 v[128:131], v[68:71], a[148:151], v[128:131]
ds_read_b64_tr_b16 v[86:87], v5 offset:35840
v_mfma_f32_16x16x32_bf16 v[168:171], v[64:67], a[152:155], v[168:171]
ds_read_b64_tr_b16 v[88:89], v6 offset:20512
v_mfma_f32_16x16x32_bf16 v[168:171], v[68:71], a[156:159], v[168:171]
s_waitcnt lgkmcnt(5)
ds_read_b64_tr_b16 v[90:91], v6 offset:25632
buffer_load_dwordx2 v[44:45], v34, s[80:83], s12 offen offset:512
v_mfma_f32_16x16x32_bf16 v[132:135], v[72:75], a[144:147], v[132:135]
ds_read_b64_tr_b16 v[92:93], v6 offset:30752
v_mfma_f32_16x16x32_bf16 v[132:135], v[76:79], a[148:151], v[132:135]
ds_read_b64_tr_b16 v[94:95], v6 offset:35872
v_mfma_f32_16x16x32_bf16 v[172:175], v[72:75], a[152:155], v[172:175]
ds_read_b64_tr_b16 v[64:65], v5 offset:20544
v_mfma_f32_16x16x32_bf16 v[172:175], v[76:79], a[156:159], v[172:175]
s_waitcnt vmcnt(4) lgkmcnt(5)
ds_read_b64_tr_b16 v[66:67], v5 offset:25664
v_mfma_f32_16x16x32_bf16 v[96:99], v[80:83], a[192:195], v[96:99]
ds_read_b64_tr_b16 v[68:69], v5 offset:30784
v_mfma_f32_16x16x32_bf16 v[96:99], v[84:87], a[196:199], v[96:99]
ds_read_b64_tr_b16 v[70:71], v5 offset:35904
buffer_load_dwordx2 v[46:47], v34, s[80:83], s12 offen offset:544
v_mfma_f32_16x16x32_bf16 v[136:139], v[80:83], a[200:203], v[136:139]
ds_read_b64_tr_b16 v[72:73], v6 offset:20576
v_mfma_f32_16x16x32_bf16 v[136:139], v[84:87], a[204:207], v[136:139]
s_waitcnt lgkmcnt(5)
ds_read_b64_tr_b16 v[74:75], v6 offset:25696
v_mfma_f32_16x16x32_bf16 v[100:103], v[88:91], a[192:195], v[100:103]
ds_read_b64_tr_b16 v[76:77], v6 offset:30816
v_mfma_f32_16x16x32_bf16 v[100:103], v[92:95], a[196:199], v[100:103]
ds_read_b64_tr_b16 v[78:79], v6 offset:35936
v_mfma_f32_16x16x32_bf16 v[140:143], v[88:91], a[200:203], v[140:143]
ds_read_b64_tr_b16 v[80:81], v5 offset:20608
v_mfma_f32_16x16x32_bf16 v[140:143], v[92:95], a[204:207], v[140:143]
s_waitcnt lgkmcnt(5)
ds_read_b64_tr_b16 v[82:83], v5 offset:25728
buffer_load_dwordx2 v[48:49], v35, s[80:83], s12 offen offset:1024
v_mfma_f32_16x16x32_bf16 v[104:107], v[64:67], a[192:195], v[104:107]
ds_read_b64_tr_b16 v[84:85], v5 offset:30848
v_cvt_pk_bf16_f32 v96, v96, v97
v_mfma_f32_16x16x32_bf16 v[104:107], v[68:71], a[196:199], v[104:107]
ds_read_b64_tr_b16 v[86:87], v5 offset:35968
v_cvt_pk_bf16_f32 v97, v98, v99
v_mfma_f32_16x16x32_bf16 v[144:147], v[64:67], a[200:203], v[144:147]
ds_read_b64_tr_b16 v[88:89], v6 offset:20640
v_cvt_pk_bf16_f32 v98, v100, v101
v_mfma_f32_16x16x32_bf16 v[144:147], v[68:71], a[204:207], v[144:147]
s_waitcnt lgkmcnt(5)
ds_read_b64_tr_b16 v[90:91], v6 offset:25760
v_mfma_f32_16x16x32_bf16 v[108:111], v[72:75], a[192:195], v[108:111]
ds_read_b64_tr_b16 v[92:93], v6 offset:30880
v_cvt_pk_bf16_f32 v99, v102, v103
v_mfma_f32_16x16x32_bf16 v[108:111], v[76:79], a[196:199], v[108:111]
ds_read_b64_tr_b16 v[94:95], v6 offset:36000
buffer_load_dwordx2 v[50:51], v35, s[80:83], s12 offen offset:1056
v_mfma_f32_16x16x32_bf16 v[148:151], v[72:75], a[200:203], v[148:151]
ds_read_b64_tr_b16 v[64:65], v5 offset:20672
v_mfma_f32_16x16x32_bf16 v[148:151], v[76:79], a[204:207], v[148:151]
s_waitcnt lgkmcnt(5)
ds_read_b64_tr_b16 v[66:67], v5 offset:25792
v_mfma_f32_16x16x32_bf16 v[112:115], v[80:83], a[192:195], v[112:115]
ds_read_b64_tr_b16 v[68:69], v5 offset:30912
v_mfma_f32_16x16x32_bf16 v[112:115], v[84:87], a[196:199], v[112:115]
ds_read_b64_tr_b16 v[70:71], v5 offset:36032
v_mfma_f32_16x16x32_bf16 v[152:155], v[80:83], a[200:203], v[152:155]
ds_read_b64_tr_b16 v[72:73], v6 offset:20704
v_mfma_f32_16x16x32_bf16 v[152:155], v[84:87], a[204:207], v[152:155]
s_waitcnt lgkmcnt(5)
ds_read_b64_tr_b16 v[74:75], v6 offset:25824
buffer_load_dwordx4 v[52:55], v36, s[84:87], 0 offen offset:2560
v_mfma_f32_16x16x32_bf16 v[116:119], v[88:91], a[192:195], v[116:119]
ds_read_b64_tr_b16 v[76:77], v6 offset:30944
v_mfma_f32_16x16x32_bf16 v[116:119], v[92:95], a[196:199], v[116:119]
ds_read_b64_tr_b16 v[78:79], v6 offset:36064
v_mfma_f32_16x16x32_bf16 v[156:159], v[88:91], a[200:203], v[156:159]
ds_read_b64_tr_b16 v[80:81], v5 offset:20736
v_mfma_f32_16x16x32_bf16 v[156:159], v[92:95], a[204:207], v[156:159]
s_waitcnt lgkmcnt(5)
ds_read_b64_tr_b16 v[82:83], v5 offset:25856
v_mfma_f32_16x16x32_bf16 v[120:123], v[64:67], a[192:195], v[120:123]
ds_read_b64_tr_b16 v[84:85], v5 offset:30976
buffer_load_dwordx4 v[56:59], v36, s[84:87], 0 offen offset:3072
v_mfma_f32_16x16x32_bf16 v[120:123], v[68:71], a[196:199], v[120:123]
ds_read_b64_tr_b16 v[86:87], v5 offset:36096
v_mfma_f32_16x16x32_bf16 v[160:163], v[64:67], a[200:203], v[160:163]
ds_read_b64_tr_b16 v[88:89], v6 offset:20768
v_mfma_f32_16x16x32_bf16 v[160:163], v[68:71], a[204:207], v[160:163]
s_waitcnt lgkmcnt(5)
ds_read_b64_tr_b16 v[90:91], v6 offset:25888
v_mfma_f32_16x16x32_bf16 v[124:127], v[72:75], a[192:195], v[124:127]
ds_read_b64_tr_b16 v[92:93], v6 offset:31008
v_mfma_f32_16x16x32_bf16 v[124:127], v[76:79], a[196:199], v[124:127]
ds_read_b64_tr_b16 v[94:95], v6 offset:36128
v_mfma_f32_16x16x32_bf16 v[164:167], v[72:75], a[200:203], v[164:167]
ds_read_b64_tr_b16 v[64:65], v7 offset:57344
buffer_load_dwordx4 v[60:63], v37, s[84:87], 0 offen offset:3584
v_mfma_f32_16x16x32_bf16 v[164:167], v[76:79], a[204:207], v[164:167]
s_waitcnt lgkmcnt(5)
ds_read_b64_tr_b16 v[66:67], v7 offset:62464
v_mfma_f32_16x16x32_bf16 v[128:131], v[80:83], a[192:195], v[128:131]
ds_read_b64_tr_b16 v[68:69], v9 offset:2048
v_mfma_f32_16x16x32_bf16 v[128:131], v[84:87], a[196:199], v[128:131]
ds_read_b64_tr_b16 v[70:71], v9 offset:7168
v_mfma_f32_16x16x32_bf16 v[168:171], v[80:83], a[200:203], v[168:171]
ds_read_b64_tr_b16 v[72:73], v8 offset:57376
v_mfma_f32_16x16x32_bf16 v[168:171], v[84:87], a[204:207], v[168:171]
s_waitcnt lgkmcnt(5)
ds_read_b64_tr_b16 v[74:75], v8 offset:62496
v_mfma_f32_16x16x32_bf16 v[132:135], v[88:91], a[192:195], v[132:135]
ds_read_b64_tr_b16 v[76:77], v10 offset:2080
v_mfma_f32_16x16x32_bf16 v[132:135], v[92:95], a[196:199], v[132:135]
ds_read_b64_tr_b16 v[78:79], v10 offset:7200
v_mfma_f32_16x16x32_bf16 v[172:175], v[88:91], a[200:203], v[172:175]
ds_read_b64_tr_b16 v[80:81], v7 offset:57408
v_mfma_f32_16x16x32_bf16 v[172:175], v[92:95], a[204:207], v[172:175]
s_waitcnt lgkmcnt(5)
ds_read_b64_tr_b16 v[82:83], v7 offset:62528
v_mfma_f32_16x16x32_bf16 v[176:179], v[64:67], a[48:51], v[176:179]
ds_read_b64_tr_b16 v[84:85], v9 offset:2112
v_mfma_f32_16x16x32_bf16 v[176:179], v[68:71], a[52:55], v[176:179]
ds_read_b64_tr_b16 v[86:87], v9 offset:7232
v_mfma_f32_16x16x32_bf16 v[216:219], v[64:67], a[56:59], v[216:219]
ds_read_b64_tr_b16 v[88:89], v8 offset:57440
v_mfma_f32_16x16x32_bf16 v[216:219], v[68:71], a[60:63], v[216:219]
s_waitcnt lgkmcnt(5)
ds_read_b64_tr_b16 v[90:91], v8 offset:62560
v_mfma_f32_16x16x32_bf16 v[180:183], v[72:75], a[48:51], v[180:183]
ds_read_b64_tr_b16 v[92:93], v10 offset:2144
v_mfma_f32_16x16x32_bf16 v[180:183], v[76:79], a[52:55], v[180:183]
ds_read_b64_tr_b16 v[94:95], v10 offset:7264
v_mfma_f32_16x16x32_bf16 v[220:223], v[72:75], a[56:59], v[220:223]
ds_read_b64_tr_b16 v[64:65], v7 offset:57472
v_mfma_f32_16x16x32_bf16 v[220:223], v[76:79], a[60:63], v[220:223]
s_waitcnt lgkmcnt(5)
ds_read_b64_tr_b16 v[66:67], v7 offset:62592
v_mfma_f32_16x16x32_bf16 v[184:187], v[80:83], a[48:51], v[184:187]
ds_read_b64_tr_b16 v[68:69], v9 offset:2176
v_mfma_f32_16x16x32_bf16 v[184:187], v[84:87], a[52:55], v[184:187]
ds_read_b64_tr_b16 v[70:71], v9 offset:7296
v_mfma_f32_16x16x32_bf16 v[224:227], v[80:83], a[56:59], v[224:227]
ds_read_b64_tr_b16 v[72:73], v8 offset:57504
v_mfma_f32_16x16x32_bf16 v[224:227], v[84:87], a[60:63], v[224:227]
s_waitcnt lgkmcnt(5)
ds_read_b64_tr_b16 v[74:75], v8 offset:62624
v_mfma_f32_16x16x32_bf16 v[188:191], v[88:91], a[48:51], v[188:191]
ds_read_b64_tr_b16 v[76:77], v10 offset:2208
v_mfma_f32_16x16x32_bf16 v[188:191], v[92:95], a[52:55], v[188:191]
ds_read_b64_tr_b16 v[78:79], v10 offset:7328
v_mfma_f32_16x16x32_bf16 v[228:231], v[88:91], a[56:59], v[228:231]
ds_read_b64_tr_b16 v[80:81], v7 offset:57536
v_mfma_f32_16x16x32_bf16 v[228:231], v[92:95], a[60:63], v[228:231]
s_waitcnt lgkmcnt(5)
ds_read_b64_tr_b16 v[82:83], v7 offset:62656
v_mfma_f32_16x16x32_bf16 v[192:195], v[64:67], a[48:51], v[192:195]
buffer_store_dwordx4 v[96:99], v11, s[76:79], s36 offen offset:0 sc1
v_mfma_f32_16x16x32_bf16 v[192:195], v[68:71], a[52:55], v[192:195]
ds_read_b64_tr_b16 v[84:85], v9 offset:2240
ds_read_b64_tr_b16 v[86:87], v9 offset:7360
v_cvt_pk_bf16_f32 v104, v104, v105
v_mfma_f32_16x16x32_bf16 v[232:235], v[64:67], a[56:59], v[232:235]
ds_read_b64_tr_b16 v[88:89], v8 offset:57568
v_cvt_pk_bf16_f32 v105, v106, v107
v_mfma_f32_16x16x32_bf16 v[232:235], v[68:71], a[60:63], v[232:235]
s_waitcnt lgkmcnt(5)
ds_read_b64_tr_b16 v[90:91], v8 offset:62688
v_mfma_f32_16x16x32_bf16 v[196:199], v[72:75], a[48:51], v[196:199]
ds_read_b64_tr_b16 v[92:93], v10 offset:2272
v_cvt_pk_bf16_f32 v106, v108, v109
v_mfma_f32_16x16x32_bf16 v[196:199], v[76:79], a[52:55], v[196:199]
ds_read_b64_tr_b16 v[94:95], v10 offset:7392
v_cvt_pk_bf16_f32 v107, v110, v111
v_mfma_f32_16x16x32_bf16 v[236:239], v[72:75], a[56:59], v[236:239]
ds_read_b64_tr_b16 v[64:65], v7 offset:57600
v_mfma_f32_16x16x32_bf16 v[236:239], v[76:79], a[60:63], v[236:239]
s_waitcnt lgkmcnt(5)
ds_read_b64_tr_b16 v[66:67], v7 offset:62720
v_mfma_f32_16x16x32_bf16 v[200:203], v[80:83], a[48:51], v[200:203]
ds_read_b64_tr_b16 v[68:69], v9 offset:2304
v_mfma_f32_16x16x32_bf16 v[200:203], v[84:87], a[52:55], v[200:203]
ds_read_b64_tr_b16 v[70:71], v9 offset:7424
v_mfma_f32_16x16x32_bf16 v[240:243], v[80:83], a[56:59], v[240:243]
ds_read_b64_tr_b16 v[72:73], v8 offset:57632
v_mfma_f32_16x16x32_bf16 v[240:243], v[84:87], a[60:63], v[240:243]
s_waitcnt lgkmcnt(5)
ds_read_b64_tr_b16 v[74:75], v8 offset:62752
v_mfma_f32_16x16x32_bf16 v[204:207], v[88:91], a[48:51], v[204:207]
ds_read_b64_tr_b16 v[76:77], v10 offset:2336
v_mfma_f32_16x16x32_bf16 v[204:207], v[92:95], a[52:55], v[204:207]
ds_read_b64_tr_b16 v[78:79], v10 offset:7456
v_mfma_f32_16x16x32_bf16 v[244:247], v[88:91], a[56:59], v[244:247]
ds_read_b64_tr_b16 v[80:81], v9 offset:12288
v_mfma_f32_16x16x32_bf16 v[244:247], v[92:95], a[60:63], v[244:247]
s_waitcnt lgkmcnt(5)
ds_read_b64_tr_b16 v[82:83], v9 offset:17408
buffer_store_dwordx4 v[104:107], v11, s[76:79], s36 offen offset:1024 sc1
v_mfma_f32_16x16x32_bf16 v[208:211], v[64:67], a[48:51], v[208:211]
ds_read_b64_tr_b16 v[84:85], v9 offset:22528
v_cvt_pk_bf16_f32 v112, v112, v113
v_mfma_f32_16x16x32_bf16 v[208:211], v[68:71], a[52:55], v[208:211]
ds_read_b64_tr_b16 v[86:87], v9 offset:27648
v_cvt_pk_bf16_f32 v113, v114, v115
v_mfma_f32_16x16x32_bf16 v[248:251], v[64:67], a[56:59], v[248:251]
ds_read_b64_tr_b16 v[88:89], v10 offset:12320
v_cvt_pk_bf16_f32 v114, v116, v117
v_mfma_f32_16x16x32_bf16 v[248:251], v[68:71], a[60:63], v[248:251]
s_waitcnt lgkmcnt(5)
ds_read_b64_tr_b16 v[90:91], v10 offset:17440
v_mfma_f32_16x16x32_bf16 v[212:215], v[72:75], a[48:51], v[212:215]
ds_read_b64_tr_b16 v[92:93], v10 offset:22560
v_cvt_pk_bf16_f32 v115, v118, v119
v_mfma_f32_16x16x32_bf16 v[212:215], v[76:79], a[52:55], v[212:215]
ds_read_b64_tr_b16 v[94:95], v10 offset:27680
v_mfma_f32_16x16x32_bf16 v[252:255], v[72:75], a[56:59], v[252:255]
ds_read_b64_tr_b16 v[64:65], v9 offset:12352
v_mfma_f32_16x16x32_bf16 v[252:255], v[76:79], a[60:63], v[252:255]
s_waitcnt lgkmcnt(5)
ds_read_b64_tr_b16 v[66:67], v9 offset:17472
v_mfma_f32_16x16x32_bf16 v[176:179], v[80:83], a[112:115], v[176:179]
ds_read_b64_tr_b16 v[68:69], v9 offset:22592
v_mfma_f32_16x16x32_bf16 v[176:179], v[84:87], a[116:119], v[176:179]
ds_read_b64_tr_b16 v[70:71], v9 offset:27712
v_mfma_f32_16x16x32_bf16 v[216:219], v[80:83], a[120:123], v[216:219]
ds_read_b64_tr_b16 v[72:73], v10 offset:12384
v_mfma_f32_16x16x32_bf16 v[216:219], v[84:87], a[124:127], v[216:219]
s_waitcnt lgkmcnt(5)
ds_read_b64_tr_b16 v[74:75], v10 offset:17504
v_mfma_f32_16x16x32_bf16 v[180:183], v[88:91], a[112:115], v[180:183]
ds_read_b64_tr_b16 v[76:77], v10 offset:22624
v_mfma_f32_16x16x32_bf16 v[180:183], v[92:95], a[116:119], v[180:183]
ds_read_b64_tr_b16 v[78:79], v10 offset:27744
v_mfma_f32_16x16x32_bf16 v[220:223], v[88:91], a[120:123], v[220:223]
buffer_store_dwordx4 v[112:115], v11, s[76:79], s36 offen offset:2048 sc1
v_mfma_f32_16x16x32_bf16 v[220:223], v[92:95], a[124:127], v[220:223]
s_waitcnt lgkmcnt(4)
ds_read_b64_tr_b16 v[80:81], v9 offset:12416
v_mfma_f32_16x16x32_bf16 v[184:187], v[64:67], a[112:115], v[184:187]
ds_read_b64_tr_b16 v[82:83], v9 offset:17536
v_cvt_pk_bf16_f32 v120, v120, v121
v_mfma_f32_16x16x32_bf16 v[184:187], v[68:71], a[116:119], v[184:187]
ds_read_b64_tr_b16 v[84:85], v9 offset:22656
ds_read_b64_tr_b16 v[86:87], v9 offset:27776
v_cvt_pk_bf16_f32 v121, v122, v123
v_mfma_f32_16x16x32_bf16 v[224:227], v[64:67], a[120:123], v[224:227]
ds_read_b64_tr_b16 v[88:89], v10 offset:12448
v_cvt_pk_bf16_f32 v122, v124, v125
v_mfma_f32_16x16x32_bf16 v[224:227], v[68:71], a[124:127], v[224:227]
s_waitcnt lgkmcnt(5)
ds_read_b64_tr_b16 v[90:91], v10 offset:17568
v_mfma_f32_16x16x32_bf16 v[188:191], v[72:75], a[112:115], v[188:191]
ds_read_b64_tr_b16 v[92:93], v10 offset:22688
v_cvt_pk_bf16_f32 v123, v126, v127
v_mfma_f32_16x16x32_bf16 v[188:191], v[76:79], a[116:119], v[188:191]
ds_read_b64_tr_b16 v[94:95], v10 offset:27808
v_mfma_f32_16x16x32_bf16 v[228:231], v[72:75], a[120:123], v[228:231]
ds_read_b64_tr_b16 v[64:65], v9 offset:12480
v_mfma_f32_16x16x32_bf16 v[228:231], v[76:79], a[124:127], v[228:231]
s_waitcnt lgkmcnt(5)
ds_read_b64_tr_b16 v[66:67], v9 offset:17600
v_mfma_f32_16x16x32_bf16 v[192:195], v[80:83], a[112:115], v[192:195]
ds_read_b64_tr_b16 v[68:69], v9 offset:22720
v_mfma_f32_16x16x32_bf16 v[192:195], v[84:87], a[116:119], v[192:195]
ds_read_b64_tr_b16 v[70:71], v9 offset:27840
v_mfma_f32_16x16x32_bf16 v[232:235], v[80:83], a[120:123], v[232:235]
ds_read_b64_tr_b16 v[72:73], v10 offset:12512
v_mfma_f32_16x16x32_bf16 v[232:235], v[84:87], a[124:127], v[232:235]
s_waitcnt lgkmcnt(5)
ds_read_b64_tr_b16 v[74:75], v10 offset:17632
v_mfma_f32_16x16x32_bf16 v[196:199], v[88:91], a[112:115], v[196:199]
ds_read_b64_tr_b16 v[76:77], v10 offset:22752
v_mfma_f32_16x16x32_bf16 v[196:199], v[92:95], a[116:119], v[196:199]
buffer_store_dwordx4 v[120:123], v11, s[76:79], s36 offen offset:3072 sc1
ds_read_b64_tr_b16 v[78:79], v10 offset:27872
v_mfma_f32_16x16x32_bf16 v[236:239], v[88:91], a[120:123], v[236:239]
ds_read_b64_tr_b16 v[80:81], v9 offset:12544
v_cvt_pk_bf16_f32 v128, v128, v129
v_mfma_f32_16x16x32_bf16 v[236:239], v[92:95], a[124:127], v[236:239]
s_waitcnt lgkmcnt(5)
ds_read_b64_tr_b16 v[82:83], v9 offset:17664
v_mfma_f32_16x16x32_bf16 v[200:203], v[64:67], a[112:115], v[200:203]
ds_read_b64_tr_b16 v[84:85], v9 offset:22784
v_cvt_pk_bf16_f32 v129, v130, v131
v_mfma_f32_16x16x32_bf16 v[200:203], v[68:71], a[116:119], v[200:203]
ds_read_b64_tr_b16 v[86:87], v9 offset:27904
v_cvt_pk_bf16_f32 v130, v132, v133
v_mfma_f32_16x16x32_bf16 v[240:243], v[64:67], a[120:123], v[240:243]
ds_read_b64_tr_b16 v[88:89], v10 offset:12576
v_cvt_pk_bf16_f32 v131, v134, v135
v_mfma_f32_16x16x32_bf16 v[240:243], v[68:71], a[124:127], v[240:243]
s_waitcnt lgkmcnt(5)
ds_read_b64_tr_b16 v[90:91], v10 offset:17696
v_mfma_f32_16x16x32_bf16 v[204:207], v[72:75], a[112:115], v[204:207]
ds_read_b64_tr_b16 v[92:93], v10 offset:22816
v_mfma_f32_16x16x32_bf16 v[204:207], v[76:79], a[116:119], v[204:207]
ds_read_b64_tr_b16 v[94:95], v10 offset:27936
v_mfma_f32_16x16x32_bf16 v[244:247], v[72:75], a[120:123], v[244:247]
ds_read_b64_tr_b16 v[64:65], v5 offset:0
v_mfma_f32_16x16x32_bf16 v[244:247], v[76:79], a[124:127], v[244:247]
s_waitcnt lgkmcnt(5)
ds_read_b64_tr_b16 v[66:67], v5 offset:5120
v_mfma_f32_16x16x32_bf16 v[208:211], v[80:83], a[112:115], v[208:211]
ds_read_b64_tr_b16 v[68:69], v5 offset:10240
v_mfma_f32_16x16x32_bf16 v[208:211], v[84:87], a[116:119], v[208:211]
ds_read_b64_tr_b16 v[70:71], v5 offset:15360
v_mfma_f32_16x16x32_bf16 v[248:251], v[80:83], a[120:123], v[248:251]
ds_read_b64_tr_b16 v[72:73], v6 offset:32
v_mfma_f32_16x16x32_bf16 v[248:251], v[84:87], a[124:127], v[248:251]
s_waitcnt lgkmcnt(5)
ds_read_b64_tr_b16 v[74:75], v6 offset:5152
v_mfma_f32_16x16x32_bf16 v[212:215], v[88:91], a[112:115], v[212:215]
buffer_store_dwordx4 v[128:131], v18, s[76:79], s36 offen offset:0 sc1
v_mfma_f32_16x16x32_bf16 v[212:215], v[92:95], a[116:119], v[212:215]
ds_read_b64_tr_b16 v[76:77], v6 offset:10272
ds_read_b64_tr_b16 v[78:79], v6 offset:15392
v_cvt_pk_bf16_f32 v136, v136, v137
v_mfma_f32_16x16x32_bf16 v[252:255], v[88:91], a[120:123], v[252:255]
ds_read_b64_tr_b16 v[80:81], v5 offset:64
v_cvt_pk_bf16_f32 v137, v138, v139
v_mfma_f32_16x16x32_bf16 v[252:255], v[92:95], a[124:127], v[252:255]
s_waitcnt lgkmcnt(5)
ds_read_b64_tr_b16 v[82:83], v5 offset:5184
v_mfma_f32_16x16x32_bf16 v[176:179], v[64:67], a[176:179], v[176:179]
ds_read_b64_tr_b16 v[84:85], v5 offset:10304
v_cvt_pk_bf16_f32 v138, v140, v141
v_mfma_f32_16x16x32_bf16 v[176:179], v[68:71], a[180:183], v[176:179]
ds_read_b64_tr_b16 v[86:87], v5 offset:15424
v_cvt_pk_bf16_f32 v139, v142, v143
v_mfma_f32_16x16x32_bf16 v[216:219], v[64:67], a[184:187], v[216:219]
ds_read_b64_tr_b16 v[88:89], v6 offset:96
v_mfma_f32_16x16x32_bf16 v[216:219], v[68:71], a[188:191], v[216:219]
s_waitcnt lgkmcnt(5)
ds_read_b64_tr_b16 v[90:91], v6 offset:5216
v_mfma_f32_16x16x32_bf16 v[180:183], v[72:75], a[176:179], v[180:183]
ds_read_b64_tr_b16 v[92:93], v6 offset:10336
v_mfma_f32_16x16x32_bf16 v[180:183], v[76:79], a[180:183], v[180:183]
ds_read_b64_tr_b16 v[94:95], v6 offset:15456
v_mfma_f32_16x16x32_bf16 v[220:223], v[72:75], a[184:187], v[220:223]
ds_read_b64_tr_b16 v[64:65], v5 offset:128
v_mfma_f32_16x16x32_bf16 v[220:223], v[76:79], a[188:191], v[220:223]
s_waitcnt lgkmcnt(5)
ds_read_b64_tr_b16 v[66:67], v5 offset:5248
v_mfma_f32_16x16x32_bf16 v[184:187], v[80:83], a[176:179], v[184:187]
ds_read_b64_tr_b16 v[68:69], v5 offset:10368
v_mfma_f32_16x16x32_bf16 v[184:187], v[84:87], a[180:183], v[184:187]
ds_read_b64_tr_b16 v[70:71], v5 offset:15488
v_mfma_f32_16x16x32_bf16 v[224:227], v[80:83], a[184:187], v[224:227]
ds_read_b64_tr_b16 v[72:73], v6 offset:160
v_mfma_f32_16x16x32_bf16 v[224:227], v[84:87], a[188:191], v[224:227]
s_waitcnt lgkmcnt(5)
ds_read_b64_tr_b16 v[74:75], v6 offset:5280
buffer_store_dwordx4 v[136:139], v11, s[76:79], s37 offen offset:0 sc1
v_mfma_f32_16x16x32_bf16 v[188:191], v[88:91], a[176:179], v[188:191]
ds_read_b64_tr_b16 v[76:77], v6 offset:10400
v_cvt_pk_bf16_f32 v144, v144, v145
v_mfma_f32_16x16x32_bf16 v[188:191], v[92:95], a[180:183], v[188:191]
ds_read_b64_tr_b16 v[78:79], v6 offset:15520
v_cvt_pk_bf16_f32 v145, v146, v147
v_mfma_f32_16x16x32_bf16 v[228:231], v[88:91], a[184:187], v[228:231]
ds_read_b64_tr_b16 v[80:81], v5 offset:192
v_cvt_pk_bf16_f32 v146, v148, v149
v_mfma_f32_16x16x32_bf16 v[228:231], v[92:95], a[188:191], v[228:231]
s_waitcnt lgkmcnt(5)
ds_read_b64_tr_b16 v[82:83], v5 offset:5312
v_mfma_f32_16x16x32_bf16 v[192:195], v[64:67], a[176:179], v[192:195]
ds_read_b64_tr_b16 v[84:85], v5 offset:10432
v_cvt_pk_bf16_f32 v147, v150, v151
v_mfma_f32_16x16x32_bf16 v[192:195], v[68:71], a[180:183], v[192:195]
ds_read_b64_tr_b16 v[86:87], v5 offset:15552
v_mfma_f32_16x16x32_bf16 v[232:235], v[64:67], a[184:187], v[232:235]
ds_read_b64_tr_b16 v[88:89], v6 offset:224
v_mfma_f32_16x16x32_bf16 v[232:235], v[68:71], a[188:191], v[232:235]
s_waitcnt lgkmcnt(5)
ds_read_b64_tr_b16 v[90:91], v6 offset:5344
v_mfma_f32_16x16x32_bf16 v[196:199], v[72:75], a[176:179], v[196:199]
ds_read_b64_tr_b16 v[92:93], v6 offset:10464
v_mfma_f32_16x16x32_bf16 v[196:199], v[76:79], a[180:183], v[196:199]
ds_read_b64_tr_b16 v[94:95], v6 offset:15584
v_mfma_f32_16x16x32_bf16 v[236:239], v[72:75], a[184:187], v[236:239]
ds_read_b64_tr_b16 v[64:65], v5 offset:256
v_mfma_f32_16x16x32_bf16 v[236:239], v[76:79], a[188:191], v[236:239]
s_waitcnt lgkmcnt(5)
ds_read_b64_tr_b16 v[66:67], v5 offset:5376
v_mfma_f32_16x16x32_bf16 v[200:203], v[80:83], a[176:179], v[200:203]
ds_read_b64_tr_b16 v[68:69], v5 offset:10496
v_mfma_f32_16x16x32_bf16 v[200:203], v[84:87], a[180:183], v[200:203]
ds_read_b64_tr_b16 v[70:71], v5 offset:15616
v_mfma_f32_16x16x32_bf16 v[240:243], v[80:83], a[184:187], v[240:243]
buffer_store_dwordx4 v[144:147], v11, s[76:79], s37 offen offset:1024 sc1
v_mfma_f32_16x16x32_bf16 v[240:243], v[84:87], a[188:191], v[240:243]
s_waitcnt lgkmcnt(4)
ds_read_b64_tr_b16 v[72:73], v6 offset:288
v_mfma_f32_16x16x32_bf16 v[204:207], v[88:91], a[176:179], v[204:207]
ds_read_b64_tr_b16 v[74:75], v6 offset:5408
v_cvt_pk_bf16_f32 v152, v152, v153
v_mfma_f32_16x16x32_bf16 v[204:207], v[92:95], a[180:183], v[204:207]
ds_read_b64_tr_b16 v[76:77], v6 offset:10528
ds_read_b64_tr_b16 v[78:79], v6 offset:15648
v_cvt_pk_bf16_f32 v153, v154, v155
v_mfma_f32_16x16x32_bf16 v[244:247], v[88:91], a[184:187], v[244:247]
ds_read_b64_tr_b16 v[80:81], v5 offset:20480
v_cvt_pk_bf16_f32 v154, v156, v157
v_mfma_f32_16x16x32_bf16 v[244:247], v[92:95], a[188:191], v[244:247]
s_waitcnt lgkmcnt(5)
ds_read_b64_tr_b16 v[82:83], v5 offset:25600
v_mfma_f32_16x16x32_bf16 v[208:211], v[64:67], a[176:179], v[208:211]
ds_read_b64_tr_b16 v[84:85], v5 offset:30720
v_cvt_pk_bf16_f32 v155, v158, v159
v_mfma_f32_16x16x32_bf16 v[208:211], v[68:71], a[180:183], v[208:211]
ds_read_b64_tr_b16 v[86:87], v5 offset:35840
v_mfma_f32_16x16x32_bf16 v[248:251], v[64:67], a[184:187], v[248:251]
ds_read_b64_tr_b16 v[88:89], v6 offset:20512
v_mfma_f32_16x16x32_bf16 v[248:251], v[68:71], a[188:191], v[248:251]
s_waitcnt lgkmcnt(5)
ds_read_b64_tr_b16 v[90:91], v6 offset:25632
v_mfma_f32_16x16x32_bf16 v[212:215], v[72:75], a[176:179], v[212:215]
ds_read_b64_tr_b16 v[92:93], v6 offset:30752
v_mfma_f32_16x16x32_bf16 v[212:215], v[76:79], a[180:183], v[212:215]
ds_read_b64_tr_b16 v[94:95], v6 offset:35872
v_mfma_f32_16x16x32_bf16 v[252:255], v[72:75], a[184:187], v[252:255]
ds_read_b64_tr_b16 v[64:65], v5 offset:20544
v_mfma_f32_16x16x32_bf16 v[252:255], v[76:79], a[188:191], v[252:255]
s_waitcnt lgkmcnt(5)
ds_read_b64_tr_b16 v[66:67], v5 offset:25664
v_mfma_f32_16x16x32_bf16 v[176:179], v[80:83], a[208:211], v[176:179]
ds_read_b64_tr_b16 v[68:69], v5 offset:30784
v_mfma_f32_16x16x32_bf16 v[176:179], v[84:87], a[212:215], v[176:179]
buffer_store_dwordx4 v[152:155], v11, s[76:79], s37 offen offset:2048 sc1
ds_read_b64_tr_b16 v[70:71], v5 offset:35904
v_mfma_f32_16x16x32_bf16 v[216:219], v[80:83], a[216:219], v[216:219]
ds_read_b64_tr_b16 v[72:73], v6 offset:20576
v_cvt_pk_bf16_f32 v160, v160, v161
v_mfma_f32_16x16x32_bf16 v[216:219], v[84:87], a[220:223], v[216:219]
s_waitcnt lgkmcnt(5)
ds_read_b64_tr_b16 v[74:75], v6 offset:25696
v_mfma_f32_16x16x32_bf16 v[180:183], v[88:91], a[208:211], v[180:183]
ds_read_b64_tr_b16 v[76:77], v6 offset:30816
v_cvt_pk_bf16_f32 v161, v162, v163
v_mfma_f32_16x16x32_bf16 v[180:183], v[92:95], a[212:215], v[180:183]
ds_read_b64_tr_b16 v[78:79], v6 offset:35936
v_cvt_pk_bf16_f32 v162, v164, v165
v_mfma_f32_16x16x32_bf16 v[220:223], v[88:91], a[216:219], v[220:223]
ds_read_b64_tr_b16 v[80:81], v5 offset:20608
v_cvt_pk_bf16_f32 v163, v166, v167
v_mfma_f32_16x16x32_bf16 v[220:223], v[92:95], a[220:223], v[220:223]
s_waitcnt lgkmcnt(5)
ds_read_b64_tr_b16 v[82:83], v5 offset:25728
v_mfma_f32_16x16x32_bf16 v[184:187], v[64:67], a[208:211], v[184:187]
ds_read_b64_tr_b16 v[84:85], v5 offset:30848
v_mfma_f32_16x16x32_bf16 v[184:187], v[68:71], a[212:215], v[184:187]
ds_read_b64_tr_b16 v[86:87], v5 offset:35968
v_mfma_f32_16x16x32_bf16 v[224:227], v[64:67], a[216:219], v[224:227]
ds_read_b64_tr_b16 v[88:89], v6 offset:20640
v_mfma_f32_16x16x32_bf16 v[224:227], v[68:71], a[220:223], v[224:227]
s_waitcnt lgkmcnt(5)
ds_read_b64_tr_b16 v[90:91], v6 offset:25760
v_mfma_f32_16x16x32_bf16 v[188:191], v[72:75], a[208:211], v[188:191]
ds_read_b64_tr_b16 v[92:93], v6 offset:30880
v_mfma_f32_16x16x32_bf16 v[188:191], v[76:79], a[212:215], v[188:191]
ds_read_b64_tr_b16 v[94:95], v6 offset:36000
v_mfma_f32_16x16x32_bf16 v[228:231], v[72:75], a[216:219], v[228:231]
ds_read_b64_tr_b16 v[64:65], v5 offset:20672
v_mfma_f32_16x16x32_bf16 v[228:231], v[76:79], a[220:223], v[228:231]
s_waitcnt lgkmcnt(5)
ds_read_b64_tr_b16 v[66:67], v5 offset:25792
v_mfma_f32_16x16x32_bf16 v[192:195], v[80:83], a[208:211], v[192:195]
buffer_store_dwordx4 v[160:163], v11, s[76:79], s37 offen offset:3072 sc1
v_mfma_f32_16x16x32_bf16 v[192:195], v[84:87], a[212:215], v[192:195]
ds_read_b64_tr_b16 v[68:69], v5 offset:30912
ds_read_b64_tr_b16 v[70:71], v5 offset:36032
v_cvt_pk_bf16_f32 v168, v168, v169
v_mfma_f32_16x16x32_bf16 v[232:235], v[80:83], a[216:219], v[232:235]
ds_read_b64_tr_b16 v[72:73], v6 offset:20704
v_cvt_pk_bf16_f32 v169, v170, v171
v_mfma_f32_16x16x32_bf16 v[232:235], v[84:87], a[220:223], v[232:235]
s_waitcnt lgkmcnt(5)
ds_read_b64_tr_b16 v[74:75], v6 offset:25824
v_mfma_f32_16x16x32_bf16 v[196:199], v[88:91], a[208:211], v[196:199]
ds_read_b64_tr_b16 v[76:77], v6 offset:30944
v_cvt_pk_bf16_f32 v170, v172, v173
v_mfma_f32_16x16x32_bf16 v[196:199], v[92:95], a[212:215], v[196:199]
ds_read_b64_tr_b16 v[78:79], v6 offset:36064
v_cvt_pk_bf16_f32 v171, v174, v175
v_mfma_f32_16x16x32_bf16 v[236:239], v[88:91], a[216:219], v[236:239]
ds_read_b64_tr_b16 v[80:81], v5 offset:20736
v_mfma_f32_16x16x32_bf16 v[236:239], v[92:95], a[220:223], v[236:239]
s_waitcnt lgkmcnt(5)
ds_read_b64_tr_b16 v[82:83], v5 offset:25856
v_mfma_f32_16x16x32_bf16 v[200:203], v[64:67], a[208:211], v[200:203]
ds_read_b64_tr_b16 v[84:85], v5 offset:30976
v_mfma_f32_16x16x32_bf16 v[200:203], v[68:71], a[212:215], v[200:203]
ds_read_b64_tr_b16 v[86:87], v5 offset:36096
v_mfma_f32_16x16x32_bf16 v[240:243], v[64:67], a[216:219], v[240:243]
ds_read_b64_tr_b16 v[88:89], v6 offset:20768
v_mfma_f32_16x16x32_bf16 v[240:243], v[68:71], a[220:223], v[240:243]
s_waitcnt lgkmcnt(5)
ds_read_b64_tr_b16 v[90:91], v6 offset:25888
v_mfma_f32_16x16x32_bf16 v[204:207], v[72:75], a[208:211], v[204:207]
ds_read_b64_tr_b16 v[92:93], v6 offset:31008
v_mfma_f32_16x16x32_bf16 v[204:207], v[76:79], a[212:215], v[204:207]
ds_read_b64_tr_b16 v[94:95], v6 offset:36128
v_mfma_f32_16x16x32_bf16 v[244:247], v[72:75], a[216:219], v[244:247]
buffer_store_dwordx4 v[168:171], v18, s[76:79], s37 offen offset:0 sc1
v_mfma_f32_16x16x32_bf16 v[244:247], v[76:79], a[220:223], v[244:247]
s_waitcnt lgkmcnt(4)
v_mfma_f32_16x16x32_bf16 v[208:211], v[80:83], a[208:211], v[208:211]
v_mfma_f32_16x16x32_bf16 v[208:211], v[84:87], a[212:215], v[208:211]
v_mfma_f32_16x16x32_bf16 v[248:251], v[80:83], a[216:219], v[248:251]
v_mfma_f32_16x16x32_bf16 v[248:251], v[84:87], a[220:223], v[248:251]
s_waitcnt lgkmcnt(0)
v_mfma_f32_16x16x32_bf16 v[212:215], v[88:91], a[208:211], v[212:215]
v_mfma_f32_16x16x32_bf16 v[212:215], v[92:95], a[212:215], v[212:215]
v_mfma_f32_16x16x32_bf16 v[252:255], v[88:91], a[216:219], v[252:255]
v_mfma_f32_16x16x32_bf16 v[252:255], v[92:95], a[220:223], v[252:255]
s_barrier
s_nop 6
s_lshr_b32 s6, s2, 3
s_and_b32 s3, s6, 7
s_and_b32 s6, s6, 15
s_mul_i32 s7, s3, 102400
s_add_u32 s52, s52, s7
s_addc_u32 s53, s53, 0
s_mov_b32 s54, 102400
s_mul_i32 s7, s3, 102400
s_add_u32 s56, s56, s7
s_addc_u32 s57, s57, 0
s_mov_b32 s58, 102400
s_mul_i32 s7, s6, 122880
s_add_u32 s60, s60, s7
s_addc_u32 s61, s61, 0
s_mov_b32 s62, 122880
s_mul_i32 s7, s3, 245760
s_add_u32 s64, s64, s7
s_addc_u32 s65, s65, 0
s_mov_b32 s66, 245760
v_cvt_pk_bf16_f32 v176, v176, v177
v_cvt_pk_bf16_f32 v177, v178, v179
v_cvt_pk_bf16_f32 v178, v180, v181
v_cvt_pk_bf16_f32 v179, v182, v183
buffer_store_dwordx4 v[176:179], v11, s[76:79], s38 offen offset:0 sc1
v_cvt_pk_bf16_f32 v184, v184, v185
v_cvt_pk_bf16_f32 v185, v186, v187
v_cvt_pk_bf16_f32 v186, v188, v189
v_cvt_pk_bf16_f32 v187, v190, v191
buffer_store_dwordx4 v[184:187], v11, s[76:79], s38 offen offset:1024 sc1
v_cvt_pk_bf16_f32 v192, v192, v193
v_cvt_pk_bf16_f32 v193, v194, v195
v_cvt_pk_bf16_f32 v194, v196, v197
v_cvt_pk_bf16_f32 v195, v198, v199
buffer_store_dwordx4 v[192:195], v11, s[76:79], s38 offen offset:2048 sc1
v_cvt_pk_bf16_f32 v200, v200, v201
v_cvt_pk_bf16_f32 v201, v202, v203
v_cvt_pk_bf16_f32 v202, v204, v205
v_cvt_pk_bf16_f32 v203, v206, v207
buffer_store_dwordx4 v[200:203], v11, s[76:79], s38 offen offset:3072 sc1
v_cvt_pk_bf16_f32 v208, v208, v209
v_cvt_pk_bf16_f32 v209, v210, v211
v_cvt_pk_bf16_f32 v210, v212, v213
v_cvt_pk_bf16_f32 v211, v214, v215
buffer_store_dwordx4 v[208:211], v18, s[76:79], s38 offen offset:0 sc1
v_cvt_pk_bf16_f32 v216, v216, v217
v_cvt_pk_bf16_f32 v217, v218, v219
v_cvt_pk_bf16_f32 v218, v220, v221
v_cvt_pk_bf16_f32 v219, v222, v223
buffer_store_dwordx4 v[216:219], v11, s[76:79], s39 offen offset:0 sc1
v_cvt_pk_bf16_f32 v224, v224, v225
v_cvt_pk_bf16_f32 v225, v226, v227
v_cvt_pk_bf16_f32 v226, v228, v229
v_cvt_pk_bf16_f32 v227, v230, v231
buffer_store_dwordx4 v[224:227], v11, s[76:79], s39 offen offset:1024 sc1
v_cvt_pk_bf16_f32 v232, v232, v233
v_cvt_pk_bf16_f32 v233, v234, v235
v_cvt_pk_bf16_f32 v234, v236, v237
v_cvt_pk_bf16_f32 v235, v238, v239
buffer_store_dwordx4 v[232:235], v11, s[76:79], s39 offen offset:2048 sc1
v_cvt_pk_bf16_f32 v240, v240, v241
v_cvt_pk_bf16_f32 v241, v242, v243
v_cvt_pk_bf16_f32 v242, v244, v245
v_cvt_pk_bf16_f32 v243, v246, v247
buffer_store_dwordx4 v[240:243], v11, s[76:79], s39 offen offset:3072 sc1
v_cvt_pk_bf16_f32 v248, v248, v249
v_cvt_pk_bf16_f32 v249, v250, v251
v_cvt_pk_bf16_f32 v250, v252, v253
v_cvt_pk_bf16_f32 v251, v254, v255
buffer_store_dwordx4 v[248:251], v18, s[76:79], s39 offen offset:0 sc1
s_waitcnt vmcnt(0)
s_mov_b64 exec, 1
buffer_atomic_add v31, off, s[68:71], s16 sc1
s_mov_b64 exec, -1
s_add_u32 s72, s4, 33554432
s_addc_u32 s73, s5, 0
s_mov_b32 s74, 20971520
s_mov_b32 s75, 0x20000
v_and_b32 v16, 7, v0
v_lshlrev_b32 v16, 2, v16
buffer_load_dword v19, v16, s[68:71], s13 offen sc1
s_movk_i32 s7, 5120
buffer_load_dwordx4 v[116:119], v36, s[84:87], s7 offen offset:0
buffer_load_dwordx4 v[120:123], v36, s[84:87], s7 offen offset:512
buffer_load_dwordx4 v[124:127], v37, s[84:87], s7 offen offset:1024
s_movk_i32 s7, 3840
buffer_load_dwordx4 v[128:131], v36, s[84:87], s7 offen offset:0
buffer_load_dwordx4 v[132:135], v36, s[84:87], s7 offen offset:512
buffer_load_dwordx4 v[136:139], v37, s[84:87], s7 offen offset:1024
s_mov_b32 s15, 0
s_mov_b32 s19, 1
s_mov_b32 s101, 0x200000
s_waitcnt vmcnt(6)
L_pd_top:
v_cmp_le_u32 vcc, 4, v19
s_nop 0
s_andn2_b32 s17, vcc_lo, s15
s_and_b32 s17, s17, 0xff
s_bitcmp1_b32 s17, 0
s_cbranch_scc0 L_pd_0
s_add_u32 s16, s12, 0
s_add_u32 s18, s16, 8192
buffer_load_dwordx4 v[160:163], v32, s[72:75], s16 offen sc1
buffer_load_dwordx4 v[164:167], v32, s[72:75], s18 offen sc1
buffer_load_dwordx4 v[168:171], v33, s[72:75], s16 offen sc1
L_pd_0:
s_bitcmp1_b32 s17, 1
s_cbranch_scc0 L_pd_1
s_add_u32 s16, s12, 2621440
s_add_u32 s18, s16, 8192
buffer_load_dwordx4 v[172:175], v32, s[72:75], s16 offen sc1
buffer_load_dwordx4 v[176:179], v32, s[72:75], s18 offen sc1
buffer_load_dwordx4 v[180:183], v33, s[72:75], s16 offen sc1
L_pd_1:
s_bitcmp1_b32 s17, 2
s_cbranch_scc0 L_pd_2
s_add_u32 s16, s12, 5242880
s_add_u32 s18, s16, 8192
buffer_load_dwordx4 v[184:187], v32, s[72:75], s16 offen sc1
buffer_load_dwordx4 v[188:191], v32, s[72:75], s18 offen sc1
buffer_load_dwordx4 v[192:195], v33, s[72:75], s16 offen sc1
L_pd_2:
s_bitcmp1_b32 s17, 3
s_cbranch_scc0 L_pd_3
s_add_u32 s16, s12, 7864320
s_add_u32 s18, s16, 8192
buffer_load_dwordx4 v[196:199], v32, s[72:75], s16 offen sc1
buffer_load_dwordx4 v[200:203], v32, s[72:75], s18 offen sc1
buffer_load_dwordx4 v[204:207], v33, s[72:75], s16 offen sc1
L_pd_3:
s_bitcmp1_b32 s17, 4
s_cbranch_scc0 L_pd_4
s_add_u32 s16, s12, 10485760
s_add_u32 s18, s16, 8192
buffer_load_dwordx4 v[208:211], v32, s[72:75], s16 offen sc1
buffer_load_dwordx4 v[212:215], v32, s[72:75], s18 offen sc1
buffer_load_dwordx4 v[216:219], v33, s[72:75], s16 offen sc1
L_pd_4:
s_bitcmp1_b32 s17, 5
s_cbranch_scc0 L_pd_5
s_add_u32 s16, s12, 13107200
s_add_u32 s18, s16, 8192
buffer_load_dwordx4 v[220:223], v32, s[72:75], s16 offen sc1
buffer_load_dwordx4 v[224:227], v32, s[72:75], s18 offen sc1
buffer_load_dwordx4 v[228:231], v33, s[72:75], s16 offen sc1
L_pd_5:
s_bitcmp1_b32 s17, 6
s_cbranch_scc0 L_pd_6
s_add_u32 s16, s12, 15728640
s_add_u32 s18, s16, 8192
buffer_load_dwordx4 v[232:235], v32, s[72:75], s16 offen sc1
buffer_load_dwordx4 v[236:239], v32, s[72:75], s18 offen sc1
buffer_load_dwordx4 v[240:243], v33, s[72:75], s16 offen sc1
L_pd_6:
s_bitcmp1_b32 s17, 7
s_cbranch_scc0 L_pd_7
s_add_u32 s16, s12, 18350080
s_add_u32 s18, s16, 8192
buffer_load_dwordx4 v[244:247], v32, s[72:75], s16 offen sc1
buffer_load_dwordx4 v[248:251], v32, s[72:75], s18 offen sc1
buffer_load_dwordx4 v[252:255], v33, s[72:75], s16 offen sc1
L_pd_7:
s_or_b32 s15, s15, s17
s_cmp_eq_u32 s15, 0xff
s_cbranch_scc1 L_pd_all
s_cmp_eq_u32 s19, 0
s_cbranch_scc1 L_pd_poll
s_mov_b32 s19, 0
s_mov_b32 s92, 0
s_add_u32 m0, s94, 40960
s_nop 0
buffer_load_dwordx4 v26, s[52:55], s92 offen offset:0  lds
buffer_load_dwordx4 v26, s[52:55], s92 offen offset:1024  lds
buffer_load_dwordx4 v26, s[52:55], s92 offen offset:2048  lds
buffer_load_dwordx4 v26, s[52:55], s92 offen offset:3072  lds
s_add_u32 s92, s92, 4096
s_add_u32 m0, s94, 45056
s_nop 0
buffer_load_dwordx4 v26, s[52:55], s92 offen offset:0  lds
s_mov_b32 s92, 20480
s_add_u32 m0, s94, 61440
s_nop 0
buffer_load_dwordx4 v26, s[52:55], s92 offen offset:0  lds
buffer_load_dwordx4 v26, s[52:55], s92 offen offset:1024  lds
buffer_load_dwordx4 v26, s[52:55], s92 offen offset:2048  lds
buffer_load_dwordx4 v26, s[52:55], s92 offen offset:3072  lds
s_add_u32 s92, s92, 4096
s_add_u32 m0, s94, 65536
s_nop 0
buffer_load_dwordx4 v26, s[52:55], s92 offen offset:0  lds
s_mov_b32 s92, 40960
s_add_u32 m0, s94, 81920
s_nop 0
buffer_load_dwordx4 v26, s[52:55], s92 offen offset:0  lds
buffer_load_dwordx4 v26, s[52:55], s92 offen offset:1024  lds
buffer_load_dwordx4 v26, s[52:55], s92 offen offset:2048  lds
buffer_load_dwordx4 v26, s[52:55], s92 offen offset:3072  lds
s_add_u32 s92, s92, 4096
s_add_u32 m0, s94, 86016
s_nop 0
buffer_load_dwordx4 v26, s[52:55], s92 offen offset:0  lds
s_mov_b32 s92, 61440
s_add_u32 m0, s94, 102400
s_nop 0
buffer_load_dwordx4 v26, s[52:55], s92 offen offset:0  lds
buffer_load_dwordx4 v26, s[52:55], s92 offen offset:1024  lds
buffer_load_dwordx4 v26, s[52:55], s92 offen offset:2048  lds
buffer_load_dwordx4 v26, s[52:55], s92 offen offset:3072  lds
s_add_u32 s92, s92, 4096
s_add_u32 m0, s94, 106496
s_nop 0
buffer_load_dwordx4 v26, s[52:55], s92 offen offset:0  lds
s_mov_b32 s92, 81920
s_add_u32 m0, s94, 122880
s_nop 0
buffer_load_dwordx4 v26, s[52:55], s92 offen offset:0  lds
buffer_load_dwordx4 v26, s[52:55], s92 offen offset:1024  lds
buffer_load_dwordx4 v26, s[52:55], s92 offen offset:2048  lds
buffer_load_dwordx4 v26, s[52:55], s92 offen offset:3072  lds
s_add_u32 s92, s92, 4096
s_add_u32 m0, s94, 126976
s_nop 0
buffer_load_dwordx4 v26, s[52:55], s92 offen offset:0  lds
L_pd_poll:
s_sub_u32 s101, s101, 1
s_cmp_eq_u32 s101, 0
s_cbranch_scc1 L_pd_all
buffer_load_dword v19, v16, s[68:71], s13 offen sc1
s_waitcnt vmcnt(0)
s_branch L_pd_top
L_pd_all:
s_waitcnt vmcnt(0)
L_al_on11:
s_movk_i32 s16, 0x3f80
s_mov_b32 s18, 0x3f800000
s_cmp_lg_u32 s19, 0
s_cbranch_scc1 L_ln2_late
v_lshlrev_b32 v80, 16, v160
v_and_b32 v81, 0xffff0000, v160
v_lshlrev_b32 v82, 16, v161
v_and_b32 v83, 0xffff0000, v161
v_lshlrev_b32 v84, 16, v162
v_and_b32 v85, 0xffff0000, v162
v_lshlrev_b32 v86, 16, v163
v_and_b32 v87, 0xffff0000, v163
v_lshlrev_b32 v88, 16, v164
v_and_b32 v89, 0xffff0000, v164
v_lshlrev_b32 v90, 16, v165
v_and_b32 v91, 0xffff0000, v165
v_lshlrev_b32 v92, 16, v166
v_and_b32 v93, 0xffff0000, v166
v_lshlrev_b32 v94, 16, v167
v_and_b32 v95, 0xffff0000, v167
v_lshlrev_b32 v96, 16, v168
v_and_b32 v97, 0xffff0000, v168
v_lshlrev_b32 v98, 16, v169
v_and_b32 v99, 0xffff0000, v169
v_lshlrev_b32_e64 v100, 16, v170
v_and_b32 v101, 0xffff0000, v170
v_lshlrev_b32 v102, 16, v171
v_and_b32 v103, 0xffff0000, v171
v_dot2c_f32_bf16 v80, s16, v172
v_dot2c_f32_bf16 v81, s18, v172
v_dot2c_f32_bf16 v82, s16, v173
v_dot2c_f32_bf16 v83, s18, v173
v_dot2c_f32_bf16 v84, s16, v174
v_dot2c_f32_bf16 v85, s18, v174
v_dot2c_f32_bf16 v86, s16, v175
v_dot2c_f32_bf16 v87, s18, v175
v_dot2c_f32_bf16 v88, s16, v176
v_dot2c_f32_bf16 v89, s18, v176
v_dot2c_f32_bf16 v90, s16, v177
v_dot2c_f32_bf16 v91, s18, v177
v_dot2c_f32_bf16 v92, s16, v178
v_dot2c_f32_bf16 v93, s18, v178
v_dot2c_f32_bf16 v94, s16, v179
v_dot2c_f32_bf16 v95, s18, v179
v_dot2c_f32_bf16 v96, s16, v180
v_dot2c_f32_bf16 v97, s18, v180
v_dot2c_f32_bf16 v98, s16, v181
v_dot2c_f32_bf16 v99, s18, v181
v_dot2c_f32_bf16 v100, s16, v182
v_dot2c_f32_bf16 v101, s18, v182
v_dot2c_f32_bf16 v102, s16, v183
v_dot2c_f32_bf16 v103, s18, v183
v_dot2c_f32_bf16 v80, s16, v184
v_dot2c_f32_bf16 v81, s18, v184
v_dot2c_f32_bf16 v82, s16, v185
v_dot2c_f32_bf16 v83, s18, v185
v_dot2c_f32_bf16 v84, s16, v186
v_dot2c_f32_bf16 v85, s18, v186
v_dot2c_f32_bf16 v86, s16, v187
v_dot2c_f32_bf16 v87, s18, v187
v_dot2c_f32_bf16 v88, s16, v188
v_dot2c_f32_bf16 v89, s18, v188
v_dot2c_f32_bf16 v90, s16, v189
v_dot2c_f32_bf16 v91, s18, v189
v_dot2c_f32_bf16 v92, s16, v190
v_dot2c_f32_bf16 v93, s18, v190
v_dot2c_f32_bf16 v94, s16, v191
v_dot2c_f32_bf16 v95, s18, v191
v_dot2c_f32_bf16 v96, s16, v192
v_dot2c_f32_bf16 v97, s18, v192
v_dot2c_f32_bf16 v98, s16, v193
v_dot2c_f32_bf16 v99, s18, v193
v_dot2c_f32_bf16 v100, s16, v194
v_dot2c_f32_bf16 v101, s18, v194
v_dot2c_f32_bf16 v102, s16, v195
v_dot2c_f32_bf16 v103, s18, v195
v_dot2c_f32_bf16 v80, s16, v196
v_dot2c_f32_bf16 v81, s18, v196
v_dot2c_f32_bf16 v82, s16, v197
v_dot2c_f32_bf16 v83, s18, v197
v_dot2c_f32_bf16 v84, s16, v198
v_dot2c_f32_bf16 v85, s18, v198
v_dot2c_f32_bf16 v86, s16, v199
v_dot2c_f32_bf16 v87, s18, v199
v_dot2c_f32_bf16 v88, s16, v200
v_dot2c_f32_bf16 v89, s18, v200
v_dot2c_f32_bf16 v90, s16, v201
v_dot2c_f32_bf16 v91, s18, v201
v_dot2c_f32_bf16 v92, s16, v202
v_dot2c_f32_bf16 v93, s18, v202
v_dot2c_f32_bf16 v94, s16, v203
v_dot2c_f32_bf16 v95, s18, v203
v_dot2c_f32_bf16 v96, s16, v204
v_dot2c_f32_bf16 v97, s18, v204
v_dot2c_f32_bf16 v98, s16, v205
v_dot2c_f32_bf16 v99, s18, v205
v_dot2c_f32_bf16 v100, s16, v206
v_dot2c_f32_bf16 v101, s18, v206
v_dot2c_f32_bf16 v102, s16, v207
v_dot2c_f32_bf16 v103, s18, v207
v_dot2c_f32_bf16 v80, s16, v208
v_dot2c_f32_bf16 v81, s18, v208
v_dot2c_f32_bf16 v82, s16, v209
v_dot2c_f32_bf16 v83, s18, v209
v_dot2c_f32_bf16 v84, s16, v210
v_dot2c_f32_bf16 v85, s18, v210
v_dot2c_f32_bf16 v86, s16, v211
v_dot2c_f32_bf16 v87, s18, v211
v_dot2c_f32_bf16 v88, s16, v212
v_dot2c_f32_bf16 v89, s18, v212
v_dot2c_f32_bf16 v90, s16, v213
v_dot2c_f32_bf16 v91, s18, v213
v_dot2c_f32_bf16 v92, s16, v214
v_dot2c_f32_bf16 v93, s18, v214
v_dot2c_f32_bf16 v94, s16, v215
v_dot2c_f32_bf16 v95, s18, v215
v_dot2c_f32_bf16 v96, s16, v216
v_dot2c_f32_bf16 v97, s18, v216
v_dot2c_f32_bf16 v98, s16, v217
v_dot2c_f32_bf16 v99, s18, v217
v_dot2c_f32_bf16 v100, s16, v218
v_dot2c_f32_bf16 v101, s18, v218
v_dot2c_f32_bf16 v102, s16, v219
v_dot2c_f32_bf16 v103, s18, v219
v_dot2c_f32_bf16 v80, s16, v220
v_dot2c_f32_bf16 v81, s18, v220
v_dot2c_f32_bf16 v82, s16, v221
v_dot2c_f32_bf16 v83, s18, v221
v_dot2c_f32_bf16 v84, s16, v222
v_dot2c_f32_bf16 v85, s18, v222
v_dot2c_f32_bf16 v86, s16, v223
v_dot2c_f32_bf16 v87, s18, v223
v_dot2c_f32_bf16 v88, s16, v224
v_dot2c_f32_bf16 v89, s18, v224
v_dot2c_f32_bf16 v90, s16, v225
v_dot2c_f32_bf16 v91, s18, v225
v_dot2c_f32_bf16 v92, s16, v226
v_dot2c_f32_bf16 v93, s18, v226
v_dot2c_f32_bf16 v94, s16, v227
v_dot2c_f32_bf16 v95, s18, v227
v_dot2c_f32_bf16 v96, s16, v228
v_dot2c_f32_bf16 v97, s18, v228
v_dot2c_f32_bf16 v98, s16, v229
v_dot2c_f32_bf16 v99, s18, v229
v_dot2c_f32_bf16 v100, s16, v230
v_dot2c_f32_bf16 v101, s18, v230
v_dot2c_f32_bf16 v102, s16, v231
v_dot2c_f32_bf16 v103, s18, v231
v_dot2c_f32_bf16 v80, s16, v232
v_dot2c_f32_bf16 v81, s18, v232
v_dot2c_f32_bf16 v82, s16, v233
v_dot2c_f32_bf16 v83, s18, v233
v_dot2c_f32_bf16 v84, s16, v234
v_dot2c_f32_bf16 v85, s18, v234
v_dot2c_f32_bf16 v86, s16, v235
v_dot2c_f32_bf16 v87, s18, v235
v_dot2c_f32_bf16 v88, s16, v236
v_dot2c_f32_bf16 v89, s18, v236
v_dot2c_f32_bf16 v90, s16, v237
v_dot2c_f32_bf16 v91, s18, v237
v_dot2c_f32_bf16 v92, s16, v238
v_dot2c_f32_bf16 v93, s18, v238
v_dot2c_f32_bf16 v94, s16, v239
v_dot2c_f32_bf16 v95, s18, v239
v_dot2c_f32_bf16 v96, s16, v240
v_dot2c_f32_bf16 v97, s18, v240
v_dot2c_f32_bf16 v98, s16, v241
v_dot2c_f32_bf16 v99, s18, v241
v_dot2c_f32_bf16 v100, s16, v242
v_dot2c_f32_bf16 v101, s18, v242
v_dot2c_f32_bf16 v102, s16, v243
v_dot2c_f32_bf16 v103, s18, v243
v_dot2c_f32_bf16 v80, s16, v244
v_dot2c_f32_bf16 v81, s18, v244
v_dot2c_f32_bf16 v82, s16, v245
v_dot2c_f32_bf16 v83, s18, v245
v_dot2c_f32_bf16 v84, s16, v246
v_dot2c_f32_bf16 v85, s18, v246
v_dot2c_f32_bf16 v86, s16, v247
v_dot2c_f32_bf16 v87, s18, v247
v_dot2c_f32_bf16 v88, s16, v248
v_dot2c_f32_bf16 v89, s18, v248
v_dot2c_f32_bf16 v90, s16, v249
v_dot2c_f32_bf16 v91, s18, v249
v_dot2c_f32_bf16 v92, s16, v250
v_dot2c_f32_bf16 v93, s18, v250
v_dot2c_f32_bf16 v94, s16, v251
v_dot2c_f32_bf16 v95, s18, v251
v_dot2c_f32_bf16 v96, s16, v252
v_dot2c_f32_bf16 v97, s18, v252
v_dot2c_f32_bf16 v98, s16, v253
v_dot2c_f32_bf16 v99, s18, v253
v_dot2c_f32_bf16 v100, s16, v254
v_dot2c_f32_bf16 v101, s18, v254
v_dot2c_f32_bf16 v102, s16, v255
v_dot2c_f32_bf16 v103, s18, v255
s_nop 2
s_branch L_ln2_join
L_ln2_late:
s_mov_b32 s92, 0
s_add_u32 m0, s94, 40960
s_nop 0
buffer_load_dwordx4 v26, s[52:55], s92 offen offset:0  lds
buffer_load_dwordx4 v26, s[52:55], s92 offen offset:1024  lds
buffer_load_dwordx4 v26, s[52:55], s92 offen offset:2048  lds
buffer_load_dwordx4 v26, s[52:55], s92 offen offset:3072  lds
v_lshlrev_b32 v80, 16, v160
v_and_b32 v81, 0xffff0000, v160
v_lshlrev_b32 v82, 16, v161
v_and_b32 v83, 0xffff0000, v161
v_lshlrev_b32 v84, 16, v162
v_and_b32 v85, 0xffff0000, v162
v_lshlrev_b32 v86, 16, v163
v_and_b32 v87, 0xffff0000, v163
v_lshlrev_b32 v88, 16, v164
v_and_b32 v89, 0xffff0000, v164
v_lshlrev_b32 v90, 16, v165
v_and_b32 v91, 0xffff0000, v165
v_lshlrev_b32 v92, 16, v166
v_and_b32 v93, 0xffff0000, v166
v_lshlrev_b32 v94, 16, v167
v_and_b32 v95, 0xffff0000, v167
v_lshlrev_b32 v96, 16, v168
v_and_b32 v97, 0xffff0000, v168
v_lshlrev_b32 v98, 16, v169
v_and_b32 v99, 0xffff0000, v169
v_lshlrev_b32 v100, 16, v170
v_and_b32 v101, 0xffff0000, v170
v_lshlrev_b32 v102, 16, v171
v_and_b32 v103, 0xffff0000, v171
s_add_u32 s92, s92, 4096
s_add_u32 m0, s94, 45056
s_nop 0
buffer_load_dwordx4 v26, s[52:55], s92 offen offset:0  lds
s_mov_b32 s92, 20480
s_add_u32 m0, s94, 61440
s_nop 0
buffer_load_dwordx4 v26, s[52:55], s92 offen offset:0  lds
buffer_load_dwordx4 v26, s[52:55], s92 offen offset:1024  lds
buffer_load_dwordx4 v26, s[52:55], s92 offen offset:2048  lds
v_dot2c_f32_bf16 v80, s16, v172
v_dot2c_f32_bf16 v81, s18, v172
v_dot2c_f32_bf16 v82, s16, v173
v_dot2c_f32_bf16 v83, s18, v173
v_dot2c_f32_bf16 v84, s16, v174
v_dot2c_f32_bf16 v85, s18, v174
v_dot2c_f32_bf16 v86, s16, v175
v_dot2c_f32_bf16 v87, s18, v175
v_dot2c_f32_bf16 v88, s16, v176
v_dot2c_f32_bf16 v89, s18, v176
v_dot2c_f32_bf16 v90, s16, v177
v_dot2c_f32_bf16 v91, s18, v177
v_dot2c_f32_bf16 v92, s16, v178
v_dot2c_f32_bf16 v93, s18, v178
v_dot2c_f32_bf16 v94, s16, v179
v_dot2c_f32_bf16 v95, s18, v179
v_dot2c_f32_bf16 v96, s16, v180
v_dot2c_f32_bf16 v97, s18, v180
v_dot2c_f32_bf16 v98, s16, v181
v_dot2c_f32_bf16 v99, s18, v181
v_dot2c_f32_bf16 v100, s16, v182
v_dot2c_f32_bf16 v101, s18, v182
v_dot2c_f32_bf16 v102, s16, v183
v_dot2c_f32_bf16 v103, s18, v183
buffer_load_dwordx4 v26, s[52:55], s92 offen offset:3072  lds
s_add_u32 s92, s92, 4096
s_add_u32 m0, s94, 65536
s_nop 0
buffer_load_dwordx4 v26, s[52:55], s92 offen offset:0  lds
s_mov_b32 s92, 40960
s_add_u32 m0, s94, 81920
s_nop 0
buffer_load_dwordx4 v26, s[52:55], s92 offen offset:0  lds
buffer_load_dwordx4 v26, s[52:55], s92 offen offset:1024  lds
v_dot2c_f32_bf16 v80, s16, v184
v_dot2c_f32_bf16 v81, s18, v184
v_dot2c_f32_bf16 v82, s16, v185
v_dot2c_f32_bf16 v83, s18, v185
v_dot2c_f32_bf16 v84, s16, v186
v_dot2c_f32_bf16 v85, s18, v186
v_dot2c_f32_bf16 v86, s16, v187
v_dot2c_f32_bf16 v87, s18, v187
v_dot2c_f32_bf16 v88, s16, v188
v_dot2c_f32_bf16 v89, s18, v188
v_dot2c_f32_bf16 v90, s16, v189
v_dot2c_f32_bf16 v91, s18, v189
v_dot2c_f32_bf16 v92, s16, v190
v_dot2c_f32_bf16 v93, s18, v190
v_dot2c_f32_bf16 v94, s16, v191
v_dot2c_f32_bf16 v95, s18, v191
v_dot2c_f32_bf16 v96, s16, v192
v_dot2c_f32_bf16 v97, s18, v192
v_dot2c_f32_bf16 v98, s16, v193
v_dot2c_f32_bf16 v99, s18, v193
v_dot2c_f32_bf16 v100, s16, v194
v_dot2c_f32_bf16 v101, s18, v194
v_dot2c_f32_bf16 v102, s16, v195
v_dot2c_f32_bf16 v103, s18, v195
buffer_load_dwordx4 v26, s[52:55], s92 offen offset:2048  lds
buffer_load_dwordx4 v26, s[52:55], s92 offen offset:3072  lds
s_add_u32 s92, s92, 4096
s_add_u32 m0, s94, 86016
s_nop 0
buffer_load_dwordx4 v26, s[52:55], s92 offen offset:0  lds
s_mov_b32 s92, 61440
s_add_u32 m0, s94, 102400
s_nop 0
buffer_load_dwordx4 v26, s[52:55], s92 offen offset:0  lds
v_dot2c_f32_bf16 v80, s16, v196
v_dot2c_f32_bf16 v81, s18, v196
v_dot2c_f32_bf16 v82, s16, v197
v_dot2c_f32_bf16 v83, s18, v197
v_dot2c_f32_bf16 v84, s16, v198
v_dot2c_f32_bf16 v85, s18, v198
v_dot2c_f32_bf16 v86, s16, v199
v_dot2c_f32_bf16 v87, s18, v199
v_dot2c_f32_bf16 v88, s16, v200
v_dot2c_f32_bf16 v89, s18, v200
v_dot2c_f32_bf16 v90, s16, v201
v_dot2c_f32_bf16 v91, s18, v201
v_dot2c_f32_bf16 v92, s16, v202
v_dot2c_f32_bf16 v93, s18, v202
v_dot2c_f32_bf16 v94, s16, v203
v_dot2c_f32_bf16 v95, s18, v203
v_dot2c_f32_bf16 v96, s16, v204
v_dot2c_f32_bf16 v97, s18, v204
v_dot2c_f32_bf16 v98, s16, v205
v_dot2c_f32_bf16 v99, s18, v205
v_dot2c_f32_bf16 v100, s16, v206
v_dot2c_f32_bf16 v101, s18, v206
v_dot2c_f32_bf16 v102, s16, v207
v_dot2c_f32_bf16 v103, s18, v207
buffer_load_dwordx4 v26, s[52:55], s92 offen offset:1024  lds
buffer_load_dwordx4 v26, s[52:55], s92 offen offset:2048  lds
buffer_load_dwordx4 v26, s[52:55], s92 offen offset:3072  lds
s_add_u32 s92, s92, 4096
s_add_u32 m0, s94, 106496
s_nop 0
buffer_load_dwordx4 v26, s[52:55], s92 offen offset:0  lds
v_dot2c_f32_bf16 v80, s16, v208
v_dot2c_f32_bf16 v81, s18, v208
v_dot2c_f32_bf16 v82, s16, v209
v_dot2c_f32_bf16 v83, s18, v209
v_dot2c_f32_bf16 v84, s16, v210
v_dot2c_f32_bf16 v85, s18, v210
v_dot2c_f32_bf16 v86, s16, v211
v_dot2c_f32_bf16 v87, s18, v211
v_dot2c_f32_bf16 v88, s16, v212
v_dot2c_f32_bf16 v89, s18, v212
v_dot2c_f32_bf16 v90, s16, v213
v_dot2c_f32_bf16 v91, s18, v213
v_dot2c_f32_bf16 v92, s16, v214
v_dot2c_f32_bf16 v93, s18, v214
v_dot2c_f32_bf16 v94, s16, v215
v_dot2c_f32_bf16 v95, s18, v215
v_dot2c_f32_bf16 v96, s16, v216
v_dot2c_f32_bf16 v97, s18, v216
v_dot2c_f32_bf16 v98, s16, v217
v_dot2c_f32_bf16 v99, s18, v217
v_dot2c_f32_bf16 v100, s16, v218
v_dot2c_f32_bf16 v101, s18, v218
v_dot2c_f32_bf16 v102, s16, v219
v_dot2c_f32_bf16 v103, s18, v219
s_mov_b32 s92, 81920
s_add_u32 m0, s94, 122880
s_nop 0
buffer_load_dwordx4 v26, s[52:55], s92 offen offset:0  lds
buffer_load_dwordx4 v26, s[52:55], s92 offen offset:1024  lds
buffer_load_dwordx4 v26, s[52:55], s92 offen offset:2048  lds
buffer_load_dwordx4 v26, s[52:55], s92 offen offset:3072  lds
v_dot2c_f32_bf16 v80, s16, v220
v_dot2c_f32_bf16 v81, s18, v220
v_dot2c_f32_bf16 v82, s16, v221
v_dot2c_f32_bf16 v83, s18, v221
v_dot2c_f32_bf16 v84, s16, v222
v_dot2c_f32_bf16 v85, s18, v222
v_dot2c_f32_bf16 v86, s16, v223
v_dot2c_f32_bf16 v87, s18, v223
v_dot2c_f32_bf16 v88, s16, v224
v_dot2c_f32_bf16 v89, s18, v224
v_dot2c_f32_bf16 v90, s16, v225
v_dot2c_f32_bf16 v91, s18, v225
v_dot2c_f32_bf16 v92, s16, v226
v_dot2c_f32_bf16 v93, s18, v226
v_dot2c_f32_bf16 v94, s16, v227
v_dot2c_f32_bf16 v95, s18, v227
v_dot2c_f32_bf16 v96, s16, v228
v_dot2c_f32_bf16 v97, s18, v228
v_dot2c_f32_bf16 v98, s16, v229
v_dot2c_f32_bf16 v99, s18, v229
v_dot2c_f32_bf16 v100, s16, v230
v_dot2c_f32_bf16 v101, s18, v230
v_dot2c_f32_bf16 v102, s16, v231
v_dot2c_f32_bf16 v103, s18, v231
s_add_u32 s92, s92, 4096
s_add_u32 m0, s94, 126976
s_nop 0
buffer_load_dwordx4 v26, s[52:55], s92 offen offset:0  lds
v_dot2c_f32_bf16 v80, s16, v232
v_dot2c_f32_bf16 v81, s18, v232
v_dot2c_f32_bf16 v82, s16, v233
v_dot2c_f32_bf16 v83, s18, v233
v_dot2c_f32_bf16 v84, s16, v234
v_dot2c_f32_bf16 v85, s18, v234
v_dot2c_f32_bf16 v86, s16, v235
v_dot2c_f32_bf16 v87, s18, v235
v_dot2c_f32_bf16 v88, s16, v236
v_dot2c_f32_bf16 v89, s18, v236
v_dot2c_f32_bf16 v90, s16, v237
v_dot2c_f32_bf16 v91, s18, v237
v_dot2c_f32_bf16 v92, s16, v238
v_dot2c_f32_bf16 v93, s18, v238
v_dot2c_f32_bf16 v94, s16, v239
v_dot2c_f32_bf16 v95, s18, v239
v_dot2c_f32_bf16 v96, s16, v240
v_dot2c_f32_bf16 v97, s18, v240
v_dot2c_f32_bf16 v98, s16, v241
v_dot2c_f32_bf16 v99, s18, v241
v_dot2c_f32_bf16 v100, s16, v242
v_dot2c_f32_bf16 v101, s18, v242
v_dot2c_f32_bf16 v102, s16, v243
v_dot2c_f32_bf16 v103, s18, v243
v_dot2c_f32_bf16 v80, s16, v244
v_dot2c_f32_bf16 v81, s18, v244
v_dot2c_f32_bf16 v82, s16, v245
v_dot2c_f32_bf16 v83, s18, v245
v_dot2c_f32_bf16 v84, s16, v246
v_dot2c_f32_bf16 v85, s18, v246
v_dot2c_f32_bf16 v86, s16, v247
v_dot2c_f32_bf16 v87, s18, v247
v_dot2c_f32_bf16 v88, s16, v248
v_dot2c_f32_bf16 v89, s18, v248
v_dot2c_f32_bf16 v90, s16, v249
v_dot2c_f32_bf16 v91, s18, v249
v_dot2c_f32_bf16 v92, s16, v250
v_dot2c_f32_bf16 v93, s18, v250
v_dot2c_f32_bf16 v94, s16, v251
v_dot2c_f32_bf16 v95, s18, v251
v_dot2c_f32_bf16 v96, s16, v252
v_dot2c_f32_bf16 v97, s18, v252
v_dot2c_f32_bf16 v98, s16, v253
v_dot2c_f32_bf16 v99, s18, v253
v_dot2c_f32_bf16 v100, s16, v254
v_dot2c_f32_bf16 v101, s18, v254
v_dot2c_f32_bf16 v102, s16, v255
v_dot2c_f32_bf16 v103, s18, v255
s_nop 2
L_ln2_join:
s_add_u32 s76, s4, 38797312
s_addc_u32 s77, s5, 0
s_mov_b32 s78, 2621440
s_mov_b32 s79, 0x20000
s_add_u32 s80, s4, 33554432
s_addc_u32 s81, s5, 0
s_mov_b32 s82, 2621440
s_mov_b32 s83, 0x20000
s_add_u32 s72, s4, 36175872
s_addc_u32 s73, s5, 0
s_mov_b32 s74, 2621440
s_mov_b32 s75, 0x20000
v_lshlrev_b32 v64, 16, v52
v_and_b32 v65, 0xffff0000, v52
v_lshlrev_b32_e64 v66, 16, v40
v_and_b32 v67, 0xffff0000, v40
v_pk_fma_f32 v[80:81], v[80:81], v[64:65], v[66:67]
v_lshlrev_b32 v68, 16, v53
v_and_b32 v69, 0xffff0000, v53
v_lshlrev_b32 v70, 16, v41
v_and_b32 v71, 0xffff0000, v41
v_pk_fma_f32 v[82:83], v[82:83], v[68:69], v[70:71]
v_lshlrev_b32 v64, 16, v54
v_and_b32 v65, 0xffff0000, v54
v_lshlrev_b32 v66, 16, v42
v_and_b32 v67, 0xffff0000, v42
v_pk_fma_f32 v[84:85], v[84:85], v[64:65], v[66:67]
v_lshlrev_b32 v68, 16, v55
v_and_b32 v69, 0xffff0000, v55
v_lshlrev_b32 v70, 16, v43
v_and_b32 v71, 0xffff0000, v43
v_pk_fma_f32 v[86:87], v[86:87], v[68:69], v[70:71]
v_lshlrev_b32 v64, 16, v56
v_and_b32 v65, 0xffff0000, v56
v_lshlrev_b32 v66, 16, v44
v_and_b32 v67, 0xffff0000, v44
v_pk_fma_f32 v[88:89], v[88:89], v[64:65], v[66:67]
v_lshlrev_b32 v68, 16, v57
v_and_b32 v69, 0xffff0000, v57
v_lshlrev_b32 v70, 16, v45
v_and_b32 v71, 0xffff0000, v45
v_pk_fma_f32 v[90:91], v[90:91], v[68:69], v[70:71]
v_lshlrev_b32 v64, 16, v58
v_and_b32 v65, 0xffff0000, v58
v_lshlrev_b32 v66, 16, v46
v_and_b32 v67, 0xffff0000, v46
v_pk_fma_f32 v[92:93], v[92:93], v[64:65], v[66:67]
v_lshlrev_b32 v68, 16, v59
v_and_b32 v69, 0xffff0000, v59
v_lshlrev_b32 v70, 16, v47
v_and_b32 v71, 0xffff0000, v47
v_pk_fma_f32 v[94:95], v[94:95], v[68:69], v[70:71]
v_lshlrev_b32 v64, 16, v60
v_and_b32 v65, 0xffff0000, v60
v_lshlrev_b32 v66, 16, v48
v_and_b32 v67, 0xffff0000, v48
v_pk_fma_f32 v[96:97], v[96:97], v[64:65], v[66:67]
v_lshlrev_b32 v68, 16, v61
v_and_b32 v69, 0xffff0000, v61
v_lshlrev_b32 v70, 16, v49
v_and_b32 v71, 0xffff0000, v49
v_pk_fma_f32 v[98:99], v[98:99], v[68:69], v[70:71]
v_lshlrev_b32 v64, 16, v62
v_and_b32 v65, 0xffff0000, v62
v_lshlrev_b32 v66, 16, v50
v_and_b32 v67, 0xffff0000, v50
v_pk_fma_f32 v[100:101], v[100:101], v[64:65], v[66:67]
v_lshlrev_b32_e64 v68, 16, v63
v_and_b32 v69, 0xffff0000, v63
v_lshlrev_b32 v70, 16, v51
v_and_b32 v71, 0xffff0000, v51
v_pk_fma_f32 v[102:103], v[102:103], v[68:69], v[70:71]
v_cvt_pk_bf16_f32 v140, v80, v81
v_cvt_pk_bf16_f32 v141, v82, v83
v_cvt_pk_bf16_f32 v142, v84, v85
v_cvt_pk_bf16_f32 v143, v86, v87
v_cvt_pk_bf16_f32 v144, v88, v89
v_cvt_pk_bf16_f32 v145, v90, v91
v_cvt_pk_bf16_f32 v146, v92, v93
v_cvt_pk_bf16_f32 v147, v94, v95
v_cvt_pk_bf16_f32 v148, v96, v97
v_cvt_pk_bf16_f32 v149, v98, v99
v_cvt_pk_bf16_f32 v150, v100, v101
v_cvt_pk_bf16_f32 v151, v102, v103
s_cmp_eq_u32 s46, 0
s_cbranch_scc1 L_wt12
buffer_store_dwordx4 v[140:143], v32, s[76:79], s12 offen
buffer_store_dwordx4 v[144:147], v32, s[76:79], s14 offen
buffer_store_dwordx4 v[148:151], v33, s[76:79], s12 offen
L_wj12:
v_pk_add_f32 v[72:73], v[80:81], v[82:83]
v_pk_mul_f32 v[74:75], v[80:81], v[80:81]
v_pk_fma_f32 v[74:75], v[82:83], v[82:83], v[74:75]
v_pk_add_f32 v[72:73], v[72:73], v[84:85]
v_pk_fma_f32 v[74:75], v[84:85], v[84:85], v[74:75]
v_pk_add_f32 v[72:73], v[72:73], v[86:87]
v_pk_fma_f32 v[74:75], v[86:87], v[86:87], v[74:75]
v_pk_add_f32 v[72:73], v[72:73], v[88:89]
v_pk_fma_f32 v[74:75], v[88:89], v[88:89], v[74:75]
v_pk_add_f32 v[72:73], v[72:73], v[90:91]
v_pk_fma_f32 v[74:75], v[90:91], v[90:91], v[74:75]
v_pk_add_f32 v[72:73], v[72:73], v[92:93]
v_pk_fma_f32 v[74:75], v[92:93], v[92:93], v[74:75]
v_pk_add_f32 v[72:73], v[72:73], v[94:95]
v_pk_fma_f32 v[74:75], v[94:95], v[94:95], v[74:75]
v_pk_add_f32 v[72:73], v[72:73], v[96:97]
v_pk_fma_f32 v[74:75], v[96:97], v[96:97], v[74:75]
v_pk_add_f32 v[72:73], v[72:73], v[98:99]
v_pk_fma_f32 v[74:75], v[98:99], v[98:99], v[74:75]
v_pk_add_f32 v[72:73], v[72:73], v[100:101]
v_pk_fma_f32 v[74:75], v[100:101], v[100:101], v[74:75]
v_pk_add_f32 v[72:73], v[72:73], v[102:103]
v_pk_fma_f32 v[74:75], v[102:103], v[102:103], v[74:75]
v_add_f32_e64 v72, v72, v73
v_add_f32 v73, v74, v75
s_nop 1
v_add_f32_dpp v72, v72, v72 row_ror:8 row_mask:0xf bank_mask:0xf
v_add_f32_dpp v73, v73, v73 row_ror:8 row_mask:0xf bank_mask:0xf
v_mov_b32_e64 v64, v72
v_mov_b32 v65, v73
s_nop 0
v_permlane32_swap_b32 v72, v64
v_permlane32_swap_b32 v73, v65
v_pk_add_f32 v[72:73], v[72:73], v[64:65]
v_mov_b32 v64, v72
v_mov_b32 v65, v73
s_nop 0
v_permlane16_swap_b32 v72, v64
v_permlane16_swap_b32 v73, v65
v_pk_add_f32 v[72:73], v[72:73], v[64:65]
ds_write_b64 v38, v[72:73] offset:0
s_waitcnt lgkmcnt(0)
s_barrier
ds_read_b128 v[64:67], v39 offset:0
ds_read_b128 v[68:71], v39 offset:16
s_waitcnt lgkmcnt(0)
v_pk_add_f32 v[64:65], v[64:65], v[66:67]
v_pk_add_f32 v[68:69], v[68:69], v[70:71]
v_pk_add_f32 v[72:73], v[64:65], v[68:69]
v_mul_f32 v72, 0x3acccccd, v72
v_mov_b32 v74, 0x3727c5ac
v_fmac_f32 v74, 0x3acccccd, v73
v_fma_f32 v75, -v72, v72, v74
v_max_f32 v74, 0x3727c5ac, v75
v_rsq_f32 v74, v74
s_nop 0
v_mul_f32_e64 v72, v72, v74
v_pk_fma_f32 v[80:81], v[80:81], v[74:75], v[72:73] op_sel_hi:[1,0,0] neg_lo:[0,0,1] neg_hi:[0,0,1]
v_pk_fma_f32 v[82:83], v[82:83], v[74:75], v[72:73] op_sel_hi:[1,0,0] neg_lo:[0,0,1] neg_hi:[0,0,1]
v_pk_fma_f32 v[84:85], v[84:85], v[74:75], v[72:73] op_sel_hi:[1,0,0] neg_lo:[0,0,1] neg_hi:[0,0,1]
v_pk_fma_f32 v[86:87], v[86:87], v[74:75], v[72:73] op_sel_hi:[1,0,0] neg_lo:[0,0,1] neg_hi:[0,0,1]
v_pk_fma_f32 v[88:89], v[88:89], v[74:75], v[72:73] op_sel_hi:[1,0,0] neg_lo:[0,0,1] neg_hi:[0,0,1]
v_pk_fma_f32 v[90:91], v[90:91], v[74:75], v[72:73] op_sel_hi:[1,0,0] neg_lo:[0,0,1] neg_hi:[0,0,1]
v_pk_fma_f32 v[92:93], v[92:93], v[74:75], v[72:73] op_sel_hi:[1,0,0] neg_lo:[0,0,1] neg_hi:[0,0,1]
v_pk_fma_f32 v[94:95], v[94:95], v[74:75], v[72:73] op_sel_hi:[1,0,0] neg_lo:[0,0,1] neg_hi:[0,0,1]
v_pk_fma_f32 v[96:97], v[96:97], v[74:75], v[72:73] op_sel_hi:[1,0,0] neg_lo:[0,0,1] neg_hi:[0,0,1]
v_pk_fma_f32 v[98:99], v[98:99], v[74:75], v[72:73] op_sel_hi:[1,0,0] neg_lo:[0,0,1] neg_hi:[0,0,1]
v_pk_fma_f32 v[100:101], v[100:101], v[74:75], v[72:73] op_sel_hi:[1,0,0] neg_lo:[0,0,1] neg_hi:[0,0,1]
v_pk_fma_f32 v[102:103], v[102:103], v[74:75], v[72:73] op_sel_hi:[1,0,0] neg_lo:[0,0,1] neg_hi:[0,0,1]
v_lshlrev_b32 v64, 16, v116
v_and_b32 v65, 0xffff0000, v116
v_lshlrev_b32 v66, 16, v128
v_and_b32 v67, 0xffff0000, v128
v_pk_fma_f32 v[80:81], v[80:81], v[64:65], v[66:67]
v_lshlrev_b32 v68, 16, v117
v_and_b32 v69, 0xffff0000, v117
v_lshlrev_b32 v70, 16, v129
v_and_b32 v71, 0xffff0000, v129
v_pk_fma_f32 v[82:83], v[82:83], v[68:69], v[70:71]
v_lshlrev_b32 v64, 16, v118
v_and_b32 v65, 0xffff0000, v118
v_lshlrev_b32 v66, 16, v130
v_and_b32 v67, 0xffff0000, v130
v_pk_fma_f32 v[84:85], v[84:85], v[64:65], v[66:67]
v_lshlrev_b32 v68, 16, v119
v_and_b32 v69, 0xffff0000, v119
v_lshlrev_b32 v70, 16, v131
v_and_b32 v71, 0xffff0000, v131
v_pk_fma_f32 v[86:87], v[86:87], v[68:69], v[70:71]
v_lshlrev_b32 v64, 16, v120
v_and_b32 v65, 0xffff0000, v120
v_lshlrev_b32 v66, 16, v132
v_and_b32 v67, 0xffff0000, v132
v_pk_fma_f32 v[88:89], v[88:89], v[64:65], v[66:67]
v_lshlrev_b32 v68, 16, v121
v_and_b32 v69, 0xffff0000, v121
v_lshlrev_b32 v70, 16, v133
v_and_b32 v71, 0xffff0000, v133
v_pk_fma_f32 v[90:91], v[90:91], v[68:69], v[70:71]
v_lshlrev_b32 v64, 16, v122
v_and_b32 v65, 0xffff0000, v122
v_lshlrev_b32 v66, 16, v134
v_and_b32 v67, 0xffff0000, v134
v_pk_fma_f32 v[92:93], v[92:93], v[64:65], v[66:67]
v_lshlrev_b32 v68, 16, v123
v_and_b32 v69, 0xffff0000, v123
v_lshlrev_b32 v70, 16, v135
v_and_b32 v71, 0xffff0000, v135
v_pk_fma_f32 v[94:95], v[94:95], v[68:69], v[70:71]
v_lshlrev_b32 v64, 16, v124
v_and_b32 v65, 0xffff0000, v124
v_lshlrev_b32 v66, 16, v136
v_and_b32 v67, 0xffff0000, v136
v_pk_fma_f32 v[96:97], v[96:97], v[64:65], v[66:67]
v_lshlrev_b32 v68, 16, v125
v_and_b32 v69, 0xffff0000, v125
v_lshlrev_b32 v70, 16, v137
v_and_b32 v71, 0xffff0000, v137
v_pk_fma_f32 v[98:99], v[98:99], v[68:69], v[70:71]
v_lshlrev_b32 v64, 16, v126
v_and_b32 v65, 0xffff0000, v126
v_lshlrev_b32 v66, 16, v138
v_and_b32 v67, 0xffff0000, v138
v_pk_fma_f32 v[100:101], v[100:101], v[64:65], v[66:67]
v_lshlrev_b32_e64 v68, 16, v127
v_and_b32 v69, 0xffff0000, v127
v_lshlrev_b32 v70, 16, v139
v_and_b32 v71, 0xffff0000, v139
v_pk_fma_f32 v[102:103], v[102:103], v[68:69], v[70:71]
v_cvt_pk_bf16_f32 v40, v80, v81
v_cvt_pk_bf16_f32 v41, v82, v83
v_cvt_pk_bf16_f32 v42, v84, v85
v_cvt_pk_bf16_f32 v43, v86, v87
v_cvt_pk_bf16_f32 v44, v88, v89
v_cvt_pk_bf16_f32 v45, v90, v91
v_cvt_pk_bf16_f32 v46, v92, v93
v_cvt_pk_bf16_f32 v47, v94, v95
v_cvt_pk_bf16_f32 v48, v96, v97
v_cvt_pk_bf16_f32 v49, v98, v99
v_cvt_pk_bf16_f32 v50, v100, v101
v_cvt_pk_bf16_f32 v51, v102, v103
s_cmp_eq_u32 s46, 0
s_cbranch_scc1 L_wt13
buffer_store_dwordx4 v[40:43], v32, s[72:75], s12 offen
buffer_store_dwordx4 v[44:47], v32, s[72:75], s14 offen
buffer_store_dwordx4 v[48:51], v33, s[72:75], s12 offen
L_wj13:
v_pk_add_f32 v[72:73], v[80:81], v[82:83]
v_pk_mul_f32 v[74:75], v[80:81], v[80:81]
v_pk_fma_f32 v[74:75], v[82:83], v[82:83], v[74:75]
v_pk_add_f32 v[72:73], v[72:73], v[84:85]
v_pk_fma_f32 v[74:75], v[84:85], v[84:85], v[74:75]
v_pk_add_f32 v[72:73], v[72:73], v[86:87]
v_pk_fma_f32 v[74:75], v[86:87], v[86:87], v[74:75]
v_pk_add_f32 v[72:73], v[72:73], v[88:89]
v_pk_fma_f32 v[74:75], v[88:89], v[88:89], v[74:75]
v_pk_add_f32 v[72:73], v[72:73], v[90:91]
v_pk_fma_f32 v[74:75], v[90:91], v[90:91], v[74:75]
v_pk_add_f32 v[72:73], v[72:73], v[92:93]
v_pk_fma_f32 v[74:75], v[92:93], v[92:93], v[74:75]
v_pk_add_f32 v[72:73], v[72:73], v[94:95]
v_pk_fma_f32 v[74:75], v[94:95], v[94:95], v[74:75]
v_pk_add_f32 v[72:73], v[72:73], v[96:97]
v_pk_fma_f32 v[74:75], v[96:97], v[96:97], v[74:75]
v_pk_add_f32 v[72:73], v[72:73], v[98:99]
v_pk_fma_f32 v[74:75], v[98:99], v[98:99], v[74:75]
v_pk_add_f32 v[72:73], v[72:73], v[100:101]
v_pk_fma_f32 v[74:75], v[100:101], v[100:101], v[74:75]
v_pk_add_f32 v[72:73], v[72:73], v[102:103]
v_pk_fma_f32 v[74:75], v[102:103], v[102:103], v[74:75]
v_add_f32_e64 v72, v72, v73
v_add_f32 v73, v74, v75
s_nop 1
v_add_f32_dpp v72, v72, v72 row_ror:8 row_mask:0xf bank_mask:0xf
v_add_f32_dpp v73, v73, v73 row_ror:8 row_mask:0xf bank_mask:0xf
v_mov_b32_e64 v64, v72
v_mov_b32 v65, v73
s_nop 0
v_permlane32_swap_b32 v72, v64
v_permlane32_swap_b32 v73, v65
v_pk_add_f32 v[72:73], v[72:73], v[64:65]
v_mov_b32 v64, v72
v_mov_b32 v65, v73
s_nop 0
v_permlane16_swap_b32 v72, v64
v_permlane16_swap_b32 v73, v65
v_pk_add_f32 v[72:73], v[72:73], v[64:65]
ds_write_b64 v38, v[72:73] offset:256
s_waitcnt lgkmcnt(0)
s_barrier
ds_read_b128 v[64:67], v39 offset:256
ds_read_b128 v[68:71], v39 offset:272
s_waitcnt lgkmcnt(0)
v_pk_add_f32 v[64:65], v[64:65], v[66:67]
v_pk_add_f32 v[68:69], v[68:69], v[70:71]
v_pk_add_f32 v[72:73], v[64:65], v[68:69]
v_mul_f32 v72, 0x3acccccd, v72
v_mov_b32 v74, 0x3727c5ac
v_fmac_f32 v74, 0x3acccccd, v73
v_fma_f32 v75, -v72, v72, v74
v_max_f32 v74, 0x3727c5ac, v75
v_rsq_f32 v74, v74
s_nop 0
v_mul_f32_e64 v72, v72, v74
v_pk_fma_f32 v[80:81], v[80:81], v[74:75], v[72:73] op_sel_hi:[1,0,0] neg_lo:[0,0,1] neg_hi:[0,0,1]
v_pk_fma_f32 v[82:83], v[82:83], v[74:75], v[72:73] op_sel_hi:[1,0,0] neg_lo:[0,0,1] neg_hi:[0,0,1]
v_pk_fma_f32 v[84:85], v[84:85], v[74:75], v[72:73] op_sel_hi:[1,0,0] neg_lo:[0,0,1] neg_hi:[0,0,1]
v_pk_fma_f32 v[86:87], v[86:87], v[74:75], v[72:73] op_sel_hi:[1,0,0] neg_lo:[0,0,1] neg_hi:[0,0,1]
v_pk_fma_f32 v[88:89], v[88:89], v[74:75], v[72:73] op_sel_hi:[1,0,0] neg_lo:[0,0,1] neg_hi:[0,0,1]
v_pk_fma_f32 v[90:91], v[90:91], v[74:75], v[72:73] op_sel_hi:[1,0,0] neg_lo:[0,0,1] neg_hi:[0,0,1]
v_pk_fma_f32 v[92:93], v[92:93], v[74:75], v[72:73] op_sel_hi:[1,0,0] neg_lo:[0,0,1] neg_hi:[0,0,1]
v_pk_fma_f32 v[94:95], v[94:95], v[74:75], v[72:73] op_sel_hi:[1,0,0] neg_lo:[0,0,1] neg_hi:[0,0,1]
v_pk_fma_f32 v[96:97], v[96:97], v[74:75], v[72:73] op_sel_hi:[1,0,0] neg_lo:[0,0,1] neg_hi:[0,0,1]
v_pk_fma_f32 v[98:99], v[98:99], v[74:75], v[72:73] op_sel_hi:[1,0,0] neg_lo:[0,0,1] neg_hi:[0,0,1]
v_pk_fma_f32 v[100:101], v[100:101], v[74:75], v[72:73] op_sel_hi:[1,0,0] neg_lo:[0,0,1] neg_hi:[0,0,1]
v_pk_fma_f32 v[102:103], v[102:103], v[74:75], v[72:73] op_sel_hi:[1,0,0] neg_lo:[0,0,1] neg_hi:[0,0,1]
v_cvt_pk_bf16_f32 v104, v80, v81
v_cvt_pk_bf16_f32 v105, v82, v83
v_cvt_pk_bf16_f32 v106, v84, v85
v_cvt_pk_bf16_f32 v107, v86, v87
v_cvt_pk_bf16_f32 v108, v88, v89
v_cvt_pk_bf16_f32 v109, v90, v91
v_cvt_pk_bf16_f32 v110, v92, v93
v_cvt_pk_bf16_f32 v111, v94, v95
v_cvt_pk_bf16_f32 v112, v96, v97
v_cvt_pk_bf16_f32 v113, v98, v99
v_cvt_pk_bf16_f32 v114, v100, v101
v_cvt_pk_bf16_f32 v115, v102, v103
s_cmp_eq_u32 s46, 0
s_cbranch_scc1 L_wt14
buffer_store_dwordx4 v[104:107], v32, s[80:83], s12 offen
buffer_store_dwordx4 v[108:111], v32, s[80:83], s14 offen
buffer_store_dwordx4 v[112:115], v33, s[80:83], s12 offen
L_wj14:
s_mov_b32 s92, 0
s_add_u32 m0, s94, 0
s_nop 0
buffer_load_dwordx4 v26, s[56:59], s92 offen offset:0  lds
buffer_load_dwordx4 v26, s[56:59], s92 offen offset:1024  lds
buffer_load_dwordx4 v26, s[56:59], s92 offen offset:2048  lds
buffer_load_dwordx4 v26, s[56:59], s92 offen offset:3072  lds
s_add_u32 s92, s92, 4096
s_add_u32 m0, s94, 4096
s_nop 0
buffer_load_dwordx4 v26, s[56:59], s92 offen offset:0  lds
s_mov_b32 s92, 20480
s_add_u32 m0, s94, 20480
s_nop 0
buffer_load_dwordx4 v26, s[56:59], s92 offen offset:0  lds
buffer_load_dwordx4 v26, s[56:59], s92 offen offset:1024  lds
buffer_load_dwordx4 v26, s[56:59], s92 offen offset:2048  lds
buffer_load_dwordx4 v26, s[56:59], s92 offen offset:3072  lds
s_add_u32 s92, s92, 4096
s_add_u32 m0, s94, 24576
s_nop 0
buffer_load_dwordx4 v26, s[56:59], s92 offen offset:0  lds
s_lshr_b32 s95, s20, 1
s_add_u32 s6, s95, 1
s_and_b32 s6, s6, 14
s_cmp_eq_u32 s6, 0
s_cselect_b32 s26, 0, s46
s_lshl_b32 s95, s95, 5
s_and_b32 s6, s20, 1
s_lshl_b32 s6, s6, 2
s_add_u32 s6, s6, s28
s_add_u32 s95, s95, s6
s_lshl_b32 s95, s95, 2
s_add_u32 s95, s95, 98304
s_lshr_b32 s6, s2, 3
s_and_b32 s10, s6, 7
s_lshr_b32 s6, s6, 3
s_lshl_b32 s9, s8, 2
s_add_u32 s9, s9, s6
s_lshl_b32 s11, s9, 2
s_add_u32 s11, s11, s28
v_add_u32 v5, 0, v11
v_add_u32 v7, 65536, v11
v_add_u32 v9, 131072, v11
v_add_u32_e64 v12, 0, v11
s_mul_i32 s3, s11, 20480
s_add_u32 s3, s3, 33554432
s_add_u32 s72, s4, s3
s_addc_u32 s73, s5, 0
s_mov_b32 s74, 20480
s_mov_b32 s75, 0x20000
s_mul_i32 s6, s10, 5
s_and_b32 s7, s10, 1
s_add_u32 s3, s6, s7
s_lshr_b32 s3, s3, 1
s_lshl_b32 s36, s3, 10
s_lshl_b32 s3, s7, 2
s_sub_u32 s6, s6, s3
s_add_u32 s6, s6, 4
s_lshr_b32 s6, s6, 1
s_lshl_b32 s6, s6, 10
s_lshl_b32 s7, s7, 3
s_add_u32 s37, s6, s7
s_mul_i32 s6, s10, 5
s_and_b32 s7, s10, 1
s_add_u32 s3, s6, s7
s_lshr_b32 s3, s3, 1
s_lshl_b32 s41, s3, 6
s_lshl_b32 s3, s7, 2
s_sub_u32 s6, s6, s3
s_add_u32 s6, s6, 4
s_lshr_b32 s6, s6, 1
s_lshl_b32 s6, s6, 6
s_lshl_b32 s7, s7, 3
s_add_u32 s42, s6, s7
s_add_u32 s76, s4, 41418752
s_addc_u32 s77, s5, 0
s_mov_b32 s78, 2621440
s_mov_b32 s79, 0x20000
s_add_u32 s80, s4, 6400
s_addc_u32 s81, s5, 0
s_mov_b32 s82, 1280
s_mov_b32 s83, 0x20000
v_and_b32 v32, 48, v0
s_mov_b32 s24, 0xbdd2d3e8
s_mov_b32 s25, s24
v_mov_b32 v28, 0xc0135761
v_mov_b32_e64 v29, v28
buffer_load_dwordx4 v[208:211], v32, s[80:83], s41 offen
buffer_load_dwordx4 v[212:215], v32, s[80:83], s41 offen offset:64
buffer_load_dwordx2 v[216:217], v32, s[80:83], s42 offen
s_add_u32 s6, s11, 1
s_and_b32 s6, s6, 14
s_cmp_eq_u32 s6, 0
s_cselect_b32 s26, 0, s46
v_lshrrev_b32 v18, 3, v0
v_min_u32 v18, 2, v18
s_add_u32 s3, s11, 127
v_add_u32 v18, s3, v18
v_and_b32 v18, 127, v18
v_and_b32 v33, 7, v0
v_lshlrev_b32 v33, 2, v33
v_lshl_add_u32 v18, v18, 7, v33
s_lshl_b32 s12, s11, 5
s_add_u32 s12, s12, s10
s_lshl_b32 s12, s12, 2
s_add_u32 s12, s12, 131072
s_lshl_b32 s47, s11, 5
s_add_u32 s47, s47, s10
s_lshl_b32 s47, s47, 2
s_add_u32 s47, s47, 163840
s_lshl_b32 s14, s11, 7
s_add_u32 s14, s14, 98304
s_add_u32 s80, s4, 36175872
s_addc_u32 s81, s5, 0
s_mov_b32 s82, 2621440
s_mov_b32 s83, 0x20000
s_add_u32 s84, s4, 38797312
s_addc_u32 s85, s5, 0
s_mov_b32 s86, 2621440
s_mov_b32 s87, 0x20000
s_mul_i32 s6, s11, 20480
s_add_u32 s41, s36, s6
s_add_u32 s42, s37, s6
s_waitcnt vmcnt(13)
s_mov_b64 exec, 1
s_cmp_eq_u32 s46, 0
s_cbranch_scc1 L_wt15
buffer_store_dword v31, off, s[68:71], s95
L_wj15:
s_mov_b64 exec, -1
buffer_load_dword v19, v33, s[68:71], s14 offen sc1
s_mov_b32 s101, 0x200000
s_waitcnt vmcnt(0)
L_poll16:
v_cmp_gt_u32 vcc, 1, v19
s_cbranch_vccz L_go16
s_sub_u32 s101, s101, 1
s_cmp_eq_u32 s101, 0
s_cbranch_scc1 L_go16
buffer_load_dword v19, v33, s[68:71], s14 offen sc1
s_waitcnt vmcnt(0)
s_branch L_poll16
L_go16:
L_al_off17:
s_mov_b32 s93, 0
buffer_load_dwordx4 a[0:3], v12, s[72:75], s93 offen offset:0 sc1
buffer_load_dwordx4 a[4:7], v12, s[72:75], s93 offen offset:1024 sc1
buffer_load_dwordx4 a[8:11], v12, s[72:75], s93 offen offset:2048 sc1
buffer_load_dwordx4 a[12:15], v12, s[72:75], s93 offen offset:3072 sc1
s_mov_b32 s93, 4096
buffer_load_dwordx4 a[16:19], v12, s[72:75], s93 offen offset:0 sc1
buffer_load_dwordx4 a[20:23], v12, s[72:75], s93 offen offset:1024 sc1
buffer_load_dwordx4 a[24:27], v12, s[72:75], s93 offen offset:2048 sc1
buffer_load_dwordx4 a[28:31], v12, s[72:75], s93 offen offset:3072 sc1
s_barrier
ds_read_b128 v[64:67], v5 offset:40960
ds_read_b128 v[68:71], v5 offset:46080
ds_read_b128 v[72:75], v5 offset:41984
ds_read_b128 v[76:79], v5 offset:47104
ds_read_b128 v[80:83], v5 offset:43008
ds_read_b128 v[84:87], v5 offset:48128
ds_read_b128 v[88:91], v5 offset:44032
ds_read_b128 v[92:95], v5 offset:49152
ds_read_b128 v[96:99], v5 offset:45056
ds_read_b128 v[100:103], v5 offset:50176
ds_read_b128 v[104:107], v5 offset:51200
ds_read_b128 v[108:111], v5 offset:56320
s_waitcnt vmcnt(6) lgkmcnt(10)
v_mfma_f32_16x16x32_bf16 v[112:115], v[64:67], a[0:3], 0
v_mfma_f32_16x16x32_bf16 v[112:115], v[68:71], a[4:7], v[112:115]
s_waitcnt lgkmcnt(8)
ds_read_b128 v[64:67], v5 offset:52224
v_mfma_f32_16x16x32_bf16 v[116:119], v[72:75], a[0:3], 0
s_mov_b32 s93, 8192
buffer_load_dwordx4 a[32:35], v12, s[72:75], s93 offen offset:0 sc1
v_mfma_f32_16x16x32_bf16 v[116:119], v[76:79], a[4:7], v[116:119]
s_waitcnt lgkmcnt(7)
ds_read_b128 v[68:71], v5 offset:57344
v_mfma_f32_16x16x32_bf16 v[120:123], v[80:83], a[0:3], 0
ds_read_b128 v[72:75], v5 offset:53248
v_mfma_f32_16x16x32_bf16 v[120:123], v[84:87], a[4:7], v[120:123]
s_waitcnt lgkmcnt(7)
ds_read_b128 v[76:79], v5 offset:58368
v_mfma_f32_16x16x32_bf16 v[124:127], v[88:91], a[0:3], 0
buffer_load_dwordx4 a[36:39], v12, s[72:75], s93 offen offset:1024 sc1
v_mfma_f32_16x16x32_bf16 v[124:127], v[92:95], a[4:7], v[124:127]
s_waitcnt lgkmcnt(6)
ds_read_b128 v[80:83], v5 offset:54272
v_mfma_f32_16x16x32_bf16 v[128:131], v[96:99], a[0:3], 0
ds_read_b128 v[84:87], v5 offset:59392
v_mfma_f32_16x16x32_bf16 v[128:131], v[100:103], a[4:7], v[128:131]
s_waitcnt vmcnt(6) lgkmcnt(6)
ds_read_b128 v[88:91], v5 offset:55296
v_mfma_f32_16x16x32_bf16 v[112:115], v[104:107], a[8:11], v[112:115]
buffer_load_dwordx4 a[40:43], v12, s[72:75], s93 offen offset:2048 sc1
v_mfma_f32_16x16x32_bf16 v[112:115], v[108:111], a[12:15], v[112:115]
s_waitcnt lgkmcnt(5)
ds_read_b128 v[92:95], v5 offset:60416
v_mfma_f32_16x16x32_bf16 v[116:119], v[64:67], a[8:11], v[116:119]
ds_read_b128 v[96:99], v5 offset:61440
v_mfma_f32_16x16x32_bf16 v[116:119], v[68:71], a[12:15], v[116:119]
s_waitcnt lgkmcnt(5)
ds_read_b128 v[100:103], v7 offset:1024
v_mfma_f32_16x16x32_bf16 v[120:123], v[72:75], a[8:11], v[120:123]
buffer_load_dwordx4 a[44:47], v12, s[72:75], s93 offen offset:3072 sc1
v_mfma_f32_16x16x32_bf16 v[120:123], v[76:79], a[12:15], v[120:123]
s_waitcnt lgkmcnt(4)
ds_read_b128 v[104:107], v5 offset:62464
ds_read_b128 v[108:111], v7 offset:2048
v_mfma_f32_16x16x32_bf16 v[124:127], v[80:83], a[8:11], v[124:127]
ds_read_b128 v[64:67], v5 offset:63488
v_mfma_f32_16x16x32_bf16 v[124:127], v[84:87], a[12:15], v[124:127]
s_waitcnt lgkmcnt(5)
ds_read_b128 v[68:71], v7 offset:3072
v_mfma_f32_16x16x32_bf16 v[128:131], v[88:91], a[8:11], v[128:131]
s_mov_b32 s93, 12288
buffer_load_dwordx4 a[48:51], v12, s[72:75], s93 offen offset:0 sc1
v_mfma_f32_16x16x32_bf16 v[128:131], v[92:95], a[12:15], v[128:131]
s_waitcnt vmcnt(7) lgkmcnt(4)
ds_read_b128 v[72:75], v5 offset:64512
ds_read_b128 v[76:79], v7 offset:4096
v_mfma_f32_16x16x32_bf16 v[112:115], v[96:99], a[16:19], v[112:115]
ds_read_b128 v[80:83], v7 offset:0
v_mfma_f32_16x16x32_bf16 v[112:115], v[100:103], a[20:23], v[112:115]
s_waitcnt lgkmcnt(5)
ds_read_b128 v[84:87], v7 offset:5120
v_mfma_f32_16x16x32_bf16 v[116:119], v[104:107], a[16:19], v[116:119]
buffer_load_dwordx4 a[52:55], v12, s[72:75], s93 offen offset:1024 sc1
v_mfma_f32_16x16x32_bf16 v[116:119], v[108:111], a[20:23], v[116:119]
s_waitcnt lgkmcnt(4)
ds_read_b128 v[88:91], v7 offset:6144
ds_read_b128 v[92:95], v7 offset:11264
v_mfma_f32_16x16x32_bf16 v[120:123], v[64:67], a[16:19], v[120:123]
ds_read_b128 v[96:99], v7 offset:7168
v_mfma_f32_16x16x32_bf16 v[120:123], v[68:71], a[20:23], v[120:123]
s_waitcnt lgkmcnt(5)
ds_read_b128 v[100:103], v7 offset:12288
v_mfma_f32_16x16x32_bf16 v[124:127], v[72:75], a[16:19], v[124:127]
buffer_load_dwordx4 a[56:59], v12, s[72:75], s93 offen offset:2048 sc1
v_mfma_f32_16x16x32_bf16 v[124:127], v[76:79], a[20:23], v[124:127]
s_waitcnt lgkmcnt(4)
ds_read_b128 v[104:107], v7 offset:8192
ds_read_b128 v[108:111], v7 offset:13312
v_mfma_f32_16x16x32_bf16 v[128:131], v[80:83], a[16:19], v[128:131]
ds_read_b128 v[64:67], v7 offset:9216
v_mfma_f32_16x16x32_bf16 v[128:131], v[84:87], a[20:23], v[128:131]
s_waitcnt vmcnt(7) lgkmcnt(5)
ds_read_b128 v[68:71], v7 offset:14336
v_mfma_f32_16x16x32_bf16 v[112:115], v[88:91], a[24:27], v[112:115]
buffer_load_dwordx4 a[60:63], v12, s[72:75], s93 offen offset:3072 sc1
v_mfma_f32_16x16x32_bf16 v[112:115], v[92:95], a[28:31], v[112:115]
s_waitcnt lgkmcnt(4)
ds_read_b128 v[72:75], v7 offset:10240
ds_read_b128 v[76:79], v7 offset:15360
v_mfma_f32_16x16x32_bf16 v[116:119], v[96:99], a[24:27], v[116:119]
ds_read_b128 v[80:83], v7 offset:16384
v_mfma_f32_16x16x32_bf16 v[116:119], v[100:103], a[28:31], v[116:119]
s_waitcnt lgkmcnt(5)
ds_read_b128 v[84:87], v7 offset:21504
v_mfma_f32_16x16x32_bf16 v[120:123], v[104:107], a[24:27], v[120:123]
s_mov_b32 s93, 16384
buffer_load_dwordx4 a[64:67], v12, s[72:75], s93 offen offset:0 sc1
v_mfma_f32_16x16x32_bf16 v[120:123], v[108:111], a[28:31], v[120:123]
s_waitcnt lgkmcnt(4)
ds_read_b128 v[88:91], v7 offset:17408
ds_read_b128 v[92:95], v7 offset:22528
v_mfma_f32_16x16x32_bf16 v[124:127], v[64:67], a[24:27], v[124:127]
ds_read_b128 v[96:99], v7 offset:18432
v_mfma_f32_16x16x32_bf16 v[124:127], v[68:71], a[28:31], v[124:127]
s_waitcnt lgkmcnt(5)
ds_read_b128 v[100:103], v7 offset:23552
v_mfma_f32_16x16x32_bf16 v[128:131], v[72:75], a[24:27], v[128:131]
buffer_load_dwordx4 a[68:71], v12, s[72:75], s93 offen offset:1024 sc1
v_mfma_f32_16x16x32_bf16 v[128:131], v[76:79], a[28:31], v[128:131]
s_waitcnt vmcnt(8) lgkmcnt(4)
ds_read_b128 v[104:107], v7 offset:19456
ds_read_b128 v[108:111], v7 offset:24576
v_mfma_f32_16x16x32_bf16 v[112:115], v[80:83], a[32:35], v[112:115]
ds_read_b128 v[64:67], v7 offset:20480
v_mfma_f32_16x16x32_bf16 v[112:115], v[84:87], a[36:39], v[112:115]
s_waitcnt lgkmcnt(5)
ds_read_b128 v[68:71], v7 offset:25600
v_mfma_f32_16x16x32_bf16 v[116:119], v[88:91], a[32:35], v[116:119]
buffer_load_dwordx4 a[72:75], v12, s[72:75], s93 offen offset:2048 sc1
v_mfma_f32_16x16x32_bf16 v[116:119], v[92:95], a[36:39], v[116:119]
s_waitcnt lgkmcnt(4)
ds_read_b128 v[72:75], v7 offset:26624
ds_read_b128 v[76:79], v7 offset:31744
v_mfma_f32_16x16x32_bf16 v[120:123], v[96:99], a[32:35], v[120:123]
ds_read_b128 v[80:83], v7 offset:27648
v_mfma_f32_16x16x32_bf16 v[120:123], v[100:103], a[36:39], v[120:123]
s_waitcnt lgkmcnt(5)
ds_read_b128 v[84:87], v7 offset:32768
v_mfma_f32_16x16x32_bf16 v[124:127], v[104:107], a[32:35], v[124:127]
buffer_load_dwordx4 a[76:79], v12, s[72:75], s93 offen offset:3072 sc1
v_mfma_f32_16x16x32_bf16 v[124:127], v[108:111], a[36:39], v[124:127]
s_waitcnt lgkmcnt(4)
ds_read_b128 v[88:91], v7 offset:28672
ds_read_b128 v[92:95], v7 offset:33792
v_mfma_f32_16x16x32_bf16 v[128:131], v[64:67], a[32:35], v[128:131]
ds_read_b128 v[96:99], v7 offset:29696
v_mfma_f32_16x16x32_bf16 v[128:131], v[68:71], a[36:39], v[128:131]
s_waitcnt vmcnt(8) lgkmcnt(5)
ds_read_b128 v[100:103], v7 offset:34816
ds_read_b128 v[104:107], v7 offset:30720
ds_read_b128 v[108:111], v7 offset:35840
s_barrier
v_mfma_f32_16x16x32_bf16 v[112:115], v[72:75], a[40:43], v[112:115]
ds_read_b128 v[64:67], v7 offset:36864
buffer_load_dwordx4 v[220:223], v11, s[80:83], s41 offen sc1
buffer_load_dwordx4 v[224:227], v11, s[80:83], s41 offen offset:1024 sc1
buffer_load_dwordx2 v[228:229], v11, s[80:83], s42 offen sc1
v_mfma_f32_16x16x32_bf16 v[112:115], v[76:79], a[44:47], v[112:115]
s_waitcnt lgkmcnt(7)
ds_read_b128 v[68:71], v7 offset:41984
v_mfma_f32_16x16x32_bf16 v[116:119], v[80:83], a[40:43], v[116:119]
ds_read_b128 v[72:75], v7 offset:37888
v_mfma_f32_16x16x32_bf16 v[116:119], v[84:87], a[44:47], v[116:119]
s_waitcnt lgkmcnt(7)
ds_read_b128 v[76:79], v7 offset:43008
v_mfma_f32_16x16x32_bf16 v[120:123], v[88:91], a[40:43], v[120:123]
ds_read_b128 v[80:83], v7 offset:38912
buffer_load_dwordx4 v[196:199], v11, s[84:87], s41 offen sc1
buffer_load_dwordx4 v[200:203], v11, s[84:87], s41 offen offset:1024 sc1
buffer_load_dwordx2 v[204:205], v11, s[84:87], s42 offen sc1
v_mfma_f32_16x16x32_bf16 v[120:123], v[92:95], a[44:47], v[120:123]
s_waitcnt lgkmcnt(7)
ds_read_b128 v[84:87], v7 offset:44032
v_mfma_f32_16x16x32_bf16 v[124:127], v[96:99], a[40:43], v[124:127]
ds_read_b128 v[88:91], v7 offset:39936
v_mfma_f32_16x16x32_bf16 v[124:127], v[100:103], a[44:47], v[124:127]
s_waitcnt lgkmcnt(7)
ds_read_b128 v[92:95], v7 offset:45056
v_mfma_f32_16x16x32_bf16 v[128:131], v[104:107], a[40:43], v[128:131]
ds_read_b128 v[96:99], v7 offset:40960
buffer_load_dword v20, off, s[68:71], s12 sc1
v_mfma_f32_16x16x32_bf16 v[128:131], v[108:111], a[44:47], v[128:131]
s_waitcnt vmcnt(13) lgkmcnt(7)
ds_read_b128 v[100:103], v7 offset:46080
v_mfma_f32_16x16x32_bf16 v[112:115], v[64:67], a[48:51], v[112:115]
ds_read_b128 v[104:107], v7 offset:47104
v_mfma_f32_16x16x32_bf16 v[112:115], v[68:71], a[52:55], v[112:115]
s_waitcnt lgkmcnt(7)
ds_read_b128 v[108:111], v7 offset:52224
v_mfma_f32_16x16x32_bf16 v[116:119], v[72:75], a[48:51], v[116:119]
ds_read_b128 v[64:67], v7 offset:48128
buffer_load_dword v20, off, s[68:71], s47 sc1
v_mfma_f32_16x16x32_bf16 v[116:119], v[76:79], a[52:55], v[116:119]
s_waitcnt lgkmcnt(7)
ds_read_b128 v[68:71], v7 offset:53248
v_mfma_f32_16x16x32_bf16 v[120:123], v[80:83], a[48:51], v[120:123]
ds_read_b128 v[72:75], v7 offset:49152
v_mfma_f32_16x16x32_bf16 v[120:123], v[84:87], a[52:55], v[120:123]
s_waitcnt lgkmcnt(7)
s_mov_b32 s92, 40960
s_add_u32 m0, s94, 40960
v_mfma_f32_16x16x32_bf16 v[124:127], v[88:91], a[48:51], v[124:127]
buffer_load_dwordx4 v26, s[56:59], s92 offen offset:0  lds
v_mfma_f32_16x16x32_bf16 v[124:127], v[92:95], a[52:55], v[124:127]
s_waitcnt lgkmcnt(5)
ds_read_b128 v[76:79], v7 offset:54272
v_mfma_f32_16x16x32_bf16 v[128:131], v[96:99], a[48:51], v[128:131]
ds_read_b128 v[80:83], v7 offset:50176
v_mfma_f32_16x16x32_bf16 v[128:131], v[100:103], a[52:55], v[128:131]
s_waitcnt vmcnt(13) lgkmcnt(5)
ds_read_b128 v[84:87], v7 offset:55296
v_mfma_f32_16x16x32_bf16 v[112:115], v[104:107], a[56:59], v[112:115]
buffer_load_dwordx4 v26, s[56:59], s92 offen offset:1024  lds
v_mfma_f32_16x16x32_bf16 v[112:115], v[108:111], a[60:63], v[112:115]
s_waitcnt lgkmcnt(4)
ds_read_b128 v[88:91], v7 offset:51200
ds_read_b128 v[92:95], v7 offset:56320
v_mfma_f32_16x16x32_bf16 v[116:119], v[64:67], a[56:59], v[116:119]
ds_read_b128 v[96:99], v7 offset:57344
v_mfma_f32_16x16x32_bf16 v[116:119], v[68:71], a[60:63], v[116:119]
s_waitcnt lgkmcnt(5)
ds_read_b128 v[100:103], v7 offset:62464
v_mfma_f32_16x16x32_bf16 v[120:123], v[72:75], a[56:59], v[120:123]
buffer_load_dwordx4 v26, s[56:59], s92 offen offset:2048  lds
v_mfma_f32_16x16x32_bf16 v[120:123], v[76:79], a[60:63], v[120:123]
s_waitcnt lgkmcnt(4)
ds_read_b128 v[104:107], v7 offset:58368
ds_read_b128 v[108:111], v7 offset:63488
v_mfma_f32_16x16x32_bf16 v[124:127], v[80:83], a[56:59], v[124:127]
ds_read_b128 v[64:67], v7 offset:59392
v_mfma_f32_16x16x32_bf16 v[124:127], v[84:87], a[60:63], v[124:127]
s_waitcnt lgkmcnt(5)
ds_read_b128 v[68:71], v7 offset:64512
v_mfma_f32_16x16x32_bf16 v[128:131], v[88:91], a[56:59], v[128:131]
buffer_load_dwordx4 v26, s[56:59], s92 offen offset:3072  lds
v_mfma_f32_16x16x32_bf16 v[128:131], v[92:95], a[60:63], v[128:131]
s_waitcnt vmcnt(14) lgkmcnt(4)
ds_read_b128 v[72:75], v7 offset:60416
ds_read_b128 v[76:79], v9 offset:0
v_mfma_f32_16x16x32_bf16 v[112:115], v[96:99], a[64:67], v[112:115]
ds_read_b128 v[80:83], v7 offset:61440
v_mfma_f32_16x16x32_bf16 v[112:115], v[100:103], a[68:71], v[112:115]
s_waitcnt lgkmcnt(5)
ds_read_b128 v[84:87], v9 offset:1024
s_add_u32 s92, s92, 4096
s_add_u32 m0, s94, 45056
v_mfma_f32_16x16x32_bf16 v[116:119], v[104:107], a[64:67], v[116:119]
buffer_load_dwordx4 v26, s[56:59], s92 offen offset:0  lds
v_mfma_f32_16x16x32_bf16 v[116:119], v[108:111], a[68:71], v[116:119]
s_waitcnt lgkmcnt(4)
ds_read_b128 v[88:91], v9 offset:2048
ds_read_b128 v[92:95], v9 offset:7168
v_mfma_f32_16x16x32_bf16 v[120:123], v[64:67], a[64:67], v[120:123]
ds_read_b128 v[96:99], v9 offset:3072
v_mfma_f32_16x16x32_bf16 v[120:123], v[68:71], a[68:71], v[120:123]
s_waitcnt lgkmcnt(5)
ds_read_b128 v[100:103], v9 offset:8192
s_mov_b32 s92, 61440
s_add_u32 m0, s94, 61440
v_mfma_f32_16x16x32_bf16 v[124:127], v[72:75], a[64:67], v[124:127]
buffer_load_dwordx4 v26, s[56:59], s92 offen offset:0  lds
v_mfma_f32_16x16x32_bf16 v[124:127], v[76:79], a[68:71], v[124:127]
s_waitcnt lgkmcnt(4)
ds_read_b128 v[104:107], v9 offset:4096
ds_read_b128 v[108:111], v9 offset:9216
v_mfma_f32_16x16x32_bf16 v[128:131], v[80:83], a[64:67], v[128:131]
ds_read_b128 v[64:67], v9 offset:5120
v_mfma_f32_16x16x32_bf16 v[128:131], v[84:87], a[68:71], v[128:131]
s_waitcnt vmcnt(14) lgkmcnt(5)
ds_read_b128 v[68:71], v9 offset:10240
v_mfma_f32_16x16x32_bf16 v[112:115], v[88:91], a[72:75], v[112:115]
buffer_load_dwordx4 v26, s[56:59], s92 offen offset:1024  lds
v_mfma_f32_16x16x32_bf16 v[112:115], v[92:95], a[76:79], v[112:115]
s_waitcnt lgkmcnt(4)
ds_read_b128 v[72:75], v9 offset:6144
ds_read_b128 v[76:79], v9 offset:11264
v_mfma_f32_16x16x32_bf16 v[116:119], v[96:99], a[72:75], v[116:119]
v_mfma_f32_16x16x32_bf16 v[116:119], v[100:103], a[76:79], v[116:119]
s_waitcnt lgkmcnt(4)
v_mfma_f32_16x16x32_bf16 v[120:123], v[104:107], a[72:75], v[120:123]
buffer_load_dwordx4 v26, s[56:59], s92 offen offset:2048  lds
v_mfma_f32_16x16x32_bf16 v[120:123], v[108:111], a[76:79], v[120:123]
s_waitcnt lgkmcnt(2)
v_mfma_f32_16x16x32_bf16 v[124:127], v[64:67], a[72:75], v[124:127]
v_mfma_f32_16x16x32_bf16 v[124:127], v[68:71], a[76:79], v[124:127]
s_waitcnt lgkmcnt(0)
v_mfma_f32_16x16x32_bf16 v[128:131], v[72:75], a[72:75], v[128:131]
buffer_load_dwordx4 v26, s[56:59], s92 offen offset:3072  lds
v_mfma_f32_16x16x32_bf16 v[128:131], v[76:79], a[76:79], v[128:131]
s_barrier
s_nop 6
v_pk_mul_f32 v[40:41], v[112:113], v[112:113]
v_pk_mul_f32 v[42:43], v[114:115], v[114:115]
v_pk_mul_f32 v[44:45], v[116:117], v[116:117]
v_pk_mul_f32 v[46:47], v[118:119], v[118:119]
v_pk_mul_f32 v[48:49], v[120:121], v[120:121]
v_pk_mul_f32 v[50:51], v[122:123], v[122:123]
v_pk_mul_f32 v[52:53], v[124:125], v[124:125]
v_pk_mul_f32 v[54:55], v[126:127], v[126:127]
v_pk_mul_f32 v[56:57], v[128:129], v[128:129]
v_pk_mul_f32 v[58:59], v[130:131], v[130:131]
v_pk_fma_f32 v[40:41], v[40:41], s[24:25], v[28:29]
v_pk_fma_f32 v[42:43], v[42:43], s[24:25], v[28:29]
v_pk_fma_f32 v[44:45], v[44:45], s[24:25], v[28:29]
v_pk_fma_f32 v[46:47], v[46:47], s[24:25], v[28:29]
v_pk_fma_f32 v[48:49], v[48:49], s[24:25], v[28:29]
v_pk_fma_f32 v[50:51], v[50:51], s[24:25], v[28:29]
v_pk_fma_f32 v[52:53], v[52:53], s[24:25], v[28:29]
v_pk_fma_f32 v[54:55], v[54:55], s[24:25], v[28:29]
v_pk_fma_f32 v[56:57], v[56:57], s[24:25], v[28:29]
v_pk_fma_f32 v[58:59], v[58:59], s[24:25], v[28:29]
v_pk_mul_f32 v[40:41], v[40:41], v[112:113]
v_pk_mul_f32 v[42:43], v[42:43], v[114:115]
v_pk_mul_f32 v[44:45], v[44:45], v[116:117]
v_pk_mul_f32 v[46:47], v[46:47], v[118:119]
v_pk_mul_f32 v[48:49], v[48:49], v[120:121]
v_pk_mul_f32 v[50:51], v[50:51], v[122:123]
v_pk_mul_f32 v[52:53], v[52:53], v[124:125]
v_pk_mul_f32 v[54:55], v[54:55], v[126:127]
v_pk_mul_f32 v[56:57], v[56:57], v[128:129]
v_pk_mul_f32 v[58:59], v[58:59], v[130:131]
v_exp_f32 v40, v40
v_exp_f32 v41, v41
v_exp_f32 v42, v42
v_exp_f32 v43, v43
v_exp_f32 v44, v44
v_exp_f32 v45, v45
v_exp_f32 v46, v46
v_exp_f32 v47, v47
v_exp_f32 v48, v48
v_exp_f32 v49, v49
v_exp_f32 v50, v50
v_exp_f32 v51, v51
v_exp_f32 v52, v52
v_exp_f32 v53, v53
v_exp_f32 v54, v54
v_exp_f32 v55, v55
v_exp_f32 v56, v56
v_exp_f32 v57, v57
v_exp_f32 v58, v58
v_exp_f32 v59, v59
s_nop 0
v_pk_add_f32 v[40:41], v[40:41], 1.0 op_sel_hi:[1,0]
v_pk_add_f32 v[42:43], v[42:43], 1.0 op_sel_hi:[1,0]
v_pk_add_f32 v[44:45], v[44:45], 1.0 op_sel_hi:[1,0]
v_pk_add_f32 v[46:47], v[46:47], 1.0 op_sel_hi:[1,0]
v_pk_add_f32 v[48:49], v[48:49], 1.0 op_sel_hi:[1,0]
v_pk_add_f32 v[50:51], v[50:51], 1.0 op_sel_hi:[1,0]
v_pk_add_f32 v[52:53], v[52:53], 1.0 op_sel_hi:[1,0]
v_pk_add_f32 v[54:55], v[54:55], 1.0 op_sel_hi:[1,0]
v_pk_add_f32 v[56:57], v[56:57], 1.0 op_sel_hi:[1,0]
v_pk_add_f32 v[58:59], v[58:59], 1.0 op_sel_hi:[1,0]
v_rcp_f32 v40, v40
v_rcp_f32 v41, v41
v_rcp_f32 v42, v42
v_rcp_f32 v43, v43
v_rcp_f32 v44, v44
v_rcp_f32 v45, v45
v_rcp_f32 v46, v46
v_rcp_f32 v47, v47
v_rcp_f32 v48, v48
v_rcp_f32 v49, v49
v_rcp_f32 v50, v50
v_rcp_f32 v51, v51
v_rcp_f32 v52, v52
v_rcp_f32 v53, v53
v_rcp_f32 v54, v54
v_rcp_f32 v55, v55
v_rcp_f32 v56, v56
v_rcp_f32 v57, v57
v_rcp_f32 v58, v58
v_rcp_f32 v59, v59
s_nop 0
v_pk_mul_f32 v[112:113], v[112:113], v[40:41]
v_pk_mul_f32 v[114:115], v[114:115], v[42:43]
v_pk_mul_f32 v[116:117], v[116:117], v[44:45]
v_pk_mul_f32 v[118:119], v[118:119], v[46:47]
v_pk_mul_f32 v[120:121], v[120:121], v[48:49]
v_pk_mul_f32 v[122:123], v[122:123], v[50:51]
v_pk_mul_f32 v[124:125], v[124:125], v[52:53]
v_pk_mul_f32 v[126:127], v[126:127], v[54:55]
v_pk_mul_f32 v[128:129], v[128:129], v[56:57]
v_pk_mul_f32 v[130:131], v[130:131], v[58:59]
v_cvt_pk_bf16_f32 v112, v112, v113
v_cvt_pk_bf16_f32 v113, v114, v115
v_cvt_pk_bf16_f32 v114, v116, v117
v_cvt_pk_bf16_f32 v115, v118, v119
v_cvt_pk_bf16_f32 v116, v120, v121
v_cvt_pk_bf16_f32 v117, v122, v123
v_cvt_pk_bf16_f32 v118, v124, v125
v_cvt_pk_bf16_f32 v119, v126, v127
v_cvt_pk_bf16_f32 v120, v128, v129
v_cvt_pk_bf16_f32 v121, v130, v131
s_cmp_eq_u32 s26, 0
s_cbranch_scc1 L_wt18
buffer_store_dwordx4 v[112:115], v11, s[76:79], s41 offen
buffer_store_dwordx4 v[116:119], v11, s[76:79], s41 offen offset:1024
buffer_store_dwordx2 v[120:121], v11, s[76:79], s42 offen
L_wj18:
s_add_u32 s72, s4, 41418752
s_addc_u32 s73, s5, 0
s_mov_b32 s74, 2621440
s_mov_b32 s75, 0x20000
s_lshl_b32 s6, s11, 4
v_and_b32 v32, 15, v0
v_add_u32 v32, s6, v32
v_and_b32 v33, 48, v0
s_movk_i32 s3, 0x7ff
v_add_u32 v34, -1, v32
v_cmp_lt_u32 vcc, s3, v34
v_lshrrev_b32 v35, 4, v34
v_mul_u32_u24 v35, 20480, v35
v_and_or_b32 v34, v34, 15, v33
v_lshl_add_u32 v34, v34, 4, v35
v_mov_b32 v35, 0x40000000
v_cndmask_b32 v12, v34, v35, vcc
v_add_u32 v34, 1, v32
v_cmp_lt_u32 vcc, s3, v34
v_lshrrev_b32 v35, 4, v34
v_mul_u32_u24 v35, 20480, v35
v_and_or_b32 v34, v34, 15, v33
v_lshl_add_u32 v34, v34, 4, v35
v_mov_b32 v35, 0x40000000
v_cndmask_b32 v13, v34, v35, vcc
v_add_u32 v34, -2, v32
v_cmp_lt_u32 vcc, s3, v34
v_lshrrev_b32 v35, 4, v34
v_mul_u32_u24 v35, 20480, v35
v_and_or_b32 v34, v34, 15, v33
v_lshl_add_u32 v34, v34, 4, v35
v_mov_b32 v35, 0x40000000
v_cndmask_b32 v14, v34, v35, vcc
v_add_u32 v34, 2, v32
v_cmp_lt_u32 vcc, s3, v34
v_lshrrev_b32 v35, 4, v34
v_mul_u32_u24 v35, 20480, v35
v_and_or_b32 v34, v34, 15, v33
v_lshl_add_u32 v34, v34, 4, v35
v_mov_b32 v35, 0x40000000
v_cndmask_b32 v15, v34, v35, vcc
s_add_u32 s76, s4, 51904512
s_addc_u32 s77, s5, 0
s_mov_b32 s78, 2621440
s_mov_b32 s79, 0x20000
s_add_u32 s80, s4, 16384
s_addc_u32 s81, s5, 0
s_mov_b32 s82, 6144
s_mov_b32 s83, 0x20000
s_add_u32 s84, s4, 44056576
s_addc_u32 s85, s5, 0
s_mov_b32 s86, 2605056
s_mov_b32 s87, 0x20000
s_lshr_b32 s6, s2, 3
s_and_b32 s6, s6, 15
s_mul_i32 s6, s6, 384
v_and_b32 v32, 48, v0
buffer_load_dwordx4 v[232:235], v32, s[80:83], s6 offen offset:0
buffer_load_dwordx4 v[236:239], v32, s[80:83], s6 offen offset:64
buffer_load_dwordx4 v[240:243], v32, s[80:83], s6 offen offset:128
buffer_load_dwordx4 v[244:247], v32, s[80:83], s6 offen offset:192
buffer_load_dwordx4 v[248:251], v32, s[80:83], s6 offen offset:256
buffer_load_dwordx4 v[252:255], v32, s[80:83], s6 offen offset:320
s_waitcnt vmcnt(6)
s_mov_b64 exec, 1
s_cmp_eq_u32 s26, 0
s_cbranch_scc1 L_wt19
buffer_store_dword v31, off, s[68:71], s12
L_wj19:
s_mov_b64 exec, -1
s_add_u32 s92, s92, 4096
s_add_u32 m0, s94, 65536
s_nop 0
buffer_load_dwordx4 v26, s[56:59], s92 offen offset:0  lds
s_mov_b32 s92, 81920
s_add_u32 m0, s94, 81920
s_nop 0
buffer_load_dwordx4 v26, s[56:59], s92 offen offset:0  lds
buffer_load_dwordx4 v26, s[56:59], s92 offen offset:1024  lds
buffer_load_dwordx4 v26, s[56:59], s92 offen offset:2048  lds
buffer_load_dwordx4 v26, s[56:59], s92 offen offset:3072  lds
s_add_u32 s92, s92, 4096
s_add_u32 m0, s94, 86016
s_nop 0
buffer_load_dwordx4 v26, s[56:59], s92 offen offset:0  lds
s_mov_b32 s92, 0
s_add_u32 m0, s29, 102400
s_nop 0
buffer_load_dwordx4 v27, s[60:63], s92 offen offset:0  lds
buffer_load_dwordx4 v27, s[60:63], s92 offen offset:1024  lds
buffer_load_dwordx4 v27, s[60:63], s92 offen offset:2048  lds
s_mov_b32 s92, 12288
s_add_u32 m0, s29, 114688
s_nop 0
buffer_load_dwordx4 v27, s[60:63], s92 offen offset:0  lds
buffer_load_dwordx4 v27, s[60:63], s92 offen offset:1024  lds
buffer_load_dwordx4 v27, s[60:63], s92 offen offset:2048  lds
s_mov_b32 s92, 24576
s_add_u32 m0, s29, 126976
s_nop 0
buffer_load_dwordx4 v27, s[60:63], s92 offen offset:0  lds
buffer_load_dwordx4 v27, s[60:63], s92 offen offset:1024  lds
buffer_load_dwordx4 v27, s[60:63], s92 offen offset:2048  lds
s_mov_b32 s92, 36864
s_add_u32 m0, s29, 139264
s_nop 0
buffer_load_dwordx4 v27, s[60:63], s92 offen offset:0  lds
buffer_load_dwordx4 v27, s[60:63], s92 offen offset:1024  lds
buffer_load_dwordx4 v27, s[60:63], s92 offen offset:2048  lds
s_mov_b32 s95, 131072
buffer_load_dword v19, v18, s[68:71], s95 offen sc1
s_mov_b32 s101, 0x200000
s_waitcnt vmcnt(0)
L_poll20:
v_cmp_gt_u32 vcc, 1, v19
s_cbranch_vccz L_go20
s_sub_u32 s101, s101, 1
s_cmp_eq_u32 s101, 0
s_cbranch_scc1 L_go20
buffer_load_dword v19, v18, s[68:71], s95 offen sc1
s_waitcnt vmcnt(0)
s_branch L_poll20
L_go20:
s_mov_b32 s93, 0
buffer_load_dwordx4 a[0:3], v12, s[72:75], s93 offen offset:0 sc1
buffer_load_dwordx4 a[4:7], v12, s[72:75], s93 offen offset:1024 sc1
buffer_load_dwordx4 a[8:11], v12, s[72:75], s93 offen offset:2048 sc1
buffer_load_dwordx4 a[12:15], v12, s[72:75], s93 offen offset:3072 sc1
s_mov_b32 s93, 4096
buffer_load_dwordx4 a[16:19], v12, s[72:75], s93 offen offset:0 sc1
buffer_load_dwordx4 a[20:23], v13, s[72:75], s93 offen offset:1024 sc1
buffer_load_dwordx4 a[24:27], v13, s[72:75], s93 offen offset:2048 sc1
buffer_load_dwordx4 a[28:31], v13, s[72:75], s93 offen offset:3072 sc1
s_barrier
ds_read_b128 v[64:67], v5 offset:0
ds_read_b128 v[68:71], v5 offset:5120
ds_read_b128 v[72:75], v5 offset:1024
ds_read_b128 v[76:79], v5 offset:6144
ds_read_b128 v[80:83], v5 offset:2048
ds_read_b128 v[84:87], v5 offset:7168
ds_read_b128 v[88:91], v5 offset:3072
ds_read_b128 v[92:95], v5 offset:8192
ds_read_b128 v[96:99], v5 offset:4096
ds_read_b128 v[100:103], v5 offset:9216
ds_read_b128 v[104:107], v5 offset:10240
ds_read_b128 v[108:111], v5 offset:15360
s_waitcnt vmcnt(6) lgkmcnt(10)
v_mfma_f32_16x16x32_bf16 v[112:115], v[64:67], a[0:3], 0
v_mfma_f32_16x16x32_bf16 v[112:115], v[68:71], a[4:7], v[112:115]
s_waitcnt lgkmcnt(8)
ds_read_b128 v[64:67], v5 offset:11264
v_mfma_f32_16x16x32_bf16 v[116:119], v[72:75], a[0:3], 0
s_mov_b32 s93, 8192
buffer_load_dwordx4 a[32:35], v13, s[72:75], s93 offen offset:0 sc1
v_mfma_f32_16x16x32_bf16 v[116:119], v[76:79], a[4:7], v[116:119]
s_waitcnt lgkmcnt(7)
ds_read_b128 v[68:71], v5 offset:16384
v_mfma_f32_16x16x32_bf16 v[120:123], v[80:83], a[0:3], 0
ds_read_b128 v[72:75], v5 offset:12288
v_mfma_f32_16x16x32_bf16 v[120:123], v[84:87], a[4:7], v[120:123]
s_waitcnt lgkmcnt(7)
ds_read_b128 v[76:79], v5 offset:17408
v_mfma_f32_16x16x32_bf16 v[124:127], v[88:91], a[0:3], 0
buffer_load_dwordx4 a[36:39], v13, s[72:75], s93 offen offset:1024 sc1
v_mfma_f32_16x16x32_bf16 v[124:127], v[92:95], a[4:7], v[124:127]
s_waitcnt lgkmcnt(6)
ds_read_b128 v[80:83], v5 offset:13312
v_mfma_f32_16x16x32_bf16 v[128:131], v[96:99], a[0:3], 0
ds_read_b128 v[84:87], v5 offset:18432
v_mfma_f32_16x16x32_bf16 v[128:131], v[100:103], a[4:7], v[128:131]
s_waitcnt vmcnt(6) lgkmcnt(6)
ds_read_b128 v[88:91], v5 offset:14336
v_mfma_f32_16x16x32_bf16 v[112:115], v[104:107], a[8:11], v[112:115]
buffer_load_dwordx4 a[40:43], v14, s[72:75], s93 offen offset:2048 sc1
v_mfma_f32_16x16x32_bf16 v[112:115], v[108:111], a[12:15], v[112:115]
s_waitcnt lgkmcnt(5)
ds_read_b128 v[92:95], v5 offset:19456
v_mfma_f32_16x16x32_bf16 v[116:119], v[64:67], a[8:11], v[116:119]
ds_read_b128 v[96:99], v5 offset:20480
v_mfma_f32_16x16x32_bf16 v[116:119], v[68:71], a[12:15], v[116:119]
s_waitcnt lgkmcnt(5)
ds_read_b128 v[100:103], v5 offset:25600
v_mfma_f32_16x16x32_bf16 v[120:123], v[72:75], a[8:11], v[120:123]
buffer_load_dwordx4 a[44:47], v14, s[72:75], s93 offen offset:3072 sc1
v_mfma_f32_16x16x32_bf16 v[120:123], v[76:79], a[12:15], v[120:123]
s_waitcnt lgkmcnt(4)
ds_read_b128 v[104:107], v5 offset:21504
ds_read_b128 v[108:111], v5 offset:26624
v_mfma_f32_16x16x32_bf16 v[124:127], v[80:83], a[8:11], v[124:127]
ds_read_b128 v[64:67], v5 offset:22528
v_mfma_f32_16x16x32_bf16 v[124:127], v[84:87], a[12:15], v[124:127]
s_waitcnt lgkmcnt(5)
ds_read_b128 v[68:71], v5 offset:27648
v_mfma_f32_16x16x32_bf16 v[128:131], v[88:91], a[8:11], v[128:131]
s_mov_b32 s93, 12288
buffer_load_dwordx4 a[48:51], v14, s[72:75], s93 offen offset:0 sc1
v_mfma_f32_16x16x32_bf16 v[128:131], v[92:95], a[12:15], v[128:131]
s_waitcnt vmcnt(7) lgkmcnt(4)
ds_read_b128 v[72:75], v5 offset:23552
ds_read_b128 v[76:79], v5 offset:28672
v_mfma_f32_16x16x32_bf16 v[112:115], v[96:99], a[16:19], v[112:115]
ds_read_b128 v[80:83], v5 offset:24576
v_mfma_f32_16x16x32_bf16 v[112:115], v[100:103], a[20:23], v[112:115]
s_waitcnt lgkmcnt(5)
ds_read_b128 v[84:87], v5 offset:29696
v_mfma_f32_16x16x32_bf16 v[116:119], v[104:107], a[16:19], v[116:119]
buffer_load_dwordx4 a[52:55], v14, s[72:75], s93 offen offset:1024 sc1
v_mfma_f32_16x16x32_bf16 v[116:119], v[108:111], a[20:23], v[116:119]
s_waitcnt lgkmcnt(4)
ds_read_b128 v[88:91], v5 offset:30720
ds_read_b128 v[92:95], v5 offset:35840
v_mfma_f32_16x16x32_bf16 v[120:123], v[64:67], a[16:19], v[120:123]
ds_read_b128 v[96:99], v5 offset:31744
v_mfma_f32_16x16x32_bf16 v[120:123], v[68:71], a[20:23], v[120:123]
s_waitcnt lgkmcnt(5)
ds_read_b128 v[100:103], v5 offset:36864
v_mfma_f32_16x16x32_bf16 v[124:127], v[72:75], a[16:19], v[124:127]
buffer_load_dwordx4 a[56:59], v14, s[72:75], s93 offen offset:2048 sc1
v_mfma_f32_16x16x32_bf16 v[124:127], v[76:79], a[20:23], v[124:127]
s_waitcnt lgkmcnt(4)
ds_read_b128 v[104:107], v5 offset:32768
ds_read_b128 v[108:111], v5 offset:37888
v_mfma_f32_16x16x32_bf16 v[128:131], v[80:83], a[16:19], v[128:131]
ds_read_b128 v[64:67], v5 offset:33792
v_mfma_f32_16x16x32_bf16 v[128:131], v[84:87], a[20:23], v[128:131]
s_waitcnt vmcnt(7) lgkmcnt(5)
ds_read_b128 v[68:71], v5 offset:38912
v_mfma_f32_16x16x32_bf16 v[112:115], v[88:91], a[24:27], v[112:115]
buffer_load_dwordx4 a[60:63], v15, s[72:75], s93 offen offset:3072 sc1
v_mfma_f32_16x16x32_bf16 v[112:115], v[92:95], a[28:31], v[112:115]
s_waitcnt lgkmcnt(4)
ds_read_b128 v[72:75], v5 offset:34816
ds_read_b128 v[76:79], v5 offset:39936
v_mfma_f32_16x16x32_bf16 v[116:119], v[96:99], a[24:27], v[116:119]
ds_read_b128 v[80:83], v5 offset:40960
v_mfma_f32_16x16x32_bf16 v[116:119], v[100:103], a[28:31], v[116:119]
s_waitcnt lgkmcnt(5)
ds_read_b128 v[84:87], v5 offset:46080
v_mfma_f32_16x16x32_bf16 v[120:123], v[104:107], a[24:27], v[120:123]
s_mov_b32 s93, 16384
buffer_load_dwordx4 a[64:67], v15, s[72:75], s93 offen offset:0 sc1
v_mfma_f32_16x16x32_bf16 v[120:123], v[108:111], a[28:31], v[120:123]
s_waitcnt lgkmcnt(4)
ds_read_b128 v[88:91], v5 offset:41984
ds_read_b128 v[92:95], v5 offset:47104
v_mfma_f32_16x16x32_bf16 v[124:127], v[64:67], a[24:27], v[124:127]
ds_read_b128 v[96:99], v5 offset:43008
v_mfma_f32_16x16x32_bf16 v[124:127], v[68:71], a[28:31], v[124:127]
s_waitcnt lgkmcnt(5)
ds_read_b128 v[100:103], v5 offset:48128
v_mfma_f32_16x16x32_bf16 v[128:131], v[72:75], a[24:27], v[128:131]
buffer_load_dwordx4 a[68:71], v15, s[72:75], s93 offen offset:1024 sc1
v_mfma_f32_16x16x32_bf16 v[128:131], v[76:79], a[28:31], v[128:131]
s_waitcnt vmcnt(8) lgkmcnt(4)
ds_read_b128 v[104:107], v5 offset:44032
ds_read_b128 v[108:111], v5 offset:49152
v_mfma_f32_16x16x32_bf16 v[112:115], v[80:83], a[32:35], v[112:115]
ds_read_b128 v[64:67], v5 offset:45056
v_mfma_f32_16x16x32_bf16 v[112:115], v[84:87], a[36:39], v[112:115]
s_waitcnt lgkmcnt(5)
ds_read_b128 v[68:71], v5 offset:50176
v_mfma_f32_16x16x32_bf16 v[116:119], v[88:91], a[32:35], v[116:119]
buffer_load_dwordx4 a[72:75], v15, s[72:75], s93 offen offset:2048 sc1
v_mfma_f32_16x16x32_bf16 v[116:119], v[92:95], a[36:39], v[116:119]
s_waitcnt lgkmcnt(4)
ds_read_b128 v[72:75], v5 offset:51200
ds_read_b128 v[76:79], v5 offset:56320
v_mfma_f32_16x16x32_bf16 v[120:123], v[96:99], a[32:35], v[120:123]
ds_read_b128 v[80:83], v5 offset:52224
v_mfma_f32_16x16x32_bf16 v[120:123], v[100:103], a[36:39], v[120:123]
s_waitcnt lgkmcnt(5)
ds_read_b128 v[84:87], v5 offset:57344
v_mfma_f32_16x16x32_bf16 v[124:127], v[104:107], a[32:35], v[124:127]
buffer_load_dwordx4 a[76:79], v15, s[72:75], s93 offen offset:3072 sc1
v_mfma_f32_16x16x32_bf16 v[124:127], v[108:111], a[36:39], v[124:127]
s_waitcnt lgkmcnt(4)
ds_read_b128 v[88:91], v5 offset:53248
ds_read_b128 v[92:95], v5 offset:58368
v_mfma_f32_16x16x32_bf16 v[128:131], v[64:67], a[32:35], v[128:131]
ds_read_b128 v[96:99], v5 offset:54272
v_mfma_f32_16x16x32_bf16 v[128:131], v[68:71], a[36:39], v[128:131]
s_waitcnt vmcnt(8) lgkmcnt(5)
ds_read_b128 v[100:103], v5 offset:59392
ds_read_b128 v[104:107], v5 offset:55296
ds_read_b128 v[108:111], v5 offset:60416
s_barrier
v_mfma_f32_16x16x32_bf16 v[112:115], v[72:75], a[40:43], v[112:115]
ds_read_b128 v[64:67], v5 offset:61440
v_mfma_f32_16x16x32_bf16 v[112:115], v[76:79], a[44:47], v[112:115]
s_waitcnt lgkmcnt(7)
ds_read_b128 v[68:71], v7 offset:1024
v_mfma_f32_16x16x32_bf16 v[116:119], v[80:83], a[40:43], v[116:119]
ds_read_b128 v[72:75], v5 offset:62464
v_mfma_f32_16x16x32_bf16 v[116:119], v[84:87], a[44:47], v[116:119]
s_waitcnt lgkmcnt(7)
s_mov_b32 s92, 49152
s_add_u32 m0, s29, 0
v_mfma_f32_16x16x32_bf16 v[120:123], v[88:91], a[40:43], v[120:123]
buffer_load_dwordx4 v27, s[60:63], s92 offen offset:0  lds
v_mfma_f32_16x16x32_bf16 v[120:123], v[92:95], a[44:47], v[120:123]
s_waitcnt lgkmcnt(5)
ds_read_b128 v[76:79], v7 offset:2048
v_mfma_f32_16x16x32_bf16 v[124:127], v[96:99], a[40:43], v[124:127]
ds_read_b128 v[80:83], v5 offset:63488
v_mfma_f32_16x16x32_bf16 v[124:127], v[100:103], a[44:47], v[124:127]
s_waitcnt lgkmcnt(5)
ds_read_b128 v[84:87], v7 offset:3072
v_mfma_f32_16x16x32_bf16 v[128:131], v[104:107], a[40:43], v[128:131]
buffer_load_dwordx4 v27, s[60:63], s92 offen offset:1024  lds
v_mfma_f32_16x16x32_bf16 v[128:131], v[108:111], a[44:47], v[128:131]
s_waitcnt vmcnt(8) lgkmcnt(4)
ds_read_b128 v[88:91], v5 offset:64512
ds_read_b128 v[92:95], v7 offset:4096
v_mfma_f32_16x16x32_bf16 v[112:115], v[64:67], a[48:51], v[112:115]
ds_read_b128 v[96:99], v7 offset:0
v_mfma_f32_16x16x32_bf16 v[112:115], v[68:71], a[52:55], v[112:115]
s_waitcnt lgkmcnt(5)
ds_read_b128 v[100:103], v7 offset:5120
v_mfma_f32_16x16x32_bf16 v[116:119], v[72:75], a[48:51], v[116:119]
buffer_load_dwordx4 v27, s[60:63], s92 offen offset:2048  lds
v_mfma_f32_16x16x32_bf16 v[116:119], v[76:79], a[52:55], v[116:119]
s_waitcnt lgkmcnt(4)
ds_read_b128 v[104:107], v7 offset:6144
ds_read_b128 v[108:111], v7 offset:11264
v_mfma_f32_16x16x32_bf16 v[120:123], v[80:83], a[48:51], v[120:123]
ds_read_b128 v[64:67], v7 offset:7168
v_mfma_f32_16x16x32_bf16 v[120:123], v[84:87], a[52:55], v[120:123]
s_waitcnt lgkmcnt(5)
ds_read_b128 v[68:71], v7 offset:12288
s_mov_b32 s92, 61440
s_add_u32 m0, s29, 12288
v_mfma_f32_16x16x32_bf16 v[124:127], v[88:91], a[48:51], v[124:127]
buffer_load_dwordx4 v27, s[60:63], s92 offen offset:0  lds
v_mfma_f32_16x16x32_bf16 v[124:127], v[92:95], a[52:55], v[124:127]
s_waitcnt lgkmcnt(4)
ds_read_b128 v[72:75], v7 offset:8192
ds_read_b128 v[76:79], v7 offset:13312
v_mfma_f32_16x16x32_bf16 v[128:131], v[96:99], a[48:51], v[128:131]
ds_read_b128 v[80:83], v7 offset:9216
v_mfma_f32_16x16x32_bf16 v[128:131], v[100:103], a[52:55], v[128:131]
s_waitcnt vmcnt(8) lgkmcnt(5)
ds_read_b128 v[84:87], v7 offset:14336
v_mfma_f32_16x16x32_bf16 v[112:115], v[104:107], a[56:59], v[112:115]
buffer_load_dwordx4 v27, s[60:63], s92 offen offset:1024  lds
v_mfma_f32_16x16x32_bf16 v[112:115], v[108:111], a[60:63], v[112:115]
s_waitcnt lgkmcnt(4)
ds_read_b128 v[88:91], v7 offset:10240
ds_read_b128 v[92:95], v7 offset:15360
v_mfma_f32_16x16x32_bf16 v[116:119], v[64:67], a[56:59], v[116:119]
ds_read_b128 v[96:99], v7 offset:16384
v_mfma_f32_16x16x32_bf16 v[116:119], v[68:71], a[60:63], v[116:119]
s_waitcnt lgkmcnt(5)
ds_read_b128 v[100:103], v7 offset:21504
v_mfma_f32_16x16x32_bf16 v[120:123], v[72:75], a[56:59], v[120:123]
buffer_load_dwordx4 v27, s[60:63], s92 offen offset:2048  lds
v_mfma_f32_16x16x32_bf16 v[120:123], v[76:79], a[60:63], v[120:123]
s_waitcnt lgkmcnt(4)
ds_read_b128 v[104:107], v7 offset:17408
ds_read_b128 v[108:111], v7 offset:22528
v_mfma_f32_16x16x32_bf16 v[124:127], v[80:83], a[56:59], v[124:127]
ds_read_b128 v[64:67], v7 offset:18432
v_mfma_f32_16x16x32_bf16 v[124:127], v[84:87], a[60:63], v[124:127]
s_waitcnt lgkmcnt(5)
ds_read_b128 v[68:71], v7 offset:23552
s_mov_b32 s92, 73728
s_add_u32 m0, s29, 24576
v_mfma_f32_16x16x32_bf16 v[128:131], v[88:91], a[56:59], v[128:131]
buffer_load_dwordx4 v27, s[60:63], s92 offen offset:0  lds
v_mfma_f32_16x16x32_bf16 v[128:131], v[92:95], a[60:63], v[128:131]
s_waitcnt vmcnt(9) lgkmcnt(4)
ds_read_b128 v[72:75], v7 offset:19456
ds_read_b128 v[76:79], v7 offset:24576
v_mfma_f32_16x16x32_bf16 v[112:115], v[96:99], a[64:67], v[112:115]
ds_read_b128 v[80:83], v7 offset:20480
v_mfma_f32_16x16x32_bf16 v[112:115], v[100:103], a[68:71], v[112:115]
s_waitcnt lgkmcnt(5)
ds_read_b128 v[84:87], v7 offset:25600
v_mfma_f32_16x16x32_bf16 v[116:119], v[104:107], a[64:67], v[116:119]
buffer_load_dwordx4 v27, s[60:63], s92 offen offset:1024  lds
v_mfma_f32_16x16x32_bf16 v[116:119], v[108:111], a[68:71], v[116:119]
s_waitcnt lgkmcnt(4)
ds_read_b128 v[88:91], v7 offset:26624
ds_read_b128 v[92:95], v7 offset:31744
v_mfma_f32_16x16x32_bf16 v[120:123], v[64:67], a[64:67], v[120:123]
ds_read_b128 v[96:99], v7 offset:27648
v_mfma_f32_16x16x32_bf16 v[120:123], v[68:71], a[68:71], v[120:123]
s_waitcnt lgkmcnt(5)
ds_read_b128 v[100:103], v7 offset:32768
v_mfma_f32_16x16x32_bf16 v[124:127], v[72:75], a[64:67], v[124:127]
buffer_load_dwordx4 v27, s[60:63], s92 offen offset:2048  lds
v_mfma_f32_16x16x32_bf16 v[124:127], v[76:79], a[68:71], v[124:127]
s_waitcnt lgkmcnt(4)
ds_read_b128 v[104:107], v7 offset:28672
ds_read_b128 v[108:111], v7 offset:33792
v_mfma_f32_16x16x32_bf16 v[128:131], v[80:83], a[64:67], v[128:131]
ds_read_b128 v[64:67], v7 offset:29696
v_mfma_f32_16x16x32_bf16 v[128:131], v[84:87], a[68:71], v[128:131]
s_waitcnt vmcnt(9) lgkmcnt(5)
ds_read_b128 v[68:71], v7 offset:34816
v_mfma_f32_16x16x32_bf16 v[112:115], v[88:91], a[72:75], v[112:115]
ds_read_b128 v[72:75], v7 offset:30720
v_mfma_f32_16x16x32_bf16 v[112:115], v[92:95], a[76:79], v[112:115]
s_waitcnt lgkmcnt(5)
ds_read_b128 v[76:79], v7 offset:35840
v_mfma_f32_16x16x32_bf16 v[116:119], v[96:99], a[72:75], v[116:119]
v_mfma_f32_16x16x32_bf16 v[116:119], v[100:103], a[76:79], v[116:119]
s_waitcnt lgkmcnt(4)
v_mfma_f32_16x16x32_bf16 v[120:123], v[104:107], a[72:75], v[120:123]
v_mfma_f32_16x16x32_bf16 v[120:123], v[108:111], a[76:79], v[120:123]
s_waitcnt lgkmcnt(2)
v_mfma_f32_16x16x32_bf16 v[124:127], v[64:67], a[72:75], v[124:127]
v_mfma_f32_16x16x32_bf16 v[124:127], v[68:71], a[76:79], v[124:127]
s_waitcnt lgkmcnt(0)
v_mfma_f32_16x16x32_bf16 v[128:131], v[72:75], a[72:75], v[128:131]
v_mfma_f32_16x16x32_bf16 v[128:131], v[76:79], a[76:79], v[128:131]
s_barrier
s_nop 6
L_al_on21:
v_lshlrev_b32_e64 v32, 16, v220
v_and_b32 v33, 0xffff0000, v220
v_pk_add_f32 v[176:177], v[112:113], v[32:33]
v_lshlrev_b32_e64 v34, 16, v221
v_and_b32 v35, 0xffff0000, v221
v_pk_add_f32 v[178:179], v[114:115], v[34:35]
v_lshlrev_b32_e64 v32, 16, v222
v_and_b32 v33, 0xffff0000, v222
v_pk_add_f32 v[180:181], v[116:117], v[32:33]
v_lshlrev_b32_e64 v34, 16, v223
v_and_b32 v35, 0xffff0000, v223
v_pk_add_f32 v[182:183], v[118:119], v[34:35]
v_lshlrev_b32_e64 v32, 16, v224
v_and_b32 v33, 0xffff0000, v224
v_pk_add_f32 v[184:185], v[120:121], v[32:33]
v_lshlrev_b32_e64 v34, 16, v225
v_and_b32 v35, 0xffff0000, v225
v_pk_add_f32 v[186:187], v[122:123], v[34:35]
v_lshlrev_b32_e64 v32, 16, v226
v_and_b32 v33, 0xffff0000, v226
v_pk_add_f32 v[188:189], v[124:125], v[32:33]
v_lshlrev_b32_e64 v34, 16, v227
v_and_b32 v35, 0xffff0000, v227
v_pk_add_f32 v[190:191], v[126:127], v[34:35]
v_lshlrev_b32_e64 v32, 16, v228
v_and_b32 v33, 0xffff0000, v228
v_pk_add_f32 v[192:193], v[128:129], v[32:33]
v_lshlrev_b32 v34, 16, v229
v_and_b32 v35, 0xffff0000, v229
v_pk_add_f32 v[194:195], v[130:131], v[34:35]
v_cvt_pk_bf16_f32 v112, v176, v177
v_cvt_pk_bf16_f32 v113, v178, v179
v_cvt_pk_bf16_f32 v114, v180, v181
v_cvt_pk_bf16_f32 v115, v182, v183
v_cvt_pk_bf16_f32 v116, v184, v185
v_cvt_pk_bf16_f32 v117, v186, v187
v_cvt_pk_bf16_f32 v118, v188, v189
v_cvt_pk_bf16_f32 v119, v190, v191
v_cvt_pk_bf16_f32 v120, v192, v193
v_cvt_pk_bf16_f32 v121, v194, v195
s_cmp_eq_u32 s46, 0
s_cbranch_scc1 L_wt22
buffer_store_dwordx4 v[112:115], v11, s[76:79], s41 offen
buffer_store_dwordx4 v[116:119], v11, s[76:79], s41 offen offset:1024
buffer_store_dwordx2 v[120:121], v11, s[76:79], s42 offen
L_wj22:
v_pk_add_f32 v[34:35], v[176:177], v[178:179]
v_pk_mul_f32 v[38:39], v[176:177], v[176:177]
v_pk_fma_f32 v[38:39], v[178:179], v[178:179], v[38:39]
v_pk_add_f32 v[34:35], v[34:35], v[180:181]
v_pk_fma_f32 v[38:39], v[180:181], v[180:181], v[38:39]
v_pk_add_f32 v[34:35], v[34:35], v[182:183]
v_pk_fma_f32 v[38:39], v[182:183], v[182:183], v[38:39]
v_pk_add_f32 v[34:35], v[34:35], v[184:185]
v_pk_fma_f32 v[38:39], v[184:185], v[184:185], v[38:39]
v_pk_add_f32 v[34:35], v[34:35], v[186:187]
v_pk_fma_f32 v[38:39], v[186:187], v[186:187], v[38:39]
v_pk_add_f32 v[34:35], v[34:35], v[188:189]
v_pk_fma_f32 v[38:39], v[188:189], v[188:189], v[38:39]
v_pk_add_f32 v[34:35], v[34:35], v[190:191]
v_pk_fma_f32 v[38:39], v[190:191], v[190:191], v[38:39]
v_pk_add_f32 v[34:35], v[34:35], v[192:193]
v_pk_fma_f32 v[38:39], v[192:193], v[192:193], v[38:39]
v_pk_add_f32 v[34:35], v[34:35], v[194:195]
v_pk_fma_f32 v[38:39], v[194:195], v[194:195], v[38:39]
v_add_f32 v36, v34, v35
v_add_f32 v37, v38, v39
v_mov_b32 v34, v36
v_mov_b32 v35, v37
s_nop 0
v_permlane32_swap_b32 v36, v34
v_permlane32_swap_b32 v37, v35
v_pk_add_f32 v[36:37], v[36:37], v[34:35]
v_mov_b32 v34, v36
v_mov_b32 v35, v37
s_nop 0
v_permlane16_swap_b32 v36, v34
v_permlane16_swap_b32 v37, v35
v_pk_add_f32 v[36:37], v[36:37], v[34:35]
v_and_b32 v32, 15, v0
v_lshlrev_b32 v32, 6, v32
s_mul_i32 s6, s11, 20480
s_lshl_b32 s7, s10, 3
s_add_u32 s6, s6, s7
s_mov_b64 exec, 0xffff
s_cmp_eq_u32 s46, 0
s_cbranch_scc1 L_wt23
buffer_store_dwordx2 v[36:37], v32, s[84:87], s6 offen
L_wj23:
s_mov_b64 exec, -1
s_mov_b32 s92, 86016
s_add_u32 m0, s29, 36864
s_nop 0
buffer_load_dwordx4 v27, s[60:63], s92 offen offset:0  lds
buffer_load_dwordx4 v27, s[60:63], s92 offen offset:1024  lds
buffer_load_dwordx4 v27, s[60:63], s92 offen offset:2048  lds
s_mov_b32 s92, 98304
s_add_u32 m0, s29, 49152
s_nop 0
buffer_load_dwordx4 v27, s[60:63], s92 offen offset:0  lds
buffer_load_dwordx4 v27, s[60:63], s92 offen offset:1024  lds
buffer_load_dwordx4 v27, s[60:63], s92 offen offset:2048  lds
s_lshr_b32 s6, s2, 3
s_and_b32 s10, s6, 15
s_lshr_b32 s6, s6, 4
s_lshl_b32 s9, s8, 1
s_add_u32 s9, s9, s6
s_lshl_b32 s11, s9, 2
s_add_u32 s11, s11, s28
s_lshl_b32 s17, s11, 5
s_add_u32 s17, s17, s10
s_lshl_b32 s17, s17, 2
s_add_u32 s17, s17, 196608
s_lshl_b32 s11, s11, 1
v_add_u32 v5, 0, v11
v_add_u32 v7, 65536, v11
v_add_u32 v9, 131072, v11
v_add_u32_e64 v12, 0, v11
v_add_u32 v13, 20480, v11
s_mul_i32 s3, s11, 20480
s_add_u32 s3, s3, 51904512
s_add_u32 s72, s4, s3
s_addc_u32 s73, s5, 0
s_mov_b32 s74, 40960
s_mov_b32 s75, 0x20000
s_add_u32 s76, s4, 44040192
s_addc_u32 s77, s5, 0
s_mov_b32 s78, 7864320
s_mov_b32 s79, 0x20000
v_bfe_u32 v18, v0, 3, 1
v_and_b32 v40, 7, v0
v_lshlrev_b32_e64 v41, 7, v40
v_mul_u32_u24 v42, 20480, v18
v_add_u32 v16, v41, v42
v_lshlrev_b32 v40, 2, v40
v_lshl_add_u32 v18, v18, 7, v40
v_and_b32 v40, 15, v0
v_lshlrev_b32 v40, 6, v40
v_and_b32_e64 v41, 48, v0
v_add_u32 v17, v40, v41
s_mul_i32 s12, s11, 20480
s_add_u32 s13, s12, 20480
s_mul_i32 s3, s10, 3
s_add_u32 s6, s3, 0
s_lshr_b32 s7, s6, 4
s_mul_i32 s7, s7, 2621440
s_and_b32 s6, s6, 15
s_lshl_b32 s6, s6, 10
s_add_u32 s6, s6, s7
s_add_u32 s14, s6, s12
s_add_u32 s6, s3, 1
s_lshr_b32 s7, s6, 4
s_mul_i32 s7, s7, 2621440
s_and_b32 s6, s6, 15
s_lshl_b32 s6, s6, 10
s_add_u32 s6, s6, s7
s_add_u32 s15, s6, s12
s_add_u32 s6, s3, 2
s_lshr_b32 s7, s6, 4
s_mul_i32 s7, s7, 2621440
s_and_b32 s6, s6, 15
s_lshl_b32 s6, s6, 10
s_add_u32 s6, s6, s7
s_add_u32 s16, s6, s12
s_lshl_b32 s95, s11, 7
s_add_u32 s95, s95, 163840
s_waitcnt vmcnt(6)
s_mov_b64 exec, 1
s_cmp_eq_u32 s46, 0
s_cbranch_scc1 L_wt24
buffer_store_dword v31, off, s[68:71], s47
L_wj24:
s_mov_b64 exec, -1
s_mov_b32 s92, 110592
s_add_u32 m0, s29, 61440
s_nop 0
buffer_load_dwordx4 v27, s[60:63], s92 offen offset:0  lds
buffer_load_dwordx4 v27, s[60:63], s92 offen offset:1024  lds
buffer_load_dwordx4 v27, s[60:63], s92 offen offset:2048  lds
s_mov_b32 s92, 0
s_add_u32 m0, s94, 73728
s_nop 0
buffer_load_dwordx4 v26, s[64:67], s92 offen offset:0  lds
buffer_load_dwordx4 v26, s[64:67], s92 offen offset:1024  lds
buffer_load_dwordx4 v26, s[64:67], s92 offen offset:2048  lds
buffer_load_dwordx4 v26, s[64:67], s92 offen offset:3072  lds
s_add_u32 s92, s92, 4096
s_add_u32 m0, s94, 77824
s_nop 0
buffer_load_dwordx4 v26, s[64:67], s92 offen offset:0  lds
buffer_load_dword v19, v18, s[68:71], s95 offen sc1
s_mov_b32 s101, 0x200000
s_waitcnt vmcnt(0)
L_poll25:
v_cmp_gt_u32 vcc, 1, v19
s_cbranch_vccz L_go25
s_sub_u32 s101, s101, 1
s_cmp_eq_u32 s101, 0
s_cbranch_scc1 L_go25
buffer_load_dword v19, v18, s[68:71], s95 offen sc1
s_waitcnt vmcnt(0)
s_branch L_poll25
L_go25:
L_al_off26:
s_mov_b32 s93, 0
buffer_load_dwordx4 a[0:3], v12, s[72:75], s93 offen offset:0 sc1
buffer_load_dwordx4 a[8:11], v13, s[72:75], s93 offen offset:0 sc1
buffer_load_dwordx4 a[4:7], v12, s[72:75], s93 offen offset:1024 sc1
buffer_load_dwordx4 a[12:15], v13, s[72:75], s93 offen offset:1024 sc1
s_mov_b32 s93, 2048
buffer_load_dwordx4 a[16:19], v12, s[72:75], s93 offen offset:0 sc1
buffer_load_dwordx4 a[24:27], v13, s[72:75], s93 offen offset:0 sc1
buffer_load_dwordx4 a[20:23], v12, s[72:75], s93 offen offset:1024 sc1
buffer_load_dwordx4 a[28:31], v13, s[72:75], s93 offen offset:1024 sc1
buffer_load_dwordx4 v[32:35], v17, s[84:87], s12 offen sc1
buffer_load_dwordx4 v[36:39], v17, s[84:87], s13 offen sc1
s_barrier
ds_read_b128 v[64:67], v7 offset:36864
ds_read_b128 v[68:71], v7 offset:43008
ds_read_b128 v[72:75], v7 offset:37888
ds_read_b128 v[76:79], v7 offset:44032
ds_read_b128 v[80:83], v7 offset:38912
ds_read_b128 v[84:87], v7 offset:45056
ds_read_b128 v[88:91], v7 offset:39936
ds_read_b128 v[92:95], v7 offset:46080
s_waitcnt vmcnt(6) lgkmcnt(6)
v_mfma_f32_16x16x32_bf16 v[96:99], v[64:67], a[0:3], 0
v_mfma_f32_16x16x32_bf16 v[96:99], v[68:71], a[4:7], v[96:99]
s_mov_b32 s93, 4096
buffer_load_dwordx4 a[32:35], v12, s[72:75], s93 offen offset:0 sc1
v_mfma_f32_16x16x32_bf16 v[120:123], v[64:67], a[8:11], 0
v_mfma_f32_16x16x32_bf16 v[120:123], v[68:71], a[12:15], v[120:123]
s_waitcnt lgkmcnt(4)
ds_read_b128 v[64:67], v7 offset:40960
v_mfma_f32_16x16x32_bf16 v[100:103], v[72:75], a[0:3], 0
ds_read_b128 v[68:71], v7 offset:47104
v_mfma_f32_16x16x32_bf16 v[100:103], v[76:79], a[4:7], v[100:103]
buffer_load_dwordx4 a[40:43], v13, s[72:75], s93 offen offset:0 sc1
v_mfma_f32_16x16x32_bf16 v[124:127], v[72:75], a[8:11], 0
v_mfma_f32_16x16x32_bf16 v[124:127], v[76:79], a[12:15], v[124:127]
s_waitcnt lgkmcnt(4)
ds_read_b128 v[72:75], v7 offset:41984
v_mfma_f32_16x16x32_bf16 v[104:107], v[80:83], a[0:3], 0
ds_read_b128 v[76:79], v7 offset:48128
v_mfma_f32_16x16x32_bf16 v[104:107], v[84:87], a[4:7], v[104:107]
buffer_load_dwordx4 a[36:39], v12, s[72:75], s93 offen offset:1024 sc1
v_mfma_f32_16x16x32_bf16 v[128:131], v[80:83], a[8:11], 0
v_mfma_f32_16x16x32_bf16 v[128:131], v[84:87], a[12:15], v[128:131]
s_waitcnt lgkmcnt(4)
ds_read_b128 v[80:83], v7 offset:49152
v_mfma_f32_16x16x32_bf16 v[108:111], v[88:91], a[0:3], 0
ds_read_b128 v[84:87], v7 offset:55296
v_mfma_f32_16x16x32_bf16 v[108:111], v[92:95], a[4:7], v[108:111]
buffer_load_dwordx4 a[44:47], v13, s[72:75], s93 offen offset:1024 sc1
v_mfma_f32_16x16x32_bf16 v[132:135], v[88:91], a[8:11], 0
v_mfma_f32_16x16x32_bf16 v[132:135], v[92:95], a[12:15], v[132:135]
s_waitcnt lgkmcnt(4)
ds_read_b128 v[88:91], v7 offset:50176
v_mfma_f32_16x16x32_bf16 v[112:115], v[64:67], a[0:3], 0
ds_read_b128 v[92:95], v7 offset:56320
v_mfma_f32_16x16x32_bf16 v[112:115], v[68:71], a[4:7], v[112:115]
s_mov_b32 s93, 6144
buffer_load_dwordx4 a[48:51], v12, s[72:75], s93 offen offset:0 sc1
v_mfma_f32_16x16x32_bf16 v[136:139], v[64:67], a[8:11], 0
v_mfma_f32_16x16x32_bf16 v[136:139], v[68:71], a[12:15], v[136:139]
s_waitcnt lgkmcnt(4)
ds_read_b128 v[64:67], v7 offset:51200
v_mfma_f32_16x16x32_bf16 v[116:119], v[72:75], a[0:3], 0
ds_read_b128 v[68:71], v7 offset:57344
v_mfma_f32_16x16x32_bf16 v[116:119], v[76:79], a[4:7], v[116:119]
buffer_load_dwordx4 a[56:59], v13, s[72:75], s93 offen offset:0 sc1
v_mfma_f32_16x16x32_bf16 v[140:143], v[72:75], a[8:11], 0
v_mfma_f32_16x16x32_bf16 v[140:143], v[76:79], a[12:15], v[140:143]
s_waitcnt vmcnt(8) lgkmcnt(4)
ds_read_b128 v[72:75], v7 offset:52224
v_mfma_f32_16x16x32_bf16 v[96:99], v[80:83], a[16:19], v[96:99]
ds_read_b128 v[76:79], v7 offset:58368
v_mfma_f32_16x16x32_bf16 v[96:99], v[84:87], a[20:23], v[96:99]
buffer_load_dwordx4 a[52:55], v12, s[72:75], s93 offen offset:1024 sc1
v_mfma_f32_16x16x32_bf16 v[120:123], v[80:83], a[24:27], v[120:123]
v_mfma_f32_16x16x32_bf16 v[120:123], v[84:87], a[28:31], v[120:123]
s_waitcnt lgkmcnt(4)
ds_read_b128 v[80:83], v7 offset:53248
v_mfma_f32_16x16x32_bf16 v[100:103], v[88:91], a[16:19], v[100:103]
ds_read_b128 v[84:87], v7 offset:59392
v_mfma_f32_16x16x32_bf16 v[100:103], v[92:95], a[20:23], v[100:103]
buffer_load_dwordx4 a[60:63], v13, s[72:75], s93 offen offset:1024 sc1
v_mfma_f32_16x16x32_bf16 v[124:127], v[88:91], a[24:27], v[124:127]
v_mfma_f32_16x16x32_bf16 v[124:127], v[92:95], a[28:31], v[124:127]
s_waitcnt lgkmcnt(4)
ds_read_b128 v[88:91], v7 offset:54272
v_mfma_f32_16x16x32_bf16 v[104:107], v[64:67], a[16:19], v[104:107]
ds_read_b128 v[92:95], v7 offset:60416
v_mfma_f32_16x16x32_bf16 v[104:107], v[68:71], a[20:23], v[104:107]
s_mov_b32 s93, 8192
buffer_load_dwordx4 a[64:67], v12, s[72:75], s93 offen offset:0 sc1
v_mfma_f32_16x16x32_bf16 v[128:131], v[64:67], a[24:27], v[128:131]
v_mfma_f32_16x16x32_bf16 v[128:131], v[68:71], a[28:31], v[128:131]
s_waitcnt lgkmcnt(4)
ds_read_b128 v[64:67], v7 offset:61440
v_mfma_f32_16x16x32_bf16 v[108:111], v[72:75], a[16:19], v[108:111]
ds_read_b128 v[68:71], v9 offset:2048
v_mfma_f32_16x16x32_bf16 v[108:111], v[76:79], a[20:23], v[108:111]
buffer_load_dwordx4 a[72:75], v13, s[72:75], s93 offen offset:0 sc1
v_mfma_f32_16x16x32_bf16 v[132:135], v[72:75], a[24:27], v[132:135]
v_mfma_f32_16x16x32_bf16 v[132:135], v[76:79], a[28:31], v[132:135]
s_waitcnt lgkmcnt(4)
ds_read_b128 v[72:75], v7 offset:62464
v_mfma_f32_16x16x32_bf16 v[112:115], v[80:83], a[16:19], v[112:115]
ds_read_b128 v[76:79], v9 offset:3072
v_mfma_f32_16x16x32_bf16 v[112:115], v[84:87], a[20:23], v[112:115]
buffer_load_dwordx4 a[68:71], v12, s[72:75], s93 offen offset:1024 sc1
v_mfma_f32_16x16x32_bf16 v[136:139], v[80:83], a[24:27], v[136:139]
v_mfma_f32_16x16x32_bf16 v[136:139], v[84:87], a[28:31], v[136:139]
s_waitcnt lgkmcnt(4)
ds_read_b128 v[80:83], v7 offset:63488
v_mfma_f32_16x16x32_bf16 v[116:119], v[88:91], a[16:19], v[116:119]
ds_read_b128 v[84:87], v9 offset:4096
v_mfma_f32_16x16x32_bf16 v[116:119], v[92:95], a[20:23], v[116:119]
buffer_load_dwordx4 a[76:79], v13, s[72:75], s93 offen offset:1024 sc1
v_mfma_f32_16x16x32_bf16 v[140:143], v[88:91], a[24:27], v[140:143]
v_mfma_f32_16x16x32_bf16 v[140:143], v[92:95], a[28:31], v[140:143]
s_waitcnt vmcnt(8) lgkmcnt(4)
ds_read_b128 v[88:91], v7 offset:64512
v_mfma_f32_16x16x32_bf16 v[96:99], v[64:67], a[32:35], v[96:99]
ds_read_b128 v[92:95], v9 offset:5120
v_mfma_f32_16x16x32_bf16 v[96:99], v[68:71], a[36:39], v[96:99]
s_mov_b32 s93, 10240
buffer_load_dwordx4 a[80:83], v12, s[72:75], s93 offen offset:0 sc1
v_mfma_f32_16x16x32_bf16 v[120:123], v[64:67], a[40:43], v[120:123]
v_mfma_f32_16x16x32_bf16 v[120:123], v[68:71], a[44:47], v[120:123]
s_waitcnt lgkmcnt(4)
ds_read_b128 v[64:67], v9 offset:0
v_mfma_f32_16x16x32_bf16 v[100:103], v[72:75], a[32:35], v[100:103]
ds_read_b128 v[68:71], v9 offset:6144
v_mfma_f32_16x16x32_bf16 v[100:103], v[76:79], a[36:39], v[100:103]
buffer_load_dwordx4 a[88:91], v13, s[72:75], s93 offen offset:0 sc1
v_mfma_f32_16x16x32_bf16 v[124:127], v[72:75], a[40:43], v[124:127]
v_mfma_f32_16x16x32_bf16 v[124:127], v[76:79], a[44:47], v[124:127]
s_waitcnt lgkmcnt(4)
ds_read_b128 v[72:75], v9 offset:1024
v_mfma_f32_16x16x32_bf16 v[104:107], v[80:83], a[32:35], v[104:107]
ds_read_b128 v[76:79], v9 offset:7168
v_mfma_f32_16x16x32_bf16 v[104:107], v[84:87], a[36:39], v[104:107]
buffer_load_dwordx4 a[84:87], v12, s[72:75], s93 offen offset:1024 sc1
v_mfma_f32_16x16x32_bf16 v[128:131], v[80:83], a[40:43], v[128:131]
v_mfma_f32_16x16x32_bf16 v[128:131], v[84:87], a[44:47], v[128:131]
s_waitcnt lgkmcnt(4)
ds_read_b128 v[80:83], v9 offset:8192
v_mfma_f32_16x16x32_bf16 v[108:111], v[88:91], a[32:35], v[108:111]
ds_read_b128 v[84:87], v9 offset:14336
v_mfma_f32_16x16x32_bf16 v[108:111], v[92:95], a[36:39], v[108:111]
buffer_load_dwordx4 a[92:95], v13, s[72:75], s93 offen offset:1024 sc1
v_mfma_f32_16x16x32_bf16 v[132:135], v[88:91], a[40:43], v[132:135]
v_mfma_f32_16x16x32_bf16 v[132:135], v[92:95], a[44:47], v[132:135]
s_waitcnt lgkmcnt(4)
ds_read_b128 v[88:91], v9 offset:9216
v_mfma_f32_16x16x32_bf16 v[112:115], v[64:67], a[32:35], v[112:115]
ds_read_b128 v[92:95], v9 offset:15360
v_mfma_f32_16x16x32_bf16 v[112:115], v[68:71], a[36:39], v[112:115]
s_mov_b32 s93, 12288
buffer_load_dwordx4 a[96:99], v12, s[72:75], s93 offen offset:0 sc1
v_mfma_f32_16x16x32_bf16 v[136:139], v[64:67], a[40:43], v[136:139]
v_mfma_f32_16x16x32_bf16 v[136:139], v[68:71], a[44:47], v[136:139]
s_waitcnt lgkmcnt(4)
ds_read_b128 v[64:67], v9 offset:10240
v_mfma_f32_16x16x32_bf16 v[116:119], v[72:75], a[32:35], v[116:119]
ds_read_b128 v[68:71], v9 offset:16384
v_mfma_f32_16x16x32_bf16 v[116:119], v[76:79], a[36:39], v[116:119]
buffer_load_dwordx4 a[104:107], v13, s[72:75], s93 offen offset:0 sc1
v_mfma_f32_16x16x32_bf16 v[140:143], v[72:75], a[40:43], v[140:143]
v_mfma_f32_16x16x32_bf16 v[140:143], v[76:79], a[44:47], v[140:143]
s_waitcnt vmcnt(10) lgkmcnt(4)
ds_read_b128 v[72:75], v9 offset:11264
v_mfma_f32_16x16x32_bf16 v[96:99], v[80:83], a[48:51], v[96:99]
ds_read_b128 v[76:79], v9 offset:17408
v_mfma_f32_16x16x32_bf16 v[96:99], v[84:87], a[52:55], v[96:99]
buffer_load_dwordx4 a[100:103], v12, s[72:75], s93 offen offset:1024 sc1
v_mfma_f32_16x16x32_bf16 v[120:123], v[80:83], a[56:59], v[120:123]
v_add_f32 v32, v32, v34
v_add_f32 v33, v33, v35
v_mfma_f32_16x16x32_bf16 v[120:123], v[84:87], a[60:63], v[120:123]
s_waitcnt lgkmcnt(4)
ds_read_b128 v[80:83], v9 offset:12288
v_mfma_f32_16x16x32_bf16 v[100:103], v[88:91], a[48:51], v[100:103]
ds_read_b128 v[84:87], v9 offset:18432
v_add_f32 v36, v36, v38
v_mfma_f32_16x16x32_bf16 v[100:103], v[92:95], a[52:55], v[100:103]
buffer_load_dwordx4 a[108:111], v13, s[72:75], s93 offen offset:1024 sc1
v_mfma_f32_16x16x32_bf16 v[124:127], v[88:91], a[56:59], v[124:127]
v_add_f32 v37, v37, v39
v_mov_b32 v34, v32
v_mfma_f32_16x16x32_bf16 v[124:127], v[92:95], a[60:63], v[124:127]
s_waitcnt lgkmcnt(4)
ds_read_b128 v[88:91], v9 offset:13312
v_mfma_f32_16x16x32_bf16 v[104:107], v[64:67], a[48:51], v[104:107]
ds_read_b128 v[92:95], v9 offset:19456
v_mov_b32 v35, v33
v_mfma_f32_16x16x32_bf16 v[104:107], v[68:71], a[52:55], v[104:107]
s_mov_b32 s93, 14336
buffer_load_dwordx4 a[112:115], v12, s[72:75], s93 offen offset:0 sc1
v_mfma_f32_16x16x32_bf16 v[128:131], v[64:67], a[56:59], v[128:131]
v_mov_b32 v38, v36
v_mov_b32 v39, v37
v_mfma_f32_16x16x32_bf16 v[128:131], v[68:71], a[60:63], v[128:131]
s_waitcnt lgkmcnt(4)
s_barrier
v_mfma_f32_16x16x32_bf16 v[108:111], v[72:75], a[48:51], v[108:111]
ds_read_b128 v[64:67], v5 offset:0
v_permlane32_swap_b32 v32, v34
v_mfma_f32_16x16x32_bf16 v[108:111], v[76:79], a[52:55], v[108:111]
buffer_load_dwordx4 a[120:123], v13, s[72:75], s93 offen offset:0 sc1
v_mfma_f32_16x16x32_bf16 v[132:135], v[72:75], a[56:59], v[132:135]
ds_read_b128 v[68:71], v5 offset:6144
v_permlane32_swap_b32 v33, v35
v_mfma_f32_16x16x32_bf16 v[132:135], v[76:79], a[60:63], v[132:135]
s_waitcnt lgkmcnt(4)
ds_read_b128 v[72:75], v5 offset:1024
v_mfma_f32_16x16x32_bf16 v[112:115], v[80:83], a[48:51], v[112:115]
ds_read_b128 v[76:79], v5 offset:7168
v_permlane32_swap_b32 v36, v38
v_mfma_f32_16x16x32_bf16 v[112:115], v[84:87], a[52:55], v[112:115]
buffer_load_dwordx4 a[116:119], v12, s[72:75], s93 offen offset:1024 sc1
v_mfma_f32_16x16x32_bf16 v[136:139], v[80:83], a[56:59], v[136:139]
v_permlane32_swap_b32 v37, v39
v_add_f32 v32, v32, v34
v_mfma_f32_16x16x32_bf16 v[136:139], v[84:87], a[60:63], v[136:139]
s_waitcnt lgkmcnt(4)
ds_read_b128 v[80:83], v5 offset:2048
v_mfma_f32_16x16x32_bf16 v[116:119], v[88:91], a[48:51], v[116:119]
ds_read_b128 v[84:87], v5 offset:8192
v_add_f32 v33, v33, v35
v_mfma_f32_16x16x32_bf16 v[116:119], v[92:95], a[52:55], v[116:119]
buffer_load_dwordx4 a[124:127], v13, s[72:75], s93 offen offset:1024 sc1
v_mfma_f32_16x16x32_bf16 v[140:143], v[88:91], a[56:59], v[140:143]
v_add_f32 v36, v36, v38
v_add_f32 v37, v37, v39
v_mfma_f32_16x16x32_bf16 v[140:143], v[92:95], a[60:63], v[140:143]
s_waitcnt vmcnt(12) lgkmcnt(4)
ds_read_b128 v[88:91], v5 offset:3072
v_mfma_f32_16x16x32_bf16 v[96:99], v[64:67], a[64:67], v[96:99]
ds_read_b128 v[92:95], v5 offset:9216
v_mov_b32 v34, v32
v_mfma_f32_16x16x32_bf16 v[96:99], v[68:71], a[68:71], v[96:99]
s_mov_b32 s93, 16384
buffer_load_dwordx4 a[128:131], v12, s[72:75], s93 offen offset:0 sc1
v_mfma_f32_16x16x32_bf16 v[120:123], v[64:67], a[72:75], v[120:123]
v_mov_b32 v35, v33
v_mov_b32 v38, v36
v_mfma_f32_16x16x32_bf16 v[120:123], v[68:71], a[76:79], v[120:123]
s_waitcnt lgkmcnt(4)
ds_read_b128 v[64:67], v5 offset:4096
v_mfma_f32_16x16x32_bf16 v[100:103], v[72:75], a[64:67], v[100:103]
ds_read_b128 v[68:71], v5 offset:10240
v_mov_b32 v39, v37
v_mfma_f32_16x16x32_bf16 v[100:103], v[76:79], a[68:71], v[100:103]
buffer_load_dwordx4 a[136:139], v13, s[72:75], s93 offen offset:0 sc1
v_mfma_f32_16x16x32_bf16 v[124:127], v[72:75], a[72:75], v[124:127]
v_permlane16_swap_b32 v32, v34
v_permlane16_swap_b32 v33, v35
v_mfma_f32_16x16x32_bf16 v[124:127], v[76:79], a[76:79], v[124:127]
s_waitcnt lgkmcnt(4)
ds_read_b128 v[72:75], v5 offset:5120
v_mfma_f32_16x16x32_bf16 v[104:107], v[80:83], a[64:67], v[104:107]
ds_read_b128 v[76:79], v5 offset:11264
v_permlane16_swap_b32 v36, v38
v_mfma_f32_16x16x32_bf16 v[104:107], v[84:87], a[68:71], v[104:107]
buffer_load_dwordx4 a[132:135], v12, s[72:75], s93 offen offset:1024 sc1
v_mfma_f32_16x16x32_bf16 v[128:131], v[80:83], a[72:75], v[128:131]
v_permlane16_swap_b32 v37, v39
v_add_f32 v32, v32, v34
v_mfma_f32_16x16x32_bf16 v[128:131], v[84:87], a[76:79], v[128:131]
s_waitcnt lgkmcnt(4)
ds_read_b128 v[80:83], v5 offset:12288
v_mfma_f32_16x16x32_bf16 v[108:111], v[88:91], a[64:67], v[108:111]
ds_read_b128 v[84:87], v5 offset:18432
v_add_f32 v33, v33, v35
v_mfma_f32_16x16x32_bf16 v[108:111], v[92:95], a[68:71], v[108:111]
buffer_load_dwordx4 a[140:143], v13, s[72:75], s93 offen offset:1024 sc1
v_mfma_f32_16x16x32_bf16 v[132:135], v[88:91], a[72:75], v[132:135]
v_add_f32 v36, v36, v38
v_add_f32 v37, v37, v39
v_mfma_f32_16x16x32_bf16 v[132:135], v[92:95], a[76:79], v[132:135]
s_waitcnt lgkmcnt(4)
ds_read_b128 v[88:91], v5 offset:13312
v_mfma_f32_16x16x32_bf16 v[112:115], v[64:67], a[64:67], v[112:115]
ds_read_b128 v[92:95], v5 offset:19456
v_mul_f32 v144, 0x3acccccd, v32
v_mfma_f32_16x16x32_bf16 v[112:115], v[68:71], a[68:71], v[112:115]
s_mov_b32 s93, 18432
buffer_load_dwordx4 a[144:147], v12, s[72:75], s93 offen offset:0 sc1
v_mfma_f32_16x16x32_bf16 v[136:139], v[64:67], a[72:75], v[136:139]
v_mov_b32 v146, 0x3727c5ac
v_fmac_f32 v146, 0x3acccccd, v33
v_mfma_f32_16x16x32_bf16 v[136:139], v[68:71], a[76:79], v[136:139]
s_waitcnt lgkmcnt(4)
ds_read_b128 v[64:67], v5 offset:14336
v_mfma_f32_16x16x32_bf16 v[116:119], v[72:75], a[64:67], v[116:119]
ds_read_b128 v[68:71], v5 offset:20480
v_fma_f32 v146, -v144, v144, v146
v_mfma_f32_16x16x32_bf16 v[116:119], v[76:79], a[68:71], v[116:119]
buffer_load_dwordx4 a[152:155], v13, s[72:75], s93 offen offset:0 sc1
v_mfma_f32_16x16x32_bf16 v[140:143], v[72:75], a[72:75], v[140:143]
v_max_f32 v146, 0x3727c5ac, v146
v_mfma_f32_16x16x32_bf16 v[140:143], v[76:79], a[76:79], v[140:143]
s_waitcnt vmcnt(14) lgkmcnt(4)
ds_read_b128 v[72:75], v5 offset:15360
v_mfma_f32_16x16x32_bf16 v[96:99], v[80:83], a[80:83], v[96:99]
ds_read_b128 v[76:79], v5 offset:21504
v_mfma_f32_16x16x32_bf16 v[96:99], v[84:87], a[84:87], v[96:99]
buffer_load_dwordx4 a[148:151], v12, s[72:75], s93 offen offset:1024 sc1
v_mfma_f32_16x16x32_bf16 v[120:123], v[80:83], a[88:91], v[120:123]
v_rsq_f32 v146, v146
v_mfma_f32_16x16x32_bf16 v[120:123], v[84:87], a[92:95], v[120:123]
s_waitcnt lgkmcnt(4)
ds_read_b128 v[80:83], v5 offset:16384
v_mfma_f32_16x16x32_bf16 v[100:103], v[88:91], a[80:83], v[100:103]
ds_read_b128 v[84:87], v5 offset:22528
v_mul_f32 v148, 0x3acccccd, v36
v_mfma_f32_16x16x32_bf16 v[100:103], v[92:95], a[84:87], v[100:103]
buffer_load_dwordx4 a[156:159], v13, s[72:75], s93 offen offset:1024 sc1
v_mfma_f32_16x16x32_bf16 v[124:127], v[88:91], a[88:91], v[124:127]
v_mov_b32 v150, 0x3727c5ac
v_fmac_f32 v150, 0x3acccccd, v37
v_mfma_f32_16x16x32_bf16 v[124:127], v[92:95], a[92:95], v[124:127]
s_waitcnt lgkmcnt(4)
ds_read_b128 v[88:91], v5 offset:17408
v_mfma_f32_16x16x32_bf16 v[104:107], v[64:67], a[80:83], v[104:107]
ds_read_b128 v[92:95], v5 offset:23552
v_fma_f32 v150, -v148, v148, v150
v_mfma_f32_16x16x32_bf16 v[104:107], v[68:71], a[84:87], v[104:107]
v_max_f32 v150, 0x3727c5ac, v150
v_mfma_f32_16x16x32_bf16 v[128:131], v[64:67], a[88:91], v[128:131]
buffer_load_dword v20, off, s[68:71], s17 sc1
v_rsq_f32 v150, v150
v_mfma_f32_16x16x32_bf16 v[128:131], v[68:71], a[92:95], v[128:131]
s_waitcnt lgkmcnt(4)
ds_read_b128 v[64:67], v5 offset:24576
v_mfma_f32_16x16x32_bf16 v[108:111], v[72:75], a[80:83], v[108:111]
s_mov_b32 s92, 20480
s_add_u32 m0, s94, 94208
v_mfma_f32_16x16x32_bf16 v[108:111], v[76:79], a[84:87], v[108:111]
buffer_load_dwordx4 v26, s[64:67], s92 offen offset:0  lds
v_mfma_f32_16x16x32_bf16 v[132:135], v[72:75], a[88:91], v[132:135]
ds_read_b128 v[68:71], v5 offset:30720
v_mfma_f32_16x16x32_bf16 v[132:135], v[76:79], a[92:95], v[132:135]
s_waitcnt lgkmcnt(4)
ds_read_b128 v[72:75], v5 offset:25600
v_mfma_f32_16x16x32_bf16 v[112:115], v[80:83], a[80:83], v[112:115]
ds_read_b128 v[76:79], v5 offset:31744
v_mfma_f32_16x16x32_bf16 v[112:115], v[84:87], a[84:87], v[112:115]
buffer_load_dwordx4 v26, s[64:67], s92 offen offset:1024  lds
v_mfma_f32_16x16x32_bf16 v[136:139], v[80:83], a[88:91], v[136:139]
v_mfma_f32_16x16x32_bf16 v[136:139], v[84:87], a[92:95], v[136:139]
s_waitcnt lgkmcnt(4)
ds_read_b128 v[80:83], v5 offset:26624
v_mfma_f32_16x16x32_bf16 v[116:119], v[88:91], a[80:83], v[116:119]
ds_read_b128 v[84:87], v5 offset:32768
v_mfma_f32_16x16x32_bf16 v[116:119], v[92:95], a[84:87], v[116:119]
buffer_load_dwordx4 v26, s[64:67], s92 offen offset:2048  lds
v_mfma_f32_16x16x32_bf16 v[140:143], v[88:91], a[88:91], v[140:143]
v_mfma_f32_16x16x32_bf16 v[140:143], v[92:95], a[92:95], v[140:143]
s_waitcnt vmcnt(16) lgkmcnt(4)
ds_read_b128 v[88:91], v5 offset:27648
v_mfma_f32_16x16x32_bf16 v[96:99], v[64:67], a[96:99], v[96:99]
ds_read_b128 v[92:95], v5 offset:33792
v_mfma_f32_16x16x32_bf16 v[96:99], v[68:71], a[100:103], v[96:99]
buffer_load_dwordx4 v26, s[64:67], s92 offen offset:3072  lds
v_mfma_f32_16x16x32_bf16 v[120:123], v[64:67], a[104:107], v[120:123]
v_mfma_f32_16x16x32_bf16 v[120:123], v[68:71], a[108:111], v[120:123]
s_waitcnt lgkmcnt(4)
ds_read_b128 v[64:67], v5 offset:28672
v_mfma_f32_16x16x32_bf16 v[100:103], v[72:75], a[96:99], v[100:103]
s_add_u32 s92, s92, 4096
s_add_u32 m0, s94, 98304
v_mfma_f32_16x16x32_bf16 v[100:103], v[76:79], a[100:103], v[100:103]
buffer_load_dwordx4 v26, s[64:67], s92 offen offset:0  lds
v_mfma_f32_16x16x32_bf16 v[124:127], v[72:75], a[104:107], v[124:127]
ds_read_b128 v[68:71], v5 offset:34816
v_mfma_f32_16x16x32_bf16 v[124:127], v[76:79], a[108:111], v[124:127]
s_waitcnt lgkmcnt(4)
ds_read_b128 v[72:75], v5 offset:29696
v_mfma_f32_16x16x32_bf16 v[104:107], v[80:83], a[96:99], v[104:107]
ds_read_b128 v[76:79], v5 offset:35840
v_mfma_f32_16x16x32_bf16 v[104:107], v[84:87], a[100:103], v[104:107]
s_mov_b32 s92, 40960
s_add_u32 m0, s94, 114688
v_mfma_f32_16x16x32_bf16 v[128:131], v[80:83], a[104:107], v[128:131]
buffer_load_dwordx4 v26, s[64:67], s92 offen offset:0  lds
v_mfma_f32_16x16x32_bf16 v[128:131], v[84:87], a[108:111], v[128:131]
s_waitcnt lgkmcnt(4)
s_barrier
v_mfma_f32_16x16x32_bf16 v[108:111], v[88:91], a[96:99], v[108:111]
ds_read_b128 v[80:83], v5 offset:36864
v_mfma_f32_16x16x32_bf16 v[108:111], v[92:95], a[100:103], v[108:111]
buffer_load_dwordx4 v26, s[64:67], s92 offen offset:1024  lds
v_mfma_f32_16x16x32_bf16 v[132:135], v[88:91], a[104:107], v[132:135]
ds_read_b128 v[84:87], v5 offset:43008
v_mfma_f32_16x16x32_bf16 v[132:135], v[92:95], a[108:111], v[132:135]
s_waitcnt lgkmcnt(4)
ds_read_b128 v[88:91], v5 offset:37888
v_mfma_f32_16x16x32_bf16 v[112:115], v[64:67], a[96:99], v[112:115]
ds_read_b128 v[92:95], v5 offset:44032
v_mfma_f32_16x16x32_bf16 v[112:115], v[68:71], a[100:103], v[112:115]
buffer_load_dwordx4 v26, s[64:67], s92 offen offset:2048  lds
v_mfma_f32_16x16x32_bf16 v[136:139], v[64:67], a[104:107], v[136:139]
v_mfma_f32_16x16x32_bf16 v[136:139], v[68:71], a[108:111], v[136:139]
s_waitcnt lgkmcnt(4)
ds_read_b128 v[64:67], v5 offset:38912
v_mfma_f32_16x16x32_bf16 v[116:119], v[72:75], a[96:99], v[116:119]
ds_read_b128 v[68:71], v5 offset:45056
v_mfma_f32_16x16x32_bf16 v[116:119], v[76:79], a[100:103], v[116:119]
buffer_load_dwordx4 v26, s[64:67], s92 offen offset:3072  lds
v_mfma_f32_16x16x32_bf16 v[140:143], v[72:75], a[104:107], v[140:143]
v_mfma_f32_16x16x32_bf16 v[140:143], v[76:79], a[108:111], v[140:143]
s_waitcnt vmcnt(18) lgkmcnt(4)
ds_read_b128 v[72:75], v5 offset:39936
v_mfma_f32_16x16x32_bf16 v[96:99], v[80:83], a[112:115], v[96:99]
s_add_u32 s92, s92, 4096
s_add_u32 m0, s94, 118784
v_mfma_f32_16x16x32_bf16 v[96:99], v[84:87], a[116:119], v[96:99]
buffer_load_dwordx4 v26, s[64:67], s92 offen offset:0  lds
v_mfma_f32_16x16x32_bf16 v[120:123], v[80:83], a[120:123], v[120:123]
ds_read_b128 v[76:79], v5 offset:46080
v_mfma_f32_16x16x32_bf16 v[120:123], v[84:87], a[124:127], v[120:123]
s_waitcnt lgkmcnt(4)
ds_read_b128 v[80:83], v5 offset:40960
v_mfma_f32_16x16x32_bf16 v[100:103], v[88:91], a[112:115], v[100:103]
s_mov_b32 s92, 61440
s_add_u32 m0, s94, 135168
v_mfma_f32_16x16x32_bf16 v[100:103], v[92:95], a[116:119], v[100:103]
buffer_load_dwordx4 v26, s[64:67], s92 offen offset:0  lds
v_mfma_f32_16x16x32_bf16 v[124:127], v[88:91], a[120:123], v[124:127]
ds_read_b128 v[84:87], v5 offset:47104
v_mfma_f32_16x16x32_bf16 v[124:127], v[92:95], a[124:127], v[124:127]
s_waitcnt lgkmcnt(4)
ds_read_b128 v[88:91], v5 offset:41984
v_mfma_f32_16x16x32_bf16 v[104:107], v[64:67], a[112:115], v[104:107]
ds_read_b128 v[92:95], v5 offset:48128
v_mfma_f32_16x16x32_bf16 v[104:107], v[68:71], a[116:119], v[104:107]
buffer_load_dwordx4 v26, s[64:67], s92 offen offset:1024  lds
v_mfma_f32_16x16x32_bf16 v[128:131], v[64:67], a[120:123], v[128:131]
v_mfma_f32_16x16x32_bf16 v[128:131], v[68:71], a[124:127], v[128:131]
s_waitcnt lgkmcnt(4)
ds_read_b128 v[64:67], v5 offset:49152
v_mfma_f32_16x16x32_bf16 v[108:111], v[72:75], a[112:115], v[108:111]
ds_read_b128 v[68:71], v5 offset:55296
v_mfma_f32_16x16x32_bf16 v[108:111], v[76:79], a[116:119], v[108:111]
buffer_load_dwordx4 v26, s[64:67], s92 offen offset:2048  lds
v_mfma_f32_16x16x32_bf16 v[132:135], v[72:75], a[120:123], v[132:135]
v_mfma_f32_16x16x32_bf16 v[132:135], v[76:79], a[124:127], v[132:135]
s_waitcnt lgkmcnt(4)
ds_read_b128 v[72:75], v5 offset:50176
v_mfma_f32_16x16x32_bf16 v[112:115], v[80:83], a[112:115], v[112:115]
ds_read_b128 v[76:79], v5 offset:56320
v_mfma_f32_16x16x32_bf16 v[112:115], v[84:87], a[116:119], v[112:115]
buffer_load_dwordx4 v26, s[64:67], s92 offen offset:3072  lds
v_mfma_f32_16x16x32_bf16 v[136:139], v[80:83], a[120:123], v[136:139]
v_mfma_f32_16x16x32_bf16 v[136:139], v[84:87], a[124:127], v[136:139]
s_waitcnt lgkmcnt(4)
ds_read_b128 v[80:83], v5 offset:51200
v_mfma_f32_16x16x32_bf16 v[116:119], v[88:91], a[112:115], v[116:119]
s_add_u32 s92, s92, 4096
s_add_u32 m0, s94, 139264
v_mfma_f32_16x16x32_bf16 v[116:119], v[92:95], a[116:119], v[116:119]
buffer_load_dwordx4 v26, s[64:67], s92 offen offset:0  lds
v_mfma_f32_16x16x32_bf16 v[140:143], v[88:91], a[120:123], v[140:143]
ds_read_b128 v[84:87], v5 offset:57344
v_mfma_f32_16x16x32_bf16 v[140:143], v[92:95], a[124:127], v[140:143]
s_waitcnt vmcnt(20) lgkmcnt(4)
ds_read_b128 v[88:91], v5 offset:52224
v_mfma_f32_16x16x32_bf16 v[96:99], v[64:67], a[128:131], v[96:99]
s_mov_b32 s92, 81920
s_add_u32 m0, s94, 0
v_mfma_f32_16x16x32_bf16 v[96:99], v[68:71], a[132:135], v[96:99]
buffer_load_dwordx4 v26, s[64:67], s92 offen offset:0  lds
v_mfma_f32_16x16x32_bf16 v[120:123], v[64:67], a[136:139], v[120:123]
ds_read_b128 v[92:95], v5 offset:58368
v_mfma_f32_16x16x32_bf16 v[120:123], v[68:71], a[140:143], v[120:123]
s_waitcnt lgkmcnt(4)
ds_read_b128 v[64:67], v5 offset:53248
v_mfma_f32_16x16x32_bf16 v[100:103], v[72:75], a[128:131], v[100:103]
ds_read_b128 v[68:71], v5 offset:59392
v_mfma_f32_16x16x32_bf16 v[100:103], v[76:79], a[132:135], v[100:103]
buffer_load_dwordx4 v26, s[64:67], s92 offen offset:1024  lds
v_mfma_f32_16x16x32_bf16 v[124:127], v[72:75], a[136:139], v[124:127]
v_mfma_f32_16x16x32_bf16 v[124:127], v[76:79], a[140:143], v[124:127]
s_waitcnt lgkmcnt(4)
ds_read_b128 v[72:75], v5 offset:54272
v_mfma_f32_16x16x32_bf16 v[104:107], v[80:83], a[128:131], v[104:107]
ds_read_b128 v[76:79], v5 offset:60416
v_mfma_f32_16x16x32_bf16 v[104:107], v[84:87], a[132:135], v[104:107]
buffer_load_dwordx4 v26, s[64:67], s92 offen offset:2048  lds
v_mfma_f32_16x16x32_bf16 v[128:131], v[80:83], a[136:139], v[128:131]
v_mfma_f32_16x16x32_bf16 v[128:131], v[84:87], a[140:143], v[128:131]
s_waitcnt lgkmcnt(4)
ds_read_b128 v[80:83], v5 offset:61440
v_mfma_f32_16x16x32_bf16 v[108:111], v[88:91], a[128:131], v[108:111]
ds_read_b128 v[84:87], v7 offset:2048
v_mfma_f32_16x16x32_bf16 v[108:111], v[92:95], a[132:135], v[108:111]
buffer_load_dwordx4 v26, s[64:67], s92 offen offset:3072  lds
v_mfma_f32_16x16x32_bf16 v[132:135], v[88:91], a[136:139], v[132:135]
v_mfma_f32_16x16x32_bf16 v[132:135], v[92:95], a[140:143], v[132:135]
s_waitcnt lgkmcnt(4)
ds_read_b128 v[88:91], v5 offset:62464
v_mfma_f32_16x16x32_bf16 v[112:115], v[64:67], a[128:131], v[112:115]
s_add_u32 s92, s92, 4096
s_add_u32 m0, s94, 4096
v_mfma_f32_16x16x32_bf16 v[112:115], v[68:71], a[132:135], v[112:115]
buffer_load_dwordx4 v26, s[64:67], s92 offen offset:0  lds
v_mfma_f32_16x16x32_bf16 v[136:139], v[64:67], a[136:139], v[136:139]
ds_read_b128 v[92:95], v7 offset:3072
v_mfma_f32_16x16x32_bf16 v[136:139], v[68:71], a[140:143], v[136:139]
s_waitcnt lgkmcnt(4)
ds_read_b128 v[64:67], v5 offset:63488
v_mfma_f32_16x16x32_bf16 v[116:119], v[72:75], a[128:131], v[116:119]
ds_read_b128 v[68:71], v7 offset:4096
v_mfma_f32_16x16x32_bf16 v[116:119], v[76:79], a[132:135], v[116:119]
v_mfma_f32_16x16x32_bf16 v[140:143], v[72:75], a[136:139], v[140:143]
v_mfma_f32_16x16x32_bf16 v[140:143], v[76:79], a[140:143], v[140:143]
s_waitcnt vmcnt(21) lgkmcnt(4)
ds_read_b128 v[72:75], v5 offset:64512
v_mfma_f32_16x16x32_bf16 v[96:99], v[80:83], a[144:147], v[96:99]
ds_read_b128 v[76:79], v7 offset:5120
v_mfma_f32_16x16x32_bf16 v[96:99], v[84:87], a[148:151], v[96:99]
v_mfma_f32_16x16x32_bf16 v[120:123], v[80:83], a[152:155], v[120:123]
v_mfma_f32_16x16x32_bf16 v[120:123], v[84:87], a[156:159], v[120:123]
s_waitcnt lgkmcnt(4)
ds_read_b128 v[80:83], v7 offset:0
v_mfma_f32_16x16x32_bf16 v[100:103], v[88:91], a[144:147], v[100:103]
ds_read_b128 v[84:87], v7 offset:6144
v_mfma_f32_16x16x32_bf16 v[100:103], v[92:95], a[148:151], v[100:103]
v_mfma_f32_16x16x32_bf16 v[124:127], v[88:91], a[152:155], v[124:127]
v_mfma_f32_16x16x32_bf16 v[124:127], v[92:95], a[156:159], v[124:127]
s_waitcnt lgkmcnt(4)
ds_read_b128 v[88:91], v7 offset:1024
v_mfma_f32_16x16x32_bf16 v[104:107], v[64:67], a[144:147], v[104:107]
ds_read_b128 v[92:95], v7 offset:7168
v_mfma_f32_16x16x32_bf16 v[104:107], v[68:71], a[148:151], v[104:107]
v_mfma_f32_16x16x32_bf16 v[128:131], v[64:67], a[152:155], v[128:131]
v_mfma_f32_16x16x32_bf16 v[128:131], v[68:71], a[156:159], v[128:131]
s_waitcnt lgkmcnt(4)
v_mfma_f32_16x16x32_bf16 v[108:111], v[72:75], a[144:147], v[108:111]
v_mfma_f32_16x16x32_bf16 v[108:111], v[76:79], a[148:151], v[108:111]
v_mfma_f32_16x16x32_bf16 v[132:135], v[72:75], a[152:155], v[132:135]
v_mfma_f32_16x16x32_bf16 v[132:135], v[76:79], a[156:159], v[132:135]
s_waitcnt lgkmcnt(2)
v_mfma_f32_16x16x32_bf16 v[112:115], v[80:83], a[144:147], v[112:115]
v_mfma_f32_16x16x32_bf16 v[112:115], v[84:87], a[148:151], v[112:115]
v_mfma_f32_16x16x32_bf16 v[136:139], v[80:83], a[152:155], v[136:139]
v_mfma_f32_16x16x32_bf16 v[136:139], v[84:87], a[156:159], v[136:139]
s_waitcnt lgkmcnt(0)
v_mfma_f32_16x16x32_bf16 v[116:119], v[88:91], a[144:147], v[116:119]
v_mfma_f32_16x16x32_bf16 v[116:119], v[92:95], a[148:151], v[116:119]
v_mfma_f32_16x16x32_bf16 v[140:143], v[88:91], a[152:155], v[140:143]
v_mfma_f32_16x16x32_bf16 v[140:143], v[92:95], a[156:159], v[140:143]
s_barrier
s_nop 6
v_pk_fma_f32 v[96:97], v[232:233], v[144:145], v[96:97] op_sel_hi:[1,0,1] neg_lo:[0,1,0] neg_hi:[0,1,0]
v_pk_fma_f32 v[98:99], v[234:235], v[144:145], v[98:99] op_sel_hi:[1,0,1] neg_lo:[0,1,0] neg_hi:[0,1,0]
v_pk_fma_f32 v[100:101], v[236:237], v[144:145], v[100:101] op_sel_hi:[1,0,1] neg_lo:[0,1,0] neg_hi:[0,1,0]
v_pk_fma_f32 v[102:103], v[238:239], v[144:145], v[102:103] op_sel_hi:[1,0,1] neg_lo:[0,1,0] neg_hi:[0,1,0]
v_pk_fma_f32 v[104:105], v[240:241], v[144:145], v[104:105] op_sel_hi:[1,0,1] neg_lo:[0,1,0] neg_hi:[0,1,0]
v_pk_fma_f32 v[106:107], v[242:243], v[144:145], v[106:107] op_sel_hi:[1,0,1] neg_lo:[0,1,0] neg_hi:[0,1,0]
v_pk_fma_f32 v[108:109], v[244:245], v[144:145], v[108:109] op_sel_hi:[1,0,1] neg_lo:[0,1,0] neg_hi:[0,1,0]
v_pk_fma_f32 v[110:111], v[246:247], v[144:145], v[110:111] op_sel_hi:[1,0,1] neg_lo:[0,1,0] neg_hi:[0,1,0]
v_pk_fma_f32 v[112:113], v[248:249], v[144:145], v[112:113] op_sel_hi:[1,0,1] neg_lo:[0,1,0] neg_hi:[0,1,0]
v_pk_fma_f32 v[114:115], v[250:251], v[144:145], v[114:115] op_sel_hi:[1,0,1] neg_lo:[0,1,0] neg_hi:[0,1,0]
v_pk_fma_f32 v[116:117], v[252:253], v[144:145], v[116:117] op_sel_hi:[1,0,1] neg_lo:[0,1,0] neg_hi:[0,1,0]
v_pk_fma_f32 v[118:119], v[254:255], v[144:145], v[118:119] op_sel_hi:[1,0,1] neg_lo:[0,1,0] neg_hi:[0,1,0]
s_mov_b32 s92, 102400
s_add_u32 m0, s94, 20480
s_nop 0
buffer_load_dwordx4 v26, s[64:67], s92 offen offset:0  lds
v_pk_mul_f32 v[96:97], v[96:97], v[146:147] op_sel_hi:[1,0]
v_pk_mul_f32 v[98:99], v[98:99], v[146:147] op_sel_hi:[1,0]
v_pk_mul_f32 v[100:101], v[100:101], v[146:147] op_sel_hi:[1,0]
v_pk_mul_f32 v[102:103], v[102:103], v[146:147] op_sel_hi:[1,0]
v_pk_mul_f32 v[104:105], v[104:105], v[146:147] op_sel_hi:[1,0]
v_pk_mul_f32 v[106:107], v[106:107], v[146:147] op_sel_hi:[1,0]
v_pk_mul_f32 v[108:109], v[108:109], v[146:147] op_sel_hi:[1,0]
v_pk_mul_f32 v[110:111], v[110:111], v[146:147] op_sel_hi:[1,0]
v_pk_mul_f32 v[112:113], v[112:113], v[146:147] op_sel_hi:[1,0]
v_pk_mul_f32 v[114:115], v[114:115], v[146:147] op_sel_hi:[1,0]
v_pk_mul_f32 v[116:117], v[116:117], v[146:147] op_sel_hi:[1,0]
v_pk_mul_f32 v[118:119], v[118:119], v[146:147] op_sel_hi:[1,0]
buffer_load_dwordx4 v26, s[64:67], s92 offen offset:1024  lds
v_pk_mul_f32 v[40:41], v[96:97], v[96:97]
v_pk_mul_f32 v[42:43], v[98:99], v[98:99]
v_pk_mul_f32 v[44:45], v[100:101], v[100:101]
v_pk_mul_f32 v[46:47], v[102:103], v[102:103]
v_pk_mul_f32 v[48:49], v[104:105], v[104:105]
v_pk_mul_f32 v[50:51], v[106:107], v[106:107]
v_pk_mul_f32 v[52:53], v[108:109], v[108:109]
v_pk_mul_f32 v[54:55], v[110:111], v[110:111]
v_pk_mul_f32 v[56:57], v[112:113], v[112:113]
v_pk_mul_f32 v[58:59], v[114:115], v[114:115]
v_pk_mul_f32 v[60:61], v[116:117], v[116:117]
v_pk_mul_f32 v[62:63], v[118:119], v[118:119]
buffer_load_dwordx4 v26, s[64:67], s92 offen offset:2048  lds
v_pk_fma_f32 v[40:41], v[40:41], s[24:25], v[28:29]
v_pk_fma_f32 v[42:43], v[42:43], s[24:25], v[28:29]
v_pk_fma_f32 v[44:45], v[44:45], s[24:25], v[28:29]
v_pk_fma_f32 v[46:47], v[46:47], s[24:25], v[28:29]
v_pk_fma_f32 v[48:49], v[48:49], s[24:25], v[28:29]
v_pk_fma_f32 v[50:51], v[50:51], s[24:25], v[28:29]
v_pk_fma_f32 v[52:53], v[52:53], s[24:25], v[28:29]
v_pk_fma_f32 v[54:55], v[54:55], s[24:25], v[28:29]
v_pk_fma_f32 v[56:57], v[56:57], s[24:25], v[28:29]
v_pk_fma_f32 v[58:59], v[58:59], s[24:25], v[28:29]
v_pk_fma_f32 v[60:61], v[60:61], s[24:25], v[28:29]
v_pk_fma_f32 v[62:63], v[62:63], s[24:25], v[28:29]
buffer_load_dwordx4 v26, s[64:67], s92 offen offset:3072  lds
v_pk_mul_f32 v[40:41], v[40:41], v[96:97]
v_pk_mul_f32 v[42:43], v[42:43], v[98:99]
v_pk_mul_f32 v[44:45], v[44:45], v[100:101]
v_pk_mul_f32 v[46:47], v[46:47], v[102:103]
v_pk_mul_f32 v[48:49], v[48:49], v[104:105]
v_pk_mul_f32 v[50:51], v[50:51], v[106:107]
v_pk_mul_f32 v[52:53], v[52:53], v[108:109]
v_pk_mul_f32 v[54:55], v[54:55], v[110:111]
v_pk_mul_f32 v[56:57], v[56:57], v[112:113]
v_pk_mul_f32 v[58:59], v[58:59], v[114:115]
v_pk_mul_f32 v[60:61], v[60:61], v[116:117]
v_pk_mul_f32 v[62:63], v[62:63], v[118:119]
s_add_u32 s92, s92, 4096
s_add_u32 m0, s94, 24576
s_nop 0
buffer_load_dwordx4 v26, s[64:67], s92 offen offset:0  lds
v_exp_f32 v40, v40
v_exp_f32 v41, v41
v_exp_f32 v42, v42
v_exp_f32 v43, v43
v_exp_f32 v44, v44
v_exp_f32 v45, v45
v_exp_f32 v46, v46
v_exp_f32 v47, v47
v_exp_f32 v48, v48
v_exp_f32 v49, v49
v_exp_f32 v50, v50
v_exp_f32 v51, v51
s_mov_b32 s92, 122880
s_add_u32 m0, s94, 40960
s_nop 0
buffer_load_dwordx4 v26, s[64:67], s92 offen offset:0  lds
v_exp_f32 v52, v52
v_exp_f32 v53, v53
v_exp_f32 v54, v54
v_exp_f32 v55, v55
v_exp_f32 v56, v56
v_exp_f32 v57, v57
v_exp_f32 v58, v58
v_exp_f32 v59, v59
v_exp_f32 v60, v60
v_exp_f32 v61, v61
v_exp_f32 v62, v62
v_exp_f32 v63, v63
buffer_load_dwordx4 v26, s[64:67], s92 offen offset:1024  lds
s_nop 0
v_pk_add_f32 v[40:41], v[40:41], 1.0 op_sel_hi:[1,0]
v_pk_add_f32 v[42:43], v[42:43], 1.0 op_sel_hi:[1,0]
v_pk_add_f32 v[44:45], v[44:45], 1.0 op_sel_hi:[1,0]
v_pk_add_f32 v[46:47], v[46:47], 1.0 op_sel_hi:[1,0]
v_pk_add_f32 v[48:49], v[48:49], 1.0 op_sel_hi:[1,0]
v_pk_add_f32 v[50:51], v[50:51], 1.0 op_sel_hi:[1,0]
v_pk_add_f32 v[52:53], v[52:53], 1.0 op_sel_hi:[1,0]
v_pk_add_f32 v[54:55], v[54:55], 1.0 op_sel_hi:[1,0]
v_pk_add_f32 v[56:57], v[56:57], 1.0 op_sel_hi:[1,0]
v_pk_add_f32 v[58:59], v[58:59], 1.0 op_sel_hi:[1,0]
v_pk_add_f32 v[60:61], v[60:61], 1.0 op_sel_hi:[1,0]
buffer_load_dwordx4 v26, s[64:67], s92 offen offset:2048  lds
v_pk_add_f32 v[62:63], v[62:63], 1.0 op_sel_hi:[1,0]
v_rcp_f32 v40, v40
v_rcp_f32 v41, v41
v_rcp_f32 v42, v42
v_rcp_f32 v43, v43
v_rcp_f32 v44, v44
v_rcp_f32 v45, v45
v_rcp_f32 v46, v46
v_rcp_f32 v47, v47
v_rcp_f32 v48, v48
v_rcp_f32 v49, v49
v_rcp_f32 v50, v50
buffer_load_dwordx4 v26, s[64:67], s92 offen offset:3072  lds
v_rcp_f32 v51, v51
v_rcp_f32 v52, v52
v_rcp_f32 v53, v53
v_rcp_f32 v54, v54
v_rcp_f32 v55, v55
v_rcp_f32 v56, v56
v_rcp_f32 v57, v57
v_rcp_f32 v58, v58
v_rcp_f32 v59, v59
v_rcp_f32 v60, v60
v_rcp_f32 v61, v61
v_rcp_f32 v62, v62
s_add_u32 s92, s92, 4096
s_add_u32 m0, s94, 45056
s_nop 0
buffer_load_dwordx4 v26, s[64:67], s92 offen offset:0  lds
v_rcp_f32 v63, v63
s_nop 0
v_pk_mul_f32 v[96:97], v[96:97], v[40:41]
v_pk_mul_f32 v[98:99], v[98:99], v[42:43]
v_pk_mul_f32 v[100:101], v[100:101], v[44:45]
v_pk_mul_f32 v[102:103], v[102:103], v[46:47]
v_pk_mul_f32 v[104:105], v[104:105], v[48:49]
v_pk_mul_f32 v[106:107], v[106:107], v[50:51]
v_pk_mul_f32 v[108:109], v[108:109], v[52:53]
v_pk_mul_f32 v[110:111], v[110:111], v[54:55]
v_pk_mul_f32 v[112:113], v[112:113], v[56:57]
v_pk_mul_f32 v[114:115], v[114:115], v[58:59]
v_pk_mul_f32 v[116:117], v[116:117], v[60:61]
v_pk_mul_f32 v[118:119], v[118:119], v[62:63]
v_cvt_pk_bf16_f32 v96, v96, v97
v_cvt_pk_bf16_f32 v97, v98, v99
v_cvt_pk_bf16_f32 v98, v100, v101
v_cvt_pk_bf16_f32 v99, v102, v103
v_cvt_pk_bf16_f32 v104, v104, v105
v_cvt_pk_bf16_f32 v105, v106, v107
v_cvt_pk_bf16_f32 v106, v108, v109
v_cvt_pk_bf16_f32 v107, v110, v111
v_cvt_pk_bf16_f32 v112, v112, v113
v_cvt_pk_bf16_f32 v113, v114, v115
v_cvt_pk_bf16_f32 v114, v116, v117
v_cvt_pk_bf16_f32 v115, v118, v119
s_cmp_eq_u32 s46, 0
s_cbranch_scc1 L_wt27
buffer_store_dwordx4 v[96:99], v12, s[76:79], s14 offen
buffer_store_dwordx4 v[104:107], v12, s[76:79], s15 offen
buffer_store_dwordx4 v[112:115], v12, s[76:79], s16 offen
L_wj27:
v_pk_fma_f32 v[120:121], v[232:233], v[148:149], v[120:121] op_sel_hi:[1,0,1] neg_lo:[0,1,0] neg_hi:[0,1,0]
v_pk_fma_f32 v[122:123], v[234:235], v[148:149], v[122:123] op_sel_hi:[1,0,1] neg_lo:[0,1,0] neg_hi:[0,1,0]
v_pk_fma_f32 v[124:125], v[236:237], v[148:149], v[124:125] op_sel_hi:[1,0,1] neg_lo:[0,1,0] neg_hi:[0,1,0]
v_pk_fma_f32 v[126:127], v[238:239], v[148:149], v[126:127] op_sel_hi:[1,0,1] neg_lo:[0,1,0] neg_hi:[0,1,0]
v_pk_fma_f32 v[128:129], v[240:241], v[148:149], v[128:129] op_sel_hi:[1,0,1] neg_lo:[0,1,0] neg_hi:[0,1,0]
v_pk_fma_f32 v[130:131], v[242:243], v[148:149], v[130:131] op_sel_hi:[1,0,1] neg_lo:[0,1,0] neg_hi:[0,1,0]
v_pk_fma_f32 v[132:133], v[244:245], v[148:149], v[132:133] op_sel_hi:[1,0,1] neg_lo:[0,1,0] neg_hi:[0,1,0]
v_pk_fma_f32 v[134:135], v[246:247], v[148:149], v[134:135] op_sel_hi:[1,0,1] neg_lo:[0,1,0] neg_hi:[0,1,0]
v_pk_fma_f32 v[136:137], v[248:249], v[148:149], v[136:137] op_sel_hi:[1,0,1] neg_lo:[0,1,0] neg_hi:[0,1,0]
v_pk_fma_f32 v[138:139], v[250:251], v[148:149], v[138:139] op_sel_hi:[1,0,1] neg_lo:[0,1,0] neg_hi:[0,1,0]
v_pk_fma_f32 v[140:141], v[252:253], v[148:149], v[140:141] op_sel_hi:[1,0,1] neg_lo:[0,1,0] neg_hi:[0,1,0]
v_pk_fma_f32 v[142:143], v[254:255], v[148:149], v[142:143] op_sel_hi:[1,0,1] neg_lo:[0,1,0] neg_hi:[0,1,0]
v_pk_mul_f32 v[120:121], v[120:121], v[150:151] op_sel_hi:[1,0]
v_pk_mul_f32 v[122:123], v[122:123], v[150:151] op_sel_hi:[1,0]
v_pk_mul_f32 v[124:125], v[124:125], v[150:151] op_sel_hi:[1,0]
v_pk_mul_f32 v[126:127], v[126:127], v[150:151] op_sel_hi:[1,0]
v_pk_mul_f32 v[128:129], v[128:129], v[150:151] op_sel_hi:[1,0]
v_pk_mul_f32 v[130:131], v[130:131], v[150:151] op_sel_hi:[1,0]
v_pk_mul_f32 v[132:133], v[132:133], v[150:151] op_sel_hi:[1,0]
v_pk_mul_f32 v[134:135], v[134:135], v[150:151] op_sel_hi:[1,0]
v_pk_mul_f32 v[136:137], v[136:137], v[150:151] op_sel_hi:[1,0]
v_pk_mul_f32 v[138:139], v[138:139], v[150:151] op_sel_hi:[1,0]
v_pk_mul_f32 v[140:141], v[140:141], v[150:151] op_sel_hi:[1,0]
v_pk_mul_f32 v[142:143], v[142:143], v[150:151] op_sel_hi:[1,0]
v_pk_mul_f32 v[40:41], v[120:121], v[120:121]
v_pk_mul_f32 v[42:43], v[122:123], v[122:123]
v_pk_mul_f32 v[44:45], v[124:125], v[124:125]
v_pk_mul_f32 v[46:47], v[126:127], v[126:127]
v_pk_mul_f32 v[48:49], v[128:129], v[128:129]
v_pk_mul_f32 v[50:51], v[130:131], v[130:131]
v_pk_mul_f32 v[52:53], v[132:133], v[132:133]
v_pk_mul_f32 v[54:55], v[134:135], v[134:135]
v_pk_mul_f32 v[56:57], v[136:137], v[136:137]
v_pk_mul_f32 v[58:59], v[138:139], v[138:139]
v_pk_mul_f32 v[60:61], v[140:141], v[140:141]
v_pk_mul_f32 v[62:63], v[142:143], v[142:143]
v_pk_fma_f32 v[40:41], v[40:41], s[24:25], v[28:29]
v_pk_fma_f32 v[42:43], v[42:43], s[24:25], v[28:29]
v_pk_fma_f32 v[44:45], v[44:45], s[24:25], v[28:29]
v_pk_fma_f32 v[46:47], v[46:47], s[24:25], v[28:29]
v_pk_fma_f32 v[48:49], v[48:49], s[24:25], v[28:29]
v_pk_fma_f32 v[50:51], v[50:51], s[24:25], v[28:29]
v_pk_fma_f32 v[52:53], v[52:53], s[24:25], v[28:29]
v_pk_fma_f32 v[54:55], v[54:55], s[24:25], v[28:29]
v_pk_fma_f32 v[56:57], v[56:57], s[24:25], v[28:29]
v_pk_fma_f32 v[58:59], v[58:59], s[24:25], v[28:29]
v_pk_fma_f32 v[60:61], v[60:61], s[24:25], v[28:29]
v_pk_fma_f32 v[62:63], v[62:63], s[24:25], v[28:29]
v_pk_mul_f32 v[40:41], v[40:41], v[120:121]
v_pk_mul_f32 v[42:43], v[42:43], v[122:123]
v_pk_mul_f32 v[44:45], v[44:45], v[124:125]
v_pk_mul_f32 v[46:47], v[46:47], v[126:127]
v_pk_mul_f32 v[48:49], v[48:49], v[128:129]
v_pk_mul_f32 v[50:51], v[50:51], v[130:131]
v_pk_mul_f32 v[52:53], v[52:53], v[132:133]
v_pk_mul_f32 v[54:55], v[54:55], v[134:135]
v_pk_mul_f32 v[56:57], v[56:57], v[136:137]
v_pk_mul_f32 v[58:59], v[58:59], v[138:139]
v_pk_mul_f32 v[60:61], v[60:61], v[140:141]
v_pk_mul_f32 v[62:63], v[62:63], v[142:143]
v_exp_f32 v40, v40
v_exp_f32 v41, v41
v_exp_f32 v42, v42
v_exp_f32 v43, v43
v_exp_f32 v44, v44
v_exp_f32 v45, v45
v_exp_f32 v46, v46
v_exp_f32 v47, v47
v_exp_f32 v48, v48
v_exp_f32 v49, v49
v_exp_f32 v50, v50
v_exp_f32 v51, v51
v_exp_f32 v52, v52
v_exp_f32 v53, v53
v_exp_f32 v54, v54
v_exp_f32 v55, v55
v_exp_f32 v56, v56
v_exp_f32 v57, v57
v_exp_f32 v58, v58
v_exp_f32 v59, v59
v_exp_f32 v60, v60
v_exp_f32 v61, v61
v_exp_f32 v62, v62
v_exp_f32 v63, v63
s_nop 0
v_pk_add_f32 v[40:41], v[40:41], 1.0 op_sel_hi:[1,0]
v_pk_add_f32 v[42:43], v[42:43], 1.0 op_sel_hi:[1,0]
v_pk_add_f32 v[44:45], v[44:45], 1.0 op_sel_hi:[1,0]
v_pk_add_f32 v[46:47], v[46:47], 1.0 op_sel_hi:[1,0]
v_pk_add_f32 v[48:49], v[48:49], 1.0 op_sel_hi:[1,0]
v_pk_add_f32 v[50:51], v[50:51], 1.0 op_sel_hi:[1,0]
v_pk_add_f32 v[52:53], v[52:53], 1.0 op_sel_hi:[1,0]
v_pk_add_f32 v[54:55], v[54:55], 1.0 op_sel_hi:[1,0]
v_pk_add_f32 v[56:57], v[56:57], 1.0 op_sel_hi:[1,0]
v_pk_add_f32 v[58:59], v[58:59], 1.0 op_sel_hi:[1,0]
v_pk_add_f32 v[60:61], v[60:61], 1.0 op_sel_hi:[1,0]
v_pk_add_f32 v[62:63], v[62:63], 1.0 op_sel_hi:[1,0]
v_rcp_f32 v40, v40
v_rcp_f32 v41, v41
v_rcp_f32 v42, v42
v_rcp_f32 v43, v43
v_rcp_f32 v44, v44
v_rcp_f32 v45, v45
v_rcp_f32 v46, v46
v_rcp_f32 v47, v47
v_rcp_f32 v48, v48
v_rcp_f32 v49, v49
v_rcp_f32 v50, v50
v_rcp_f32 v51, v51
v_rcp_f32 v52, v52
v_rcp_f32 v53, v53
v_rcp_f32 v54, v54
v_rcp_f32 v55, v55
v_rcp_f32 v56, v56
v_rcp_f32 v57, v57
v_rcp_f32 v58, v58
v_rcp_f32 v59, v59
v_rcp_f32 v60, v60
v_rcp_f32 v61, v61
v_rcp_f32 v62, v62
v_rcp_f32 v63, v63
s_nop 0
v_pk_mul_f32 v[120:121], v[120:121], v[40:41]
v_pk_mul_f32 v[122:123], v[122:123], v[42:43]
v_pk_mul_f32 v[124:125], v[124:125], v[44:45]
v_pk_mul_f32 v[126:127], v[126:127], v[46:47]
v_pk_mul_f32 v[128:129], v[128:129], v[48:49]
v_pk_mul_f32 v[130:131], v[130:131], v[50:51]
v_pk_mul_f32 v[132:133], v[132:133], v[52:53]
v_pk_mul_f32 v[134:135], v[134:135], v[54:55]
v_pk_mul_f32 v[136:137], v[136:137], v[56:57]
v_pk_mul_f32 v[138:139], v[138:139], v[58:59]
v_pk_mul_f32 v[140:141], v[140:141], v[60:61]
v_pk_mul_f32 v[142:143], v[142:143], v[62:63]
v_cvt_pk_bf16_f32 v120, v120, v121
v_cvt_pk_bf16_f32 v121, v122, v123
v_cvt_pk_bf16_f32 v122, v124, v125
v_cvt_pk_bf16_f32 v123, v126, v127
v_cvt_pk_bf16_f32 v128, v128, v129
v_cvt_pk_bf16_f32 v129, v130, v131
v_cvt_pk_bf16_f32 v130, v132, v133
v_cvt_pk_bf16_f32 v131, v134, v135
v_cvt_pk_bf16_f32 v136, v136, v137
v_cvt_pk_bf16_f32 v137, v138, v139
v_cvt_pk_bf16_f32 v138, v140, v141
v_cvt_pk_bf16_f32 v139, v142, v143
s_cmp_eq_u32 s46, 0
s_cbranch_scc1 L_wt28
buffer_store_dwordx4 v[120:123], v13, s[76:79], s14 offen
buffer_store_dwordx4 v[128:131], v13, s[76:79], s15 offen
buffer_store_dwordx4 v[136:139], v13, s[76:79], s16 offen
L_wj28:
s_load_dwordx2 s[76:77], s[0:1], 96
s_lshr_b32 s6, s2, 3
s_and_b32 s10, s6, 7
s_lshr_b32 s6, s6, 3
s_lshl_b32 s9, s8, 2
s_add_u32 s9, s9, s6
s_lshl_b32 s11, s9, 2
s_add_u32 s11, s11, s28
v_add_u32 v5, 0, v11
v_add_u32 v7, 65536, v11
v_add_u32 v9, 131072, v11
v_add_u32 v12, 0, v11
s_mul_i32 s3, s11, 20480
s_add_u32 s3, s3, 44040192
s_add_u32 s72, s4, s3
s_addc_u32 s73, s5, 0
s_mov_b32 s74, 5259264
s_mov_b32 s75, 0x20000
v_and_b32 v18, 15, v0
v_lshlrev_b32 v18, 2, v18
v_and_b32 v32, 15, v0
v_mul_u32_u24 v32, 1280, v32
v_lshrrev_b32 v33, 4, v0
v_lshl_add_u32 v17, v33, 3, v32
v_lshl_add_u32 v16, v33, 4, v32
s_mul_i32 s12, s11, 20480
s_mul_i32 s3, s10, 160
s_add_u32 s12, s12, s3
s_and_b32 s3, s10, 1
s_lshl_b32 s6, s3, 7
s_sub_u32 s13, s12, s6
s_add_u32 s13, s13, 128
s_lshl_b32 s3, s3, 5
s_add_u32 s12, s12, s3
s_lshr_b32 s95, s11, 1
s_lshl_b32 s95, s95, 7
s_add_u32 s95, s95, 196608
s_waitcnt lgkmcnt(0)
s_mov_b32 s78, 2621440
s_mov_b32 s79, 0x20000
s_waitcnt vmcnt(0)
s_mov_b64 exec, 1
s_cmp_eq_u32 s46, 0
s_cbranch_scc1 L_wt29
buffer_store_dword v31, off, s[68:71], s17
L_wj29:
s_mov_b64 exec, -1
buffer_load_dword v19, v18, s[68:71], s95 offen sc1
s_mov_b32 s101, 0x200000
s_waitcnt vmcnt(0)
L_poll30:
v_cmp_gt_u32 vcc, 1, v19
s_cbranch_vccz L_go30
s_sub_u32 s101, s101, 1
s_cmp_eq_u32 s101, 0
s_cbranch_scc1 L_go30
buffer_load_dword v19, v18, s[68:71], s95 offen sc1
s_waitcnt vmcnt(0)
s_branch L_poll30
L_go30:
s_mov_b32 s93, 0
buffer_load_dwordx4 a[0:3], v12, s[72:75], s93 offen offset:0 sc1
buffer_load_dwordx4 a[4:7], v12, s[72:75], s93 offen offset:1024 sc1
buffer_load_dwordx4 a[8:11], v12, s[72:75], s93 offen offset:2048 sc1
buffer_load_dwordx4 a[12:15], v12, s[72:75], s93 offen offset:3072 sc1
s_mov_b32 s93, 4096
buffer_load_dwordx4 a[16:19], v12, s[72:75], s93 offen offset:0 sc1
buffer_load_dwordx4 a[20:23], v12, s[72:75], s93 offen offset:1024 sc1
buffer_load_dwordx4 a[24:27], v12, s[72:75], s93 offen offset:2048 sc1
buffer_load_dwordx4 a[28:31], v12, s[72:75], s93 offen offset:3072 sc1
s_barrier
ds_read_b128 v[64:67], v7 offset:8192
ds_read_b128 v[68:71], v7 offset:13312
ds_read_b128 v[72:75], v7 offset:9216
ds_read_b128 v[76:79], v7 offset:14336
ds_read_b128 v[80:83], v7 offset:10240
ds_read_b128 v[84:87], v7 offset:15360
ds_read_b128 v[88:91], v7 offset:11264
ds_read_b128 v[92:95], v7 offset:16384
ds_read_b128 v[96:99], v7 offset:12288
ds_read_b128 v[100:103], v7 offset:17408
ds_read_b128 v[104:107], v7 offset:18432
ds_read_b128 v[108:111], v7 offset:23552
s_waitcnt vmcnt(6) lgkmcnt(10)
v_mfma_f32_16x16x32_bf16 v[112:115], v[64:67], a[0:3], 0
v_mfma_f32_16x16x32_bf16 v[112:115], v[68:71], a[4:7], v[112:115]
s_waitcnt lgkmcnt(8)
ds_read_b128 v[64:67], v7 offset:19456
v_mfma_f32_16x16x32_bf16 v[116:119], v[72:75], a[0:3], 0
s_mov_b32 s93, 8192
buffer_load_dwordx4 a[32:35], v12, s[72:75], s93 offen offset:0 sc1
v_mfma_f32_16x16x32_bf16 v[116:119], v[76:79], a[4:7], v[116:119]
s_waitcnt lgkmcnt(7)
ds_read_b128 v[68:71], v7 offset:24576
v_mfma_f32_16x16x32_bf16 v[120:123], v[80:83], a[0:3], 0
buffer_load_dwordx4 a[36:39], v12, s[72:75], s93 offen offset:1024 sc1
v_mfma_f32_16x16x32_bf16 v[120:123], v[84:87], a[4:7], v[120:123]
s_waitcnt lgkmcnt(6)
ds_read_b128 v[72:75], v7 offset:20480
v_mfma_f32_16x16x32_bf16 v[124:127], v[88:91], a[0:3], 0
ds_read_b128 v[76:79], v7 offset:25600
v_mfma_f32_16x16x32_bf16 v[124:127], v[92:95], a[4:7], v[124:127]
s_waitcnt lgkmcnt(6)
ds_read_b128 v[80:83], v7 offset:21504
v_mfma_f32_16x16x32_bf16 v[128:131], v[96:99], a[0:3], 0
buffer_load_dwordx4 a[40:43], v12, s[72:75], s93 offen offset:2048 sc1
v_mfma_f32_16x16x32_bf16 v[128:131], v[100:103], a[4:7], v[128:131]
s_waitcnt vmcnt(7) lgkmcnt(5)
ds_read_b128 v[84:87], v7 offset:26624
v_mfma_f32_16x16x32_bf16 v[112:115], v[104:107], a[8:11], v[112:115]
ds_read_b128 v[88:91], v7 offset:22528
v_mfma_f32_16x16x32_bf16 v[112:115], v[108:111], a[12:15], v[112:115]
s_waitcnt lgkmcnt(5)
ds_read_b128 v[92:95], v7 offset:27648
buffer_load_dwordx4 a[44:47], v12, s[72:75], s93 offen offset:3072 sc1
v_mfma_f32_16x16x32_bf16 v[116:119], v[64:67], a[8:11], v[116:119]
ds_read_b128 v[96:99], v7 offset:28672
v_mfma_f32_16x16x32_bf16 v[116:119], v[68:71], a[12:15], v[116:119]
s_waitcnt lgkmcnt(5)
ds_read_b128 v[100:103], v7 offset:33792
v_mfma_f32_16x16x32_bf16 v[120:123], v[72:75], a[8:11], v[120:123]
s_mov_b32 s93, 12288
buffer_load_dwordx4 a[48:51], v12, s[72:75], s93 offen offset:0 sc1
v_mfma_f32_16x16x32_bf16 v[120:123], v[76:79], a[12:15], v[120:123]
s_waitcnt lgkmcnt(4)
ds_read_b128 v[104:107], v7 offset:29696
ds_read_b128 v[108:111], v7 offset:34816
v_mfma_f32_16x16x32_bf16 v[124:127], v[80:83], a[8:11], v[124:127]
ds_read_b128 v[64:67], v7 offset:30720
v_mfma_f32_16x16x32_bf16 v[124:127], v[84:87], a[12:15], v[124:127]
s_waitcnt lgkmcnt(5)
ds_read_b128 v[68:71], v7 offset:35840
buffer_load_dwordx4 a[52:55], v12, s[72:75], s93 offen offset:1024 sc1
v_mfma_f32_16x16x32_bf16 v[128:131], v[88:91], a[8:11], v[128:131]
ds_read_b128 v[72:75], v7 offset:31744
v_mfma_f32_16x16x32_bf16 v[128:131], v[92:95], a[12:15], v[128:131]
s_waitcnt vmcnt(8) lgkmcnt(5)
ds_read_b128 v[76:79], v7 offset:36864
v_mfma_f32_16x16x32_bf16 v[112:115], v[96:99], a[16:19], v[112:115]
buffer_load_dwordx4 a[56:59], v12, s[72:75], s93 offen offset:2048 sc1
v_mfma_f32_16x16x32_bf16 v[112:115], v[100:103], a[20:23], v[112:115]
s_waitcnt lgkmcnt(4)
ds_read_b128 v[80:83], v7 offset:32768
ds_read_b128 v[84:87], v7 offset:37888
v_mfma_f32_16x16x32_bf16 v[116:119], v[104:107], a[16:19], v[116:119]
ds_read_b128 v[88:91], v7 offset:38912
v_mfma_f32_16x16x32_bf16 v[116:119], v[108:111], a[20:23], v[116:119]
s_waitcnt lgkmcnt(5)
ds_read_b128 v[92:95], v7 offset:44032
buffer_load_dwordx4 a[60:63], v12, s[72:75], s93 offen offset:3072 sc1
v_mfma_f32_16x16x32_bf16 v[120:123], v[64:67], a[16:19], v[120:123]
ds_read_b128 v[96:99], v7 offset:39936
v_mfma_f32_16x16x32_bf16 v[120:123], v[68:71], a[20:23], v[120:123]
s_waitcnt lgkmcnt(5)
ds_read_b128 v[100:103], v7 offset:45056
v_mfma_f32_16x16x32_bf16 v[124:127], v[72:75], a[16:19], v[124:127]
s_mov_b32 s93, 2621440
buffer_load_dwordx4 a[64:67], v12, s[72:75], s93 offen offset:0 sc1
v_mfma_f32_16x16x32_bf16 v[124:127], v[76:79], a[20:23], v[124:127]
s_waitcnt lgkmcnt(4)
ds_read_b128 v[104:107], v7 offset:40960
ds_read_b128 v[108:111], v7 offset:46080
v_mfma_f32_16x16x32_bf16 v[128:131], v[80:83], a[16:19], v[128:131]
ds_read_b128 v[64:67], v7 offset:41984
v_mfma_f32_16x16x32_bf16 v[128:131], v[84:87], a[20:23], v[128:131]
s_waitcnt vmcnt(9) lgkmcnt(5)
ds_read_b128 v[68:71], v7 offset:47104
ds_read_b128 v[72:75], v7 offset:43008
ds_read_b128 v[76:79], v7 offset:48128
s_barrier
buffer_load_dwordx4 a[68:71], v12, s[72:75], s93 offen offset:1024 sc1
v_mfma_f32_16x16x32_bf16 v[112:115], v[88:91], a[24:27], v[112:115]
ds_read_b128 v[80:83], v7 offset:49152
v_mfma_f32_16x16x32_bf16 v[112:115], v[92:95], a[28:31], v[112:115]
s_waitcnt lgkmcnt(7)
ds_read_b128 v[84:87], v7 offset:54272
v_mfma_f32_16x16x32_bf16 v[116:119], v[96:99], a[24:27], v[116:119]
buffer_load_dwordx4 a[72:75], v12, s[72:75], s93 offen offset:2048 sc1
v_mfma_f32_16x16x32_bf16 v[116:119], v[100:103], a[28:31], v[116:119]
s_waitcnt lgkmcnt(6)
ds_read_b128 v[88:91], v7 offset:50176
v_mfma_f32_16x16x32_bf16 v[120:123], v[104:107], a[24:27], v[120:123]
buffer_load_dwordx4 a[76:79], v12, s[72:75], s93 offen offset:3072 sc1
v_mfma_f32_16x16x32_bf16 v[120:123], v[108:111], a[28:31], v[120:123]
s_waitcnt lgkmcnt(5)
ds_read_b128 v[92:95], v7 offset:55296
v_mfma_f32_16x16x32_bf16 v[124:127], v[64:67], a[24:27], v[124:127]
ds_read_b128 v[96:99], v7 offset:51200
v_mfma_f32_16x16x32_bf16 v[124:127], v[68:71], a[28:31], v[124:127]
s_waitcnt lgkmcnt(5)
ds_read_b128 v[100:103], v7 offset:56320
v_mfma_f32_16x16x32_bf16 v[128:131], v[72:75], a[24:27], v[128:131]
s_mov_b32 s93, 2625536
buffer_load_dwordx4 a[80:83], v12, s[72:75], s93 offen offset:0 sc1
v_mfma_f32_16x16x32_bf16 v[128:131], v[76:79], a[28:31], v[128:131]
s_waitcnt vmcnt(11) lgkmcnt(4)
ds_read_b128 v[104:107], v7 offset:52224
ds_read_b128 v[108:111], v7 offset:57344
v_mfma_f32_16x16x32_bf16 v[112:115], v[80:83], a[32:35], v[112:115]
ds_read_b128 v[64:67], v7 offset:53248
v_mfma_f32_16x16x32_bf16 v[112:115], v[84:87], a[36:39], v[112:115]
s_waitcnt lgkmcnt(5)
ds_read_b128 v[68:71], v7 offset:58368
buffer_load_dwordx4 a[84:87], v12, s[72:75], s93 offen offset:1024 sc1
v_mfma_f32_16x16x32_bf16 v[116:119], v[88:91], a[32:35], v[116:119]
ds_read_b128 v[72:75], v7 offset:59392
v_mfma_f32_16x16x32_bf16 v[116:119], v[92:95], a[36:39], v[116:119]
s_waitcnt lgkmcnt(5)
ds_read_b128 v[76:79], v7 offset:64512
v_mfma_f32_16x16x32_bf16 v[120:123], v[96:99], a[32:35], v[120:123]
buffer_load_dwordx4 a[88:91], v12, s[72:75], s93 offen offset:2048 sc1
v_mfma_f32_16x16x32_bf16 v[120:123], v[100:103], a[36:39], v[120:123]
s_waitcnt lgkmcnt(4)
ds_read_b128 v[80:83], v7 offset:60416
ds_read_b128 v[84:87], v9 offset:0
v_mfma_f32_16x16x32_bf16 v[124:127], v[104:107], a[32:35], v[124:127]
ds_read_b128 v[88:91], v7 offset:61440
v_mfma_f32_16x16x32_bf16 v[124:127], v[108:111], a[36:39], v[124:127]
s_waitcnt lgkmcnt(5)
ds_read_b128 v[92:95], v9 offset:1024
buffer_load_dwordx4 a[92:95], v12, s[72:75], s93 offen offset:3072 sc1
v_mfma_f32_16x16x32_bf16 v[128:131], v[64:67], a[32:35], v[128:131]
ds_read_b128 v[96:99], v7 offset:62464
v_mfma_f32_16x16x32_bf16 v[128:131], v[68:71], a[36:39], v[128:131]
s_waitcnt vmcnt(12) lgkmcnt(5)
ds_read_b128 v[100:103], v9 offset:2048
v_mfma_f32_16x16x32_bf16 v[112:115], v[72:75], a[40:43], v[112:115]
s_mov_b32 s93, 2629632
buffer_load_dwordx4 a[96:99], v12, s[72:75], s93 offen offset:0 sc1
v_mfma_f32_16x16x32_bf16 v[112:115], v[76:79], a[44:47], v[112:115]
s_waitcnt lgkmcnt(4)
ds_read_b128 v[104:107], v7 offset:63488
ds_read_b128 v[108:111], v9 offset:3072
v_mfma_f32_16x16x32_bf16 v[116:119], v[80:83], a[40:43], v[116:119]
ds_read_b128 v[64:67], v9 offset:4096
v_mfma_f32_16x16x32_bf16 v[116:119], v[84:87], a[44:47], v[116:119]
s_waitcnt lgkmcnt(5)
ds_read_b128 v[68:71], v9 offset:9216
buffer_load_dwordx4 a[100:103], v12, s[72:75], s93 offen offset:1024 sc1
v_mfma_f32_16x16x32_bf16 v[120:123], v[88:91], a[40:43], v[120:123]
ds_read_b128 v[72:75], v9 offset:5120
v_mfma_f32_16x16x32_bf16 v[120:123], v[92:95], a[44:47], v[120:123]
s_waitcnt lgkmcnt(5)
ds_read_b128 v[76:79], v9 offset:10240
v_mfma_f32_16x16x32_bf16 v[124:127], v[96:99], a[40:43], v[124:127]
buffer_load_dwordx4 a[104:107], v12, s[72:75], s93 offen offset:2048 sc1
v_mfma_f32_16x16x32_bf16 v[124:127], v[100:103], a[44:47], v[124:127]
s_waitcnt lgkmcnt(4)
ds_read_b128 v[80:83], v9 offset:6144
ds_read_b128 v[84:87], v9 offset:11264
v_mfma_f32_16x16x32_bf16 v[128:131], v[104:107], a[40:43], v[128:131]
ds_read_b128 v[88:91], v9 offset:7168
v_mfma_f32_16x16x32_bf16 v[128:131], v[108:111], a[44:47], v[128:131]
s_waitcnt vmcnt(13) lgkmcnt(5)
ds_read_b128 v[92:95], v9 offset:12288
buffer_load_dwordx4 a[108:111], v12, s[72:75], s93 offen offset:3072 sc1
v_mfma_f32_16x16x32_bf16 v[112:115], v[64:67], a[48:51], v[112:115]
ds_read_b128 v[96:99], v9 offset:8192
v_mfma_f32_16x16x32_bf16 v[112:115], v[68:71], a[52:55], v[112:115]
s_waitcnt lgkmcnt(5)
ds_read_b128 v[100:103], v9 offset:13312
s_mov_b32 s92, 143360
s_add_u32 m0, s94, 61440
v_mfma_f32_16x16x32_bf16 v[116:119], v[72:75], a[48:51], v[116:119]
buffer_load_dwordx4 v26, s[64:67], s92 offen offset:0  lds
v_mfma_f32_16x16x32_bf16 v[116:119], v[76:79], a[52:55], v[116:119]
s_waitcnt lgkmcnt(4)
ds_read_b128 v[104:107], v9 offset:14336
ds_read_b128 v[108:111], v9 offset:19456
v_mfma_f32_16x16x32_bf16 v[120:123], v[80:83], a[48:51], v[120:123]
ds_read_b128 v[64:67], v9 offset:15360
v_mfma_f32_16x16x32_bf16 v[120:123], v[84:87], a[52:55], v[120:123]
s_waitcnt lgkmcnt(5)
ds_read_b128 v[68:71], v9 offset:20480
buffer_load_dwordx4 v26, s[64:67], s92 offen offset:1024  lds
v_mfma_f32_16x16x32_bf16 v[124:127], v[88:91], a[48:51], v[124:127]
ds_read_b128 v[72:75], v9 offset:16384
v_mfma_f32_16x16x32_bf16 v[124:127], v[92:95], a[52:55], v[124:127]
s_waitcnt lgkmcnt(5)
ds_read_b128 v[76:79], v9 offset:21504
v_mfma_f32_16x16x32_bf16 v[128:131], v[96:99], a[48:51], v[128:131]
buffer_load_dwordx4 v26, s[64:67], s92 offen offset:2048  lds
v_mfma_f32_16x16x32_bf16 v[128:131], v[100:103], a[52:55], v[128:131]
s_waitcnt vmcnt(15) lgkmcnt(4)
ds_read_b128 v[80:83], v9 offset:17408
ds_read_b128 v[84:87], v9 offset:22528
ds_read_b128 v[88:91], v9 offset:18432
ds_read_b128 v[92:95], v9 offset:23552
s_barrier
v_mfma_f32_16x16x32_bf16 v[112:115], v[104:107], a[56:59], v[112:115]
buffer_load_dwordx4 v26, s[64:67], s92 offen offset:3072  lds
v_mfma_f32_16x16x32_bf16 v[112:115], v[108:111], a[60:63], v[112:115]
s_waitcnt lgkmcnt(6)
ds_read_b128 v[96:99], v5 offset:0
v_mfma_f32_16x16x32_bf16 v[116:119], v[64:67], a[56:59], v[116:119]
ds_read_b128 v[100:103], v5 offset:5120
v_mfma_f32_16x16x32_bf16 v[116:119], v[68:71], a[60:63], v[116:119]
s_waitcnt lgkmcnt(6)
ds_read_b128 v[104:107], v5 offset:1024
s_add_u32 s92, s92, 4096
s_add_u32 m0, s94, 65536
v_mfma_f32_16x16x32_bf16 v[120:123], v[72:75], a[56:59], v[120:123]
buffer_load_dwordx4 v26, s[64:67], s92 offen offset:0  lds
v_mfma_f32_16x16x32_bf16 v[120:123], v[76:79], a[60:63], v[120:123]
s_waitcnt lgkmcnt(5)
ds_read_b128 v[108:111], v5 offset:6144
v_mfma_f32_16x16x32_bf16 v[124:127], v[80:83], a[56:59], v[124:127]
ds_read_b128 v[64:67], v5 offset:2048
s_mov_b32 s92, 163840
s_add_u32 m0, s94, 81920
v_mfma_f32_16x16x32_bf16 v[124:127], v[84:87], a[60:63], v[124:127]
s_waitcnt lgkmcnt(5)
ds_read_b128 v[68:71], v5 offset:7168
buffer_load_dwordx4 v26, s[64:67], s92 offen offset:0  lds
v_mfma_f32_16x16x32_bf16 v[128:131], v[88:91], a[56:59], v[128:131]
ds_read_b128 v[72:75], v5 offset:3072
v_mfma_f32_16x16x32_bf16 v[128:131], v[92:95], a[60:63], v[128:131]
s_waitcnt vmcnt(16) lgkmcnt(5)
ds_read_b128 v[76:79], v5 offset:8192
v_mfma_f32_16x16x32_bf16 v[112:115], v[96:99], a[64:67], v[112:115]
buffer_load_dwordx4 v26, s[64:67], s92 offen offset:1024  lds
v_mfma_f32_16x16x32_bf16 v[112:115], v[100:103], a[68:71], v[112:115]
s_waitcnt lgkmcnt(4)
ds_read_b128 v[80:83], v5 offset:4096
ds_read_b128 v[84:87], v5 offset:9216
v_mfma_f32_16x16x32_bf16 v[116:119], v[104:107], a[64:67], v[116:119]
ds_read_b128 v[88:91], v5 offset:10240
v_mfma_f32_16x16x32_bf16 v[116:119], v[108:111], a[68:71], v[116:119]
s_waitcnt lgkmcnt(5)
ds_read_b128 v[92:95], v5 offset:15360
buffer_load_dwordx4 v26, s[64:67], s92 offen offset:2048  lds
v_mfma_f32_16x16x32_bf16 v[120:123], v[64:67], a[64:67], v[120:123]
ds_read_b128 v[96:99], v5 offset:11264
v_mfma_f32_16x16x32_bf16 v[120:123], v[68:71], a[68:71], v[120:123]
s_waitcnt lgkmcnt(5)
ds_read_b128 v[100:103], v5 offset:16384
v_mfma_f32_16x16x32_bf16 v[124:127], v[72:75], a[64:67], v[124:127]
buffer_load_dwordx4 v26, s[64:67], s92 offen offset:3072  lds
v_mfma_f32_16x16x32_bf16 v[124:127], v[76:79], a[68:71], v[124:127]
s_waitcnt lgkmcnt(4)
ds_read_b128 v[104:107], v5 offset:12288
ds_read_b128 v[108:111], v5 offset:17408
v_mfma_f32_16x16x32_bf16 v[128:131], v[80:83], a[64:67], v[128:131]
ds_read_b128 v[64:67], v5 offset:13312
s_add_u32 s92, s92, 4096
s_add_u32 m0, s94, 86016
v_mfma_f32_16x16x32_bf16 v[128:131], v[84:87], a[68:71], v[128:131]
s_waitcnt vmcnt(17) lgkmcnt(5)
ds_read_b128 v[68:71], v5 offset:18432
buffer_load_dwordx4 v26, s[64:67], s92 offen offset:0  lds
v_mfma_f32_16x16x32_bf16 v[112:115], v[88:91], a[72:75], v[112:115]
ds_read_b128 v[72:75], v5 offset:14336
v_mfma_f32_16x16x32_bf16 v[112:115], v[92:95], a[76:79], v[112:115]
s_waitcnt lgkmcnt(5)
ds_read_b128 v[76:79], v5 offset:19456
v_mfma_f32_16x16x32_bf16 v[116:119], v[96:99], a[72:75], v[116:119]
s_mov_b32 s93, 2633728
buffer_load_dwordx4 a[112:115], v12, s[72:75], s93 offen offset:0 sc1
v_mfma_f32_16x16x32_bf16 v[116:119], v[100:103], a[76:79], v[116:119]
s_waitcnt lgkmcnt(4)
ds_read_b128 v[80:83], v5 offset:20480
ds_read_b128 v[84:87], v5 offset:25600
v_mfma_f32_16x16x32_bf16 v[120:123], v[104:107], a[72:75], v[120:123]
ds_read_b128 v[88:91], v5 offset:21504
v_mfma_f32_16x16x32_bf16 v[120:123], v[108:111], a[76:79], v[120:123]
s_waitcnt lgkmcnt(5)
ds_read_b128 v[92:95], v5 offset:26624
buffer_load_dwordx4 a[116:119], v12, s[72:75], s93 offen offset:1024 sc1
v_mfma_f32_16x16x32_bf16 v[124:127], v[64:67], a[72:75], v[124:127]
ds_read_b128 v[96:99], v5 offset:22528
v_mfma_f32_16x16x32_bf16 v[124:127], v[68:71], a[76:79], v[124:127]
s_waitcnt lgkmcnt(5)
ds_read_b128 v[100:103], v5 offset:27648
v_mfma_f32_16x16x32_bf16 v[128:131], v[72:75], a[72:75], v[128:131]
buffer_load_dwordx4 a[120:123], v12, s[72:75], s93 offen offset:2048 sc1
v_mfma_f32_16x16x32_bf16 v[128:131], v[76:79], a[76:79], v[128:131]
s_waitcnt vmcnt(19) lgkmcnt(4)
ds_read_b128 v[104:107], v5 offset:23552
ds_read_b128 v[108:111], v5 offset:28672
v_mfma_f32_16x16x32_bf16 v[112:115], v[80:83], a[80:83], v[112:115]
ds_read_b128 v[64:67], v5 offset:24576
v_mfma_f32_16x16x32_bf16 v[112:115], v[84:87], a[84:87], v[112:115]
s_waitcnt lgkmcnt(5)
ds_read_b128 v[68:71], v5 offset:29696
buffer_load_dwordx4 a[124:127], v12, s[72:75], s93 offen offset:3072 sc1
v_mfma_f32_16x16x32_bf16 v[116:119], v[88:91], a[80:83], v[116:119]
ds_read_b128 v[72:75], v5 offset:30720
v_mfma_f32_16x16x32_bf16 v[116:119], v[92:95], a[84:87], v[116:119]
s_waitcnt lgkmcnt(5)
ds_read_b128 v[76:79], v5 offset:35840
v_mfma_f32_16x16x32_bf16 v[120:123], v[96:99], a[80:83], v[120:123]
s_mov_b32 s93, 5242880
buffer_load_dwordx4 a[128:131], v12, s[72:75], s93 offen offset:0 sc1
v_mfma_f32_16x16x32_bf16 v[120:123], v[100:103], a[84:87], v[120:123]
s_waitcnt lgkmcnt(4)
ds_read_b128 v[80:83], v5 offset:31744
ds_read_b128 v[84:87], v5 offset:36864
v_mfma_f32_16x16x32_bf16 v[124:127], v[104:107], a[80:83], v[124:127]
ds_read_b128 v[88:91], v5 offset:32768
v_mfma_f32_16x16x32_bf16 v[124:127], v[108:111], a[84:87], v[124:127]
s_waitcnt lgkmcnt(5)
ds_read_b128 v[92:95], v5 offset:37888
buffer_load_dwordx4 a[132:135], v12, s[72:75], s93 offen offset:1024 sc1
v_mfma_f32_16x16x32_bf16 v[128:131], v[64:67], a[80:83], v[128:131]
ds_read_b128 v[96:99], v5 offset:33792
v_mfma_f32_16x16x32_bf16 v[128:131], v[68:71], a[84:87], v[128:131]
s_waitcnt vmcnt(20) lgkmcnt(5)
ds_read_b128 v[100:103], v5 offset:38912
ds_read_b128 v[104:107], v5 offset:34816
ds_read_b128 v[108:111], v5 offset:39936
s_barrier
v_mfma_f32_16x16x32_bf16 v[112:115], v[72:75], a[88:91], v[112:115]
buffer_load_dwordx4 a[136:139], v12, s[72:75], s93 offen offset:2048 sc1
v_mfma_f32_16x16x32_bf16 v[112:115], v[76:79], a[92:95], v[112:115]
s_waitcnt lgkmcnt(6)
ds_read_b128 v[64:67], v5 offset:40960
v_mfma_f32_16x16x32_bf16 v[116:119], v[80:83], a[88:91], v[116:119]
buffer_load_dwordx4 a[140:143], v12, s[72:75], s93 offen offset:3072 sc1
v_mfma_f32_16x16x32_bf16 v[116:119], v[84:87], a[92:95], v[116:119]
s_waitcnt lgkmcnt(5)
ds_read_b128 v[68:71], v5 offset:46080
v_mfma_f32_16x16x32_bf16 v[120:123], v[88:91], a[88:91], v[120:123]
ds_read_b128 v[72:75], v5 offset:41984
v_mfma_f32_16x16x32_bf16 v[120:123], v[92:95], a[92:95], v[120:123]
s_waitcnt lgkmcnt(5)
ds_read_b128 v[76:79], v5 offset:47104
s_mov_b32 s92, 184320
s_add_u32 m0, s94, 102400
v_mfma_f32_16x16x32_bf16 v[124:127], v[96:99], a[88:91], v[124:127]
buffer_load_dwordx4 v26, s[64:67], s92 offen offset:0  lds
v_mfma_f32_16x16x32_bf16 v[124:127], v[100:103], a[92:95], v[124:127]
s_waitcnt lgkmcnt(4)
ds_read_b128 v[80:83], v5 offset:43008
ds_read_b128 v[84:87], v5 offset:48128
v_mfma_f32_16x16x32_bf16 v[128:131], v[104:107], a[88:91], v[128:131]
ds_read_b128 v[88:91], v5 offset:44032
v_mfma_f32_16x16x32_bf16 v[128:131], v[108:111], a[92:95], v[128:131]
s_waitcnt vmcnt(21) lgkmcnt(5)
ds_read_b128 v[92:95], v5 offset:49152
buffer_load_dwordx4 v26, s[64:67], s92 offen offset:1024  lds
v_mfma_f32_16x16x32_bf16 v[112:115], v[64:67], a[96:99], v[112:115]
ds_read_b128 v[96:99], v5 offset:45056
v_mfma_f32_16x16x32_bf16 v[112:115], v[68:71], a[100:103], v[112:115]
s_waitcnt lgkmcnt(5)
ds_read_b128 v[100:103], v5 offset:50176
v_mfma_f32_16x16x32_bf16 v[116:119], v[72:75], a[96:99], v[116:119]
buffer_load_dwordx4 v26, s[64:67], s92 offen offset:2048  lds
v_mfma_f32_16x16x32_bf16 v[116:119], v[76:79], a[100:103], v[116:119]
s_waitcnt lgkmcnt(4)
ds_read_b128 v[104:107], v5 offset:51200
ds_read_b128 v[108:111], v5 offset:56320
v_mfma_f32_16x16x32_bf16 v[120:123], v[80:83], a[96:99], v[120:123]
ds_read_b128 v[64:67], v5 offset:52224
v_mfma_f32_16x16x32_bf16 v[120:123], v[84:87], a[100:103], v[120:123]
s_waitcnt lgkmcnt(5)
ds_read_b128 v[68:71], v5 offset:57344
buffer_load_dwordx4 v26, s[64:67], s92 offen offset:3072  lds
v_mfma_f32_16x16x32_bf16 v[124:127], v[88:91], a[96:99], v[124:127]
ds_read_b128 v[72:75], v5 offset:53248
v_mfma_f32_16x16x32_bf16 v[124:127], v[92:95], a[100:103], v[124:127]
s_waitcnt lgkmcnt(5)
ds_read_b128 v[76:79], v5 offset:58368
s_add_u32 s92, s92, 4096
s_add_u32 m0, s94, 106496
v_mfma_f32_16x16x32_bf16 v[128:131], v[96:99], a[96:99], v[128:131]
buffer_load_dwordx4 v26, s[64:67], s92 offen offset:0  lds
v_mfma_f32_16x16x32_bf16 v[128:131], v[100:103], a[100:103], v[128:131]
s_waitcnt vmcnt(23) lgkmcnt(4)
ds_read_b128 v[80:83], v5 offset:54272
ds_read_b128 v[84:87], v5 offset:59392
ds_read_b128 v[88:91], v5 offset:55296
ds_read_b128 v[92:95], v5 offset:60416
s_waitcnt vmcnt(13)
s_barrier
v_mfma_f32_16x16x32_bf16 v[112:115], v[104:107], a[104:107], v[112:115]
s_mov_b32 s92, 204800
s_add_u32 m0, s94, 122880
v_mfma_f32_16x16x32_bf16 v[112:115], v[108:111], a[108:111], v[112:115]
s_waitcnt lgkmcnt(6)
ds_read_b128 v[96:99], v5 offset:61440
buffer_load_dwordx4 v26, s[64:67], s92 offen offset:0  lds
v_mfma_f32_16x16x32_bf16 v[116:119], v[64:67], a[104:107], v[116:119]
ds_read_b128 v[100:103], v7 offset:1024
v_mfma_f32_16x16x32_bf16 v[116:119], v[68:71], a[108:111], v[116:119]
s_waitcnt lgkmcnt(6)
ds_read_b128 v[104:107], v5 offset:62464
v_mfma_f32_16x16x32_bf16 v[120:123], v[72:75], a[104:107], v[120:123]
buffer_load_dwordx4 v26, s[64:67], s92 offen offset:1024  lds
v_mfma_f32_16x16x32_bf16 v[120:123], v[76:79], a[108:111], v[120:123]
s_waitcnt lgkmcnt(5)
ds_read_b128 v[108:111], v7 offset:2048
v_mfma_f32_16x16x32_bf16 v[124:127], v[80:83], a[104:107], v[124:127]
ds_read_b128 v[64:67], v5 offset:63488
v_mfma_f32_16x16x32_bf16 v[124:127], v[84:87], a[108:111], v[124:127]
s_waitcnt lgkmcnt(5)
ds_read_b128 v[68:71], v7 offset:3072
buffer_load_dwordx4 v26, s[64:67], s92 offen offset:2048  lds
v_mfma_f32_16x16x32_bf16 v[128:131], v[88:91], a[104:107], v[128:131]
ds_read_b128 v[72:75], v5 offset:64512
v_mfma_f32_16x16x32_bf16 v[128:131], v[92:95], a[108:111], v[128:131]
s_waitcnt vmcnt(14) lgkmcnt(5)
ds_read_b128 v[76:79], v7 offset:4096
v_mfma_f32_16x16x32_bf16 v[112:115], v[96:99], a[112:115], v[112:115]
buffer_load_dwordx4 v26, s[64:67], s92 offen offset:3072  lds
v_mfma_f32_16x16x32_bf16 v[112:115], v[100:103], a[116:119], v[112:115]
s_waitcnt lgkmcnt(4)
ds_read_b128 v[80:83], v7 offset:0
ds_read_b128 v[84:87], v7 offset:5120
v_mfma_f32_16x16x32_bf16 v[116:119], v[104:107], a[112:115], v[116:119]
ds_read_b128 v[88:91], v7 offset:6144
s_add_u32 s92, s92, 4096
s_add_u32 m0, s94, 126976
v_mfma_f32_16x16x32_bf16 v[116:119], v[108:111], a[116:119], v[116:119]
s_waitcnt lgkmcnt(5)
ds_read_b128 v[92:95], v7 offset:11264
buffer_load_dwordx4 v26, s[64:67], s92 offen offset:0  lds
v_mfma_f32_16x16x32_bf16 v[120:123], v[64:67], a[112:115], v[120:123]
ds_read_b128 v[96:99], v7 offset:7168
v_mfma_f32_16x16x32_bf16 v[120:123], v[68:71], a[116:119], v[120:123]
s_waitcnt lgkmcnt(5)
ds_read_b128 v[100:103], v7 offset:12288
v_mfma_f32_16x16x32_bf16 v[124:127], v[72:75], a[112:115], v[124:127]
s_mov_b32 s93, 5246976
buffer_load_dwordx4 a[144:147], v12, s[72:75], s93 offen offset:0 sc1
v_mfma_f32_16x16x32_bf16 v[124:127], v[76:79], a[116:119], v[124:127]
s_waitcnt lgkmcnt(4)
ds_read_b128 v[104:107], v7 offset:8192
ds_read_b128 v[108:111], v7 offset:13312
v_mfma_f32_16x16x32_bf16 v[128:131], v[80:83], a[112:115], v[128:131]
ds_read_b128 v[64:67], v7 offset:9216
v_mfma_f32_16x16x32_bf16 v[128:131], v[84:87], a[116:119], v[128:131]
s_waitcnt vmcnt(15) lgkmcnt(5)
ds_read_b128 v[68:71], v7 offset:14336
buffer_load_dwordx4 a[148:151], v12, s[72:75], s93 offen offset:1024 sc1
v_mfma_f32_16x16x32_bf16 v[112:115], v[88:91], a[120:123], v[112:115]
ds_read_b128 v[72:75], v7 offset:10240
v_mfma_f32_16x16x32_bf16 v[112:115], v[92:95], a[124:127], v[112:115]
s_waitcnt lgkmcnt(5)
ds_read_b128 v[76:79], v7 offset:15360
v_mfma_f32_16x16x32_bf16 v[116:119], v[96:99], a[120:123], v[116:119]
buffer_load_dwordx4 a[152:155], v12, s[72:75], s93 offen offset:2048 sc1
v_mfma_f32_16x16x32_bf16 v[116:119], v[100:103], a[124:127], v[116:119]
s_waitcnt lgkmcnt(4)
ds_read_b128 v[80:83], v7 offset:16384
ds_read_b128 v[84:87], v7 offset:21504
v_mfma_f32_16x16x32_bf16 v[120:123], v[104:107], a[120:123], v[120:123]
ds_read_b128 v[88:91], v7 offset:17408
v_mfma_f32_16x16x32_bf16 v[120:123], v[108:111], a[124:127], v[120:123]
s_waitcnt lgkmcnt(5)
ds_read_b128 v[92:95], v7 offset:22528
buffer_load_dwordx4 a[156:159], v12, s[72:75], s93 offen offset:3072 sc1
v_mfma_f32_16x16x32_bf16 v[124:127], v[64:67], a[120:123], v[124:127]
ds_read_b128 v[96:99], v7 offset:18432
v_mfma_f32_16x16x32_bf16 v[124:127], v[68:71], a[124:127], v[124:127]
s_waitcnt lgkmcnt(5)
ds_read_b128 v[100:103], v7 offset:23552
v_mfma_f32_16x16x32_bf16 v[128:131], v[72:75], a[120:123], v[128:131]
s_mov_b32 s93, 5251072
buffer_load_dwordx4 a[160:163], v12, s[72:75], s93 offen offset:0 sc1
v_mfma_f32_16x16x32_bf16 v[128:131], v[76:79], a[124:127], v[128:131]
s_waitcnt vmcnt(17) lgkmcnt(4)
ds_read_b128 v[104:107], v7 offset:19456
ds_read_b128 v[108:111], v7 offset:24576
v_mfma_f32_16x16x32_bf16 v[112:115], v[80:83], a[128:131], v[112:115]
ds_read_b128 v[64:67], v7 offset:20480
v_mfma_f32_16x16x32_bf16 v[112:115], v[84:87], a[132:135], v[112:115]
s_waitcnt lgkmcnt(5)
ds_read_b128 v[68:71], v7 offset:25600
buffer_load_dwordx4 a[164:167], v12, s[72:75], s93 offen offset:1024 sc1
v_mfma_f32_16x16x32_bf16 v[116:119], v[88:91], a[128:131], v[116:119]
ds_read_b128 v[72:75], v7 offset:26624
v_mfma_f32_16x16x32_bf16 v[116:119], v[92:95], a[132:135], v[116:119]
s_waitcnt lgkmcnt(5)
ds_read_b128 v[76:79], v7 offset:31744
v_mfma_f32_16x16x32_bf16 v[120:123], v[96:99], a[128:131], v[120:123]
buffer_load_dwordx4 a[168:171], v12, s[72:75], s93 offen offset:2048 sc1
v_mfma_f32_16x16x32_bf16 v[120:123], v[100:103], a[132:135], v[120:123]
s_waitcnt lgkmcnt(4)
ds_read_b128 v[80:83], v7 offset:27648
ds_read_b128 v[84:87], v7 offset:32768
v_mfma_f32_16x16x32_bf16 v[124:127], v[104:107], a[128:131], v[124:127]
ds_read_b128 v[88:91], v7 offset:28672
v_mfma_f32_16x16x32_bf16 v[124:127], v[108:111], a[132:135], v[124:127]
s_waitcnt lgkmcnt(5)
ds_read_b128 v[92:95], v7 offset:33792
buffer_load_dwordx4 a[172:175], v12, s[72:75], s93 offen offset:3072 sc1
v_mfma_f32_16x16x32_bf16 v[128:131], v[64:67], a[128:131], v[128:131]
ds_read_b128 v[96:99], v7 offset:29696
v_mfma_f32_16x16x32_bf16 v[128:131], v[68:71], a[132:135], v[128:131]
s_waitcnt vmcnt(18) lgkmcnt(5)
ds_read_b128 v[100:103], v7 offset:34816
ds_read_b128 v[104:107], v7 offset:30720
ds_read_b128 v[108:111], v7 offset:35840
s_waitcnt vmcnt(8)
s_barrier
s_mov_b32 s92, 225280
s_add_u32 m0, s94, 0
v_mfma_f32_16x16x32_bf16 v[112:115], v[72:75], a[136:139], v[112:115]
buffer_load_dwordx4 v26, s[64:67], s92 offen offset:0  lds
v_mfma_f32_16x16x32_bf16 v[112:115], v[76:79], a[140:143], v[112:115]
s_waitcnt lgkmcnt(6)
ds_read_b128 v[64:67], v7 offset:36864
v_mfma_f32_16x16x32_bf16 v[116:119], v[80:83], a[136:139], v[116:119]
buffer_load_dwordx4 v26, s[64:67], s92 offen offset:1024  lds
v_mfma_f32_16x16x32_bf16 v[116:119], v[84:87], a[140:143], v[116:119]
s_waitcnt lgkmcnt(5)
ds_read_b128 v[68:71], v7 offset:41984
v_mfma_f32_16x16x32_bf16 v[120:123], v[88:91], a[136:139], v[120:123]
ds_read_b128 v[72:75], v7 offset:37888
v_mfma_f32_16x16x32_bf16 v[120:123], v[92:95], a[140:143], v[120:123]
s_waitcnt lgkmcnt(5)
ds_read_b128 v[76:79], v7 offset:43008
v_mfma_f32_16x16x32_bf16 v[124:127], v[96:99], a[136:139], v[124:127]
buffer_load_dwordx4 v26, s[64:67], s92 offen offset:2048  lds
v_mfma_f32_16x16x32_bf16 v[124:127], v[100:103], a[140:143], v[124:127]
s_waitcnt lgkmcnt(4)
ds_read_b128 v[80:83], v7 offset:38912
ds_read_b128 v[84:87], v7 offset:44032
v_mfma_f32_16x16x32_bf16 v[128:131], v[104:107], a[136:139], v[128:131]
ds_read_b128 v[88:91], v7 offset:39936
v_mfma_f32_16x16x32_bf16 v[128:131], v[108:111], a[140:143], v[128:131]
s_waitcnt vmcnt(9) lgkmcnt(5)
ds_read_b128 v[92:95], v7 offset:45056
buffer_load_dwordx4 v26, s[64:67], s92 offen offset:3072  lds
v_mfma_f32_16x16x32_bf16 v[112:115], v[64:67], a[144:147], v[112:115]
ds_read_b128 v[96:99], v7 offset:40960
v_mfma_f32_16x16x32_bf16 v[112:115], v[68:71], a[148:151], v[112:115]
s_waitcnt lgkmcnt(5)
ds_read_b128 v[100:103], v7 offset:46080
s_add_u32 s92, s92, 4096
s_add_u32 m0, s94, 4096
v_mfma_f32_16x16x32_bf16 v[116:119], v[72:75], a[144:147], v[116:119]
buffer_load_dwordx4 v26, s[64:67], s92 offen offset:0  lds
v_mfma_f32_16x16x32_bf16 v[116:119], v[76:79], a[148:151], v[116:119]
s_waitcnt lgkmcnt(4)
ds_read_b128 v[104:107], v7 offset:47104
ds_read_b128 v[108:111], v7 offset:52224
v_mfma_f32_16x16x32_bf16 v[120:123], v[80:83], a[144:147], v[120:123]
ds_read_b128 v[64:67], v7 offset:48128
v_mfma_f32_16x16x32_bf16 v[120:123], v[84:87], a[148:151], v[120:123]
s_waitcnt lgkmcnt(5)
ds_read_b128 v[68:71], v7 offset:53248
s_mov_b32 s93, 5255168
buffer_load_dwordx4 a[176:179], v12, s[72:75], s93 offen offset:0 sc1
v_mfma_f32_16x16x32_bf16 v[124:127], v[88:91], a[144:147], v[124:127]
ds_read_b128 v[72:75], v7 offset:49152
v_mfma_f32_16x16x32_bf16 v[124:127], v[92:95], a[148:151], v[124:127]
s_waitcnt lgkmcnt(5)
ds_read_b128 v[76:79], v7 offset:54272
v_mfma_f32_16x16x32_bf16 v[128:131], v[96:99], a[144:147], v[128:131]
buffer_load_dwordx4 a[180:183], v12, s[72:75], s93 offen offset:1024 sc1
v_mfma_f32_16x16x32_bf16 v[128:131], v[100:103], a[148:151], v[128:131]
s_waitcnt vmcnt(11) lgkmcnt(4)
ds_read_b128 v[80:83], v7 offset:50176
ds_read_b128 v[84:87], v7 offset:55296
v_mfma_f32_16x16x32_bf16 v[112:115], v[104:107], a[152:155], v[112:115]
ds_read_b128 v[88:91], v7 offset:51200
v_mfma_f32_16x16x32_bf16 v[112:115], v[108:111], a[156:159], v[112:115]
s_waitcnt lgkmcnt(5)
ds_read_b128 v[92:95], v7 offset:56320
buffer_load_dwordx4 a[184:187], v12, s[72:75], s93 offen offset:2048 sc1
v_mfma_f32_16x16x32_bf16 v[116:119], v[64:67], a[152:155], v[116:119]
ds_read_b128 v[96:99], v7 offset:57344
v_mfma_f32_16x16x32_bf16 v[116:119], v[68:71], a[156:159], v[116:119]
s_waitcnt lgkmcnt(5)
ds_read_b128 v[100:103], v7 offset:62464
v_mfma_f32_16x16x32_bf16 v[120:123], v[72:75], a[152:155], v[120:123]
buffer_load_dwordx4 a[188:191], v12, s[72:75], s93 offen offset:3072 sc1
v_mfma_f32_16x16x32_bf16 v[120:123], v[76:79], a[156:159], v[120:123]
s_waitcnt lgkmcnt(4)
ds_read_b128 v[104:107], v7 offset:58368
ds_read_b128 v[108:111], v7 offset:63488
v_mfma_f32_16x16x32_bf16 v[124:127], v[80:83], a[152:155], v[124:127]
ds_read_b128 v[64:67], v7 offset:59392
v_mfma_f32_16x16x32_bf16 v[124:127], v[84:87], a[156:159], v[124:127]
s_waitcnt lgkmcnt(5)
ds_read_b128 v[68:71], v7 offset:64512
v_mfma_f32_16x16x32_bf16 v[128:131], v[88:91], a[152:155], v[128:131]
ds_read_b128 v[72:75], v7 offset:60416
v_mfma_f32_16x16x32_bf16 v[128:131], v[92:95], a[156:159], v[128:131]
s_waitcnt vmcnt(11) lgkmcnt(5)
ds_read_b128 v[76:79], v9 offset:0
v_mfma_f32_16x16x32_bf16 v[112:115], v[96:99], a[160:163], v[112:115]
ds_read_b128 v[80:83], v7 offset:61440
v_mfma_f32_16x16x32_bf16 v[112:115], v[100:103], a[164:167], v[112:115]
s_waitcnt lgkmcnt(5)
ds_read_b128 v[84:87], v9 offset:1024
v_mfma_f32_16x16x32_bf16 v[116:119], v[104:107], a[160:163], v[116:119]
ds_read_b128 v[88:91], v9 offset:2048
v_mfma_f32_16x16x32_bf16 v[116:119], v[108:111], a[164:167], v[116:119]
s_waitcnt lgkmcnt(5)
ds_read_b128 v[92:95], v9 offset:7168
v_mfma_f32_16x16x32_bf16 v[120:123], v[64:67], a[160:163], v[120:123]
ds_read_b128 v[96:99], v9 offset:3072
v_mfma_f32_16x16x32_bf16 v[120:123], v[68:71], a[164:167], v[120:123]
s_waitcnt lgkmcnt(5)
ds_read_b128 v[100:103], v9 offset:8192
v_mfma_f32_16x16x32_bf16 v[124:127], v[72:75], a[160:163], v[124:127]
ds_read_b128 v[104:107], v9 offset:4096
v_mfma_f32_16x16x32_bf16 v[124:127], v[76:79], a[164:167], v[124:127]
s_waitcnt lgkmcnt(5)
ds_read_b128 v[108:111], v9 offset:9216
v_mfma_f32_16x16x32_bf16 v[128:131], v[80:83], a[160:163], v[128:131]
ds_read_b128 v[64:67], v9 offset:5120
v_mfma_f32_16x16x32_bf16 v[128:131], v[84:87], a[164:167], v[128:131]
s_waitcnt vmcnt(9) lgkmcnt(5)
ds_read_b128 v[68:71], v9 offset:10240
ds_read_b128 v[72:75], v9 offset:6144
ds_read_b128 v[76:79], v9 offset:11264
s_waitcnt vmcnt(4)
s_barrier
v_mfma_f32_16x16x32_bf16 v[112:115], v[88:91], a[168:171], v[112:115]
ds_read_b128 v[80:83], v5 offset:0
v_mfma_f32_16x16x32_bf16 v[112:115], v[92:95], a[172:175], v[112:115]
s_waitcnt lgkmcnt(7)
ds_read_b128 v[84:87], v5 offset:5120
v_mfma_f32_16x16x32_bf16 v[116:119], v[96:99], a[168:171], v[116:119]
ds_read_b128 v[88:91], v5 offset:1024
v_mfma_f32_16x16x32_bf16 v[116:119], v[100:103], a[172:175], v[116:119]
s_waitcnt lgkmcnt(7)
ds_read_b128 v[92:95], v5 offset:6144
v_mfma_f32_16x16x32_bf16 v[120:123], v[104:107], a[168:171], v[120:123]
ds_read_b128 v[96:99], v5 offset:2048
v_mfma_f32_16x16x32_bf16 v[120:123], v[108:111], a[172:175], v[120:123]
s_waitcnt lgkmcnt(7)
ds_read_b128 v[100:103], v5 offset:7168
v_mfma_f32_16x16x32_bf16 v[124:127], v[64:67], a[168:171], v[124:127]
ds_read_b128 v[104:107], v5 offset:3072
v_mfma_f32_16x16x32_bf16 v[124:127], v[68:71], a[172:175], v[124:127]
s_waitcnt lgkmcnt(7)
ds_read_b128 v[108:111], v5 offset:8192
v_mfma_f32_16x16x32_bf16 v[128:131], v[72:75], a[168:171], v[128:131]
ds_read_b128 v[64:67], v5 offset:4096
v_mfma_f32_16x16x32_bf16 v[128:131], v[76:79], a[172:175], v[128:131]
s_waitcnt vmcnt(2) lgkmcnt(7)
ds_read_b128 v[68:71], v5 offset:9216
v_mfma_f32_16x16x32_bf16 v[112:115], v[80:83], a[176:179], v[112:115]
ds_read_b128 v[72:75], v5 offset:10240
v_mfma_f32_16x16x32_bf16 v[112:115], v[84:87], a[180:183], v[112:115]
s_waitcnt lgkmcnt(7)
ds_read_b128 v[76:79], v5 offset:15360
v_mfma_f32_16x16x32_bf16 v[116:119], v[88:91], a[176:179], v[116:119]
ds_read_b128 v[80:83], v5 offset:11264
v_mfma_f32_16x16x32_bf16 v[116:119], v[92:95], a[180:183], v[116:119]
s_waitcnt lgkmcnt(7)
ds_read_b128 v[84:87], v5 offset:16384
v_mfma_f32_16x16x32_bf16 v[120:123], v[96:99], a[176:179], v[120:123]
ds_read_b128 v[88:91], v5 offset:12288
v_mfma_f32_16x16x32_bf16 v[120:123], v[100:103], a[180:183], v[120:123]
s_waitcnt lgkmcnt(7)
ds_read_b128 v[92:95], v5 offset:17408
v_mfma_f32_16x16x32_bf16 v[124:127], v[104:107], a[176:179], v[124:127]
ds_read_b128 v[96:99], v5 offset:13312
v_mfma_f32_16x16x32_bf16 v[124:127], v[108:111], a[180:183], v[124:127]
s_waitcnt lgkmcnt(7)
ds_read_b128 v[100:103], v5 offset:18432
v_mfma_f32_16x16x32_bf16 v[128:131], v[64:67], a[176:179], v[128:131]
ds_read_b128 v[104:107], v5 offset:14336
v_mfma_f32_16x16x32_bf16 v[128:131], v[68:71], a[180:183], v[128:131]
s_waitcnt vmcnt(0) lgkmcnt(7)
ds_read_b128 v[108:111], v5 offset:19456
v_mfma_f32_16x16x32_bf16 v[112:115], v[72:75], a[184:187], v[112:115]
v_mfma_f32_16x16x32_bf16 v[112:115], v[76:79], a[188:191], v[112:115]
s_waitcnt lgkmcnt(6)
v_mfma_f32_16x16x32_bf16 v[116:119], v[80:83], a[184:187], v[116:119]
v_mfma_f32_16x16x32_bf16 v[116:119], v[84:87], a[188:191], v[116:119]
s_waitcnt lgkmcnt(4)
v_mfma_f32_16x16x32_bf16 v[120:123], v[88:91], a[184:187], v[120:123]
v_mfma_f32_16x16x32_bf16 v[120:123], v[92:95], a[188:191], v[120:123]
s_waitcnt lgkmcnt(2)
v_mfma_f32_16x16x32_bf16 v[124:127], v[96:99], a[184:187], v[124:127]
v_mfma_f32_16x16x32_bf16 v[124:127], v[100:103], a[188:191], v[124:127]
s_waitcnt lgkmcnt(0)
v_mfma_f32_16x16x32_bf16 v[128:131], v[104:107], a[184:187], v[128:131]
v_mfma_f32_16x16x32_bf16 v[128:131], v[108:111], a[188:191], v[128:131]
s_barrier
s_nop 6
v_pk_add_f32 v[112:113], v[112:113], v[176:177]
v_lshlrev_b32 v32, 16, v208
v_and_b32 v33, 0xffff0000, v208
v_lshlrev_b32 v34, 16, v196
v_and_b32 v35, 0xffff0000, v196
v_pk_fma_f32 v[112:113], v[112:113], v[32:33], v[34:35]
v_cvt_pk_bf16_f32 v40, v112, v113
v_pk_add_f32 v[114:115], v[114:115], v[178:179]
v_lshlrev_b32 v36, 16, v209
v_and_b32 v37, 0xffff0000, v209
v_lshlrev_b32 v38, 16, v197
v_and_b32 v39, 0xffff0000, v197
v_pk_fma_f32 v[114:115], v[114:115], v[36:37], v[38:39]
v_cvt_pk_bf16_f32 v41, v114, v115
v_pk_add_f32 v[116:117], v[116:117], v[180:181]
v_lshlrev_b32 v32, 16, v210
v_and_b32 v33, 0xffff0000, v210
v_lshlrev_b32 v34, 16, v198
v_and_b32 v35, 0xffff0000, v198
v_pk_fma_f32 v[116:117], v[116:117], v[32:33], v[34:35]
v_cvt_pk_bf16_f32 v42, v116, v117
v_pk_add_f32 v[118:119], v[118:119], v[182:183]
v_lshlrev_b32 v36, 16, v211
v_and_b32 v37, 0xffff0000, v211
v_lshlrev_b32 v38, 16, v199
v_and_b32 v39, 0xffff0000, v199
v_pk_fma_f32 v[118:119], v[118:119], v[36:37], v[38:39]
v_cvt_pk_bf16_f32 v43, v118, v119
v_pk_add_f32 v[120:121], v[120:121], v[184:185]
v_lshlrev_b32 v32, 16, v212
v_and_b32 v33, 0xffff0000, v212
v_lshlrev_b32 v34, 16, v200
v_and_b32 v35, 0xffff0000, v200
v_pk_fma_f32 v[120:121], v[120:121], v[32:33], v[34:35]
v_cvt_pk_bf16_f32 v44, v120, v121
v_pk_add_f32 v[122:123], v[122:123], v[186:187]
v_lshlrev_b32 v36, 16, v213
v_and_b32 v37, 0xffff0000, v213
v_lshlrev_b32 v38, 16, v201
v_and_b32 v39, 0xffff0000, v201
v_pk_fma_f32 v[122:123], v[122:123], v[36:37], v[38:39]
v_cvt_pk_bf16_f32 v45, v122, v123
v_pk_add_f32 v[124:125], v[124:125], v[188:189]
v_lshlrev_b32 v32, 16, v214
v_and_b32 v33, 0xffff0000, v214
v_lshlrev_b32 v34, 16, v202
v_and_b32 v35, 0xffff0000, v202
v_pk_fma_f32 v[124:125], v[124:125], v[32:33], v[34:35]
v_cvt_pk_bf16_f32 v46, v124, v125
v_pk_add_f32 v[126:127], v[126:127], v[190:191]
v_lshlrev_b32 v36, 16, v215
v_and_b32 v37, 0xffff0000, v215
v_lshlrev_b32 v38, 16, v203
v_and_b32 v39, 0xffff0000, v203
v_pk_fma_f32 v[126:127], v[126:127], v[36:37], v[38:39]
v_cvt_pk_bf16_f32 v47, v126, v127
v_pk_add_f32 v[128:129], v[128:129], v[192:193]
v_lshlrev_b32 v32, 16, v216
v_and_b32 v33, 0xffff0000, v216
v_lshlrev_b32 v34, 16, v204
v_and_b32 v35, 0xffff0000, v204
v_pk_fma_f32 v[128:129], v[128:129], v[32:33], v[34:35]
v_cvt_pk_bf16_f32 v48, v128, v129
v_pk_add_f32 v[130:131], v[130:131], v[194:195]
v_lshlrev_b32 v36, 16, v217
v_and_b32 v37, 0xffff0000, v217
v_lshlrev_b32 v38, 16, v205
v_and_b32 v39, 0xffff0000, v205
v_pk_fma_f32 v[130:131], v[130:131], v[36:37], v[38:39]
v_cvt_pk_bf16_f32 v49, v130, v131
buffer_store_dwordx2 v[48:49], v17, s[76:79], s13 offen
v_permlane32_swap_b32 v40, v42
v_permlane32_swap_b32 v41, v43
v_permlane32_swap_b32 v44, v46
v_permlane32_swap_b32 v45, v47
v_permlane16_swap_b32 v40, v42
v_permlane16_swap_b32 v41, v43
v_permlane16_swap_b32 v44, v46
v_permlane16_swap_b32 v45, v47
buffer_store_dwordx4 v[40:43], v16, s[76:79], s12 offen offset:0
buffer_store_dwordx4 v[44:47], v16, s[76:79], s12 offen offset:64
L_attn_end:
s_endpgm
L_stub_pre:
s_call_b64 s[30:31], L_rare_0
s_branch L_ret_pre
L_stub_s0:
s_call_b64 s[30:31], L_rare_1
s_branch L_ret_s0
L_stub_l1:
s_call_b64 s[30:31], L_rare_0
s_branch L_ret_l1
L_stub_l0:
s_call_b64 s[30:31], L_rare_1
s_branch L_ret_l0
L_stub_s29:
s_call_b64 s[30:31], L_rare_0
s_branch L_ret_s29
L_stub_s30:
s_call_b64 s[30:31], L_rare_1
s_branch L_ret_s30
L_wt12:
buffer_store_dwordx4 v[140:143], v32, s[76:79], s12 offen sc1
buffer_store_dwordx4 v[144:147], v32, s[76:79], s14 offen sc1
buffer_store_dwordx4 v[148:151], v33, s[76:79], s12 offen sc1
s_branch L_wj12
L_wt13:
buffer_store_dwordx4 v[40:43], v32, s[72:75], s12 offen sc1
buffer_store_dwordx4 v[44:47], v32, s[72:75], s14 offen sc1
buffer_store_dwordx4 v[48:51], v33, s[72:75], s12 offen sc1
s_branch L_wj13
L_wt14:
buffer_store_dwordx4 v[104:107], v32, s[80:83], s12 offen sc1
buffer_store_dwordx4 v[108:111], v32, s[80:83], s14 offen sc1
buffer_store_dwordx4 v[112:115], v33, s[80:83], s12 offen sc1
s_branch L_wj14
L_wt15:
buffer_store_dword v31, off, s[68:71], s95 sc1
s_branch L_wj15
L_wt18:
buffer_store_dwordx4 v[112:115], v11, s[76:79], s41 offen sc1
buffer_store_dwordx4 v[116:119], v11, s[76:79], s41 offen offset:1024 sc1
buffer_store_dwordx2 v[120:121], v11, s[76:79], s42 offen sc1
s_branch L_wj18
L_wt19:
buffer_store_dword v31, off, s[68:71], s12 sc1
s_branch L_wj19
L_wt22:
buffer_store_dwordx4 v[112:115], v11, s[76:79], s41 offen sc1
buffer_store_dwordx4 v[116:119], v11, s[76:79], s41 offen offset:1024 sc1
buffer_store_dwordx2 v[120:121], v11, s[76:79], s42 offen sc1
s_branch L_wj22
L_wt23:
buffer_store_dwordx2 v[36:37], v32, s[84:87], s6 offen sc1
s_branch L_wj23
L_wt24:
buffer_store_dword v31, off, s[68:71], s47 sc1
s_branch L_wj24
L_wt27:
buffer_store_dwordx4 v[96:99], v12, s[76:79], s14 offen sc1
buffer_store_dwordx4 v[104:107], v12, s[76:79], s15 offen sc1
buffer_store_dwordx4 v[112:115], v12, s[76:79], s16 offen sc1
s_branch L_wj27
L_wt28:
buffer_store_dwordx4 v[120:123], v13, s[76:79], s14 offen sc1
buffer_store_dwordx4 v[128:131], v13, s[76:79], s15 offen sc1
buffer_store_dwordx4 v[136:139], v13, s[76:79], s16 offen sc1
s_branch L_wj28
L_wt29:
buffer_store_dword v31, off, s[68:71], s17 sc1
s_branch L_wj29
L_rare_0:
s_waitcnt vmcnt(0) lgkmcnt(0)
s_nop 15
v_lshrrev_b32 v250, 4, v11
v_and_b32 v249, 15, v250
v_mul_u32_u24 v249, 384, v249
v_lshrrev_b32 v250, 4, v250
v_lshl_add_u32 v249, v250, 4, v249
v_mov_b32 v240, 0x0
v_mov_b32 v241, 0x0
v_mov_b32 v242, 0x0
v_mov_b32 v243, 0x0
s_add_u32 s7, s32, 0
s_sub_u32 s7, s7, 73728
buffer_load_dwordx4 a[216:219], v249, s[16:19], s7 offen offset:0
buffer_load_dwordx4 a[220:223], v249, s[16:19], s7 offen offset:64
buffer_load_dwordx4 a[224:227], v249, s[16:19], s7 offen offset:128
buffer_load_dwordx4 a[228:231], v249, s[16:19], s7 offen offset:192
buffer_load_dwordx4 a[232:235], v249, s[16:19], s7 offen offset:256
buffer_load_dwordx4 a[236:239], v249, s[16:19], s7 offen offset:320
s_waitcnt vmcnt(0)
v_mfma_f32_16x16x32_bf16 v[48:51], a[216:219], v[64:67], v[32:35]
v_mfma_f32_16x16x32_bf16 v[48:51], a[220:223], v[96:99], v[48:51]
v_mfma_f32_16x16x32_bf16 v[48:51], a[224:227], v[128:131], v[48:51]
v_mfma_f32_16x16x32_bf16 v[48:51], a[228:231], v[160:163], v[48:51]
v_mfma_f32_16x16x32_bf16 v[48:51], a[232:235], v[192:195], v[48:51]
v_mfma_f32_16x16x32_bf16 v[48:51], a[236:239], v[224:227], v[48:51]
v_mfma_f32_16x16x32_bf16 v[52:55], a[216:219], v[68:71], v[36:39]
v_mfma_f32_16x16x32_bf16 v[52:55], a[220:223], v[100:103], v[52:55]
v_mfma_f32_16x16x32_bf16 v[52:55], a[224:227], v[132:135], v[52:55]
v_mfma_f32_16x16x32_bf16 v[52:55], a[228:231], v[164:167], v[52:55]
v_mfma_f32_16x16x32_bf16 v[52:55], a[232:235], v[196:199], v[52:55]
v_mfma_f32_16x16x32_bf16 v[52:55], a[236:239], v[228:231], v[52:55]
v_mfma_f32_16x16x32_bf16 v[56:59], a[216:219], v[72:75], v[40:43]
v_mfma_f32_16x16x32_bf16 v[56:59], a[220:223], v[104:107], v[56:59]
v_mfma_f32_16x16x32_bf16 v[56:59], a[224:227], v[136:139], v[56:59]
v_mfma_f32_16x16x32_bf16 v[56:59], a[228:231], v[168:171], v[56:59]
v_mfma_f32_16x16x32_bf16 v[56:59], a[232:235], v[200:203], v[56:59]
v_mfma_f32_16x16x32_bf16 v[56:59], a[236:239], v[232:235], v[56:59]
v_mfma_f32_16x16x32_bf16 v[60:63], a[216:219], v[76:79], v[44:47]
v_mfma_f32_16x16x32_bf16 v[60:63], a[220:223], v[108:111], v[60:63]
v_mfma_f32_16x16x32_bf16 v[60:63], a[224:227], v[140:143], v[60:63]
v_mfma_f32_16x16x32_bf16 v[60:63], a[228:231], v[172:175], v[60:63]
v_mfma_f32_16x16x32_bf16 v[60:63], a[232:235], v[204:207], v[60:63]
v_mfma_f32_16x16x32_bf16 v[60:63], a[236:239], v[236:239], v[60:63]
s_nop 7
v_max3_f32 v240, v240, v48, v49
v_max3_f32 v240, v240, v50, v51
v_max3_f32 v241, v241, v52, v53
v_max3_f32 v241, v241, v54, v55
v_max3_f32 v242, v242, v56, v57
v_max3_f32 v242, v242, v58, v59
v_max3_f32 v243, v243, v60, v61
v_max3_f32 v243, v243, v62, v63
s_add_u32 s7, s32, 6144
s_sub_u32 s7, s7, 73728
buffer_load_dwordx4 a[216:219], v249, s[16:19], s7 offen offset:0
buffer_load_dwordx4 a[220:223], v249, s[16:19], s7 offen offset:64
buffer_load_dwordx4 a[224:227], v249, s[16:19], s7 offen offset:128
buffer_load_dwordx4 a[228:231], v249, s[16:19], s7 offen offset:192
buffer_load_dwordx4 a[232:235], v249, s[16:19], s7 offen offset:256
buffer_load_dwordx4 a[236:239], v249, s[16:19], s7 offen offset:320
s_waitcnt vmcnt(0)
v_mfma_f32_16x16x32_bf16 v[48:51], a[216:219], v[64:67], v[32:35]
v_mfma_f32_16x16x32_bf16 v[48:51], a[220:223], v[96:99], v[48:51]
v_mfma_f32_16x16x32_bf16 v[48:51], a[224:227], v[128:131], v[48:51]
v_mfma_f32_16x16x32_bf16 v[48:51], a[228:231], v[160:163], v[48:51]
v_mfma_f32_16x16x32_bf16 v[48:51], a[232:235], v[192:195], v[48:51]
v_mfma_f32_16x16x32_bf16 v[48:51], a[236:239], v[224:227], v[48:51]
v_mfma_f32_16x16x32_bf16 v[52:55], a[216:219], v[68:71], v[36:39]
v_mfma_f32_16x16x32_bf16 v[52:55], a[220:223], v[100:103], v[52:55]
v_mfma_f32_16x16x32_bf16 v[52:55], a[224:227], v[132:135], v[52:55]
v_mfma_f32_16x16x32_bf16 v[52:55], a[228:231], v[164:167], v[52:55]
v_mfma_f32_16x16x32_bf16 v[52:55], a[232:235], v[196:199], v[52:55]
v_mfma_f32_16x16x32_bf16 v[52:55], a[236:239], v[228:231], v[52:55]
v_mfma_f32_16x16x32_bf16 v[56:59], a[216:219], v[72:75], v[40:43]
v_mfma_f32_16x16x32_bf16 v[56:59], a[220:223], v[104:107], v[56:59]
v_mfma_f32_16x16x32_bf16 v[56:59], a[224:227], v[136:139], v[56:59]
v_mfma_f32_16x16x32_bf16 v[56:59], a[228:231], v[168:171], v[56:59]
v_mfma_f32_16x16x32_bf16 v[56:59], a[232:235], v[200:203], v[56:59]
v_mfma_f32_16x16x32_bf16 v[56:59], a[236:239], v[232:235], v[56:59]
v_mfma_f32_16x16x32_bf16 v[60:63], a[216:219], v[76:79], v[44:47]
v_mfma_f32_16x16x32_bf16 v[60:63], a[220:223], v[108:111], v[60:63]
v_mfma_f32_16x16x32_bf16 v[60:63], a[224:227], v[140:143], v[60:63]
v_mfma_f32_16x16x32_bf16 v[60:63], a[228:231], v[172:175], v[60:63]
v_mfma_f32_16x16x32_bf16 v[60:63], a[232:235], v[204:207], v[60:63]
v_mfma_f32_16x16x32_bf16 v[60:63], a[236:239], v[236:239], v[60:63]
s_nop 7
v_max3_f32 v240, v240, v48, v49
v_max3_f32 v240, v240, v50, v51
v_max3_f32 v241, v241, v52, v53
v_max3_f32 v241, v241, v54, v55
v_max3_f32 v242, v242, v56, v57
v_max3_f32 v242, v242, v58, v59
v_max3_f32 v243, v243, v60, v61
v_max3_f32 v243, v243, v62, v63
s_add_u32 s7, s32, 12288
s_sub_u32 s7, s7, 73728
buffer_load_dwordx4 a[216:219], v249, s[16:19], s7 offen offset:0
buffer_load_dwordx4 a[220:223], v249, s[16:19], s7 offen offset:64
buffer_load_dwordx4 a[224:227], v249, s[16:19], s7 offen offset:128
buffer_load_dwordx4 a[228:231], v249, s[16:19], s7 offen offset:192
buffer_load_dwordx4 a[232:235], v249, s[16:19], s7 offen offset:256
buffer_load_dwordx4 a[236:239], v249, s[16:19], s7 offen offset:320
s_waitcnt vmcnt(0)
v_mfma_f32_16x16x32_bf16 v[48:51], a[216:219], v[64:67], v[32:35]
v_mfma_f32_16x16x32_bf16 v[48:51], a[220:223], v[96:99], v[48:51]
v_mfma_f32_16x16x32_bf16 v[48:51], a[224:227], v[128:131], v[48:51]
v_mfma_f32_16x16x32_bf16 v[48:51], a[228:231], v[160:163], v[48:51]
v_mfma_f32_16x16x32_bf16 v[48:51], a[232:235], v[192:195], v[48:51]
v_mfma_f32_16x16x32_bf16 v[48:51], a[236:239], v[224:227], v[48:51]
v_mfma_f32_16x16x32_bf16 v[52:55], a[216:219], v[68:71], v[36:39]
v_mfma_f32_16x16x32_bf16 v[52:55], a[220:223], v[100:103], v[52:55]
v_mfma_f32_16x16x32_bf16 v[52:55], a[224:227], v[132:135], v[52:55]
v_mfma_f32_16x16x32_bf16 v[52:55], a[228:231], v[164:167], v[52:55]
v_mfma_f32_16x16x32_bf16 v[52:55], a[232:235], v[196:199], v[52:55]
v_mfma_f32_16x16x32_bf16 v[52:55], a[236:239], v[228:231], v[52:55]
v_mfma_f32_16x16x32_bf16 v[56:59], a[216:219], v[72:75], v[40:43]
v_mfma_f32_16x16x32_bf16 v[56:59], a[220:223], v[104:107], v[56:59]
v_mfma_f32_16x16x32_bf16 v[56:59], a[224:227], v[136:139], v[56:59]
v_mfma_f32_16x16x32_bf16 v[56:59], a[228:231], v[168:171], v[56:59]
v_mfma_f32_16x16x32_bf16 v[56:59], a[232:235], v[200:203], v[56:59]
v_mfma_f32_16x16x32_bf16 v[56:59], a[236:239], v[232:235], v[56:59]
v_mfma_f32_16x16x32_bf16 v[60:63], a[216:219], v[76:79], v[44:47]
v_mfma_f32_16x16x32_bf16 v[60:63], a[220:223], v[108:111], v[60:63]
v_mfma_f32_16x16x32_bf16 v[60:63], a[224:227], v[140:143], v[60:63]
v_mfma_f32_16x16x32_bf16 v[60:63], a[228:231], v[172:175], v[60:63]
v_mfma_f32_16x16x32_bf16 v[60:63], a[232:235], v[204:207], v[60:63]
v_mfma_f32_16x16x32_bf16 v[60:63], a[236:239], v[236:239], v[60:63]
s_nop 7
v_max3_f32 v240, v240, v48, v49
v_max3_f32 v240, v240, v50, v51
v_max3_f32 v241, v241, v52, v53
v_max3_f32 v241, v241, v54, v55
v_max3_f32 v242, v242, v56, v57
v_max3_f32 v242, v242, v58, v59
v_max3_f32 v243, v243, v60, v61
v_max3_f32 v243, v243, v62, v63
s_add_u32 s7, s32, 18432
s_sub_u32 s7, s7, 73728
buffer_load_dwordx4 a[216:219], v249, s[16:19], s7 offen offset:0
buffer_load_dwordx4 a[220:223], v249, s[16:19], s7 offen offset:64
buffer_load_dwordx4 a[224:227], v249, s[16:19], s7 offen offset:128
buffer_load_dwordx4 a[228:231], v249, s[16:19], s7 offen offset:192
buffer_load_dwordx4 a[232:235], v249, s[16:19], s7 offen offset:256
buffer_load_dwordx4 a[236:239], v249, s[16:19], s7 offen offset:320
s_waitcnt vmcnt(0)
v_mfma_f32_16x16x32_bf16 v[48:51], a[216:219], v[64:67], v[32:35]
v_mfma_f32_16x16x32_bf16 v[48:51], a[220:223], v[96:99], v[48:51]
v_mfma_f32_16x16x32_bf16 v[48:51], a[224:227], v[128:131], v[48:51]
v_mfma_f32_16x16x32_bf16 v[48:51], a[228:231], v[160:163], v[48:51]
v_mfma_f32_16x16x32_bf16 v[48:51], a[232:235], v[192:195], v[48:51]
v_mfma_f32_16x16x32_bf16 v[48:51], a[236:239], v[224:227], v[48:51]
v_mfma_f32_16x16x32_bf16 v[52:55], a[216:219], v[68:71], v[36:39]
v_mfma_f32_16x16x32_bf16 v[52:55], a[220:223], v[100:103], v[52:55]
v_mfma_f32_16x16x32_bf16 v[52:55], a[224:227], v[132:135], v[52:55]
v_mfma_f32_16x16x32_bf16 v[52:55], a[228:231], v[164:167], v[52:55]
v_mfma_f32_16x16x32_bf16 v[52:55], a[232:235], v[196:199], v[52:55]
v_mfma_f32_16x16x32_bf16 v[52:55], a[236:239], v[228:231], v[52:55]
v_mfma_f32_16x16x32_bf16 v[56:59], a[216:219], v[72:75], v[40:43]
v_mfma_f32_16x16x32_bf16 v[56:59], a[220:223], v[104:107], v[56:59]
v_mfma_f32_16x16x32_bf16 v[56:59], a[224:227], v[136:139], v[56:59]
v_mfma_f32_16x16x32_bf16 v[56:59], a[228:231], v[168:171], v[56:59]
v_mfma_f32_16x16x32_bf16 v[56:59], a[232:235], v[200:203], v[56:59]
v_mfma_f32_16x16x32_bf16 v[56:59], a[236:239], v[232:235], v[56:59]
v_mfma_f32_16x16x32_bf16 v[60:63], a[216:219], v[76:79], v[44:47]
v_mfma_f32_16x16x32_bf16 v[60:63], a[220:223], v[108:111], v[60:63]
v_mfma_f32_16x16x32_bf16 v[60:63], a[224:227], v[140:143], v[60:63]
v_mfma_f32_16x16x32_bf16 v[60:63], a[228:231], v[172:175], v[60:63]
v_mfma_f32_16x16x32_bf16 v[60:63], a[232:235], v[204:207], v[60:63]
v_mfma_f32_16x16x32_bf16 v[60:63], a[236:239], v[236:239], v[60:63]
s_nop 7
v_max3_f32 v240, v240, v48, v49
v_max3_f32 v240, v240, v50, v51
v_max3_f32 v241, v241, v52, v53
v_max3_f32 v241, v241, v54, v55
v_max3_f32 v242, v242, v56, v57
v_max3_f32 v242, v242, v58, v59
v_max3_f32 v243, v243, v60, v61
v_max3_f32 v243, v243, v62, v63
v_mov_b32 v248, v240
s_nop 1
v_permlane32_swap_b32 v240, v248
v_max_f32 v240, v240, v248
v_mov_b32 v248, v240
s_nop 1
v_permlane16_swap_b32 v240, v248
v_max_f32 v240, v240, v248
v_mov_b32 v248, v241
s_nop 1
v_permlane32_swap_b32 v241, v248
v_max_f32 v241, v241, v248
v_mov_b32 v248, v241
s_nop 1
v_permlane16_swap_b32 v241, v248
v_max_f32 v241, v241, v248
v_mov_b32 v248, v242
s_nop 1
v_permlane32_swap_b32 v242, v248
v_max_f32 v242, v242, v248
v_mov_b32 v248, v242
s_nop 1
v_permlane16_swap_b32 v242, v248
v_max_f32 v242, v242, v248
v_mov_b32 v248, v243
s_nop 1
v_permlane32_swap_b32 v243, v248
v_max_f32 v243, v243, v248
v_mov_b32 v248, v243
s_nop 1
v_permlane16_swap_b32 v243, v248
v_max_f32 v243, v243, v248
v_sub_f32 v32, v32, v240
v_sub_f32 v33, v33, v240
v_sub_f32 v34, v34, v240
v_sub_f32 v35, v35, v240
v_exp_f32 v244, -v240
v_sub_f32 v36, v36, v241
v_sub_f32 v37, v37, v241
v_sub_f32 v38, v38, v241
v_sub_f32 v39, v39, v241
v_exp_f32 v245, -v241
v_sub_f32 v40, v40, v242
v_sub_f32 v41, v41, v242
v_sub_f32 v42, v42, v242
v_sub_f32 v43, v43, v242
v_exp_f32 v246, -v242
v_sub_f32 v44, v44, v243
v_sub_f32 v45, v45, v243
v_sub_f32 v46, v46, v243
v_sub_f32 v47, v47, v243
v_exp_f32 v247, -v243
s_nop 0
v_mul_f32 v12, v12, v244
v_mul_f32 v13, v13, v245
v_mul_f32 v14, v14, v246
v_mul_f32 v15, v15, v247
v_accvgpr_read_b32 v250, a0
v_mul_f32 v250, v250, v244
v_accvgpr_write_b32 a0, v250
v_accvgpr_read_b32 v250, a1
v_mul_f32 v250, v250, v244
v_accvgpr_write_b32 a1, v250
v_accvgpr_read_b32 v250, a2
v_mul_f32 v250, v250, v244
v_accvgpr_write_b32 a2, v250
v_accvgpr_read_b32 v250, a3
v_mul_f32 v250, v250, v244
v_accvgpr_write_b32 a3, v250
v_accvgpr_read_b32 v250, a4
v_mul_f32 v250, v250, v245
v_accvgpr_write_b32 a4, v250
v_accvgpr_read_b32 v250, a5
v_mul_f32 v250, v250, v245
v_accvgpr_write_b32 a5, v250
v_accvgpr_read_b32 v250, a6
v_mul_f32 v250, v250, v245
v_accvgpr_write_b32 a6, v250
v_accvgpr_read_b32 v250, a7
v_mul_f32 v250, v250, v245
v_accvgpr_write_b32 a7, v250
v_accvgpr_read_b32 v250, a8
v_mul_f32 v250, v250, v246
v_accvgpr_write_b32 a8, v250
v_accvgpr_read_b32 v250, a9
v_mul_f32 v250, v250, v246
v_accvgpr_write_b32 a9, v250
v_accvgpr_read_b32 v250, a10
v_mul_f32 v250, v250, v246
v_accvgpr_write_b32 a10, v250
v_accvgpr_read_b32 v250, a11
v_mul_f32 v250, v250, v246
v_accvgpr_write_b32 a11, v250
v_accvgpr_read_b32 v250, a12
v_mul_f32 v250, v250, v247
v_accvgpr_write_b32 a12, v250
v_accvgpr_read_b32 v250, a13
v_mul_f32 v250, v250, v247
v_accvgpr_write_b32 a13, v250
v_accvgpr_read_b32 v250, a14
v_mul_f32 v250, v250, v247
v_accvgpr_write_b32 a14, v250
v_accvgpr_read_b32 v250, a15
v_mul_f32 v250, v250, v247
v_accvgpr_write_b32 a15, v250
v_accvgpr_read_b32 v250, a16
v_mul_f32 v250, v250, v244
v_accvgpr_write_b32 a16, v250
v_accvgpr_read_b32 v250, a17
v_mul_f32 v250, v250, v244
v_accvgpr_write_b32 a17, v250
v_accvgpr_read_b32 v250, a18
v_mul_f32 v250, v250, v244
v_accvgpr_write_b32 a18, v250
v_accvgpr_read_b32 v250, a19
v_mul_f32 v250, v250, v244
v_accvgpr_write_b32 a19, v250
v_accvgpr_read_b32 v250, a20
v_mul_f32 v250, v250, v245
v_accvgpr_write_b32 a20, v250
v_accvgpr_read_b32 v250, a21
v_mul_f32 v250, v250, v245
v_accvgpr_write_b32 a21, v250
v_accvgpr_read_b32 v250, a22
v_mul_f32 v250, v250, v245
v_accvgpr_write_b32 a22, v250
v_accvgpr_read_b32 v250, a23
v_mul_f32 v250, v250, v245
v_accvgpr_write_b32 a23, v250
v_accvgpr_read_b32 v250, a24
v_mul_f32 v250, v250, v246
v_accvgpr_write_b32 a24, v250
v_accvgpr_read_b32 v250, a25
v_mul_f32 v250, v250, v246
v_accvgpr_write_b32 a25, v250
v_accvgpr_read_b32 v250, a26
v_mul_f32 v250, v250, v246
v_accvgpr_write_b32 a26, v250
v_accvgpr_read_b32 v250, a27
v_mul_f32 v250, v250, v246
v_accvgpr_write_b32 a27, v250
v_accvgpr_read_b32 v250, a28
v_mul_f32 v250, v250, v247
v_accvgpr_write_b32 a28, v250
v_accvgpr_read_b32 v250, a29
v_mul_f32 v250, v250, v247
v_accvgpr_write_b32 a29, v250
v_accvgpr_read_b32 v250, a30
v_mul_f32 v250, v250, v247
v_accvgpr_write_b32 a30, v250
v_accvgpr_read_b32 v250, a31
v_mul_f32 v250, v250, v247
v_accvgpr_write_b32 a31, v250
v_accvgpr_read_b32 v250, a32
v_mul_f32 v250, v250, v244
v_accvgpr_write_b32 a32, v250
v_accvgpr_read_b32 v250, a33
v_mul_f32 v250, v250, v244
v_accvgpr_write_b32 a33, v250
v_accvgpr_read_b32 v250, a34
v_mul_f32 v250, v250, v244
v_accvgpr_write_b32 a34, v250
v_accvgpr_read_b32 v250, a35
v_mul_f32 v250, v250, v244
v_accvgpr_write_b32 a35, v250
v_accvgpr_read_b32 v250, a36
v_mul_f32 v250, v250, v245
v_accvgpr_write_b32 a36, v250
v_accvgpr_read_b32 v250, a37
v_mul_f32 v250, v250, v245
v_accvgpr_write_b32 a37, v250
v_accvgpr_read_b32 v250, a38
v_mul_f32 v250, v250, v245
v_accvgpr_write_b32 a38, v250
v_accvgpr_read_b32 v250, a39
v_mul_f32 v250, v250, v245
v_accvgpr_write_b32 a39, v250
v_accvgpr_read_b32 v250, a40
v_mul_f32 v250, v250, v246
v_accvgpr_write_b32 a40, v250
v_accvgpr_read_b32 v250, a41
v_mul_f32 v250, v250, v246
v_accvgpr_write_b32 a41, v250
v_accvgpr_read_b32 v250, a42
v_mul_f32 v250, v250, v246
v_accvgpr_write_b32 a42, v250
v_accvgpr_read_b32 v250, a43
v_mul_f32 v250, v250, v246
v_accvgpr_write_b32 a43, v250
v_accvgpr_read_b32 v250, a44
v_mul_f32 v250, v250, v247
v_accvgpr_write_b32 a44, v250
v_accvgpr_read_b32 v250, a45
v_mul_f32 v250, v250, v247
v_accvgpr_write_b32 a45, v250
v_accvgpr_read_b32 v250, a46
v_mul_f32 v250, v250, v247
v_accvgpr_write_b32 a46, v250
v_accvgpr_read_b32 v250, a47
v_mul_f32 v250, v250, v247
v_accvgpr_write_b32 a47, v250
v_accvgpr_read_b32 v250, a48
v_mul_f32 v250, v250, v244
v_accvgpr_write_b32 a48, v250
v_accvgpr_read_b32 v250, a49
v_mul_f32 v250, v250, v244
v_accvgpr_write_b32 a49, v250
v_accvgpr_read_b32 v250, a50
v_mul_f32 v250, v250, v244
v_accvgpr_write_b32 a50, v250
v_accvgpr_read_b32 v250, a51
v_mul_f32 v250, v250, v244
v_accvgpr_write_b32 a51, v250
v_accvgpr_read_b32 v250, a52
v_mul_f32 v250, v250, v245
v_accvgpr_write_b32 a52, v250
v_accvgpr_read_b32 v250, a53
v_mul_f32 v250, v250, v245
v_accvgpr_write_b32 a53, v250
v_accvgpr_read_b32 v250, a54
v_mul_f32 v250, v250, v245
v_accvgpr_write_b32 a54, v250
v_accvgpr_read_b32 v250, a55
v_mul_f32 v250, v250, v245
v_accvgpr_write_b32 a55, v250
v_accvgpr_read_b32 v250, a56
v_mul_f32 v250, v250, v246
v_accvgpr_write_b32 a56, v250
v_accvgpr_read_b32 v250, a57
v_mul_f32 v250, v250, v246
v_accvgpr_write_b32 a57, v250
v_accvgpr_read_b32 v250, a58
v_mul_f32 v250, v250, v246
v_accvgpr_write_b32 a58, v250
v_accvgpr_read_b32 v250, a59
v_mul_f32 v250, v250, v246
v_accvgpr_write_b32 a59, v250
v_accvgpr_read_b32 v250, a60
v_mul_f32 v250, v250, v247
v_accvgpr_write_b32 a60, v250
v_accvgpr_read_b32 v250, a61
v_mul_f32 v250, v250, v247
v_accvgpr_write_b32 a61, v250
v_accvgpr_read_b32 v250, a62
v_mul_f32 v250, v250, v247
v_accvgpr_write_b32 a62, v250
v_accvgpr_read_b32 v250, a63
v_mul_f32 v250, v250, v247
v_accvgpr_write_b32 a63, v250
v_accvgpr_read_b32 v250, a64
v_mul_f32 v250, v250, v244
v_accvgpr_write_b32 a64, v250
v_accvgpr_read_b32 v250, a65
v_mul_f32 v250, v250, v244
v_accvgpr_write_b32 a65, v250
v_accvgpr_read_b32 v250, a66
v_mul_f32 v250, v250, v244
v_accvgpr_write_b32 a66, v250
v_accvgpr_read_b32 v250, a67
v_mul_f32 v250, v250, v244
v_accvgpr_write_b32 a67, v250
v_accvgpr_read_b32 v250, a68
v_mul_f32 v250, v250, v245
v_accvgpr_write_b32 a68, v250
v_accvgpr_read_b32 v250, a69
v_mul_f32 v250, v250, v245
v_accvgpr_write_b32 a69, v250
v_accvgpr_read_b32 v250, a70
v_mul_f32 v250, v250, v245
v_accvgpr_write_b32 a70, v250
v_accvgpr_read_b32 v250, a71
v_mul_f32 v250, v250, v245
v_accvgpr_write_b32 a71, v250
v_accvgpr_read_b32 v250, a72
v_mul_f32 v250, v250, v246
v_accvgpr_write_b32 a72, v250
v_accvgpr_read_b32 v250, a73
v_mul_f32 v250, v250, v246
v_accvgpr_write_b32 a73, v250
v_accvgpr_read_b32 v250, a74
v_mul_f32 v250, v250, v246
v_accvgpr_write_b32 a74, v250
v_accvgpr_read_b32 v250, a75
v_mul_f32 v250, v250, v246
v_accvgpr_write_b32 a75, v250
v_accvgpr_read_b32 v250, a76
v_mul_f32 v250, v250, v247
v_accvgpr_write_b32 a76, v250
v_accvgpr_read_b32 v250, a77
v_mul_f32 v250, v250, v247
v_accvgpr_write_b32 a77, v250
v_accvgpr_read_b32 v250, a78
v_mul_f32 v250, v250, v247
v_accvgpr_write_b32 a78, v250
v_accvgpr_read_b32 v250, a79
v_mul_f32 v250, v250, v247
v_accvgpr_write_b32 a79, v250
v_accvgpr_read_b32 v250, a80
v_mul_f32 v250, v250, v244
v_accvgpr_write_b32 a80, v250
v_accvgpr_read_b32 v250, a81
v_mul_f32 v250, v250, v244
v_accvgpr_write_b32 a81, v250
v_accvgpr_read_b32 v250, a82
v_mul_f32 v250, v250, v244
v_accvgpr_write_b32 a82, v250
v_accvgpr_read_b32 v250, a83
v_mul_f32 v250, v250, v244
v_accvgpr_write_b32 a83, v250
v_accvgpr_read_b32 v250, a84
v_mul_f32 v250, v250, v245
v_accvgpr_write_b32 a84, v250
v_accvgpr_read_b32 v250, a85
v_mul_f32 v250, v250, v245
v_accvgpr_write_b32 a85, v250
v_accvgpr_read_b32 v250, a86
v_mul_f32 v250, v250, v245
v_accvgpr_write_b32 a86, v250
v_accvgpr_read_b32 v250, a87
v_mul_f32 v250, v250, v245
v_accvgpr_write_b32 a87, v250
v_accvgpr_read_b32 v250, a88
v_mul_f32 v250, v250, v246
v_accvgpr_write_b32 a88, v250
v_accvgpr_read_b32 v250, a89
v_mul_f32 v250, v250, v246
v_accvgpr_write_b32 a89, v250
v_accvgpr_read_b32 v250, a90
v_mul_f32 v250, v250, v246
v_accvgpr_write_b32 a90, v250
v_accvgpr_read_b32 v250, a91
v_mul_f32 v250, v250, v246
v_accvgpr_write_b32 a91, v250
v_accvgpr_read_b32 v250, a92
v_mul_f32 v250, v250, v247
v_accvgpr_write_b32 a92, v250
v_accvgpr_read_b32 v250, a93
v_mul_f32 v250, v250, v247
v_accvgpr_write_b32 a93, v250
v_accvgpr_read_b32 v250, a94
v_mul_f32 v250, v250, v247
v_accvgpr_write_b32 a94, v250
v_accvgpr_read_b32 v250, a95
v_mul_f32 v250, v250, v247
v_accvgpr_write_b32 a95, v250
v_accvgpr_read_b32 v250, a96
v_mul_f32 v250, v250, v244
v_accvgpr_write_b32 a96, v250
v_accvgpr_read_b32 v250, a97
v_mul_f32 v250, v250, v244
v_accvgpr_write_b32 a97, v250
v_accvgpr_read_b32 v250, a98
v_mul_f32 v250, v250, v244
v_accvgpr_write_b32 a98, v250
v_accvgpr_read_b32 v250, a99
v_mul_f32 v250, v250, v244
v_accvgpr_write_b32 a99, v250
v_accvgpr_read_b32 v250, a100
v_mul_f32 v250, v250, v245
v_accvgpr_write_b32 a100, v250
v_accvgpr_read_b32 v250, a101
v_mul_f32 v250, v250, v245
v_accvgpr_write_b32 a101, v250
v_accvgpr_read_b32 v250, a102
v_mul_f32 v250, v250, v245
v_accvgpr_write_b32 a102, v250
v_accvgpr_read_b32 v250, a103
v_mul_f32 v250, v250, v245
v_accvgpr_write_b32 a103, v250
v_accvgpr_read_b32 v250, a104
v_mul_f32 v250, v250, v246
v_accvgpr_write_b32 a104, v250
v_accvgpr_read_b32 v250, a105
v_mul_f32 v250, v250, v246
v_accvgpr_write_b32 a105, v250
v_accvgpr_read_b32 v250, a106
v_mul_f32 v250, v250, v246
v_accvgpr_write_b32 a106, v250
v_accvgpr_read_b32 v250, a107
v_mul_f32 v250, v250, v246
v_accvgpr_write_b32 a107, v250
v_accvgpr_read_b32 v250, a108
v_mul_f32 v250, v250, v247
v_accvgpr_write_b32 a108, v250
v_accvgpr_read_b32 v250, a109
v_mul_f32 v250, v250, v247
v_accvgpr_write_b32 a109, v250
v_accvgpr_read_b32 v250, a110
v_mul_f32 v250, v250, v247
v_accvgpr_write_b32 a110, v250
v_accvgpr_read_b32 v250, a111
v_mul_f32 v250, v250, v247
v_accvgpr_write_b32 a111, v250
v_accvgpr_read_b32 v250, a112
v_mul_f32 v250, v250, v244
v_accvgpr_write_b32 a112, v250
v_accvgpr_read_b32 v250, a113
v_mul_f32 v250, v250, v244
v_accvgpr_write_b32 a113, v250
v_accvgpr_read_b32 v250, a114
v_mul_f32 v250, v250, v244
v_accvgpr_write_b32 a114, v250
v_accvgpr_read_b32 v250, a115
v_mul_f32 v250, v250, v244
v_accvgpr_write_b32 a115, v250
v_accvgpr_read_b32 v250, a116
v_mul_f32 v250, v250, v245
v_accvgpr_write_b32 a116, v250
v_accvgpr_read_b32 v250, a117
v_mul_f32 v250, v250, v245
v_accvgpr_write_b32 a117, v250
v_accvgpr_read_b32 v250, a118
v_mul_f32 v250, v250, v245
v_accvgpr_write_b32 a118, v250
v_accvgpr_read_b32 v250, a119
v_mul_f32 v250, v250, v245
v_accvgpr_write_b32 a119, v250
v_accvgpr_read_b32 v250, a120
v_mul_f32 v250, v250, v246
v_accvgpr_write_b32 a120, v250
v_accvgpr_read_b32 v250, a121
v_mul_f32 v250, v250, v246
v_accvgpr_write_b32 a121, v250
v_accvgpr_read_b32 v250, a122
v_mul_f32 v250, v250, v246
v_accvgpr_write_b32 a122, v250
v_accvgpr_read_b32 v250, a123
v_mul_f32 v250, v250, v246
v_accvgpr_write_b32 a123, v250
v_accvgpr_read_b32 v250, a124
v_mul_f32 v250, v250, v247
v_accvgpr_write_b32 a124, v250
v_accvgpr_read_b32 v250, a125
v_mul_f32 v250, v250, v247
v_accvgpr_write_b32 a125, v250
v_accvgpr_read_b32 v250, a126
v_mul_f32 v250, v250, v247
v_accvgpr_write_b32 a126, v250
v_accvgpr_read_b32 v250, a127
v_mul_f32 v250, v250, v247
v_accvgpr_write_b32 a127, v250
v_accvgpr_read_b32 v250, a128
v_mul_f32 v250, v250, v244
v_accvgpr_write_b32 a128, v250
v_accvgpr_read_b32 v250, a129
v_mul_f32 v250, v250, v244
v_accvgpr_write_b32 a129, v250
v_accvgpr_read_b32 v250, a130
v_mul_f32 v250, v250, v244
v_accvgpr_write_b32 a130, v250
v_accvgpr_read_b32 v250, a131
v_mul_f32 v250, v250, v244
v_accvgpr_write_b32 a131, v250
v_accvgpr_read_b32 v250, a132
v_mul_f32 v250, v250, v245
v_accvgpr_write_b32 a132, v250
v_accvgpr_read_b32 v250, a133
v_mul_f32 v250, v250, v245
v_accvgpr_write_b32 a133, v250
v_accvgpr_read_b32 v250, a134
v_mul_f32 v250, v250, v245
v_accvgpr_write_b32 a134, v250
v_accvgpr_read_b32 v250, a135
v_mul_f32 v250, v250, v245
v_accvgpr_write_b32 a135, v250
v_accvgpr_read_b32 v250, a136
v_mul_f32 v250, v250, v246
v_accvgpr_write_b32 a136, v250
v_accvgpr_read_b32 v250, a137
v_mul_f32 v250, v250, v246
v_accvgpr_write_b32 a137, v250
v_accvgpr_read_b32 v250, a138
v_mul_f32 v250, v250, v246
v_accvgpr_write_b32 a138, v250
v_accvgpr_read_b32 v250, a139
v_mul_f32 v250, v250, v246
v_accvgpr_write_b32 a139, v250
v_accvgpr_read_b32 v250, a140
v_mul_f32 v250, v250, v247
v_accvgpr_write_b32 a140, v250
v_accvgpr_read_b32 v250, a141
v_mul_f32 v250, v250, v247
v_accvgpr_write_b32 a141, v250
v_accvgpr_read_b32 v250, a142
v_mul_f32 v250, v250, v247
v_accvgpr_write_b32 a142, v250
v_accvgpr_read_b32 v250, a143
v_mul_f32 v250, v250, v247
v_accvgpr_write_b32 a143, v250
v_accvgpr_read_b32 v250, a144
v_mul_f32 v250, v250, v244
v_accvgpr_write_b32 a144, v250
v_accvgpr_read_b32 v250, a145
v_mul_f32 v250, v250, v244
v_accvgpr_write_b32 a145, v250
v_accvgpr_read_b32 v250, a146
v_mul_f32 v250, v250, v244
v_accvgpr_write_b32 a146, v250
v_accvgpr_read_b32 v250, a147
v_mul_f32 v250, v250, v244
v_accvgpr_write_b32 a147, v250
v_accvgpr_read_b32 v250, a148
v_mul_f32 v250, v250, v245
v_accvgpr_write_b32 a148, v250
v_accvgpr_read_b32 v250, a149
v_mul_f32 v250, v250, v245
v_accvgpr_write_b32 a149, v250
v_accvgpr_read_b32 v250, a150
v_mul_f32 v250, v250, v245
v_accvgpr_write_b32 a150, v250
v_accvgpr_read_b32 v250, a151
v_mul_f32 v250, v250, v245
v_accvgpr_write_b32 a151, v250
v_accvgpr_read_b32 v250, a152
v_mul_f32 v250, v250, v246
v_accvgpr_write_b32 a152, v250
v_accvgpr_read_b32 v250, a153
v_mul_f32 v250, v250, v246
v_accvgpr_write_b32 a153, v250
v_accvgpr_read_b32 v250, a154
v_mul_f32 v250, v250, v246
v_accvgpr_write_b32 a154, v250
v_accvgpr_read_b32 v250, a155
v_mul_f32 v250, v250, v246
v_accvgpr_write_b32 a155, v250
v_accvgpr_read_b32 v250, a156
v_mul_f32 v250, v250, v247
v_accvgpr_write_b32 a156, v250
v_accvgpr_read_b32 v250, a157
v_mul_f32 v250, v250, v247
v_accvgpr_write_b32 a157, v250
v_accvgpr_read_b32 v250, a158
v_mul_f32 v250, v250, v247
v_accvgpr_write_b32 a158, v250
v_accvgpr_read_b32 v250, a159
v_mul_f32 v250, v250, v247
v_accvgpr_write_b32 a159, v250
v_accvgpr_read_b32 v250, a160
v_mul_f32 v250, v250, v244
v_accvgpr_write_b32 a160, v250
v_accvgpr_read_b32 v250, a161
v_mul_f32 v250, v250, v244
v_accvgpr_write_b32 a161, v250
v_accvgpr_read_b32 v250, a162
v_mul_f32 v250, v250, v244
v_accvgpr_write_b32 a162, v250
v_accvgpr_read_b32 v250, a163
v_mul_f32 v250, v250, v244
v_accvgpr_write_b32 a163, v250
v_accvgpr_read_b32 v250, a164
v_mul_f32 v250, v250, v245
v_accvgpr_write_b32 a164, v250
v_accvgpr_read_b32 v250, a165
v_mul_f32 v250, v250, v245
v_accvgpr_write_b32 a165, v250
v_accvgpr_read_b32 v250, a166
v_mul_f32 v250, v250, v245
v_accvgpr_write_b32 a166, v250
v_accvgpr_read_b32 v250, a167
v_mul_f32 v250, v250, v245
v_accvgpr_write_b32 a167, v250
v_accvgpr_read_b32 v250, a168
v_mul_f32 v250, v250, v246
v_accvgpr_write_b32 a168, v250
v_accvgpr_read_b32 v250, a169
v_mul_f32 v250, v250, v246
v_accvgpr_write_b32 a169, v250
v_accvgpr_read_b32 v250, a170
v_mul_f32 v250, v250, v246
v_accvgpr_write_b32 a170, v250
v_accvgpr_read_b32 v250, a171
v_mul_f32 v250, v250, v246
v_accvgpr_write_b32 a171, v250
v_accvgpr_read_b32 v250, a172
v_mul_f32 v250, v250, v247
v_accvgpr_write_b32 a172, v250
v_accvgpr_read_b32 v250, a173
v_mul_f32 v250, v250, v247
v_accvgpr_write_b32 a173, v250
v_accvgpr_read_b32 v250, a174
v_mul_f32 v250, v250, v247
v_accvgpr_write_b32 a174, v250
v_accvgpr_read_b32 v250, a175
v_mul_f32 v250, v250, v247
v_accvgpr_write_b32 a175, v250
v_accvgpr_read_b32 v250, a176
v_mul_f32 v250, v250, v244
v_accvgpr_write_b32 a176, v250
v_accvgpr_read_b32 v250, a177
v_mul_f32 v250, v250, v244
v_accvgpr_write_b32 a177, v250
v_accvgpr_read_b32 v250, a178
v_mul_f32 v250, v250, v244
v_accvgpr_write_b32 a178, v250
v_accvgpr_read_b32 v250, a179
v_mul_f32 v250, v250, v244
v_accvgpr_write_b32 a179, v250
v_accvgpr_read_b32 v250, a180
v_mul_f32 v250, v250, v245
v_accvgpr_write_b32 a180, v250
v_accvgpr_read_b32 v250, a181
v_mul_f32 v250, v250, v245
v_accvgpr_write_b32 a181, v250
v_accvgpr_read_b32 v250, a182
v_mul_f32 v250, v250, v245
v_accvgpr_write_b32 a182, v250
v_accvgpr_read_b32 v250, a183
v_mul_f32 v250, v250, v245
v_accvgpr_write_b32 a183, v250
v_accvgpr_read_b32 v250, a184
v_mul_f32 v250, v250, v246
v_accvgpr_write_b32 a184, v250
v_accvgpr_read_b32 v250, a185
v_mul_f32 v250, v250, v246
v_accvgpr_write_b32 a185, v250
v_accvgpr_read_b32 v250, a186
v_mul_f32 v250, v250, v246
v_accvgpr_write_b32 a186, v250
v_accvgpr_read_b32 v250, a187
v_mul_f32 v250, v250, v246
v_accvgpr_write_b32 a187, v250
v_accvgpr_read_b32 v250, a188
v_mul_f32 v250, v250, v247
v_accvgpr_write_b32 a188, v250
v_accvgpr_read_b32 v250, a189
v_mul_f32 v250, v250, v247
v_accvgpr_write_b32 a189, v250
v_accvgpr_read_b32 v250, a190
v_mul_f32 v250, v250, v247
v_accvgpr_write_b32 a190, v250
v_accvgpr_read_b32 v250, a191
v_mul_f32 v250, v250, v247
v_accvgpr_write_b32 a191, v250
s_add_u32 s7, s32, 0
s_sub_u32 s7, s7, 73728
buffer_load_dwordx4 a[216:219], v249, s[16:19], s7 offen offset:0
buffer_load_dwordx4 a[220:223], v249, s[16:19], s7 offen offset:64
buffer_load_dwordx4 a[224:227], v249, s[16:19], s7 offen offset:128
buffer_load_dwordx4 a[228:231], v249, s[16:19], s7 offen offset:192
buffer_load_dwordx4 a[232:235], v249, s[16:19], s7 offen offset:256
buffer_load_dwordx4 a[236:239], v249, s[16:19], s7 offen offset:320
s_waitcnt vmcnt(0)
v_mfma_f32_16x16x32_bf16 v[48:51], a[216:219], v[64:67], v[32:35]
v_mfma_f32_16x16x32_bf16 v[48:51], a[220:223], v[96:99], v[48:51]
v_mfma_f32_16x16x32_bf16 v[48:51], a[224:227], v[128:131], v[48:51]
v_mfma_f32_16x16x32_bf16 v[48:51], a[228:231], v[160:163], v[48:51]
v_mfma_f32_16x16x32_bf16 v[48:51], a[232:235], v[192:195], v[48:51]
v_mfma_f32_16x16x32_bf16 v[48:51], a[236:239], v[224:227], v[48:51]
v_mfma_f32_16x16x32_bf16 v[52:55], a[216:219], v[68:71], v[36:39]
v_mfma_f32_16x16x32_bf16 v[52:55], a[220:223], v[100:103], v[52:55]
v_mfma_f32_16x16x32_bf16 v[52:55], a[224:227], v[132:135], v[52:55]
v_mfma_f32_16x16x32_bf16 v[52:55], a[228:231], v[164:167], v[52:55]
v_mfma_f32_16x16x32_bf16 v[52:55], a[232:235], v[196:199], v[52:55]
v_mfma_f32_16x16x32_bf16 v[52:55], a[236:239], v[228:231], v[52:55]
v_mfma_f32_16x16x32_bf16 v[56:59], a[216:219], v[72:75], v[40:43]
v_mfma_f32_16x16x32_bf16 v[56:59], a[220:223], v[104:107], v[56:59]
v_mfma_f32_16x16x32_bf16 v[56:59], a[224:227], v[136:139], v[56:59]
v_mfma_f32_16x16x32_bf16 v[56:59], a[228:231], v[168:171], v[56:59]
v_mfma_f32_16x16x32_bf16 v[56:59], a[232:235], v[200:203], v[56:59]
v_mfma_f32_16x16x32_bf16 v[56:59], a[236:239], v[232:235], v[56:59]
v_mfma_f32_16x16x32_bf16 v[60:63], a[216:219], v[76:79], v[44:47]
v_mfma_f32_16x16x32_bf16 v[60:63], a[220:223], v[108:111], v[60:63]
v_mfma_f32_16x16x32_bf16 v[60:63], a[224:227], v[140:143], v[60:63]
v_mfma_f32_16x16x32_bf16 v[60:63], a[228:231], v[172:175], v[60:63]
v_mfma_f32_16x16x32_bf16 v[60:63], a[232:235], v[204:207], v[60:63]
v_mfma_f32_16x16x32_bf16 v[60:63], a[236:239], v[236:239], v[60:63]
s_nop 7
v_exp_f32 v48, v48
v_exp_f32 v49, v49
v_exp_f32 v50, v50
v_add_f32 v16, v48, v49
v_cvt_pk_bf16_f32 v80, v48, v49
v_exp_f32 v51, v51
v_add_f32 v16, v16, v50
v_add_f32 v16, v16, v51
v_cvt_pk_bf16_f32 v81, v50, v51
v_exp_f32 v52, v52
v_exp_f32 v53, v53
v_exp_f32 v54, v54
v_add_f32 v17, v52, v53
v_cvt_pk_bf16_f32 v88, v52, v53
v_exp_f32 v55, v55
v_add_f32 v17, v17, v54
v_add_f32 v17, v17, v55
v_cvt_pk_bf16_f32 v89, v54, v55
v_exp_f32 v56, v56
v_exp_f32 v57, v57
v_exp_f32 v58, v58
v_add_f32 v18, v56, v57
v_cvt_pk_bf16_f32 v112, v56, v57
v_exp_f32 v59, v59
v_add_f32 v18, v18, v58
v_add_f32 v18, v18, v59
v_cvt_pk_bf16_f32 v113, v58, v59
v_exp_f32 v60, v60
v_exp_f32 v61, v61
v_exp_f32 v62, v62
v_add_f32 v19, v60, v61
v_cvt_pk_bf16_f32 v120, v60, v61
v_exp_f32 v63, v63
v_add_f32 v19, v19, v62
v_add_f32 v19, v19, v63
v_cvt_pk_bf16_f32 v121, v62, v63
s_add_u32 s7, s32, 6144
s_sub_u32 s7, s7, 73728
buffer_load_dwordx4 a[216:219], v249, s[16:19], s7 offen offset:0
buffer_load_dwordx4 a[220:223], v249, s[16:19], s7 offen offset:64
buffer_load_dwordx4 a[224:227], v249, s[16:19], s7 offen offset:128
buffer_load_dwordx4 a[228:231], v249, s[16:19], s7 offen offset:192
buffer_load_dwordx4 a[232:235], v249, s[16:19], s7 offen offset:256
buffer_load_dwordx4 a[236:239], v249, s[16:19], s7 offen offset:320
s_waitcnt vmcnt(0)
v_mfma_f32_16x16x32_bf16 v[48:51], a[216:219], v[64:67], v[32:35]
v_mfma_f32_16x16x32_bf16 v[48:51], a[220:223], v[96:99], v[48:51]
v_mfma_f32_16x16x32_bf16 v[48:51], a[224:227], v[128:131], v[48:51]
v_mfma_f32_16x16x32_bf16 v[48:51], a[228:231], v[160:163], v[48:51]
v_mfma_f32_16x16x32_bf16 v[48:51], a[232:235], v[192:195], v[48:51]
v_mfma_f32_16x16x32_bf16 v[48:51], a[236:239], v[224:227], v[48:51]
v_mfma_f32_16x16x32_bf16 v[52:55], a[216:219], v[68:71], v[36:39]
v_mfma_f32_16x16x32_bf16 v[52:55], a[220:223], v[100:103], v[52:55]
v_mfma_f32_16x16x32_bf16 v[52:55], a[224:227], v[132:135], v[52:55]
v_mfma_f32_16x16x32_bf16 v[52:55], a[228:231], v[164:167], v[52:55]
v_mfma_f32_16x16x32_bf16 v[52:55], a[232:235], v[196:199], v[52:55]
v_mfma_f32_16x16x32_bf16 v[52:55], a[236:239], v[228:231], v[52:55]
v_mfma_f32_16x16x32_bf16 v[56:59], a[216:219], v[72:75], v[40:43]
v_mfma_f32_16x16x32_bf16 v[56:59], a[220:223], v[104:107], v[56:59]
v_mfma_f32_16x16x32_bf16 v[56:59], a[224:227], v[136:139], v[56:59]
v_mfma_f32_16x16x32_bf16 v[56:59], a[228:231], v[168:171], v[56:59]
v_mfma_f32_16x16x32_bf16 v[56:59], a[232:235], v[200:203], v[56:59]
v_mfma_f32_16x16x32_bf16 v[56:59], a[236:239], v[232:235], v[56:59]
v_mfma_f32_16x16x32_bf16 v[60:63], a[216:219], v[76:79], v[44:47]
v_mfma_f32_16x16x32_bf16 v[60:63], a[220:223], v[108:111], v[60:63]
v_mfma_f32_16x16x32_bf16 v[60:63], a[224:227], v[140:143], v[60:63]
v_mfma_f32_16x16x32_bf16 v[60:63], a[228:231], v[172:175], v[60:63]
v_mfma_f32_16x16x32_bf16 v[60:63], a[232:235], v[204:207], v[60:63]
v_mfma_f32_16x16x32_bf16 v[60:63], a[236:239], v[236:239], v[60:63]
s_nop 7
v_exp_f32 v48, v48
v_exp_f32 v49, v49
v_add_f32 v16, v16, v48
v_exp_f32 v50, v50
v_add_f32 v16, v16, v49
v_cvt_pk_bf16_f32 v82, v48, v49
v_exp_f32 v51, v51
v_add_f32 v16, v16, v50
v_add_f32 v16, v16, v51
v_cvt_pk_bf16_f32 v83, v50, v51
v_exp_f32 v52, v52
v_exp_f32 v53, v53
v_add_f32 v17, v17, v52
v_exp_f32 v54, v54
v_add_f32 v17, v17, v53
v_cvt_pk_bf16_f32 v90, v52, v53
v_exp_f32 v55, v55
v_add_f32 v17, v17, v54
v_add_f32 v17, v17, v55
v_cvt_pk_bf16_f32 v91, v54, v55
v_exp_f32 v56, v56
v_exp_f32 v57, v57
v_add_f32 v18, v18, v56
v_exp_f32 v58, v58
v_add_f32 v18, v18, v57
v_cvt_pk_bf16_f32 v114, v56, v57
v_exp_f32 v59, v59
v_add_f32 v18, v18, v58
v_add_f32 v18, v18, v59
v_cvt_pk_bf16_f32 v115, v58, v59
v_exp_f32 v60, v60
v_exp_f32 v61, v61
v_add_f32 v19, v19, v60
v_exp_f32 v62, v62
v_add_f32 v19, v19, v61
v_cvt_pk_bf16_f32 v122, v60, v61
v_exp_f32 v63, v63
v_add_f32 v19, v19, v62
v_add_f32 v19, v19, v63
v_cvt_pk_bf16_f32 v123, v62, v63
s_add_u32 s7, s32, 12288
s_sub_u32 s7, s7, 73728
buffer_load_dwordx4 a[216:219], v249, s[16:19], s7 offen offset:0
buffer_load_dwordx4 a[220:223], v249, s[16:19], s7 offen offset:64
buffer_load_dwordx4 a[224:227], v249, s[16:19], s7 offen offset:128
buffer_load_dwordx4 a[228:231], v249, s[16:19], s7 offen offset:192
buffer_load_dwordx4 a[232:235], v249, s[16:19], s7 offen offset:256
buffer_load_dwordx4 a[236:239], v249, s[16:19], s7 offen offset:320
s_waitcnt vmcnt(0)
v_mfma_f32_16x16x32_bf16 v[48:51], a[216:219], v[64:67], v[32:35]
v_mfma_f32_16x16x32_bf16 v[48:51], a[220:223], v[96:99], v[48:51]
v_mfma_f32_16x16x32_bf16 v[48:51], a[224:227], v[128:131], v[48:51]
v_mfma_f32_16x16x32_bf16 v[48:51], a[228:231], v[160:163], v[48:51]
v_mfma_f32_16x16x32_bf16 v[48:51], a[232:235], v[192:195], v[48:51]
v_mfma_f32_16x16x32_bf16 v[48:51], a[236:239], v[224:227], v[48:51]
v_mfma_f32_16x16x32_bf16 v[52:55], a[216:219], v[68:71], v[36:39]
v_mfma_f32_16x16x32_bf16 v[52:55], a[220:223], v[100:103], v[52:55]
v_mfma_f32_16x16x32_bf16 v[52:55], a[224:227], v[132:135], v[52:55]
v_mfma_f32_16x16x32_bf16 v[52:55], a[228:231], v[164:167], v[52:55]
v_mfma_f32_16x16x32_bf16 v[52:55], a[232:235], v[196:199], v[52:55]
v_mfma_f32_16x16x32_bf16 v[52:55], a[236:239], v[228:231], v[52:55]
v_mfma_f32_16x16x32_bf16 v[56:59], a[216:219], v[72:75], v[40:43]
v_mfma_f32_16x16x32_bf16 v[56:59], a[220:223], v[104:107], v[56:59]
v_mfma_f32_16x16x32_bf16 v[56:59], a[224:227], v[136:139], v[56:59]
v_mfma_f32_16x16x32_bf16 v[56:59], a[228:231], v[168:171], v[56:59]
v_mfma_f32_16x16x32_bf16 v[56:59], a[232:235], v[200:203], v[56:59]
v_mfma_f32_16x16x32_bf16 v[56:59], a[236:239], v[232:235], v[56:59]
v_mfma_f32_16x16x32_bf16 v[60:63], a[216:219], v[76:79], v[44:47]
v_mfma_f32_16x16x32_bf16 v[60:63], a[220:223], v[108:111], v[60:63]
v_mfma_f32_16x16x32_bf16 v[60:63], a[224:227], v[140:143], v[60:63]
v_mfma_f32_16x16x32_bf16 v[60:63], a[228:231], v[172:175], v[60:63]
v_mfma_f32_16x16x32_bf16 v[60:63], a[232:235], v[204:207], v[60:63]
v_mfma_f32_16x16x32_bf16 v[60:63], a[236:239], v[236:239], v[60:63]
s_nop 7
v_exp_f32 v48, v48
v_exp_f32 v49, v49
v_add_f32 v16, v16, v48
v_exp_f32 v50, v50
v_add_f32 v16, v16, v49
v_cvt_pk_bf16_f32 v84, v48, v49
v_exp_f32 v51, v51
v_add_f32 v16, v16, v50
v_add_f32 v16, v16, v51
v_cvt_pk_bf16_f32 v85, v50, v51
v_exp_f32 v52, v52
v_exp_f32 v53, v53
v_add_f32 v17, v17, v52
v_exp_f32 v54, v54
v_add_f32 v17, v17, v53
v_cvt_pk_bf16_f32 v92, v52, v53
v_exp_f32 v55, v55
v_add_f32 v17, v17, v54
v_add_f32 v17, v17, v55
v_cvt_pk_bf16_f32 v93, v54, v55
v_exp_f32 v56, v56
v_exp_f32 v57, v57
v_add_f32 v18, v18, v56
v_exp_f32 v58, v58
v_add_f32 v18, v18, v57
v_cvt_pk_bf16_f32 v116, v56, v57
v_exp_f32 v59, v59
v_add_f32 v18, v18, v58
v_add_f32 v18, v18, v59
v_cvt_pk_bf16_f32 v117, v58, v59
v_exp_f32 v60, v60
v_exp_f32 v61, v61
v_add_f32 v19, v19, v60
v_exp_f32 v62, v62
v_add_f32 v19, v19, v61
v_cvt_pk_bf16_f32 v124, v60, v61
v_exp_f32 v63, v63
v_add_f32 v19, v19, v62
v_add_f32 v19, v19, v63
v_cvt_pk_bf16_f32 v125, v62, v63
s_add_u32 s7, s32, 18432
s_sub_u32 s7, s7, 73728
buffer_load_dwordx4 a[216:219], v249, s[16:19], s7 offen offset:0
buffer_load_dwordx4 a[220:223], v249, s[16:19], s7 offen offset:64
buffer_load_dwordx4 a[224:227], v249, s[16:19], s7 offen offset:128
buffer_load_dwordx4 a[228:231], v249, s[16:19], s7 offen offset:192
buffer_load_dwordx4 a[232:235], v249, s[16:19], s7 offen offset:256
buffer_load_dwordx4 a[236:239], v249, s[16:19], s7 offen offset:320
s_waitcnt vmcnt(0)
v_mfma_f32_16x16x32_bf16 v[48:51], a[216:219], v[64:67], v[32:35]
v_mfma_f32_16x16x32_bf16 v[48:51], a[220:223], v[96:99], v[48:51]
v_mfma_f32_16x16x32_bf16 v[48:51], a[224:227], v[128:131], v[48:51]
v_mfma_f32_16x16x32_bf16 v[48:51], a[228:231], v[160:163], v[48:51]
v_mfma_f32_16x16x32_bf16 v[48:51], a[232:235], v[192:195], v[48:51]
v_mfma_f32_16x16x32_bf16 v[48:51], a[236:239], v[224:227], v[48:51]
v_mfma_f32_16x16x32_bf16 v[52:55], a[216:219], v[68:71], v[36:39]
v_mfma_f32_16x16x32_bf16 v[52:55], a[220:223], v[100:103], v[52:55]
v_mfma_f32_16x16x32_bf16 v[52:55], a[224:227], v[132:135], v[52:55]
v_mfma_f32_16x16x32_bf16 v[52:55], a[228:231], v[164:167], v[52:55]
v_mfma_f32_16x16x32_bf16 v[52:55], a[232:235], v[196:199], v[52:55]
v_mfma_f32_16x16x32_bf16 v[52:55], a[236:239], v[228:231], v[52:55]
v_mfma_f32_16x16x32_bf16 v[56:59], a[216:219], v[72:75], v[40:43]
v_mfma_f32_16x16x32_bf16 v[56:59], a[220:223], v[104:107], v[56:59]
v_mfma_f32_16x16x32_bf16 v[56:59], a[224:227], v[136:139], v[56:59]
v_mfma_f32_16x16x32_bf16 v[56:59], a[228:231], v[168:171], v[56:59]
v_mfma_f32_16x16x32_bf16 v[56:59], a[232:235], v[200:203], v[56:59]
v_mfma_f32_16x16x32_bf16 v[56:59], a[236:239], v[232:235], v[56:59]
v_mfma_f32_16x16x32_bf16 v[60:63], a[216:219], v[76:79], v[44:47]
v_mfma_f32_16x16x32_bf16 v[60:63], a[220:223], v[108:111], v[60:63]
v_mfma_f32_16x16x32_bf16 v[60:63], a[224:227], v[140:143], v[60:63]
v_mfma_f32_16x16x32_bf16 v[60:63], a[228:231], v[172:175], v[60:63]
v_mfma_f32_16x16x32_bf16 v[60:63], a[232:235], v[204:207], v[60:63]
v_mfma_f32_16x16x32_bf16 v[60:63], a[236:239], v[236:239], v[60:63]
s_nop 7
v_exp_f32 v48, v48
v_exp_f32 v49, v49
v_add_f32 v16, v16, v48
v_exp_f32 v50, v50
v_add_f32 v16, v16, v49
v_cvt_pk_bf16_f32 v86, v48, v49
v_exp_f32 v51, v51
v_add_f32 v16, v16, v50
v_add_f32 v16, v16, v51
v_cvt_pk_bf16_f32 v87, v50, v51
v_exp_f32 v52, v52
v_exp_f32 v53, v53
v_add_f32 v17, v17, v52
v_exp_f32 v54, v54
v_add_f32 v17, v17, v53
v_cvt_pk_bf16_f32 v94, v52, v53
v_exp_f32 v55, v55
v_add_f32 v17, v17, v54
v_add_f32 v17, v17, v55
v_cvt_pk_bf16_f32 v95, v54, v55
v_exp_f32 v56, v56
v_exp_f32 v57, v57
v_add_f32 v18, v18, v56
v_exp_f32 v58, v58
v_add_f32 v18, v18, v57
v_cvt_pk_bf16_f32 v118, v56, v57
v_exp_f32 v59, v59
v_add_f32 v18, v18, v58
v_add_f32 v18, v18, v59
v_cvt_pk_bf16_f32 v119, v58, v59
v_exp_f32 v60, v60
v_exp_f32 v61, v61
v_add_f32 v19, v19, v60
v_exp_f32 v62, v62
v_add_f32 v19, v19, v61
v_cvt_pk_bf16_f32 v126, v60, v61
v_exp_f32 v63, v63
v_add_f32 v19, v19, v62
v_add_f32 v19, v19, v63
v_cvt_pk_bf16_f32 v127, v62, v63
s_nop 4
s_setpc_b64 s[30:31]
L_rare_1:
s_waitcnt vmcnt(0) lgkmcnt(0)
s_nop 15
v_lshrrev_b32 v250, 4, v11
v_and_b32 v249, 15, v250
v_mul_u32_u24 v249, 384, v249
v_lshrrev_b32 v250, 4, v250
v_lshl_add_u32 v249, v250, 4, v249
v_mov_b32 v240, 0x0
v_mov_b32 v241, 0x0
v_mov_b32 v242, 0x0
v_mov_b32 v243, 0x0
s_add_u32 s7, s32, 0
s_sub_u32 s7, s7, 73728
buffer_load_dwordx4 a[216:219], v249, s[16:19], s7 offen offset:0
buffer_load_dwordx4 a[220:223], v249, s[16:19], s7 offen offset:64
buffer_load_dwordx4 a[224:227], v249, s[16:19], s7 offen offset:128
buffer_load_dwordx4 a[228:231], v249, s[16:19], s7 offen offset:192
buffer_load_dwordx4 a[232:235], v249, s[16:19], s7 offen offset:256
buffer_load_dwordx4 a[236:239], v249, s[16:19], s7 offen offset:320
s_waitcnt vmcnt(0)
v_mfma_f32_16x16x32_bf16 v[48:51], a[216:219], v[64:67], v[32:35]
v_mfma_f32_16x16x32_bf16 v[48:51], a[220:223], v[96:99], v[48:51]
v_mfma_f32_16x16x32_bf16 v[48:51], a[224:227], v[128:131], v[48:51]
v_mfma_f32_16x16x32_bf16 v[48:51], a[228:231], v[160:163], v[48:51]
v_mfma_f32_16x16x32_bf16 v[48:51], a[232:235], v[192:195], v[48:51]
v_mfma_f32_16x16x32_bf16 v[48:51], a[236:239], v[224:227], v[48:51]
v_mfma_f32_16x16x32_bf16 v[52:55], a[216:219], v[68:71], v[36:39]
v_mfma_f32_16x16x32_bf16 v[52:55], a[220:223], v[100:103], v[52:55]
v_mfma_f32_16x16x32_bf16 v[52:55], a[224:227], v[132:135], v[52:55]
v_mfma_f32_16x16x32_bf16 v[52:55], a[228:231], v[164:167], v[52:55]
v_mfma_f32_16x16x32_bf16 v[52:55], a[232:235], v[196:199], v[52:55]
v_mfma_f32_16x16x32_bf16 v[52:55], a[236:239], v[228:231], v[52:55]
v_mfma_f32_16x16x32_bf16 v[56:59], a[216:219], v[72:75], v[40:43]
v_mfma_f32_16x16x32_bf16 v[56:59], a[220:223], v[104:107], v[56:59]
v_mfma_f32_16x16x32_bf16 v[56:59], a[224:227], v[136:139], v[56:59]
v_mfma_f32_16x16x32_bf16 v[56:59], a[228:231], v[168:171], v[56:59]
v_mfma_f32_16x16x32_bf16 v[56:59], a[232:235], v[200:203], v[56:59]
v_mfma_f32_16x16x32_bf16 v[56:59], a[236:239], v[232:235], v[56:59]
v_mfma_f32_16x16x32_bf16 v[60:63], a[216:219], v[76:79], v[44:47]
v_mfma_f32_16x16x32_bf16 v[60:63], a[220:223], v[108:111], v[60:63]
v_mfma_f32_16x16x32_bf16 v[60:63], a[224:227], v[140:143], v[60:63]
v_mfma_f32_16x16x32_bf16 v[60:63], a[228:231], v[172:175], v[60:63]
v_mfma_f32_16x16x32_bf16 v[60:63], a[232:235], v[204:207], v[60:63]
v_mfma_f32_16x16x32_bf16 v[60:63], a[236:239], v[236:239], v[60:63]
s_nop 7
v_max3_f32 v240, v240, v48, v49
v_max3_f32 v240, v240, v50, v51
v_max3_f32 v241, v241, v52, v53
v_max3_f32 v241, v241, v54, v55
v_max3_f32 v242, v242, v56, v57
v_max3_f32 v242, v242, v58, v59
v_max3_f32 v243, v243, v60, v61
v_max3_f32 v243, v243, v62, v63
s_add_u32 s7, s32, 6144
s_sub_u32 s7, s7, 73728
buffer_load_dwordx4 a[216:219], v249, s[16:19], s7 offen offset:0
buffer_load_dwordx4 a[220:223], v249, s[16:19], s7 offen offset:64
buffer_load_dwordx4 a[224:227], v249, s[16:19], s7 offen offset:128
buffer_load_dwordx4 a[228:231], v249, s[16:19], s7 offen offset:192
buffer_load_dwordx4 a[232:235], v249, s[16:19], s7 offen offset:256
buffer_load_dwordx4 a[236:239], v249, s[16:19], s7 offen offset:320
s_waitcnt vmcnt(0)
v_mfma_f32_16x16x32_bf16 v[48:51], a[216:219], v[64:67], v[32:35]
v_mfma_f32_16x16x32_bf16 v[48:51], a[220:223], v[96:99], v[48:51]
v_mfma_f32_16x16x32_bf16 v[48:51], a[224:227], v[128:131], v[48:51]
v_mfma_f32_16x16x32_bf16 v[48:51], a[228:231], v[160:163], v[48:51]
v_mfma_f32_16x16x32_bf16 v[48:51], a[232:235], v[192:195], v[48:51]
v_mfma_f32_16x16x32_bf16 v[48:51], a[236:239], v[224:227], v[48:51]
v_mfma_f32_16x16x32_bf16 v[52:55], a[216:219], v[68:71], v[36:39]
v_mfma_f32_16x16x32_bf16 v[52:55], a[220:223], v[100:103], v[52:55]
v_mfma_f32_16x16x32_bf16 v[52:55], a[224:227], v[132:135], v[52:55]
v_mfma_f32_16x16x32_bf16 v[52:55], a[228:231], v[164:167], v[52:55]
v_mfma_f32_16x16x32_bf16 v[52:55], a[232:235], v[196:199], v[52:55]
v_mfma_f32_16x16x32_bf16 v[52:55], a[236:239], v[228:231], v[52:55]
v_mfma_f32_16x16x32_bf16 v[56:59], a[216:219], v[72:75], v[40:43]
v_mfma_f32_16x16x32_bf16 v[56:59], a[220:223], v[104:107], v[56:59]
v_mfma_f32_16x16x32_bf16 v[56:59], a[224:227], v[136:139], v[56:59]
v_mfma_f32_16x16x32_bf16 v[56:59], a[228:231], v[168:171], v[56:59]
v_mfma_f32_16x16x32_bf16 v[56:59], a[232:235], v[200:203], v[56:59]
v_mfma_f32_16x16x32_bf16 v[56:59], a[236:239], v[232:235], v[56:59]
v_mfma_f32_16x16x32_bf16 v[60:63], a[216:219], v[76:79], v[44:47]
v_mfma_f32_16x16x32_bf16 v[60:63], a[220:223], v[108:111], v[60:63]
v_mfma_f32_16x16x32_bf16 v[60:63], a[224:227], v[140:143], v[60:63]
v_mfma_f32_16x16x32_bf16 v[60:63], a[228:231], v[172:175], v[60:63]
v_mfma_f32_16x16x32_bf16 v[60:63], a[232:235], v[204:207], v[60:63]
v_mfma_f32_16x16x32_bf16 v[60:63], a[236:239], v[236:239], v[60:63]
s_nop 7
v_max3_f32 v240, v240, v48, v49
v_max3_f32 v240, v240, v50, v51
v_max3_f32 v241, v241, v52, v53
v_max3_f32 v241, v241, v54, v55
v_max3_f32 v242, v242, v56, v57
v_max3_f32 v242, v242, v58, v59
v_max3_f32 v243, v243, v60, v61
v_max3_f32 v243, v243, v62, v63
s_add_u32 s7, s32, 12288
s_sub_u32 s7, s7, 73728
buffer_load_dwordx4 a[216:219], v249, s[16:19], s7 offen offset:0
buffer_load_dwordx4 a[220:223], v249, s[16:19], s7 offen offset:64
buffer_load_dwordx4 a[224:227], v249, s[16:19], s7 offen offset:128
buffer_load_dwordx4 a[228:231], v249, s[16:19], s7 offen offset:192
buffer_load_dwordx4 a[232:235], v249, s[16:19], s7 offen offset:256
buffer_load_dwordx4 a[236:239], v249, s[16:19], s7 offen offset:320
s_waitcnt vmcnt(0)
v_mfma_f32_16x16x32_bf16 v[48:51], a[216:219], v[64:67], v[32:35]
v_mfma_f32_16x16x32_bf16 v[48:51], a[220:223], v[96:99], v[48:51]
v_mfma_f32_16x16x32_bf16 v[48:51], a[224:227], v[128:131], v[48:51]
v_mfma_f32_16x16x32_bf16 v[48:51], a[228:231], v[160:163], v[48:51]
v_mfma_f32_16x16x32_bf16 v[48:51], a[232:235], v[192:195], v[48:51]
v_mfma_f32_16x16x32_bf16 v[48:51], a[236:239], v[224:227], v[48:51]
v_mfma_f32_16x16x32_bf16 v[52:55], a[216:219], v[68:71], v[36:39]
v_mfma_f32_16x16x32_bf16 v[52:55], a[220:223], v[100:103], v[52:55]
v_mfma_f32_16x16x32_bf16 v[52:55], a[224:227], v[132:135], v[52:55]
v_mfma_f32_16x16x32_bf16 v[52:55], a[228:231], v[164:167], v[52:55]
v_mfma_f32_16x16x32_bf16 v[52:55], a[232:235], v[196:199], v[52:55]
v_mfma_f32_16x16x32_bf16 v[52:55], a[236:239], v[228:231], v[52:55]
v_mfma_f32_16x16x32_bf16 v[56:59], a[216:219], v[72:75], v[40:43]
v_mfma_f32_16x16x32_bf16 v[56:59], a[220:223], v[104:107], v[56:59]
v_mfma_f32_16x16x32_bf16 v[56:59], a[224:227], v[136:139], v[56:59]
v_mfma_f32_16x16x32_bf16 v[56:59], a[228:231], v[168:171], v[56:59]
v_mfma_f32_16x16x32_bf16 v[56:59], a[232:235], v[200:203], v[56:59]
v_mfma_f32_16x16x32_bf16 v[56:59], a[236:239], v[232:235], v[56:59]
v_mfma_f32_16x16x32_bf16 v[60:63], a[216:219], v[76:79], v[44:47]
v_mfma_f32_16x16x32_bf16 v[60:63], a[220:223], v[108:111], v[60:63]
v_mfma_f32_16x16x32_bf16 v[60:63], a[224:227], v[140:143], v[60:63]
v_mfma_f32_16x16x32_bf16 v[60:63], a[228:231], v[172:175], v[60:63]
v_mfma_f32_16x16x32_bf16 v[60:63], a[232:235], v[204:207], v[60:63]
v_mfma_f32_16x16x32_bf16 v[60:63], a[236:239], v[236:239], v[60:63]
s_nop 7
v_max3_f32 v240, v240, v48, v49
v_max3_f32 v240, v240, v50, v51
v_max3_f32 v241, v241, v52, v53
v_max3_f32 v241, v241, v54, v55
v_max3_f32 v242, v242, v56, v57
v_max3_f32 v242, v242, v58, v59
v_max3_f32 v243, v243, v60, v61
v_max3_f32 v243, v243, v62, v63
s_add_u32 s7, s32, 18432
s_sub_u32 s7, s7, 73728
buffer_load_dwordx4 a[216:219], v249, s[16:19], s7 offen offset:0
buffer_load_dwordx4 a[220:223], v249, s[16:19], s7 offen offset:64
buffer_load_dwordx4 a[224:227], v249, s[16:19], s7 offen offset:128
buffer_load_dwordx4 a[228:231], v249, s[16:19], s7 offen offset:192
buffer_load_dwordx4 a[232:235], v249, s[16:19], s7 offen offset:256
buffer_load_dwordx4 a[236:239], v249, s[16:19], s7 offen offset:320
s_waitcnt vmcnt(0)
v_mfma_f32_16x16x32_bf16 v[48:51], a[216:219], v[64:67], v[32:35]
v_mfma_f32_16x16x32_bf16 v[48:51], a[220:223], v[96:99], v[48:51]
v_mfma_f32_16x16x32_bf16 v[48:51], a[224:227], v[128:131], v[48:51]
v_mfma_f32_16x16x32_bf16 v[48:51], a[228:231], v[160:163], v[48:51]
v_mfma_f32_16x16x32_bf16 v[48:51], a[232:235], v[192:195], v[48:51]
v_mfma_f32_16x16x32_bf16 v[48:51], a[236:239], v[224:227], v[48:51]
v_mfma_f32_16x16x32_bf16 v[52:55], a[216:219], v[68:71], v[36:39]
v_mfma_f32_16x16x32_bf16 v[52:55], a[220:223], v[100:103], v[52:55]
v_mfma_f32_16x16x32_bf16 v[52:55], a[224:227], v[132:135], v[52:55]
v_mfma_f32_16x16x32_bf16 v[52:55], a[228:231], v[164:167], v[52:55]
v_mfma_f32_16x16x32_bf16 v[52:55], a[232:235], v[196:199], v[52:55]
v_mfma_f32_16x16x32_bf16 v[52:55], a[236:239], v[228:231], v[52:55]
v_mfma_f32_16x16x32_bf16 v[56:59], a[216:219], v[72:75], v[40:43]
v_mfma_f32_16x16x32_bf16 v[56:59], a[220:223], v[104:107], v[56:59]
v_mfma_f32_16x16x32_bf16 v[56:59], a[224:227], v[136:139], v[56:59]
v_mfma_f32_16x16x32_bf16 v[56:59], a[228:231], v[168:171], v[56:59]
v_mfma_f32_16x16x32_bf16 v[56:59], a[232:235], v[200:203], v[56:59]
v_mfma_f32_16x16x32_bf16 v[56:59], a[236:239], v[232:235], v[56:59]
v_mfma_f32_16x16x32_bf16 v[60:63], a[216:219], v[76:79], v[44:47]
v_mfma_f32_16x16x32_bf16 v[60:63], a[220:223], v[108:111], v[60:63]
v_mfma_f32_16x16x32_bf16 v[60:63], a[224:227], v[140:143], v[60:63]
v_mfma_f32_16x16x32_bf16 v[60:63], a[228:231], v[172:175], v[60:63]
v_mfma_f32_16x16x32_bf16 v[60:63], a[232:235], v[204:207], v[60:63]
v_mfma_f32_16x16x32_bf16 v[60:63], a[236:239], v[236:239], v[60:63]
s_nop 7
v_max3_f32 v240, v240, v48, v49
v_max3_f32 v240, v240, v50, v51
v_max3_f32 v241, v241, v52, v53
v_max3_f32 v241, v241, v54, v55
v_max3_f32 v242, v242, v56, v57
v_max3_f32 v242, v242, v58, v59
v_max3_f32 v243, v243, v60, v61
v_max3_f32 v243, v243, v62, v63
v_mov_b32 v248, v240
s_nop 1
v_permlane32_swap_b32 v240, v248
v_max_f32 v240, v240, v248
v_mov_b32 v248, v240
s_nop 1
v_permlane16_swap_b32 v240, v248
v_max_f32 v240, v240, v248
v_mov_b32 v248, v241
s_nop 1
v_permlane32_swap_b32 v241, v248
v_max_f32 v241, v241, v248
v_mov_b32 v248, v241
s_nop 1
v_permlane16_swap_b32 v241, v248
v_max_f32 v241, v241, v248
v_mov_b32 v248, v242
s_nop 1
v_permlane32_swap_b32 v242, v248
v_max_f32 v242, v242, v248
v_mov_b32 v248, v242
s_nop 1
v_permlane16_swap_b32 v242, v248
v_max_f32 v242, v242, v248
v_mov_b32 v248, v243
s_nop 1
v_permlane32_swap_b32 v243, v248
v_max_f32 v243, v243, v248
v_mov_b32 v248, v243
s_nop 1
v_permlane16_swap_b32 v243, v248
v_max_f32 v243, v243, v248
v_sub_f32 v32, v32, v240
v_sub_f32 v33, v33, v240
v_sub_f32 v34, v34, v240
v_sub_f32 v35, v35, v240
v_exp_f32 v244, -v240
v_sub_f32 v36, v36, v241
v_sub_f32 v37, v37, v241
v_sub_f32 v38, v38, v241
v_sub_f32 v39, v39, v241
v_exp_f32 v245, -v241
v_sub_f32 v40, v40, v242
v_sub_f32 v41, v41, v242
v_sub_f32 v42, v42, v242
v_sub_f32 v43, v43, v242
v_exp_f32 v246, -v242
v_sub_f32 v44, v44, v243
v_sub_f32 v45, v45, v243
v_sub_f32 v46, v46, v243
v_sub_f32 v47, v47, v243
v_exp_f32 v247, -v243
s_nop 0
v_mul_f32 v12, v12, v244
v_mul_f32 v13, v13, v245
v_mul_f32 v14, v14, v246
v_mul_f32 v15, v15, v247
v_accvgpr_read_b32 v250, a0
v_mul_f32 v250, v250, v244
v_accvgpr_write_b32 a0, v250
v_accvgpr_read_b32 v250, a1
v_mul_f32 v250, v250, v244
v_accvgpr_write_b32 a1, v250
v_accvgpr_read_b32 v250, a2
v_mul_f32 v250, v250, v244
v_accvgpr_write_b32 a2, v250
v_accvgpr_read_b32 v250, a3
v_mul_f32 v250, v250, v244
v_accvgpr_write_b32 a3, v250
v_accvgpr_read_b32 v250, a4
v_mul_f32 v250, v250, v245
v_accvgpr_write_b32 a4, v250
v_accvgpr_read_b32 v250, a5
v_mul_f32 v250, v250, v245
v_accvgpr_write_b32 a5, v250
v_accvgpr_read_b32 v250, a6
v_mul_f32 v250, v250, v245
v_accvgpr_write_b32 a6, v250
v_accvgpr_read_b32 v250, a7
v_mul_f32 v250, v250, v245
v_accvgpr_write_b32 a7, v250
v_accvgpr_read_b32 v250, a8
v_mul_f32 v250, v250, v246
v_accvgpr_write_b32 a8, v250
v_accvgpr_read_b32 v250, a9
v_mul_f32 v250, v250, v246
v_accvgpr_write_b32 a9, v250
v_accvgpr_read_b32 v250, a10
v_mul_f32 v250, v250, v246
v_accvgpr_write_b32 a10, v250
v_accvgpr_read_b32 v250, a11
v_mul_f32 v250, v250, v246
v_accvgpr_write_b32 a11, v250
v_accvgpr_read_b32 v250, a12
v_mul_f32 v250, v250, v247
v_accvgpr_write_b32 a12, v250
v_accvgpr_read_b32 v250, a13
v_mul_f32 v250, v250, v247
v_accvgpr_write_b32 a13, v250
v_accvgpr_read_b32 v250, a14
v_mul_f32 v250, v250, v247
v_accvgpr_write_b32 a14, v250
v_accvgpr_read_b32 v250, a15
v_mul_f32 v250, v250, v247
v_accvgpr_write_b32 a15, v250
v_accvgpr_read_b32 v250, a16
v_mul_f32 v250, v250, v244
v_accvgpr_write_b32 a16, v250
v_accvgpr_read_b32 v250, a17
v_mul_f32 v250, v250, v244
v_accvgpr_write_b32 a17, v250
v_accvgpr_read_b32 v250, a18
v_mul_f32 v250, v250, v244
v_accvgpr_write_b32 a18, v250
v_accvgpr_read_b32 v250, a19
v_mul_f32 v250, v250, v244
v_accvgpr_write_b32 a19, v250
v_accvgpr_read_b32 v250, a20
v_mul_f32 v250, v250, v245
v_accvgpr_write_b32 a20, v250
v_accvgpr_read_b32 v250, a21
v_mul_f32 v250, v250, v245
v_accvgpr_write_b32 a21, v250
v_accvgpr_read_b32 v250, a22
v_mul_f32 v250, v250, v245
v_accvgpr_write_b32 a22, v250
v_accvgpr_read_b32 v250, a23
v_mul_f32 v250, v250, v245
v_accvgpr_write_b32 a23, v250
v_accvgpr_read_b32 v250, a24
v_mul_f32 v250, v250, v246
v_accvgpr_write_b32 a24, v250
v_accvgpr_read_b32 v250, a25
v_mul_f32 v250, v250, v246
v_accvgpr_write_b32 a25, v250
v_accvgpr_read_b32 v250, a26
v_mul_f32 v250, v250, v246
v_accvgpr_write_b32 a26, v250
v_accvgpr_read_b32 v250, a27
v_mul_f32 v250, v250, v246
v_accvgpr_write_b32 a27, v250
v_accvgpr_read_b32 v250, a28
v_mul_f32 v250, v250, v247
v_accvgpr_write_b32 a28, v250
v_accvgpr_read_b32 v250, a29
v_mul_f32 v250, v250, v247
v_accvgpr_write_b32 a29, v250
v_accvgpr_read_b32 v250, a30
v_mul_f32 v250, v250, v247
v_accvgpr_write_b32 a30, v250
v_accvgpr_read_b32 v250, a31
v_mul_f32 v250, v250, v247
v_accvgpr_write_b32 a31, v250
v_accvgpr_read_b32 v250, a32
v_mul_f32 v250, v250, v244
v_accvgpr_write_b32 a32, v250
v_accvgpr_read_b32 v250, a33
v_mul_f32 v250, v250, v244
v_accvgpr_write_b32 a33, v250
v_accvgpr_read_b32 v250, a34
v_mul_f32 v250, v250, v244
v_accvgpr_write_b32 a34, v250
v_accvgpr_read_b32 v250, a35
v_mul_f32 v250, v250, v244
v_accvgpr_write_b32 a35, v250
v_accvgpr_read_b32 v250, a36
v_mul_f32 v250, v250, v245
v_accvgpr_write_b32 a36, v250
v_accvgpr_read_b32 v250, a37
v_mul_f32 v250, v250, v245
v_accvgpr_write_b32 a37, v250
v_accvgpr_read_b32 v250, a38
v_mul_f32 v250, v250, v245
v_accvgpr_write_b32 a38, v250
v_accvgpr_read_b32 v250, a39
v_mul_f32 v250, v250, v245
v_accvgpr_write_b32 a39, v250
v_accvgpr_read_b32 v250, a40
v_mul_f32 v250, v250, v246
v_accvgpr_write_b32 a40, v250
v_accvgpr_read_b32 v250, a41
v_mul_f32 v250, v250, v246
v_accvgpr_write_b32 a41, v250
v_accvgpr_read_b32 v250, a42
v_mul_f32 v250, v250, v246
v_accvgpr_write_b32 a42, v250
v_accvgpr_read_b32 v250, a43
v_mul_f32 v250, v250, v246
v_accvgpr_write_b32 a43, v250
v_accvgpr_read_b32 v250, a44
v_mul_f32 v250, v250, v247
v_accvgpr_write_b32 a44, v250
v_accvgpr_read_b32 v250, a45
v_mul_f32 v250, v250, v247
v_accvgpr_write_b32 a45, v250
v_accvgpr_read_b32 v250, a46
v_mul_f32 v250, v250, v247
v_accvgpr_write_b32 a46, v250
v_accvgpr_read_b32 v250, a47
v_mul_f32 v250, v250, v247
v_accvgpr_write_b32 a47, v250
v_accvgpr_read_b32 v250, a48
v_mul_f32 v250, v250, v244
v_accvgpr_write_b32 a48, v250
v_accvgpr_read_b32 v250, a49
v_mul_f32 v250, v250, v244
v_accvgpr_write_b32 a49, v250
v_accvgpr_read_b32 v250, a50
v_mul_f32 v250, v250, v244
v_accvgpr_write_b32 a50, v250
v_accvgpr_read_b32 v250, a51
v_mul_f32 v250, v250, v244
v_accvgpr_write_b32 a51, v250
v_accvgpr_read_b32 v250, a52
v_mul_f32 v250, v250, v245
v_accvgpr_write_b32 a52, v250
v_accvgpr_read_b32 v250, a53
v_mul_f32 v250, v250, v245
v_accvgpr_write_b32 a53, v250
v_accvgpr_read_b32 v250, a54
v_mul_f32 v250, v250, v245
v_accvgpr_write_b32 a54, v250
v_accvgpr_read_b32 v250, a55
v_mul_f32 v250, v250, v245
v_accvgpr_write_b32 a55, v250
v_accvgpr_read_b32 v250, a56
v_mul_f32 v250, v250, v246
v_accvgpr_write_b32 a56, v250
v_accvgpr_read_b32 v250, a57
v_mul_f32 v250, v250, v246
v_accvgpr_write_b32 a57, v250
v_accvgpr_read_b32 v250, a58
v_mul_f32 v250, v250, v246
v_accvgpr_write_b32 a58, v250
v_accvgpr_read_b32 v250, a59
v_mul_f32 v250, v250, v246
v_accvgpr_write_b32 a59, v250
v_accvgpr_read_b32 v250, a60
v_mul_f32 v250, v250, v247
v_accvgpr_write_b32 a60, v250
v_accvgpr_read_b32 v250, a61
v_mul_f32 v250, v250, v247
v_accvgpr_write_b32 a61, v250
v_accvgpr_read_b32 v250, a62
v_mul_f32 v250, v250, v247
v_accvgpr_write_b32 a62, v250
v_accvgpr_read_b32 v250, a63
v_mul_f32 v250, v250, v247
v_accvgpr_write_b32 a63, v250
v_accvgpr_read_b32 v250, a64
v_mul_f32 v250, v250, v244
v_accvgpr_write_b32 a64, v250
v_accvgpr_read_b32 v250, a65
v_mul_f32 v250, v250, v244
v_accvgpr_write_b32 a65, v250
v_accvgpr_read_b32 v250, a66
v_mul_f32 v250, v250, v244
v_accvgpr_write_b32 a66, v250
v_accvgpr_read_b32 v250, a67
v_mul_f32 v250, v250, v244
v_accvgpr_write_b32 a67, v250
v_accvgpr_read_b32 v250, a68
v_mul_f32 v250, v250, v245
v_accvgpr_write_b32 a68, v250
v_accvgpr_read_b32 v250, a69
v_mul_f32 v250, v250, v245
v_accvgpr_write_b32 a69, v250
v_accvgpr_read_b32 v250, a70
v_mul_f32 v250, v250, v245
v_accvgpr_write_b32 a70, v250
v_accvgpr_read_b32 v250, a71
v_mul_f32 v250, v250, v245
v_accvgpr_write_b32 a71, v250
v_accvgpr_read_b32 v250, a72
v_mul_f32 v250, v250, v246
v_accvgpr_write_b32 a72, v250
v_accvgpr_read_b32 v250, a73
v_mul_f32 v250, v250, v246
v_accvgpr_write_b32 a73, v250
v_accvgpr_read_b32 v250, a74
v_mul_f32 v250, v250, v246
v_accvgpr_write_b32 a74, v250
v_accvgpr_read_b32 v250, a75
v_mul_f32 v250, v250, v246
v_accvgpr_write_b32 a75, v250
v_accvgpr_read_b32 v250, a76
v_mul_f32 v250, v250, v247
v_accvgpr_write_b32 a76, v250
v_accvgpr_read_b32 v250, a77
v_mul_f32 v250, v250, v247
v_accvgpr_write_b32 a77, v250
v_accvgpr_read_b32 v250, a78
v_mul_f32 v250, v250, v247
v_accvgpr_write_b32 a78, v250
v_accvgpr_read_b32 v250, a79
v_mul_f32 v250, v250, v247
v_accvgpr_write_b32 a79, v250
v_accvgpr_read_b32 v250, a80
v_mul_f32 v250, v250, v244
v_accvgpr_write_b32 a80, v250
v_accvgpr_read_b32 v250, a81
v_mul_f32 v250, v250, v244
v_accvgpr_write_b32 a81, v250
v_accvgpr_read_b32 v250, a82
v_mul_f32 v250, v250, v244
v_accvgpr_write_b32 a82, v250
v_accvgpr_read_b32 v250, a83
v_mul_f32 v250, v250, v244
v_accvgpr_write_b32 a83, v250
v_accvgpr_read_b32 v250, a84
v_mul_f32 v250, v250, v245
v_accvgpr_write_b32 a84, v250
v_accvgpr_read_b32 v250, a85
v_mul_f32 v250, v250, v245
v_accvgpr_write_b32 a85, v250
v_accvgpr_read_b32 v250, a86
v_mul_f32 v250, v250, v245
v_accvgpr_write_b32 a86, v250
v_accvgpr_read_b32 v250, a87
v_mul_f32 v250, v250, v245
v_accvgpr_write_b32 a87, v250
v_accvgpr_read_b32 v250, a88
v_mul_f32 v250, v250, v246
v_accvgpr_write_b32 a88, v250
v_accvgpr_read_b32 v250, a89
v_mul_f32 v250, v250, v246
v_accvgpr_write_b32 a89, v250
v_accvgpr_read_b32 v250, a90
v_mul_f32 v250, v250, v246
v_accvgpr_write_b32 a90, v250
v_accvgpr_read_b32 v250, a91
v_mul_f32 v250, v250, v246
v_accvgpr_write_b32 a91, v250
v_accvgpr_read_b32 v250, a92
v_mul_f32 v250, v250, v247
v_accvgpr_write_b32 a92, v250
v_accvgpr_read_b32 v250, a93
v_mul_f32 v250, v250, v247
v_accvgpr_write_b32 a93, v250
v_accvgpr_read_b32 v250, a94
v_mul_f32 v250, v250, v247
v_accvgpr_write_b32 a94, v250
v_accvgpr_read_b32 v250, a95
v_mul_f32 v250, v250, v247
v_accvgpr_write_b32 a95, v250
v_accvgpr_read_b32 v250, a96
v_mul_f32 v250, v250, v244
v_accvgpr_write_b32 a96, v250
v_accvgpr_read_b32 v250, a97
v_mul_f32 v250, v250, v244
v_accvgpr_write_b32 a97, v250
v_accvgpr_read_b32 v250, a98
v_mul_f32 v250, v250, v244
v_accvgpr_write_b32 a98, v250
v_accvgpr_read_b32 v250, a99
v_mul_f32 v250, v250, v244
v_accvgpr_write_b32 a99, v250
v_accvgpr_read_b32 v250, a100
v_mul_f32 v250, v250, v245
v_accvgpr_write_b32 a100, v250
v_accvgpr_read_b32 v250, a101
v_mul_f32 v250, v250, v245
v_accvgpr_write_b32 a101, v250
v_accvgpr_read_b32 v250, a102
v_mul_f32 v250, v250, v245
v_accvgpr_write_b32 a102, v250
v_accvgpr_read_b32 v250, a103
v_mul_f32 v250, v250, v245
v_accvgpr_write_b32 a103, v250
v_accvgpr_read_b32 v250, a104
v_mul_f32 v250, v250, v246
v_accvgpr_write_b32 a104, v250
v_accvgpr_read_b32 v250, a105
v_mul_f32 v250, v250, v246
v_accvgpr_write_b32 a105, v250
v_accvgpr_read_b32 v250, a106
v_mul_f32 v250, v250, v246
v_accvgpr_write_b32 a106, v250
v_accvgpr_read_b32 v250, a107
v_mul_f32 v250, v250, v246
v_accvgpr_write_b32 a107, v250
v_accvgpr_read_b32 v250, a108
v_mul_f32 v250, v250, v247
v_accvgpr_write_b32 a108, v250
v_accvgpr_read_b32 v250, a109
v_mul_f32 v250, v250, v247
v_accvgpr_write_b32 a109, v250
v_accvgpr_read_b32 v250, a110
v_mul_f32 v250, v250, v247
v_accvgpr_write_b32 a110, v250
v_accvgpr_read_b32 v250, a111
v_mul_f32 v250, v250, v247
v_accvgpr_write_b32 a111, v250
v_accvgpr_read_b32 v250, a112
v_mul_f32 v250, v250, v244
v_accvgpr_write_b32 a112, v250
v_accvgpr_read_b32 v250, a113
v_mul_f32 v250, v250, v244
v_accvgpr_write_b32 a113, v250
v_accvgpr_read_b32 v250, a114
v_mul_f32 v250, v250, v244
v_accvgpr_write_b32 a114, v250
v_accvgpr_read_b32 v250, a115
v_mul_f32 v250, v250, v244
v_accvgpr_write_b32 a115, v250
v_accvgpr_read_b32 v250, a116
v_mul_f32 v250, v250, v245
v_accvgpr_write_b32 a116, v250
v_accvgpr_read_b32 v250, a117
v_mul_f32 v250, v250, v245
v_accvgpr_write_b32 a117, v250
v_accvgpr_read_b32 v250, a118
v_mul_f32 v250, v250, v245
v_accvgpr_write_b32 a118, v250
v_accvgpr_read_b32 v250, a119
v_mul_f32 v250, v250, v245
v_accvgpr_write_b32 a119, v250
v_accvgpr_read_b32 v250, a120
v_mul_f32 v250, v250, v246
v_accvgpr_write_b32 a120, v250
v_accvgpr_read_b32 v250, a121
v_mul_f32 v250, v250, v246
v_accvgpr_write_b32 a121, v250
v_accvgpr_read_b32 v250, a122
v_mul_f32 v250, v250, v246
v_accvgpr_write_b32 a122, v250
v_accvgpr_read_b32 v250, a123
v_mul_f32 v250, v250, v246
v_accvgpr_write_b32 a123, v250
v_accvgpr_read_b32 v250, a124
v_mul_f32 v250, v250, v247
v_accvgpr_write_b32 a124, v250
v_accvgpr_read_b32 v250, a125
v_mul_f32 v250, v250, v247
v_accvgpr_write_b32 a125, v250
v_accvgpr_read_b32 v250, a126
v_mul_f32 v250, v250, v247
v_accvgpr_write_b32 a126, v250
v_accvgpr_read_b32 v250, a127
v_mul_f32 v250, v250, v247
v_accvgpr_write_b32 a127, v250
v_accvgpr_read_b32 v250, a128
v_mul_f32 v250, v250, v244
v_accvgpr_write_b32 a128, v250
v_accvgpr_read_b32 v250, a129
v_mul_f32 v250, v250, v244
v_accvgpr_write_b32 a129, v250
v_accvgpr_read_b32 v250, a130
v_mul_f32 v250, v250, v244
v_accvgpr_write_b32 a130, v250
v_accvgpr_read_b32 v250, a131
v_mul_f32 v250, v250, v244
v_accvgpr_write_b32 a131, v250
v_accvgpr_read_b32 v250, a132
v_mul_f32 v250, v250, v245
v_accvgpr_write_b32 a132, v250
v_accvgpr_read_b32 v250, a133
v_mul_f32 v250, v250, v245
v_accvgpr_write_b32 a133, v250
v_accvgpr_read_b32 v250, a134
v_mul_f32 v250, v250, v245
v_accvgpr_write_b32 a134, v250
v_accvgpr_read_b32 v250, a135
v_mul_f32 v250, v250, v245
v_accvgpr_write_b32 a135, v250
v_accvgpr_read_b32 v250, a136
v_mul_f32 v250, v250, v246
v_accvgpr_write_b32 a136, v250
v_accvgpr_read_b32 v250, a137
v_mul_f32 v250, v250, v246
v_accvgpr_write_b32 a137, v250
v_accvgpr_read_b32 v250, a138
v_mul_f32 v250, v250, v246
v_accvgpr_write_b32 a138, v250
v_accvgpr_read_b32 v250, a139
v_mul_f32 v250, v250, v246
v_accvgpr_write_b32 a139, v250
v_accvgpr_read_b32 v250, a140
v_mul_f32 v250, v250, v247
v_accvgpr_write_b32 a140, v250
v_accvgpr_read_b32 v250, a141
v_mul_f32 v250, v250, v247
v_accvgpr_write_b32 a141, v250
v_accvgpr_read_b32 v250, a142
v_mul_f32 v250, v250, v247
v_accvgpr_write_b32 a142, v250
v_accvgpr_read_b32 v250, a143
v_mul_f32 v250, v250, v247
v_accvgpr_write_b32 a143, v250
v_accvgpr_read_b32 v250, a144
v_mul_f32 v250, v250, v244
v_accvgpr_write_b32 a144, v250
v_accvgpr_read_b32 v250, a145
v_mul_f32 v250, v250, v244
v_accvgpr_write_b32 a145, v250
v_accvgpr_read_b32 v250, a146
v_mul_f32 v250, v250, v244
v_accvgpr_write_b32 a146, v250
v_accvgpr_read_b32 v250, a147
v_mul_f32 v250, v250, v244
v_accvgpr_write_b32 a147, v250
v_accvgpr_read_b32 v250, a148
v_mul_f32 v250, v250, v245
v_accvgpr_write_b32 a148, v250
v_accvgpr_read_b32 v250, a149
v_mul_f32 v250, v250, v245
v_accvgpr_write_b32 a149, v250
v_accvgpr_read_b32 v250, a150
v_mul_f32 v250, v250, v245
v_accvgpr_write_b32 a150, v250
v_accvgpr_read_b32 v250, a151
v_mul_f32 v250, v250, v245
v_accvgpr_write_b32 a151, v250
v_accvgpr_read_b32 v250, a152
v_mul_f32 v250, v250, v246
v_accvgpr_write_b32 a152, v250
v_accvgpr_read_b32 v250, a153
v_mul_f32 v250, v250, v246
v_accvgpr_write_b32 a153, v250
v_accvgpr_read_b32 v250, a154
v_mul_f32 v250, v250, v246
v_accvgpr_write_b32 a154, v250
v_accvgpr_read_b32 v250, a155
v_mul_f32 v250, v250, v246
v_accvgpr_write_b32 a155, v250
v_accvgpr_read_b32 v250, a156
v_mul_f32 v250, v250, v247
v_accvgpr_write_b32 a156, v250
v_accvgpr_read_b32 v250, a157
v_mul_f32 v250, v250, v247
v_accvgpr_write_b32 a157, v250
v_accvgpr_read_b32 v250, a158
v_mul_f32 v250, v250, v247
v_accvgpr_write_b32 a158, v250
v_accvgpr_read_b32 v250, a159
v_mul_f32 v250, v250, v247
v_accvgpr_write_b32 a159, v250
v_accvgpr_read_b32 v250, a160
v_mul_f32 v250, v250, v244
v_accvgpr_write_b32 a160, v250
v_accvgpr_read_b32 v250, a161
v_mul_f32 v250, v250, v244
v_accvgpr_write_b32 a161, v250
v_accvgpr_read_b32 v250, a162
v_mul_f32 v250, v250, v244
v_accvgpr_write_b32 a162, v250
v_accvgpr_read_b32 v250, a163
v_mul_f32 v250, v250, v244
v_accvgpr_write_b32 a163, v250
v_accvgpr_read_b32 v250, a164
v_mul_f32 v250, v250, v245
v_accvgpr_write_b32 a164, v250
v_accvgpr_read_b32 v250, a165
v_mul_f32 v250, v250, v245
v_accvgpr_write_b32 a165, v250
v_accvgpr_read_b32 v250, a166
v_mul_f32 v250, v250, v245
v_accvgpr_write_b32 a166, v250
v_accvgpr_read_b32 v250, a167
v_mul_f32 v250, v250, v245
v_accvgpr_write_b32 a167, v250
v_accvgpr_read_b32 v250, a168
v_mul_f32 v250, v250, v246
v_accvgpr_write_b32 a168, v250
v_accvgpr_read_b32 v250, a169
v_mul_f32 v250, v250, v246
v_accvgpr_write_b32 a169, v250
v_accvgpr_read_b32 v250, a170
v_mul_f32 v250, v250, v246
v_accvgpr_write_b32 a170, v250
v_accvgpr_read_b32 v250, a171
v_mul_f32 v250, v250, v246
v_accvgpr_write_b32 a171, v250
v_accvgpr_read_b32 v250, a172
v_mul_f32 v250, v250, v247
v_accvgpr_write_b32 a172, v250
v_accvgpr_read_b32 v250, a173
v_mul_f32 v250, v250, v247
v_accvgpr_write_b32 a173, v250
v_accvgpr_read_b32 v250, a174
v_mul_f32 v250, v250, v247
v_accvgpr_write_b32 a174, v250
v_accvgpr_read_b32 v250, a175
v_mul_f32 v250, v250, v247
v_accvgpr_write_b32 a175, v250
v_accvgpr_read_b32 v250, a176
v_mul_f32 v250, v250, v244
v_accvgpr_write_b32 a176, v250
v_accvgpr_read_b32 v250, a177
v_mul_f32 v250, v250, v244
v_accvgpr_write_b32 a177, v250
v_accvgpr_read_b32 v250, a178
v_mul_f32 v250, v250, v244
v_accvgpr_write_b32 a178, v250
v_accvgpr_read_b32 v250, a179
v_mul_f32 v250, v250, v244
v_accvgpr_write_b32 a179, v250
v_accvgpr_read_b32 v250, a180
v_mul_f32 v250, v250, v245
v_accvgpr_write_b32 a180, v250
v_accvgpr_read_b32 v250, a181
v_mul_f32 v250, v250, v245
v_accvgpr_write_b32 a181, v250
v_accvgpr_read_b32 v250, a182
v_mul_f32 v250, v250, v245
v_accvgpr_write_b32 a182, v250
v_accvgpr_read_b32 v250, a183
v_mul_f32 v250, v250, v245
v_accvgpr_write_b32 a183, v250
v_accvgpr_read_b32 v250, a184
v_mul_f32 v250, v250, v246
v_accvgpr_write_b32 a184, v250
v_accvgpr_read_b32 v250, a185
v_mul_f32 v250, v250, v246
v_accvgpr_write_b32 a185, v250
v_accvgpr_read_b32 v250, a186
v_mul_f32 v250, v250, v246
v_accvgpr_write_b32 a186, v250
v_accvgpr_read_b32 v250, a187
v_mul_f32 v250, v250, v246
v_accvgpr_write_b32 a187, v250
v_accvgpr_read_b32 v250, a188
v_mul_f32 v250, v250, v247
v_accvgpr_write_b32 a188, v250
v_accvgpr_read_b32 v250, a189
v_mul_f32 v250, v250, v247
v_accvgpr_write_b32 a189, v250
v_accvgpr_read_b32 v250, a190
v_mul_f32 v250, v250, v247
v_accvgpr_write_b32 a190, v250
v_accvgpr_read_b32 v250, a191
v_mul_f32 v250, v250, v247
v_accvgpr_write_b32 a191, v250
s_add_u32 s7, s32, 0
s_sub_u32 s7, s7, 73728
buffer_load_dwordx4 a[216:219], v249, s[16:19], s7 offen offset:0
buffer_load_dwordx4 a[220:223], v249, s[16:19], s7 offen offset:64
buffer_load_dwordx4 a[224:227], v249, s[16:19], s7 offen offset:128
buffer_load_dwordx4 a[228:231], v249, s[16:19], s7 offen offset:192
buffer_load_dwordx4 a[232:235], v249, s[16:19], s7 offen offset:256
buffer_load_dwordx4 a[236:239], v249, s[16:19], s7 offen offset:320
s_waitcnt vmcnt(0)
v_mfma_f32_16x16x32_bf16 v[48:51], a[216:219], v[64:67], v[32:35]
v_mfma_f32_16x16x32_bf16 v[48:51], a[220:223], v[96:99], v[48:51]
v_mfma_f32_16x16x32_bf16 v[48:51], a[224:227], v[128:131], v[48:51]
v_mfma_f32_16x16x32_bf16 v[48:51], a[228:231], v[160:163], v[48:51]
v_mfma_f32_16x16x32_bf16 v[48:51], a[232:235], v[192:195], v[48:51]
v_mfma_f32_16x16x32_bf16 v[48:51], a[236:239], v[224:227], v[48:51]
v_mfma_f32_16x16x32_bf16 v[52:55], a[216:219], v[68:71], v[36:39]
v_mfma_f32_16x16x32_bf16 v[52:55], a[220:223], v[100:103], v[52:55]
v_mfma_f32_16x16x32_bf16 v[52:55], a[224:227], v[132:135], v[52:55]
v_mfma_f32_16x16x32_bf16 v[52:55], a[228:231], v[164:167], v[52:55]
v_mfma_f32_16x16x32_bf16 v[52:55], a[232:235], v[196:199], v[52:55]
v_mfma_f32_16x16x32_bf16 v[52:55], a[236:239], v[228:231], v[52:55]
v_mfma_f32_16x16x32_bf16 v[56:59], a[216:219], v[72:75], v[40:43]
v_mfma_f32_16x16x32_bf16 v[56:59], a[220:223], v[104:107], v[56:59]
v_mfma_f32_16x16x32_bf16 v[56:59], a[224:227], v[136:139], v[56:59]
v_mfma_f32_16x16x32_bf16 v[56:59], a[228:231], v[168:171], v[56:59]
v_mfma_f32_16x16x32_bf16 v[56:59], a[232:235], v[200:203], v[56:59]
v_mfma_f32_16x16x32_bf16 v[56:59], a[236:239], v[232:235], v[56:59]
v_mfma_f32_16x16x32_bf16 v[60:63], a[216:219], v[76:79], v[44:47]
v_mfma_f32_16x16x32_bf16 v[60:63], a[220:223], v[108:111], v[60:63]
v_mfma_f32_16x16x32_bf16 v[60:63], a[224:227], v[140:143], v[60:63]
v_mfma_f32_16x16x32_bf16 v[60:63], a[228:231], v[172:175], v[60:63]
v_mfma_f32_16x16x32_bf16 v[60:63], a[232:235], v[204:207], v[60:63]
v_mfma_f32_16x16x32_bf16 v[60:63], a[236:239], v[236:239], v[60:63]
s_nop 7
v_exp_f32 v48, v48
v_exp_f32 v49, v49
v_exp_f32 v50, v50
v_add_f32 v16, v48, v49
v_cvt_pk_bf16_f32 v144, v48, v49
v_exp_f32 v51, v51
v_add_f32 v16, v16, v50
v_add_f32 v16, v16, v51
v_cvt_pk_bf16_f32 v145, v50, v51
v_exp_f32 v52, v52
v_exp_f32 v53, v53
v_exp_f32 v54, v54
v_add_f32 v17, v52, v53
v_cvt_pk_bf16_f32 v152, v52, v53
v_exp_f32 v55, v55
v_add_f32 v17, v17, v54
v_add_f32 v17, v17, v55
v_cvt_pk_bf16_f32 v153, v54, v55
v_exp_f32 v56, v56
v_exp_f32 v57, v57
v_exp_f32 v58, v58
v_add_f32 v18, v56, v57
v_cvt_pk_bf16_f32 v176, v56, v57
v_exp_f32 v59, v59
v_add_f32 v18, v18, v58
v_add_f32 v18, v18, v59
v_cvt_pk_bf16_f32 v177, v58, v59
v_exp_f32 v60, v60
v_exp_f32 v61, v61
v_exp_f32 v62, v62
v_add_f32 v19, v60, v61
v_cvt_pk_bf16_f32 v184, v60, v61
v_exp_f32 v63, v63
v_add_f32 v19, v19, v62
v_add_f32 v19, v19, v63
v_cvt_pk_bf16_f32 v185, v62, v63
s_add_u32 s7, s32, 6144
s_sub_u32 s7, s7, 73728
buffer_load_dwordx4 a[216:219], v249, s[16:19], s7 offen offset:0
buffer_load_dwordx4 a[220:223], v249, s[16:19], s7 offen offset:64
buffer_load_dwordx4 a[224:227], v249, s[16:19], s7 offen offset:128
buffer_load_dwordx4 a[228:231], v249, s[16:19], s7 offen offset:192
buffer_load_dwordx4 a[232:235], v249, s[16:19], s7 offen offset:256
buffer_load_dwordx4 a[236:239], v249, s[16:19], s7 offen offset:320
s_waitcnt vmcnt(0)
v_mfma_f32_16x16x32_bf16 v[48:51], a[216:219], v[64:67], v[32:35]
v_mfma_f32_16x16x32_bf16 v[48:51], a[220:223], v[96:99], v[48:51]
v_mfma_f32_16x16x32_bf16 v[48:51], a[224:227], v[128:131], v[48:51]
v_mfma_f32_16x16x32_bf16 v[48:51], a[228:231], v[160:163], v[48:51]
v_mfma_f32_16x16x32_bf16 v[48:51], a[232:235], v[192:195], v[48:51]
v_mfma_f32_16x16x32_bf16 v[48:51], a[236:239], v[224:227], v[48:51]
v_mfma_f32_16x16x32_bf16 v[52:55], a[216:219], v[68:71], v[36:39]
v_mfma_f32_16x16x32_bf16 v[52:55], a[220:223], v[100:103], v[52:55]
v_mfma_f32_16x16x32_bf16 v[52:55], a[224:227], v[132:135], v[52:55]
v_mfma_f32_16x16x32_bf16 v[52:55], a[228:231], v[164:167], v[52:55]
v_mfma_f32_16x16x32_bf16 v[52:55], a[232:235], v[196:199], v[52:55]
v_mfma_f32_16x16x32_bf16 v[52:55], a[236:239], v[228:231], v[52:55]
v_mfma_f32_16x16x32_bf16 v[56:59], a[216:219], v[72:75], v[40:43]
v_mfma_f32_16x16x32_bf16 v[56:59], a[220:223], v[104:107], v[56:59]
v_mfma_f32_16x16x32_bf16 v[56:59], a[224:227], v[136:139], v[56:59]
v_mfma_f32_16x16x32_bf16 v[56:59], a[228:231], v[168:171], v[56:59]
v_mfma_f32_16x16x32_bf16 v[56:59], a[232:235], v[200:203], v[56:59]
v_mfma_f32_16x16x32_bf16 v[56:59], a[236:239], v[232:235], v[56:59]
v_mfma_f32_16x16x32_bf16 v[60:63], a[216:219], v[76:79], v[44:47]
v_mfma_f32_16x16x32_bf16 v[60:63], a[220:223], v[108:111], v[60:63]
v_mfma_f32_16x16x32_bf16 v[60:63], a[224:227], v[140:143], v[60:63]
v_mfma_f32_16x16x32_bf16 v[60:63], a[228:231], v[172:175], v[60:63]
v_mfma_f32_16x16x32_bf16 v[60:63], a[232:235], v[204:207], v[60:63]
v_mfma_f32_16x16x32_bf16 v[60:63], a[236:239], v[236:239], v[60:63]
s_nop 7
v_exp_f32 v48, v48
v_exp_f32 v49, v49
v_add_f32 v16, v16, v48
v_exp_f32 v50, v50
v_add_f32 v16, v16, v49
v_cvt_pk_bf16_f32 v146, v48, v49
v_exp_f32 v51, v51
v_add_f32 v16, v16, v50
v_add_f32 v16, v16, v51
v_cvt_pk_bf16_f32 v147, v50, v51
v_exp_f32 v52, v52
v_exp_f32 v53, v53
v_add_f32 v17, v17, v52
v_exp_f32 v54, v54
v_add_f32 v17, v17, v53
v_cvt_pk_bf16_f32 v154, v52, v53
v_exp_f32 v55, v55
v_add_f32 v17, v17, v54
v_add_f32 v17, v17, v55
v_cvt_pk_bf16_f32 v155, v54, v55
v_exp_f32 v56, v56
v_exp_f32 v57, v57
v_add_f32 v18, v18, v56
v_exp_f32 v58, v58
v_add_f32 v18, v18, v57
v_cvt_pk_bf16_f32 v178, v56, v57
v_exp_f32 v59, v59
v_add_f32 v18, v18, v58
v_add_f32 v18, v18, v59
v_cvt_pk_bf16_f32 v179, v58, v59
v_exp_f32 v60, v60
v_exp_f32 v61, v61
v_add_f32 v19, v19, v60
v_exp_f32 v62, v62
v_add_f32 v19, v19, v61
v_cvt_pk_bf16_f32 v186, v60, v61
v_exp_f32 v63, v63
v_add_f32 v19, v19, v62
v_add_f32 v19, v19, v63
v_cvt_pk_bf16_f32 v187, v62, v63
s_add_u32 s7, s32, 12288
s_sub_u32 s7, s7, 73728
buffer_load_dwordx4 a[216:219], v249, s[16:19], s7 offen offset:0
buffer_load_dwordx4 a[220:223], v249, s[16:19], s7 offen offset:64
buffer_load_dwordx4 a[224:227], v249, s[16:19], s7 offen offset:128
buffer_load_dwordx4 a[228:231], v249, s[16:19], s7 offen offset:192
buffer_load_dwordx4 a[232:235], v249, s[16:19], s7 offen offset:256
buffer_load_dwordx4 a[236:239], v249, s[16:19], s7 offen offset:320
s_waitcnt vmcnt(0)
v_mfma_f32_16x16x32_bf16 v[48:51], a[216:219], v[64:67], v[32:35]
v_mfma_f32_16x16x32_bf16 v[48:51], a[220:223], v[96:99], v[48:51]
v_mfma_f32_16x16x32_bf16 v[48:51], a[224:227], v[128:131], v[48:51]
v_mfma_f32_16x16x32_bf16 v[48:51], a[228:231], v[160:163], v[48:51]
v_mfma_f32_16x16x32_bf16 v[48:51], a[232:235], v[192:195], v[48:51]
v_mfma_f32_16x16x32_bf16 v[48:51], a[236:239], v[224:227], v[48:51]
v_mfma_f32_16x16x32_bf16 v[52:55], a[216:219], v[68:71], v[36:39]
v_mfma_f32_16x16x32_bf16 v[52:55], a[220:223], v[100:103], v[52:55]
v_mfma_f32_16x16x32_bf16 v[52:55], a[224:227], v[132:135], v[52:55]
v_mfma_f32_16x16x32_bf16 v[52:55], a[228:231], v[164:167], v[52:55]
v_mfma_f32_16x16x32_bf16 v[52:55], a[232:235], v[196:199], v[52:55]
v_mfma_f32_16x16x32_bf16 v[52:55], a[236:239], v[228:231], v[52:55]
v_mfma_f32_16x16x32_bf16 v[56:59], a[216:219], v[72:75], v[40:43]
v_mfma_f32_16x16x32_bf16 v[56:59], a[220:223], v[104:107], v[56:59]
v_mfma_f32_16x16x32_bf16 v[56:59], a[224:227], v[136:139], v[56:59]
v_mfma_f32_16x16x32_bf16 v[56:59], a[228:231], v[168:171], v[56:59]
v_mfma_f32_16x16x32_bf16 v[56:59], a[232:235], v[200:203], v[56:59]
v_mfma_f32_16x16x32_bf16 v[56:59], a[236:239], v[232:235], v[56:59]
v_mfma_f32_16x16x32_bf16 v[60:63], a[216:219], v[76:79], v[44:47]
v_mfma_f32_16x16x32_bf16 v[60:63], a[220:223], v[108:111], v[60:63]
v_mfma_f32_16x16x32_bf16 v[60:63], a[224:227], v[140:143], v[60:63]
v_mfma_f32_16x16x32_bf16 v[60:63], a[228:231], v[172:175], v[60:63]
v_mfma_f32_16x16x32_bf16 v[60:63], a[232:235], v[204:207], v[60:63]
v_mfma_f32_16x16x32_bf16 v[60:63], a[236:239], v[236:239], v[60:63]
s_nop 7
v_exp_f32 v48, v48
v_exp_f32 v49, v49
v_add_f32 v16, v16, v48
v_exp_f32 v50, v50
v_add_f32 v16, v16, v49
v_cvt_pk_bf16_f32 v148, v48, v49
v_exp_f32 v51, v51
v_add_f32 v16, v16, v50
v_add_f32 v16, v16, v51
v_cvt_pk_bf16_f32 v149, v50, v51
v_exp_f32 v52, v52
v_exp_f32 v53, v53
v_add_f32 v17, v17, v52
v_exp_f32 v54, v54
v_add_f32 v17, v17, v53
v_cvt_pk_bf16_f32 v156, v52, v53
v_exp_f32 v55, v55
v_add_f32 v17, v17, v54
v_add_f32 v17, v17, v55
v_cvt_pk_bf16_f32 v157, v54, v55
v_exp_f32 v56, v56
v_exp_f32 v57, v57
v_add_f32 v18, v18, v56
v_exp_f32 v58, v58
v_add_f32 v18, v18, v57
v_cvt_pk_bf16_f32 v180, v56, v57
v_exp_f32 v59, v59
v_add_f32 v18, v18, v58
v_add_f32 v18, v18, v59
v_cvt_pk_bf16_f32 v181, v58, v59
v_exp_f32 v60, v60
v_exp_f32 v61, v61
v_add_f32 v19, v19, v60
v_exp_f32 v62, v62
v_add_f32 v19, v19, v61
v_cvt_pk_bf16_f32 v188, v60, v61
v_exp_f32 v63, v63
v_add_f32 v19, v19, v62
v_add_f32 v19, v19, v63
v_cvt_pk_bf16_f32 v189, v62, v63
s_add_u32 s7, s32, 18432
s_sub_u32 s7, s7, 73728
buffer_load_dwordx4 a[216:219], v249, s[16:19], s7 offen offset:0
buffer_load_dwordx4 a[220:223], v249, s[16:19], s7 offen offset:64
buffer_load_dwordx4 a[224:227], v249, s[16:19], s7 offen offset:128
buffer_load_dwordx4 a[228:231], v249, s[16:19], s7 offen offset:192
buffer_load_dwordx4 a[232:235], v249, s[16:19], s7 offen offset:256
buffer_load_dwordx4 a[236:239], v249, s[16:19], s7 offen offset:320
s_waitcnt vmcnt(0)
v_mfma_f32_16x16x32_bf16 v[48:51], a[216:219], v[64:67], v[32:35]
v_mfma_f32_16x16x32_bf16 v[48:51], a[220:223], v[96:99], v[48:51]
v_mfma_f32_16x16x32_bf16 v[48:51], a[224:227], v[128:131], v[48:51]
v_mfma_f32_16x16x32_bf16 v[48:51], a[228:231], v[160:163], v[48:51]
v_mfma_f32_16x16x32_bf16 v[48:51], a[232:235], v[192:195], v[48:51]
v_mfma_f32_16x16x32_bf16 v[48:51], a[236:239], v[224:227], v[48:51]
v_mfma_f32_16x16x32_bf16 v[52:55], a[216:219], v[68:71], v[36:39]
v_mfma_f32_16x16x32_bf16 v[52:55], a[220:223], v[100:103], v[52:55]
v_mfma_f32_16x16x32_bf16 v[52:55], a[224:227], v[132:135], v[52:55]
v_mfma_f32_16x16x32_bf16 v[52:55], a[228:231], v[164:167], v[52:55]
v_mfma_f32_16x16x32_bf16 v[52:55], a[232:235], v[196:199], v[52:55]
v_mfma_f32_16x16x32_bf16 v[52:55], a[236:239], v[228:231], v[52:55]
v_mfma_f32_16x16x32_bf16 v[56:59], a[216:219], v[72:75], v[40:43]
v_mfma_f32_16x16x32_bf16 v[56:59], a[220:223], v[104:107], v[56:59]
v_mfma_f32_16x16x32_bf16 v[56:59], a[224:227], v[136:139], v[56:59]
v_mfma_f32_16x16x32_bf16 v[56:59], a[228:231], v[168:171], v[56:59]
v_mfma_f32_16x16x32_bf16 v[56:59], a[232:235], v[200:203], v[56:59]
v_mfma_f32_16x16x32_bf16 v[56:59], a[236:239], v[232:235], v[56:59]
v_mfma_f32_16x16x32_bf16 v[60:63], a[216:219], v[76:79], v[44:47]
v_mfma_f32_16x16x32_bf16 v[60:63], a[220:223], v[108:111], v[60:63]
v_mfma_f32_16x16x32_bf16 v[60:63], a[224:227], v[140:143], v[60:63]
v_mfma_f32_16x16x32_bf16 v[60:63], a[228:231], v[172:175], v[60:63]
v_mfma_f32_16x16x32_bf16 v[60:63], a[232:235], v[204:207], v[60:63]
v_mfma_f32_16x16x32_bf16 v[60:63], a[236:239], v[236:239], v[60:63]
s_nop 7
v_exp_f32 v48, v48
v_exp_f32 v49, v49
v_add_f32 v16, v16, v48
v_exp_f32 v50, v50
v_add_f32 v16, v16, v49
v_cvt_pk_bf16_f32 v150, v48, v49
v_exp_f32 v51, v51
v_add_f32 v16, v16, v50
v_add_f32 v16, v16, v51
v_cvt_pk_bf16_f32 v151, v50, v51
v_exp_f32 v52, v52
v_exp_f32 v53, v53
v_add_f32 v17, v17, v52
v_exp_f32 v54, v54
v_add_f32 v17, v17, v53
v_cvt_pk_bf16_f32 v158, v52, v53
v_exp_f32 v55, v55
v_add_f32 v17, v17, v54
v_add_f32 v17, v17, v55
v_cvt_pk_bf16_f32 v159, v54, v55
v_exp_f32 v56, v56
v_exp_f32 v57, v57
v_add_f32 v18, v18, v56
v_exp_f32 v58, v58
v_add_f32 v18, v18, v57
v_cvt_pk_bf16_f32 v182, v56, v57
v_exp_f32 v59, v59
v_add_f32 v18, v18, v58
v_add_f32 v18, v18, v59
v_cvt_pk_bf16_f32 v183, v58, v59
v_exp_f32 v60, v60
v_exp_f32 v61, v61
v_add_f32 v19, v19, v60
v_exp_f32 v62, v62
v_add_f32 v19, v19, v61
v_cvt_pk_bf16_f32 v190, v60, v61
v_exp_f32 v63, v63
v_add_f32 v19, v19, v62
v_add_f32 v19, v19, v63
v_cvt_pk_bf16_f32 v191, v62, v63
s_nop 4
s_setpc_b64 s[30:31]
.section .rodata,"a"
.p2align 6
.amdhsa_kernel adaLN_cond__mha_block_cached__mixer_s_mlp__prompt_kernel
  .amdhsa_next_free_vgpr 512
  .amdhsa_next_free_sgpr 102
  .amdhsa_accum_offset 256
  .amdhsa_group_segment_fixed_size 0
  .amdhsa_kernarg_size 120
  .amdhsa_user_sgpr_count 2
  .amdhsa_user_sgpr_kernarg_segment_ptr 1
  .amdhsa_system_sgpr_workgroup_id_x 1
  .amdhsa_float_denorm_mode_32 3
.end_amdhsa_kernel
```
